```python
import torch

def _softmax(x, axis=-1):
    return torch.softmax(x, dim=axis)

def _gelu(x):
    return torch.nn.functional.gelu(x, approximate='tanh')

def _silu(x):
    return torch.nn.functional.silu(x)

def _sigmoid(x):
    return torch.sigmoid(x)

def _layernorm(x, axis=-1, eps=1e-05):
    m = x.mean(dim=axis, keepdim=True)
    v = x.var(dim=axis, keepdim=True, unbiased=False)
    return (x - m) / torch.sqrt(v + eps)

def _scatter_add(tgt, idx, src, axis=0):
    return tgt.clone().index_add_(axis, idx, src)

def _segment_sum(src, seg, n):
    out = torch.zeros((n,) + src.shape[1:], dtype=src.dtype)
    return out.index_add_(0, seg, src)

def _pad(x, pw):
    flat = tuple((v for pair in reversed(pw) for v in pair))
    return torch.nn.functional.pad(x, flat)
kernel_name = 'interleave_layers__memory_aug_recurrent_mem_tr__mixer_token_mlp__prompt'

def setup_inputs():

    _w = lambda a: (lambda t: t.to(torch.bfloat16) if t.is_floating_point() else t)(torch.as_tensor(a))

    def _A_setup():
        B, S, Dm = (1, 2048, 640)
        H, Dh = (32, 192)
        M, seg = (8, 32)
        seg = min(seg, S)
        S = S // seg * seg
        return {'x': _w((lambda *s: torch.randn(*s, dtype=torch.bfloat16) * 0.05)(B, S, Dm)), 'mem0': _w((lambda *s: torch.randn(*s, dtype=torch.bfloat16) * 0.2)(B, M, Dm)), 'Wq': _w((lambda *s: torch.randn(*s, dtype=torch.bfloat16) * 0.8)(Dm, H, Dh) * Dm ** (-0.5)), 'Wk': _w((lambda *s: torch.randn(*s, dtype=torch.bfloat16) * 0.8)(Dm, H, Dh) * Dm ** (-0.5)), 'Wv': _w((lambda *s: torch.randn(*s, dtype=torch.bfloat16) * 0.2)(Dm, H, Dh) * Dm ** (-0.5)), 'Wo': _w((lambda *s: torch.randn(*s, dtype=torch.bfloat16) * 0.2)(H, Dh, Dm) * (H * Dh) ** (-0.5)), 'seg_len': seg}
    _A_in = _A_setup()

    def _B_setup():
        B, S, D, F = (1, 2048, 640, 1536)
        return {'x': _w((lambda *s: torch.randn(*s, dtype=torch.bfloat16) * 0.05)(B, S, D)), 'w1': _w((lambda *s: torch.randn(*s, dtype=torch.bfloat16) * 0.2)(S, F) * S ** (-0.5)), 'b1': _w((lambda *s: torch.randn(*s, dtype=torch.bfloat16) * 3.2)(F) * 0.02), 'w2': _w((lambda *s: torch.randn(*s, dtype=torch.bfloat16) * 0.1)(F, S) * F ** (-0.5)), 'b2': _w((lambda *s: torch.randn(*s, dtype=torch.bfloat16) * 0.2)(S) * 0.02)}
    _B_in = _B_setup()
    return {'A_x': _A_in['x'], 'A_mem0': _A_in['mem0'], 'A_Wq': _A_in['Wq'], 'A_Wk': _A_in['Wk'], 'A_Wv': _A_in['Wv'], 'A_Wo': _A_in['Wo'], 'A_seg_len': _A_in['seg_len'], 'B_x': _B_in['x'], 'B_w1': _B_in['w1'], 'B_b1': _B_in['b1'], 'B_w2': _B_in['w2'], 'B_b2': _B_in['b2']}

def reference(A_x, A_mem0, A_Wq, A_Wk, A_Wv, A_Wo, A_seg_len, B_x, B_w1, B_b1, B_w2, B_b2):

    def _A_ref(x, mem0, Wq, Wk, Wv, Wo, seg_len):
        B, S, Dm = x.shape
        H, Dh = (Wq.shape[1], Wq.shape[2])
        M = mem0.shape[1]
        scale = Dh ** (-0.5)
        n_seg = S // seg_len
        L = M + seg_len
        idx = torch.arange(L)
        mask = (idx[:, None] < M) | (idx[:, None] >= idx[None, :])
        mem = mem0
        outs = []
        for s in range(n_seg):
            xs = x[:, s * seg_len:(s + 1) * seg_len, :].clone()
            h = torch.concatenate([mem, xs], axis=1)
            q = torch.einsum('btd,dhe->bhte', h, Wq)
            k = torch.einsum('btd,dhe->bhte', h, Wk)
            v = torch.einsum('btd,dhe->bhte', h, Wv)
            scores = torch.einsum('bhqe,bhke->bhqk', q, k) * scale
            scores = torch.where(mask[None, None], scores, -1000000000.0)
            p = _softmax(scores, axis=-1)
            o = torch.einsum('bhqk,bhke->bhqe', p, v)
            o = torch.einsum('bhte,hed->btd', o, Wo)
            mem = o[:, :M, :].clone()
            outs.append(o[:, M:, :])
        return torch.concatenate(outs, axis=1)

    def _B_ref(x, w1, b1, w2, b2):
        B, S, D = x.shape
        h = _layernorm(x, axis=-1)
        u = torch.einsum('bsd,sf->bdf', h, w1) + b1
        u = _gelu(u)
        y = torch.einsum('bdf,fs->bds', u, w2) + b2
        return (lambda x, *d: x.permute(*d))(y, 0, 2, 1)
    x = A_x
    x = x + _A_ref(_layernorm(x, axis=-1), A_mem0, A_Wq, A_Wk, A_Wv, A_Wo, A_seg_len)
    x = x + _B_ref(_layernorm(x, axis=-1), B_w1, B_b1, B_w2, B_b2)
    x = x + _A_ref(_layernorm(x, axis=-1), A_mem0, A_Wq, A_Wk, A_Wv, A_Wo, A_seg_len)
    x = x + _B_ref(_layernorm(x, axis=-1), B_w1, B_b1, B_w2, B_b2)
    return x
```

```asm
; @launch grid=(256,1,1) block=(256,1,1) lds=163840
.amdgcn_target "amdgcn-amd-amdhsa--gfx950"
.text
.globl interleave_layers__memory_aug_recurrent_mem_tr__mixer_token_mlp__prompt_kernel
.p2align 8
.type interleave_layers__memory_aug_recurrent_mem_tr__mixer_token_mlp__prompt_kernel,@function
interleave_layers__memory_aug_recurrent_mem_tr__mixer_token_mlp__prompt_kernel:
  s_cmp_ge_u32 s2, 256
  s_cbranch_scc1 la_exit
  s_mov_b32 s65, 0
  s_load_dwordx4 s[4:7], s[0:1], 104
  s_load_dwordx4 s[44:47], s[0:1], 0
  s_load_dwordx8 s[36:43], s[0:1], 16
  s_load_dwordx2 s[48:49], s[0:1], 64
  s_load_dwordx2 s[50:51], s[0:1], 80
  v_and_b32 v2, 63, v0
  v_lshrrev_b32 v1, 6, v0
  s_getreg_b32 s34, hwreg(HW_REG_XCC_ID)
  s_and_b32 s34, s34, 7
  v_readfirstlane_b32 s32, v1
  s_waitcnt lgkmcnt(0)
la_body:
  s_mov_b32 s84, s4
  s_and_b32 s85, s5, 0xffff
  s_mov_b32 s86, 256
  s_mov_b32 s87, 0x00020000
  s_mov_b64 s[4:5], s[6:7]
  s_mov_b32 s8, s4
  s_and_b32 s9, s5, 0xffff
  s_mov_b32 s10, 268435456
  s_mov_b32 s11, 0x00020000
  s_mov_b32 s72, s44
  s_and_b32 s73, s45, 0xffff
  s_mov_b32 s74, 2621440
  s_mov_b32 s75, 0x00020000
  s_mov_b32 s28, s46
  s_and_b32 s29, s47, 0xffff
  s_mov_b32 s30, 10240
  s_mov_b32 s31, 0x00020000
  s_mov_b32 s12, s36
  s_and_b32 s13, s37, 0xffff
  s_mov_b32 s14, 7864320
  s_mov_b32 s15, 0x00020000
  s_mov_b32 s16, s38
  s_and_b32 s17, s39, 0xffff
  s_mov_b32 s18, 7864320
  s_mov_b32 s19, 0x00020000
  s_mov_b32 s20, s40
  s_and_b32 s21, s41, 0xffff
  s_mov_b32 s22, 7864320
  s_mov_b32 s23, 0x00020000
  s_mov_b32 s24, s42
  s_and_b32 s25, s43, 0xffff
  s_mov_b32 s26, 7864320
  s_mov_b32 s27, 0x00020000
  s_mov_b32 s76, s48
  s_and_b32 s77, s49, 0xffff
  s_mov_b32 s78, 6291456
  s_mov_b32 s79, 0x00020000
  s_mov_b32 s80, s50
  s_and_b32 s81, s51, 0xffff
  s_mov_b32 s82, 6291456
  s_mov_b32 s83, 0x00020000
  s_mov_b32 s3, 0
  s_mov_b32 s6, 0
  s_cmp_ge_u32 s32, 2
  s_cbranch_scc1 la_ln
  s_cmp_eq_u32 s32, 1
  s_cbranch_scc1 la_probe
  s_lshl_b32 s35, s34, 5
  v_mov_b32 v20, 1
  s_mov_b64 exec, 1
  buffer_atomic_add v20, off, s[84:87], s35 sc0
  v_mov_b32 v21, 0
  s_lshl_b32 s35, s2, 7
  s_add_u32 s35, s35, 294912
  buffer_store_dword v21, off, s[8:11], s35 sc1
  s_mov_b64 exec, -1
  s_branch la_clr
la_probe:
  s_lshr_b32 s35, s2, 6
  s_lshl_b32 s35, s35, 17
  s_and_b32 s36, s2, 63
  s_lshl_b32 s36, s36, 7
  s_add_u32 s35, s35, s36
  s_add_u32 s35, s35, 218726400
  s_add_u32 s36, s4, s35
  s_addc_u32 s37, s5, 0
  v_lshlrev_b32 v3, 13, v2
  s_mov_b64 exec, 3
  buffer_store_dword v2, v3, s[8:11], s35 offen sc1
  s_mov_b64 exec, -1
  s_mov_b32 s40, 0
  s_waitcnt vmcnt(0)
  s_mov_b32 s38, -1
  s_mov_b32 s39, -1
  s_memtime s[42:43]
  s_waitcnt lgkmcnt(0)
  s_load_dword s41, s[36:37], 0 glc
  s_mov_b32 s40, s42
  s_waitcnt lgkmcnt(0)
  s_memtime s[42:43]
  s_waitcnt lgkmcnt(0)
  s_sub_u32 s40, s42, s40
  s_min_u32 s38, s38, s40
  s_load_dword s41, s[36:37], 8192 glc
  s_mov_b32 s40, s42
  s_waitcnt lgkmcnt(0)
  s_memtime s[42:43]
  s_waitcnt lgkmcnt(0)
  s_sub_u32 s40, s42, s40
  s_min_u32 s39, s39, s40
  s_load_dword s41, s[36:37], 0 glc
  s_mov_b32 s40, s42
  s_waitcnt lgkmcnt(0)
  s_memtime s[42:43]
  s_waitcnt lgkmcnt(0)
  s_sub_u32 s40, s42, s40
  s_min_u32 s38, s38, s40
  s_load_dword s41, s[36:37], 8192 glc
  s_mov_b32 s40, s42
  s_waitcnt lgkmcnt(0)
  s_memtime s[42:43]
  s_waitcnt lgkmcnt(0)
  s_sub_u32 s40, s42, s40
  s_min_u32 s39, s39, s40
  s_cmp_gt_u32 s38, s39
  s_cselect_b32 s40, 1, 0
  s_lshr_b32 s41, s34, 2
  s_xor_b32 s40, s40, s41
  v_mov_b32 v20, s40
la_clr:
  s_lshl_b32 s60, s2, 7
  v_add_u32 v4, s60, v0
  v_lshlrev_b32 v4, 4, v4
  v_mov_b32 v8, -1
  v_mov_b32 v9, -1
  v_mov_b32 v10, -1
  v_mov_b32 v11, -1
  v_and_b32 v5, 0x1ffff, v4
  v_cmp_gt_u32 vcc, 0x18000, v5
  s_nop 1
  v_cndmask_b32 v12, 0, -1, vcc
  s_mov_b32 s60, 4194304
  buffer_store_dwordx4 v[8:11], v4, s[8:11], s60 offen sc1
  s_mov_b32 s60, 4718592
  buffer_store_dwordx4 v[8:11], v4, s[8:11], s60 offen sc1
  s_mov_b32 s60, 5242880
  buffer_store_dwordx4 v[8:11], v4, s[8:11], s60 offen sc1
  s_mov_b32 s60, 5767168
  buffer_store_dwordx4 v[8:11], v4, s[8:11], s60 offen sc1
  v_mov_b32 v13, v12
  v_mov_b32 v14, v12
  v_mov_b32 v15, v12
  v_cmp_gt_u32 vcc, 0x40000, v4
  v_mov_b32 v6, 2147483632
  s_mov_b32 s60, 218103808
  v_cndmask_b32 v6, v6, v4, vcc
  v_mov_b32 v16, 0
  v_mov_b32 v17, 0
  v_mov_b32 v18, 0
  v_mov_b32 v19, 0
  buffer_store_dwordx4 v[12:15], v4, s[8:11], s60 offen sc1
  buffer_store_dwordx4 v[16:19], v6, s[8:11], 0 offen sc1
  s_lshl_b32 s60, s32, 2
  s_waitcnt vmcnt(7)
  v_mov_b32 v3, s60
  s_mov_b64 exec, 1
  ds_write_b32 v3, v20
  s_mov_b64 exec, -1
  s_waitcnt lgkmcnt(0)
  s_branch la_tk
la_ln:
  s_sub_u32 s32, s32, 2
  s_lshl_b32 s34, s2, 3
  s_lshl_b32 s60, s32, 2
  s_add_u32 s34, s34, s60
  v_bfe_u32 v3, v2, 4, 2
  v_mul_u32_u24 v3, 1280, v3
  v_bfe_u32 v1, v2, 0, 4
  v_mul_u32_u24 v1, 16, v1
  v_add_u32 v3, v3, v1
  s_mov_b32 s60, 0
  s_mul_i32 s63, s34, 1280
  s_add_u32 s60, s60, s63
  v_add_u32 v3, s60, v3
  buffer_load_dwordx4 v[8:11], v3, s[72:75], 0 offen offset:0
  buffer_load_dwordx4 v[12:15], v3, s[72:75], 0 offen offset:256
  buffer_load_dwordx4 v[16:19], v3, s[72:75], 0 offen offset:512
  buffer_load_dwordx4 v[20:23], v3, s[72:75], 0 offen offset:768
  buffer_load_dwordx4 v[24:27], v3, s[72:75], 0 offen offset:1024
  s_mov_b32 s35, 0xffff0000
  s_waitcnt vmcnt(0)
  v_lshlrev_b32 v128, 16, v8
  v_and_b32 v129, s35, v8
  v_lshlrev_b32 v130, 16, v9
  v_and_b32 v131, s35, v9
  v_lshlrev_b32 v132, 16, v10
  v_and_b32 v133, s35, v10
  v_lshlrev_b32 v134, 16, v11
  v_and_b32 v135, s35, v11
  v_lshlrev_b32 v136, 16, v12
  v_and_b32 v137, s35, v12
  v_lshlrev_b32 v138, 16, v13
  v_and_b32 v139, s35, v13
  v_lshlrev_b32 v140, 16, v14
  v_and_b32 v141, s35, v14
  v_lshlrev_b32 v142, 16, v15
  v_and_b32 v143, s35, v15
  v_lshlrev_b32 v144, 16, v16
  v_and_b32 v145, s35, v16
  v_lshlrev_b32 v146, 16, v17
  v_and_b32 v147, s35, v17
  v_lshlrev_b32 v148, 16, v18
  v_and_b32 v149, s35, v18
  v_lshlrev_b32 v150, 16, v19
  v_and_b32 v151, s35, v19
  v_lshlrev_b32 v152, 16, v20
  v_and_b32 v153, s35, v20
  v_lshlrev_b32 v154, 16, v21
  v_and_b32 v155, s35, v21
  v_lshlrev_b32 v156, 16, v22
  v_and_b32 v157, s35, v22
  v_lshlrev_b32 v158, 16, v23
  v_and_b32 v159, s35, v23
  v_lshlrev_b32 v160, 16, v24
  v_and_b32 v161, s35, v24
  v_lshlrev_b32 v162, 16, v25
  v_and_b32 v163, s35, v25
  v_lshlrev_b32 v164, 16, v26
  v_and_b32 v165, s35, v26
  v_lshlrev_b32 v166, 16, v27
  v_and_b32 v167, s35, v27
  v_pk_add_f32 v[4:5], v[128:129], v[130:131]
  v_pk_add_f32 v[4:5], v[4:5], v[132:133]
  v_pk_add_f32 v[4:5], v[4:5], v[134:135]
  v_pk_add_f32 v[4:5], v[4:5], v[136:137]
  v_pk_add_f32 v[4:5], v[4:5], v[138:139]
  v_pk_add_f32 v[4:5], v[4:5], v[140:141]
  v_pk_add_f32 v[4:5], v[4:5], v[142:143]
  v_pk_add_f32 v[4:5], v[4:5], v[144:145]
  v_pk_add_f32 v[4:5], v[4:5], v[146:147]
  v_pk_add_f32 v[4:5], v[4:5], v[148:149]
  v_pk_add_f32 v[4:5], v[4:5], v[150:151]
  v_pk_add_f32 v[4:5], v[4:5], v[152:153]
  v_pk_add_f32 v[4:5], v[4:5], v[154:155]
  v_pk_add_f32 v[4:5], v[4:5], v[156:157]
  v_pk_add_f32 v[4:5], v[4:5], v[158:159]
  v_pk_add_f32 v[4:5], v[4:5], v[160:161]
  v_pk_add_f32 v[4:5], v[4:5], v[162:163]
  v_pk_add_f32 v[4:5], v[4:5], v[164:165]
  v_pk_add_f32 v[4:5], v[4:5], v[166:167]
  v_add_f32 v4, v4, v5
  s_nop 1
  v_add_f32_dpp v4, v4, v4 row_ror:1 row_mask:0xf bank_mask:0xf
  s_nop 1
  v_add_f32_dpp v4, v4, v4 row_ror:2 row_mask:0xf bank_mask:0xf
  s_nop 1
  v_add_f32_dpp v4, v4, v4 row_ror:4 row_mask:0xf bank_mask:0xf
  s_nop 1
  v_add_f32_dpp v4, v4, v4 row_ror:8 row_mask:0xf bank_mask:0xf
  v_mul_f32 v4, 0x3acccccd, v4
  v_sub_f32 v128, v128, v4
  v_sub_f32 v129, v129, v4
  v_sub_f32 v130, v130, v4
  v_sub_f32 v131, v131, v4
  v_sub_f32 v132, v132, v4
  v_sub_f32 v133, v133, v4
  v_sub_f32 v134, v134, v4
  v_sub_f32 v135, v135, v4
  v_sub_f32 v136, v136, v4
  v_sub_f32 v137, v137, v4
  v_sub_f32 v138, v138, v4
  v_sub_f32 v139, v139, v4
  v_sub_f32 v140, v140, v4
  v_sub_f32 v141, v141, v4
  v_sub_f32 v142, v142, v4
  v_sub_f32 v143, v143, v4
  v_sub_f32 v144, v144, v4
  v_sub_f32 v145, v145, v4
  v_sub_f32 v146, v146, v4
  v_sub_f32 v147, v147, v4
  v_sub_f32 v148, v148, v4
  v_sub_f32 v149, v149, v4
  v_sub_f32 v150, v150, v4
  v_sub_f32 v151, v151, v4
  v_sub_f32 v152, v152, v4
  v_sub_f32 v153, v153, v4
  v_sub_f32 v154, v154, v4
  v_sub_f32 v155, v155, v4
  v_sub_f32 v156, v156, v4
  v_sub_f32 v157, v157, v4
  v_sub_f32 v158, v158, v4
  v_sub_f32 v159, v159, v4
  v_sub_f32 v160, v160, v4
  v_sub_f32 v161, v161, v4
  v_sub_f32 v162, v162, v4
  v_sub_f32 v163, v163, v4
  v_sub_f32 v164, v164, v4
  v_sub_f32 v165, v165, v4
  v_sub_f32 v166, v166, v4
  v_sub_f32 v167, v167, v4
  v_pk_mul_f32 v[4:5], v[128:129], v[128:129]
  v_pk_fma_f32 v[4:5], v[130:131], v[130:131], v[4:5]
  v_pk_fma_f32 v[4:5], v[132:133], v[132:133], v[4:5]
  v_pk_fma_f32 v[4:5], v[134:135], v[134:135], v[4:5]
  v_pk_fma_f32 v[4:5], v[136:137], v[136:137], v[4:5]
  v_pk_fma_f32 v[4:5], v[138:139], v[138:139], v[4:5]
  v_pk_fma_f32 v[4:5], v[140:141], v[140:141], v[4:5]
  v_pk_fma_f32 v[4:5], v[142:143], v[142:143], v[4:5]
  v_pk_fma_f32 v[4:5], v[144:145], v[144:145], v[4:5]
  v_pk_fma_f32 v[4:5], v[146:147], v[146:147], v[4:5]
  v_pk_fma_f32 v[4:5], v[148:149], v[148:149], v[4:5]
  v_pk_fma_f32 v[4:5], v[150:151], v[150:151], v[4:5]
  v_pk_fma_f32 v[4:5], v[152:153], v[152:153], v[4:5]
  v_pk_fma_f32 v[4:5], v[154:155], v[154:155], v[4:5]
  v_pk_fma_f32 v[4:5], v[156:157], v[156:157], v[4:5]
  v_pk_fma_f32 v[4:5], v[158:159], v[158:159], v[4:5]
  v_pk_fma_f32 v[4:5], v[160:161], v[160:161], v[4:5]
  v_pk_fma_f32 v[4:5], v[162:163], v[162:163], v[4:5]
  v_pk_fma_f32 v[4:5], v[164:165], v[164:165], v[4:5]
  v_pk_fma_f32 v[4:5], v[166:167], v[166:167], v[4:5]
  v_add_f32 v4, v4, v5
  s_nop 1
  v_add_f32_dpp v4, v4, v4 row_ror:1 row_mask:0xf bank_mask:0xf
  s_nop 1
  v_add_f32_dpp v4, v4, v4 row_ror:2 row_mask:0xf bank_mask:0xf
  s_nop 1
  v_add_f32_dpp v4, v4, v4 row_ror:4 row_mask:0xf bank_mask:0xf
  s_nop 1
  v_add_f32_dpp v4, v4, v4 row_ror:8 row_mask:0xf bank_mask:0xf
  v_mul_f32 v4, 0x3acccccd, v4
  v_add_f32 v5, 0x3727c5ac, v4
  v_rsq_f32 v5, v5
  s_nop 0
  v_mul_f32 v128, v128, v5
  v_mul_f32 v129, v129, v5
  v_mul_f32 v130, v130, v5
  v_mul_f32 v131, v131, v5
  v_mul_f32 v132, v132, v5
  v_mul_f32 v133, v133, v5
  v_mul_f32 v134, v134, v5
  v_mul_f32 v135, v135, v5
  v_mul_f32 v136, v136, v5
  v_mul_f32 v137, v137, v5
  v_mul_f32 v138, v138, v5
  v_mul_f32 v139, v139, v5
  v_mul_f32 v140, v140, v5
  v_mul_f32 v141, v141, v5
  v_mul_f32 v142, v142, v5
  v_mul_f32 v143, v143, v5
  v_mul_f32 v144, v144, v5
  v_mul_f32 v145, v145, v5
  v_mul_f32 v146, v146, v5
  v_mul_f32 v147, v147, v5
  v_mul_f32 v148, v148, v5
  v_mul_f32 v149, v149, v5
  v_mul_f32 v150, v150, v5
  v_mul_f32 v151, v151, v5
  v_mul_f32 v152, v152, v5
  v_mul_f32 v153, v153, v5
  v_mul_f32 v154, v154, v5
  v_mul_f32 v155, v155, v5
  v_mul_f32 v156, v156, v5
  v_mul_f32 v157, v157, v5
  v_mul_f32 v158, v158, v5
  v_mul_f32 v159, v159, v5
  v_mul_f32 v160, v160, v5
  v_mul_f32 v161, v161, v5
  v_mul_f32 v162, v162, v5
  v_mul_f32 v163, v163, v5
  v_mul_f32 v164, v164, v5
  v_mul_f32 v165, v165, v5
  v_mul_f32 v166, v166, v5
  v_mul_f32 v167, v167, v5
  v_cvt_pk_bf16_f32 v28, v128, v129
  v_cvt_pk_bf16_f32 v29, v130, v131
  v_cvt_pk_bf16_f32 v30, v132, v133
  v_cvt_pk_bf16_f32 v31, v134, v135
  v_cvt_pk_bf16_f32 v32, v136, v137
  v_cvt_pk_bf16_f32 v33, v138, v139
  v_cvt_pk_bf16_f32 v34, v140, v141
  v_cvt_pk_bf16_f32 v35, v142, v143
  v_cvt_pk_bf16_f32 v36, v144, v145
  v_cvt_pk_bf16_f32 v37, v146, v147
  v_cvt_pk_bf16_f32 v38, v148, v149
  v_cvt_pk_bf16_f32 v39, v150, v151
  v_cvt_pk_bf16_f32 v40, v152, v153
  v_cvt_pk_bf16_f32 v41, v154, v155
  v_cvt_pk_bf16_f32 v42, v156, v157
  v_cvt_pk_bf16_f32 v43, v158, v159
  v_cvt_pk_bf16_f32 v44, v160, v161
  v_cvt_pk_bf16_f32 v45, v162, v163
  v_cvt_pk_bf16_f32 v46, v164, v165
  v_cvt_pk_bf16_f32 v47, v166, v167
  s_lshr_b32 s36, s2, 2
  s_and_b32 s37, s2, 3
  v_bfe_u32 v3, v2, 2, 2
  v_mul_u32_u24 v3, 1024, v3
  v_bfe_u32 v1, v2, 0, 2
  v_mul_u32_u24 v1, 256, v1
  v_add_u32 v3, v3, v1
  v_bfe_u32 v1, v2, 4, 2
  v_mul_u32_u24 v1, 16, v1
  v_add_u32 v3, v3, v1
  s_mov_b32 s60, 7340032
  s_mul_i32 s63, s36, 40960
  s_add_u32 s60, s60, s63
  s_mul_i32 s63, s32, 20480
  s_add_u32 s60, s60, s63
  s_mul_i32 s63, s37, 64
  s_add_u32 s60, s60, s63
  v_add_u32 v3, s60, v3
  s_mov_b32 s61, 0
  buffer_store_dwordx4 v[28:31], v3, s[8:11], s61 offen sc1
  s_mov_b32 s61, 4096
  buffer_store_dwordx4 v[32:35], v3, s[8:11], s61 offen sc1
  s_mov_b32 s61, 8192
  buffer_store_dwordx4 v[36:39], v3, s[8:11], s61 offen sc1
  s_mov_b32 s61, 12288
  buffer_store_dwordx4 v[40:43], v3, s[8:11], s61 offen sc1
  s_mov_b32 s61, 16384
  buffer_store_dwordx4 v[44:47], v3, s[8:11], s61 offen sc1
  s_add_u32 s32, s32, 2
la_tk:
  s_barrier
  v_mov_b32 v3, 0
  ds_read_b64 v[4:5], v3
  s_getreg_b32 s34, hwreg(HW_REG_XCC_ID)
  s_and_b32 s34, s34, 7
  s_waitcnt lgkmcnt(0)
  v_readfirstlane_b32 s7, v4
  v_readfirstlane_b32 s6, v5
  s_barrier
  s_lshl_b32 s6, s6, 16
  s_add_u32 s6, s6, 1
  s_lshl_b32 s33, s34, 5
  s_add_u32 s33, s33, s7
  s_cmp_lt_u32 s7, 32
  s_cbranch_scc1 la_role
  s_waitcnt vmcnt(0)
  s_barrier
  s_call_b64 s[60:61], la_arrive
  s_call_b64 s[60:61], la_census
la_exit:
  s_endpgm
la_arrive:
  s_or_b32 s62, s32, s3
  s_cmp_lg_u32 s62, 0
  s_cbranch_scc1 la_cret
  s_mov_b32 s62, s6
  s_atomic_add s62, s[84:85], 132 glc
  s_waitcnt lgkmcnt(0)
  s_add_u32 s6, s6, s62
  s_and_b32 s62, s6, 0xffff
  s_cmp_lg_u32 s62, 256
  s_cbranch_scc1 la_cret
  v_lshlrev_b32 v1, 2, v2
  buffer_load_dword v250, v1, s[84:87], 0 offen sc1
  s_cmp_gt_u32 s6, 8388864
  s_cselect_b32 s6, 3, 1
  v_and_b32 v1, 7, v2
  v_cmp_eq_u32 vcc, 0, v1
  s_waitcnt vmcnt(0)
  v_cmp_ne_u32 s[62:63], 32, v250
  s_and_b64 vcc, vcc, s[62:63]
  s_cselect_b32 s62, 4, 0
  s_or_b32 s6, s6, s62
  v_lshlrev_b32 v1, 7, v2
  v_mov_b32 v250, s6
  s_mov_b32 s62, 294912
  buffer_store_dword v250, v1, s[8:11], s62 offen sc1
  s_mov_b32 s62, 303104
  buffer_store_dword v250, v1, s[8:11], s62 offen sc1
  s_mov_b32 s62, 311296
  buffer_store_dword v250, v1, s[8:11], s62 offen sc1
  s_mov_b32 s62, 319488
  buffer_store_dword v250, v1, s[8:11], s62 offen sc1
  s_setpc_b64 s[60:61]
la_census:
  s_cmp_lg_u32 s3, 0
  s_cbranch_scc1 la_cret
  s_mov_b32 s64, 400000
  s_lshl_b32 s62, s2, 7
  s_add_u32 s62, s62, 294912
la_cpoll:
  buffer_load_dword v3, off, s[8:11], s62 sc1
  s_waitcnt vmcnt(0)
  v_readfirstlane_b32 s63, v3
  s_cmp_lg_u32 s63, 0
  s_cbranch_scc1 la_call
  s_sleep 2
  s_sub_u32 s64, s64, 1
  s_cmp_lg_u32 s64, 0
  s_cbranch_scc1 la_cpoll
  s_endpgm
la_call:
  s_bfe_u32 s6, s63, 0x10001
  s_and_b32 s63, s63, 4
  s_cbranch_scc1 la_redo
la_cret:
  s_setpc_b64 s[60:61]
la_redo:
  v_lshlrev_b32 v1, 2, v2
  buffer_load_dword v3, v1, s[84:87], 0 offen sc1
  s_getreg_b32 s34, hwreg(HW_REG_XCC_ID)
  s_and_b32 s34, s34, 7
  s_mov_b32 s33, s7
  s_mov_b32 s3, 1
  s_waitcnt vmcnt(0)
  v_readlane_b32 s36, v3, 0
  s_cmp_gt_u32 s34, 0
  s_cselect_b32 s36, s36, 0
  s_add_u32 s33, s33, s36
  v_readlane_b32 s36, v3, 8
  s_cmp_gt_u32 s34, 1
  s_cselect_b32 s36, s36, 0
  s_add_u32 s33, s33, s36
  v_readlane_b32 s36, v3, 16
  s_cmp_gt_u32 s34, 2
  s_cselect_b32 s36, s36, 0
  s_add_u32 s33, s33, s36
  v_readlane_b32 s36, v3, 24
  s_cmp_gt_u32 s34, 3
  s_cselect_b32 s36, s36, 0
  s_add_u32 s33, s33, s36
  v_readlane_b32 s36, v3, 32
  s_cmp_gt_u32 s34, 4
  s_cselect_b32 s36, s36, 0
  s_add_u32 s33, s33, s36
  v_readlane_b32 s36, v3, 40
  s_cmp_gt_u32 s34, 5
  s_cselect_b32 s36, s36, 0
  s_add_u32 s33, s33, s36
  v_readlane_b32 s36, v3, 48
  s_cmp_gt_u32 s34, 6
  s_cselect_b32 s36, s36, 0
  s_add_u32 s33, s33, s36
  s_waitcnt vmcnt(0) lgkmcnt(0)
  s_barrier
la_role:
  s_and_b32 s35, s33, 31
  s_cmp_ge_u32 s33, 128
  s_cbranch_scc1 la_wk
  s_cmp_ge_u32 s35, 24
  s_cbranch_scc1 la_att
  s_cmp_lg_u32 s3, 0
  s_cbranch_scc1 la_fb
  s_lshr_b32 s37, s33, 5
  s_and_b32 s34, s33, 31
  s_mul_i32 s60, s34, 86
  s_lshr_b32 s60, s60, 8
  s_mul_i32 s61, s60, 3
  s_sub_u32 s36, s34, s61
  s_lshl_b32 s35, s37, 3
  s_add_u32 s35, s35, s60
  s_mov_b32 s38, s34
  s_sub_u32 s63, s38, 20
  s_cmp_ge_u32 s38, 20
  s_cselect_b32 s38, s63, s38
  s_lshr_b32 s39, s38, 1
  s_add_u32 s39, s39, 1
  s_mov_b32 s54, 0xff00ff00
  s_mov_b32 s55, s54
  v_bfe_u32 v3, v2, 3, 3
  v_mul_u32_u24 v3, 12288, v3
  v_bfe_u32 v1, v2, 0, 3
  v_mul_u32_u24 v1, 16, v1
  v_add_u32 v3, v3, v1
  s_mov_b32 s60, 0
  s_mul_i32 s63, s35, 384
  s_add_u32 s60, s60, s63
  s_mul_i32 s63, s36, 128
  s_add_u32 s60, s60, s63
  s_mul_i32 s63, s32, 98304
  s_add_u32 s60, s60, s63
  v_add_u32 v3, s60, v3
  v_bfe_u32 v4, v2, 2, 4
  v_mul_u32_u24 v4, 1280, v4
  v_bfe_u32 v1, v2, 0, 2
  v_mul_u32_u24 v1, 16, v1
  v_add_u32 v4, v4, v1
  s_mov_b32 s60, 0
  s_mul_i32 s63, s37, 1966080
  s_add_u32 s60, s60, s63
  s_mul_i32 s63, s38, 64
  s_add_u32 s60, s60, s63
  s_mul_i32 s63, s32, 20480
  s_add_u32 s60, s60, s63
  v_add_u32 v4, s60, v4
  v_bfe_u32 v5, v2, 4, 1
  v_mul_u32_u24 v5, 2048, v5
  v_bfe_u32 v1, v2, 5, 1
  v_mul_u32_u24 v1, 512, v1
  v_add_u32 v5, v5, v1
  v_bfe_u32 v1, v2, 3, 1
  v_mul_u32_u24 v1, 4096, v1
  v_add_u32 v5, v5, v1
  v_bfe_u32 v1, v2, 2, 1
  v_mul_u32_u24 v1, 128, v1
  v_add_u32 v5, v5, v1
  v_bfe_u32 v1, v2, 0, 2
  v_mul_u32_u24 v1, 8, v1
  v_add_u32 v5, v5, v1
  s_mov_b32 s60, 0
  s_mul_i32 s63, s32, 32
  s_add_u32 s60, s60, s63
  v_add_u32 v5, s60, v5
  v_bfe_u32 v6, v2, 4, 1
  v_mul_u32_u24 v6, 1024, v6
  v_bfe_u32 v1, v2, 5, 1
  v_mul_u32_u24 v1, 256, v1
  v_add_u32 v6, v6, v1
  v_bfe_u32 v1, v2, 3, 1
  v_mul_u32_u24 v1, 2048, v1
  v_add_u32 v6, v6, v1
  v_bfe_u32 v1, v2, 2, 1
  v_mul_u32_u24 v1, 64, v1
  v_add_u32 v6, v6, v1
  v_bfe_u32 v1, v2, 0, 2
  v_mul_u32_u24 v1, 8, v1
  v_add_u32 v6, v6, v1
  s_lshl_b32 s61, s32, 10
  s_add_u32 m0, s61, 0
  s_mov_b32 s60, 0
  buffer_load_dwordx4 v3, s[12:15], s60 offen lds
  s_add_u32 m0, s61, 4096
  s_mov_b32 s60, 393216
  buffer_load_dwordx4 v3, s[12:15], s60 offen lds
  s_add_u32 m0, s61, 8192
  s_mov_b32 s60, 786432
  buffer_load_dwordx4 v3, s[12:15], s60 offen lds
  s_add_u32 m0, s61, 12288
  s_mov_b32 s60, 1179648
  buffer_load_dwordx4 v3, s[12:15], s60 offen lds
  s_add_u32 m0, s61, 16384
  s_mov_b32 s60, 1572864
  buffer_load_dwordx4 v3, s[12:15], s60 offen lds
  s_add_u32 m0, s61, 20480
  s_mov_b32 s60, 1966080
  buffer_load_dwordx4 v3, s[12:15], s60 offen lds
  s_add_u32 m0, s61, 24576
  s_mov_b32 s60, 2359296
  buffer_load_dwordx4 v3, s[12:15], s60 offen lds
  s_add_u32 m0, s61, 28672
  s_mov_b32 s60, 2752512
  buffer_load_dwordx4 v3, s[12:15], s60 offen lds
  s_add_u32 m0, s61, 32768
  s_mov_b32 s60, 3145728
  buffer_load_dwordx4 v3, s[12:15], s60 offen lds
  s_add_u32 m0, s61, 36864
  s_mov_b32 s60, 3538944
  buffer_load_dwordx4 v3, s[12:15], s60 offen lds
  s_add_u32 m0, s61, 40960
  s_mov_b32 s60, 3932160
  buffer_load_dwordx4 v3, s[12:15], s60 offen lds
  s_add_u32 m0, s61, 45056
  s_mov_b32 s60, 4325376
  buffer_load_dwordx4 v3, s[12:15], s60 offen lds
  s_add_u32 m0, s61, 49152
  s_mov_b32 s60, 4718592
  buffer_load_dwordx4 v3, s[12:15], s60 offen lds
  s_add_u32 m0, s61, 53248
  s_mov_b32 s60, 5111808
  buffer_load_dwordx4 v3, s[12:15], s60 offen lds
  s_add_u32 m0, s61, 57344
  s_mov_b32 s60, 5505024
  buffer_load_dwordx4 v3, s[12:15], s60 offen lds
  s_add_u32 m0, s61, 61440
  s_mov_b32 s60, 5898240
  buffer_load_dwordx4 v3, s[12:15], s60 offen lds
  s_add_u32 m0, s61, 65536
  s_mov_b32 s60, 6291456
  buffer_load_dwordx4 v3, s[12:15], s60 offen lds
  s_add_u32 m0, s61, 69632
  s_mov_b32 s60, 6684672
  buffer_load_dwordx4 v3, s[12:15], s60 offen lds
  s_add_u32 m0, s61, 73728
  s_mov_b32 s60, 7077888
  buffer_load_dwordx4 v3, s[12:15], s60 offen lds
  s_add_u32 m0, s61, 77824
  s_mov_b32 s60, 7471104
  buffer_load_dwordx4 v3, s[12:15], s60 offen lds
  s_lshl_b32 s61, s32, 10
  s_add_u32 m0, s61, 81920
  s_mov_b32 s60, 0
  buffer_load_dwordx4 v3, s[16:19], s60 offen lds
  s_add_u32 m0, s61, 86016
  s_mov_b32 s60, 393216
  buffer_load_dwordx4 v3, s[16:19], s60 offen lds
  s_add_u32 m0, s61, 90112
  s_mov_b32 s60, 786432
  buffer_load_dwordx4 v3, s[16:19], s60 offen lds
  s_add_u32 m0, s61, 94208
  s_mov_b32 s60, 1179648
  buffer_load_dwordx4 v3, s[16:19], s60 offen lds
  s_add_u32 m0, s61, 98304
  s_mov_b32 s60, 1572864
  buffer_load_dwordx4 v3, s[16:19], s60 offen lds
  s_add_u32 m0, s61, 102400
  s_mov_b32 s60, 1966080
  buffer_load_dwordx4 v3, s[16:19], s60 offen lds
  s_add_u32 m0, s61, 106496
  s_mov_b32 s60, 2359296
  buffer_load_dwordx4 v3, s[16:19], s60 offen lds
  s_add_u32 m0, s61, 110592
  s_mov_b32 s60, 2752512
  buffer_load_dwordx4 v3, s[16:19], s60 offen lds
  s_add_u32 m0, s61, 114688
  s_mov_b32 s60, 3145728
  buffer_load_dwordx4 v3, s[16:19], s60 offen lds
  s_add_u32 m0, s61, 118784
  s_mov_b32 s60, 3538944
  buffer_load_dwordx4 v3, s[16:19], s60 offen lds
  s_add_u32 m0, s61, 122880
  s_mov_b32 s60, 3932160
  buffer_load_dwordx4 v3, s[16:19], s60 offen lds
  s_add_u32 m0, s61, 126976
  s_mov_b32 s60, 4325376
  buffer_load_dwordx4 v3, s[16:19], s60 offen lds
  s_add_u32 m0, s61, 131072
  s_mov_b32 s60, 4718592
  buffer_load_dwordx4 v3, s[16:19], s60 offen lds
  s_add_u32 m0, s61, 135168
  s_mov_b32 s60, 5111808
  buffer_load_dwordx4 v3, s[16:19], s60 offen lds
  s_add_u32 m0, s61, 139264
  s_mov_b32 s60, 5505024
  buffer_load_dwordx4 v3, s[16:19], s60 offen lds
  s_add_u32 m0, s61, 143360
  s_mov_b32 s60, 5898240
  buffer_load_dwordx4 v3, s[16:19], s60 offen lds
  s_add_u32 m0, s61, 147456
  s_mov_b32 s60, 6291456
  buffer_load_dwordx4 v3, s[16:19], s60 offen lds
  s_add_u32 m0, s61, 151552
  s_mov_b32 s60, 6684672
  buffer_load_dwordx4 v3, s[16:19], s60 offen lds
  s_add_u32 m0, s61, 155648
  s_mov_b32 s60, 7077888
  buffer_load_dwordx4 v3, s[16:19], s60 offen lds
  s_add_u32 m0, s61, 159744
  s_mov_b32 s60, 7471104
  buffer_load_dwordx4 v3, s[16:19], s60 offen lds
  s_waitcnt vmcnt(20)
  s_barrier
  s_add_u32 s60, s32, 0
  s_and_b32 s60, s60, 3
  s_add_u32 s60, s60, 0
  s_add_u32 s60, s60, s39
  s_sub_u32 s63, s60, 10
  s_cmp_ge_u32 s60, 10
  s_cselect_b32 s60, s63, s60
  s_lshl_b32 s60, s60, 13
  s_add_u32 s60, s60, 0
  v_add_u32 v1, s60, v5
  ds_read_b64_tr_b16 a[0:1], v1 offset:0
  ds_read_b64_tr_b16 a[2:3], v1 offset:256
  ds_read_b64_tr_b16 a[4:5], v1 offset:1024
  ds_read_b64_tr_b16 a[6:7], v1 offset:1280
  s_add_u32 s60, s32, 0
  s_and_b32 s60, s60, 3
  s_add_u32 s60, s60, 4
  s_add_u32 s60, s60, s39
  s_sub_u32 s63, s60, 10
  s_cmp_ge_u32 s60, 10
  s_cselect_b32 s60, s63, s60
  s_lshl_b32 s60, s60, 13
  s_add_u32 s60, s60, 0
  v_add_u32 v1, s60, v5
  ds_read_b64_tr_b16 a[16:17], v1 offset:0
  ds_read_b64_tr_b16 a[18:19], v1 offset:256
  ds_read_b64_tr_b16 a[20:21], v1 offset:1024
  ds_read_b64_tr_b16 a[22:23], v1 offset:1280
  s_add_u32 s60, s32, 1
  s_and_b32 s60, s60, 3
  s_add_u32 s60, s60, 0
  s_add_u32 s60, s60, s39
  s_sub_u32 s63, s60, 10
  s_cmp_ge_u32 s60, 10
  s_cselect_b32 s60, s63, s60
  s_lshl_b32 s60, s60, 13
  s_add_u32 s60, s60, 0
  v_add_u32 v1, s60, v5
  ds_read_b64_tr_b16 a[32:33], v1 offset:0
  ds_read_b64_tr_b16 a[34:35], v1 offset:256
  ds_read_b64_tr_b16 a[36:37], v1 offset:1024
  ds_read_b64_tr_b16 a[38:39], v1 offset:1280
  s_waitcnt lgkmcnt(0)
  s_add_u32 s60, s32, 1
  s_and_b32 s60, s60, 3
  s_add_u32 s60, s60, 4
  s_add_u32 s60, s60, s39
  s_sub_u32 s63, s60, 10
  s_cmp_ge_u32 s60, 10
  s_cselect_b32 s60, s63, s60
  s_lshl_b32 s60, s60, 13
  s_add_u32 s60, s60, 0
  v_add_u32 v1, s60, v5
  ds_read_b64_tr_b16 a[48:49], v1 offset:0
  ds_read_b64_tr_b16 a[50:51], v1 offset:256
  ds_read_b64_tr_b16 a[52:53], v1 offset:1024
  ds_read_b64_tr_b16 a[54:55], v1 offset:1280
  s_add_u32 s60, s32, 2
  s_and_b32 s60, s60, 3
  s_add_u32 s60, s60, 0
  s_add_u32 s60, s60, s39
  s_sub_u32 s63, s60, 10
  s_cmp_ge_u32 s60, 10
  s_cselect_b32 s60, s63, s60
  s_lshl_b32 s60, s60, 13
  s_add_u32 s60, s60, 0
  v_add_u32 v1, s60, v5
  ds_read_b64_tr_b16 a[64:65], v1 offset:0
  ds_read_b64_tr_b16 a[66:67], v1 offset:256
  ds_read_b64_tr_b16 a[68:69], v1 offset:1024
  ds_read_b64_tr_b16 a[70:71], v1 offset:1280
  s_add_u32 s60, s32, 2
  s_and_b32 s60, s60, 3
  s_add_u32 s60, s60, 4
  s_add_u32 s60, s60, s39
  s_sub_u32 s63, s60, 10
  s_cmp_ge_u32 s60, 10
  s_cselect_b32 s60, s63, s60
  s_lshl_b32 s60, s60, 13
  s_add_u32 s60, s60, 0
  v_add_u32 v1, s60, v5
  ds_read_b64_tr_b16 a[80:81], v1 offset:0
  ds_read_b64_tr_b16 a[82:83], v1 offset:256
  ds_read_b64_tr_b16 a[84:85], v1 offset:1024
  ds_read_b64_tr_b16 a[86:87], v1 offset:1280
  s_waitcnt lgkmcnt(0)
  s_add_u32 s60, s32, 3
  s_and_b32 s60, s60, 3
  s_add_u32 s60, s60, 0
  s_add_u32 s60, s60, s39
  s_sub_u32 s63, s60, 10
  s_cmp_ge_u32 s60, 10
  s_cselect_b32 s60, s63, s60
  s_lshl_b32 s60, s60, 13
  s_add_u32 s60, s60, 0
  v_add_u32 v1, s60, v5
  ds_read_b64_tr_b16 a[96:97], v1 offset:0
  ds_read_b64_tr_b16 a[98:99], v1 offset:256
  ds_read_b64_tr_b16 a[100:101], v1 offset:1024
  ds_read_b64_tr_b16 a[102:103], v1 offset:1280
  s_add_u32 s60, s32, 3
  s_and_b32 s60, s60, 3
  s_add_u32 s60, s60, 4
  s_add_u32 s60, s60, s39
  s_sub_u32 s63, s60, 10
  s_cmp_ge_u32 s60, 10
  s_cselect_b32 s60, s63, s60
  s_lshl_b32 s60, s60, 13
  s_add_u32 s60, s60, 0
  v_add_u32 v1, s60, v5
  ds_read_b64_tr_b16 a[112:113], v1 offset:0
  ds_read_b64_tr_b16 a[114:115], v1 offset:256
  ds_read_b64_tr_b16 a[116:117], v1 offset:1024
  ds_read_b64_tr_b16 a[118:119], v1 offset:1280
  s_add_u32 s60, s39, 8
  s_sub_u32 s63, s60, 10
  s_cmp_ge_u32 s60, 10
  s_cselect_b32 s60, s63, s60
  s_lshl_b32 s60, s60, 13
  s_add_u32 s60, s60, 0
  v_add_u32 v1, s60, v5
  ds_read_b64_tr_b16 a[128:129], v1 offset:0
  ds_read_b64_tr_b16 a[130:131], v1 offset:256
  ds_read_b64_tr_b16 a[132:133], v1 offset:1024
  ds_read_b64_tr_b16 a[134:135], v1 offset:1280
  s_waitcnt lgkmcnt(0)
  s_add_u32 s60, s39, 9
  s_sub_u32 s63, s60, 10
  s_cmp_ge_u32 s60, 10
  s_cselect_b32 s60, s63, s60
  s_lshl_b32 s60, s60, 13
  s_add_u32 s60, s60, 0
  v_add_u32 v1, s60, v5
  ds_read_b64_tr_b16 a[144:145], v1 offset:0
  ds_read_b64_tr_b16 a[146:147], v1 offset:256
  ds_read_b64_tr_b16 a[148:149], v1 offset:1024
  ds_read_b64_tr_b16 a[150:151], v1 offset:1280
  s_waitcnt lgkmcnt(0)
  s_barrier
  s_call_b64 s[60:61], la_arrive
  s_lshl_b32 s61, s32, 10
  s_add_u32 m0, s61, 0
  s_mov_b32 s60, 0
  buffer_load_dwordx4 v3, s[20:23], s60 offen lds
  s_add_u32 m0, s61, 4096
  s_mov_b32 s60, 393216
  buffer_load_dwordx4 v3, s[20:23], s60 offen lds
  s_add_u32 m0, s61, 8192
  s_mov_b32 s60, 786432
  buffer_load_dwordx4 v3, s[20:23], s60 offen lds
  s_add_u32 m0, s61, 12288
  s_mov_b32 s60, 1179648
  buffer_load_dwordx4 v3, s[20:23], s60 offen lds
  s_add_u32 m0, s61, 16384
  s_mov_b32 s60, 1572864
  buffer_load_dwordx4 v3, s[20:23], s60 offen lds
  s_add_u32 m0, s61, 20480
  s_mov_b32 s60, 1966080
  buffer_load_dwordx4 v3, s[20:23], s60 offen lds
  s_add_u32 m0, s61, 24576
  s_mov_b32 s60, 2359296
  buffer_load_dwordx4 v3, s[20:23], s60 offen lds
  s_add_u32 m0, s61, 28672
  s_mov_b32 s60, 2752512
  buffer_load_dwordx4 v3, s[20:23], s60 offen lds
  s_add_u32 m0, s61, 32768
  s_mov_b32 s60, 3145728
  buffer_load_dwordx4 v3, s[20:23], s60 offen lds
  s_add_u32 m0, s61, 36864
  s_mov_b32 s60, 3538944
  buffer_load_dwordx4 v3, s[20:23], s60 offen lds
  s_add_u32 m0, s61, 40960
  s_mov_b32 s60, 3932160
  buffer_load_dwordx4 v3, s[20:23], s60 offen lds
  s_add_u32 m0, s61, 45056
  s_mov_b32 s60, 4325376
  buffer_load_dwordx4 v3, s[20:23], s60 offen lds
  s_add_u32 m0, s61, 49152
  s_mov_b32 s60, 4718592
  buffer_load_dwordx4 v3, s[20:23], s60 offen lds
  s_add_u32 m0, s61, 53248
  s_mov_b32 s60, 5111808
  buffer_load_dwordx4 v3, s[20:23], s60 offen lds
  s_add_u32 m0, s61, 57344
  s_mov_b32 s60, 5505024
  buffer_load_dwordx4 v3, s[20:23], s60 offen lds
  s_add_u32 m0, s61, 61440
  s_mov_b32 s60, 5898240
  buffer_load_dwordx4 v3, s[20:23], s60 offen lds
  s_add_u32 m0, s61, 65536
  s_mov_b32 s60, 6291456
  buffer_load_dwordx4 v3, s[20:23], s60 offen lds
  s_add_u32 m0, s61, 69632
  s_mov_b32 s60, 6684672
  buffer_load_dwordx4 v3, s[20:23], s60 offen lds
  s_add_u32 m0, s61, 73728
  s_mov_b32 s60, 7077888
  buffer_load_dwordx4 v3, s[20:23], s60 offen lds
  s_add_u32 m0, s61, 77824
  s_mov_b32 s60, 7471104
  buffer_load_dwordx4 v3, s[20:23], s60 offen lds
  s_waitcnt vmcnt(20)
  s_barrier
  s_add_u32 s60, s32, 0
  s_and_b32 s60, s60, 3
  s_add_u32 s60, s60, 0
  s_add_u32 s60, s60, s39
  s_sub_u32 s63, s60, 10
  s_cmp_ge_u32 s60, 10
  s_cselect_b32 s60, s63, s60
  s_lshl_b32 s60, s60, 13
  s_add_u32 s60, s60, 81920
  v_add_u32 v1, s60, v5
  ds_read_b64_tr_b16 a[8:9], v1 offset:0
  ds_read_b64_tr_b16 a[10:11], v1 offset:256
  ds_read_b64_tr_b16 a[12:13], v1 offset:1024
  ds_read_b64_tr_b16 a[14:15], v1 offset:1280
  s_add_u32 s60, s32, 0
  s_and_b32 s60, s60, 3
  s_add_u32 s60, s60, 4
  s_add_u32 s60, s60, s39
  s_sub_u32 s63, s60, 10
  s_cmp_ge_u32 s60, 10
  s_cselect_b32 s60, s63, s60
  s_lshl_b32 s60, s60, 13
  s_add_u32 s60, s60, 81920
  v_add_u32 v1, s60, v5
  ds_read_b64_tr_b16 a[24:25], v1 offset:0
  ds_read_b64_tr_b16 a[26:27], v1 offset:256
  ds_read_b64_tr_b16 a[28:29], v1 offset:1024
  ds_read_b64_tr_b16 a[30:31], v1 offset:1280
  s_add_u32 s60, s32, 1
  s_and_b32 s60, s60, 3
  s_add_u32 s60, s60, 0
  s_add_u32 s60, s60, s39
  s_sub_u32 s63, s60, 10
  s_cmp_ge_u32 s60, 10
  s_cselect_b32 s60, s63, s60
  s_lshl_b32 s60, s60, 13
  s_add_u32 s60, s60, 81920
  v_add_u32 v1, s60, v5
  ds_read_b64_tr_b16 a[40:41], v1 offset:0
  ds_read_b64_tr_b16 a[42:43], v1 offset:256
  ds_read_b64_tr_b16 a[44:45], v1 offset:1024
  ds_read_b64_tr_b16 a[46:47], v1 offset:1280
  s_waitcnt lgkmcnt(0)
  s_add_u32 s60, s32, 1
  s_and_b32 s60, s60, 3
  s_add_u32 s60, s60, 4
  s_add_u32 s60, s60, s39
  s_sub_u32 s63, s60, 10
  s_cmp_ge_u32 s60, 10
  s_cselect_b32 s60, s63, s60
  s_lshl_b32 s60, s60, 13
  s_add_u32 s60, s60, 81920
  v_add_u32 v1, s60, v5
  ds_read_b64_tr_b16 a[56:57], v1 offset:0
  ds_read_b64_tr_b16 a[58:59], v1 offset:256
  ds_read_b64_tr_b16 a[60:61], v1 offset:1024
  ds_read_b64_tr_b16 a[62:63], v1 offset:1280
  s_add_u32 s60, s32, 2
  s_and_b32 s60, s60, 3
  s_add_u32 s60, s60, 0
  s_add_u32 s60, s60, s39
  s_sub_u32 s63, s60, 10
  s_cmp_ge_u32 s60, 10
  s_cselect_b32 s60, s63, s60
  s_lshl_b32 s60, s60, 13
  s_add_u32 s60, s60, 81920
  v_add_u32 v1, s60, v5
  ds_read_b64_tr_b16 a[72:73], v1 offset:0
  ds_read_b64_tr_b16 a[74:75], v1 offset:256
  ds_read_b64_tr_b16 a[76:77], v1 offset:1024
  ds_read_b64_tr_b16 a[78:79], v1 offset:1280
  s_add_u32 s60, s32, 2
  s_and_b32 s60, s60, 3
  s_add_u32 s60, s60, 4
  s_add_u32 s60, s60, s39
  s_sub_u32 s63, s60, 10
  s_cmp_ge_u32 s60, 10
  s_cselect_b32 s60, s63, s60
  s_lshl_b32 s60, s60, 13
  s_add_u32 s60, s60, 81920
  v_add_u32 v1, s60, v5
  ds_read_b64_tr_b16 a[88:89], v1 offset:0
  ds_read_b64_tr_b16 a[90:91], v1 offset:256
  ds_read_b64_tr_b16 a[92:93], v1 offset:1024
  ds_read_b64_tr_b16 a[94:95], v1 offset:1280
  s_waitcnt lgkmcnt(0)
  s_add_u32 s60, s32, 3
  s_and_b32 s60, s60, 3
  s_add_u32 s60, s60, 0
  s_add_u32 s60, s60, s39
  s_sub_u32 s63, s60, 10
  s_cmp_ge_u32 s60, 10
  s_cselect_b32 s60, s63, s60
  s_lshl_b32 s60, s60, 13
  s_add_u32 s60, s60, 81920
  v_add_u32 v1, s60, v5
  ds_read_b64_tr_b16 a[104:105], v1 offset:0
  ds_read_b64_tr_b16 a[106:107], v1 offset:256
  ds_read_b64_tr_b16 a[108:109], v1 offset:1024
  ds_read_b64_tr_b16 a[110:111], v1 offset:1280
  s_add_u32 s60, s32, 3
  s_and_b32 s60, s60, 3
  s_add_u32 s60, s60, 4
  s_add_u32 s60, s60, s39
  s_sub_u32 s63, s60, 10
  s_cmp_ge_u32 s60, 10
  s_cselect_b32 s60, s63, s60
  s_lshl_b32 s60, s60, 13
  s_add_u32 s60, s60, 81920
  v_add_u32 v1, s60, v5
  ds_read_b64_tr_b16 a[120:121], v1 offset:0
  ds_read_b64_tr_b16 a[122:123], v1 offset:256
  ds_read_b64_tr_b16 a[124:125], v1 offset:1024
  ds_read_b64_tr_b16 a[126:127], v1 offset:1280
  s_add_u32 s60, s39, 8
  s_sub_u32 s63, s60, 10
  s_cmp_ge_u32 s60, 10
  s_cselect_b32 s60, s63, s60
  s_lshl_b32 s60, s60, 13
  s_add_u32 s60, s60, 81920
  v_add_u32 v1, s60, v5
  ds_read_b64_tr_b16 a[136:137], v1 offset:0
  ds_read_b64_tr_b16 a[138:139], v1 offset:256
  ds_read_b64_tr_b16 a[140:141], v1 offset:1024
  ds_read_b64_tr_b16 a[142:143], v1 offset:1280
  s_waitcnt lgkmcnt(0)
  s_add_u32 s60, s39, 9
  s_sub_u32 s63, s60, 10
  s_cmp_ge_u32 s60, 10
  s_cselect_b32 s60, s63, s60
  s_lshl_b32 s60, s60, 13
  s_add_u32 s60, s60, 81920
  v_add_u32 v1, s60, v5
  ds_read_b64_tr_b16 a[152:153], v1 offset:0
  ds_read_b64_tr_b16 a[154:155], v1 offset:256
  ds_read_b64_tr_b16 a[156:157], v1 offset:1024
  ds_read_b64_tr_b16 a[158:159], v1 offset:1280
  s_waitcnt lgkmcnt(0)
  s_barrier
  s_lshl_b32 s61, s32, 10
  s_add_u32 m0, s61, 81920
  s_mov_b32 s60, 0
  buffer_load_dwordx4 v4, s[24:27], s60 offen lds
  s_add_u32 m0, s61, 86016
  s_mov_b32 s60, 81920
  buffer_load_dwordx4 v4, s[24:27], s60 offen lds
  s_add_u32 m0, s61, 90112
  s_mov_b32 s60, 163840
  buffer_load_dwordx4 v4, s[24:27], s60 offen lds
  s_add_u32 m0, s61, 94208
  s_mov_b32 s60, 245760
  buffer_load_dwordx4 v4, s[24:27], s60 offen lds
  s_add_u32 m0, s61, 98304
  s_mov_b32 s60, 327680
  buffer_load_dwordx4 v4, s[24:27], s60 offen lds
  s_add_u32 m0, s61, 102400
  s_mov_b32 s60, 409600
  buffer_load_dwordx4 v4, s[24:27], s60 offen lds
  s_add_u32 m0, s61, 106496
  s_mov_b32 s60, 491520
  buffer_load_dwordx4 v4, s[24:27], s60 offen lds
  s_add_u32 m0, s61, 110592
  s_mov_b32 s60, 573440
  buffer_load_dwordx4 v4, s[24:27], s60 offen lds
  s_add_u32 m0, s61, 114688
  s_mov_b32 s60, 655360
  buffer_load_dwordx4 v4, s[24:27], s60 offen lds
  s_add_u32 m0, s61, 118784
  s_mov_b32 s60, 737280
  buffer_load_dwordx4 v4, s[24:27], s60 offen lds
  s_add_u32 m0, s61, 122880
  s_mov_b32 s60, 819200
  buffer_load_dwordx4 v4, s[24:27], s60 offen lds
  s_add_u32 m0, s61, 126976
  s_mov_b32 s60, 901120
  buffer_load_dwordx4 v4, s[24:27], s60 offen lds
  s_add_u32 m0, s61, 131072
  s_mov_b32 s60, 983040
  buffer_load_dwordx4 v4, s[24:27], s60 offen lds
  s_add_u32 m0, s61, 135168
  s_mov_b32 s60, 1064960
  buffer_load_dwordx4 v4, s[24:27], s60 offen lds
  s_add_u32 m0, s61, 139264
  s_mov_b32 s60, 1146880
  buffer_load_dwordx4 v4, s[24:27], s60 offen lds
  s_add_u32 m0, s61, 143360
  s_mov_b32 s60, 1228800
  buffer_load_dwordx4 v4, s[24:27], s60 offen lds
  s_add_u32 m0, s61, 147456
  s_mov_b32 s60, 1310720
  buffer_load_dwordx4 v4, s[24:27], s60 offen lds
  s_add_u32 m0, s61, 151552
  s_mov_b32 s60, 1392640
  buffer_load_dwordx4 v4, s[24:27], s60 offen lds
  s_add_u32 m0, s61, 155648
  s_mov_b32 s60, 1474560
  buffer_load_dwordx4 v4, s[24:27], s60 offen lds
  s_add_u32 m0, s61, 159744
  s_mov_b32 s60, 1556480
  buffer_load_dwordx4 v4, s[24:27], s60 offen lds
  s_waitcnt vmcnt(20)
  s_barrier
  s_add_u32 s60, s32, 0
  s_and_b32 s60, s60, 3
  s_add_u32 s60, s60, 0
  s_add_u32 s60, s60, s39
  s_sub_u32 s63, s60, 10
  s_cmp_ge_u32 s60, 10
  s_cselect_b32 s60, s63, s60
  s_lshl_b32 s60, s60, 13
  s_add_u32 s60, s60, 0
  v_add_u32 v1, s60, v5
  ds_read_b64_tr_b16 v[176:177], v1 offset:0
  ds_read_b64_tr_b16 v[178:179], v1 offset:256
  ds_read_b64_tr_b16 v[180:181], v1 offset:1024
  ds_read_b64_tr_b16 v[182:183], v1 offset:1280
  s_add_u32 s60, s32, 0
  s_and_b32 s60, s60, 3
  s_add_u32 s60, s60, 4
  s_add_u32 s60, s60, s39
  s_sub_u32 s63, s60, 10
  s_cmp_ge_u32 s60, 10
  s_cselect_b32 s60, s63, s60
  s_lshl_b32 s60, s60, 13
  s_add_u32 s60, s60, 0
  v_add_u32 v1, s60, v5
  ds_read_b64_tr_b16 v[184:185], v1 offset:0
  ds_read_b64_tr_b16 v[186:187], v1 offset:256
  ds_read_b64_tr_b16 v[188:189], v1 offset:1024
  ds_read_b64_tr_b16 v[190:191], v1 offset:1280
  s_add_u32 s60, s32, 1
  s_and_b32 s60, s60, 3
  s_add_u32 s60, s60, 0
  s_add_u32 s60, s60, s39
  s_sub_u32 s63, s60, 10
  s_cmp_ge_u32 s60, 10
  s_cselect_b32 s60, s63, s60
  s_lshl_b32 s60, s60, 13
  s_add_u32 s60, s60, 0
  v_add_u32 v1, s60, v5
  ds_read_b64_tr_b16 v[192:193], v1 offset:0
  ds_read_b64_tr_b16 v[194:195], v1 offset:256
  ds_read_b64_tr_b16 v[196:197], v1 offset:1024
  ds_read_b64_tr_b16 v[198:199], v1 offset:1280
  s_waitcnt lgkmcnt(0)
  s_add_u32 s60, s32, 1
  s_and_b32 s60, s60, 3
  s_add_u32 s60, s60, 4
  s_add_u32 s60, s60, s39
  s_sub_u32 s63, s60, 10
  s_cmp_ge_u32 s60, 10
  s_cselect_b32 s60, s63, s60
  s_lshl_b32 s60, s60, 13
  s_add_u32 s60, s60, 0
  v_add_u32 v1, s60, v5
  ds_read_b64_tr_b16 v[200:201], v1 offset:0
  ds_read_b64_tr_b16 v[202:203], v1 offset:256
  ds_read_b64_tr_b16 v[204:205], v1 offset:1024
  ds_read_b64_tr_b16 v[206:207], v1 offset:1280
  s_add_u32 s60, s32, 2
  s_and_b32 s60, s60, 3
  s_add_u32 s60, s60, 0
  s_add_u32 s60, s60, s39
  s_sub_u32 s63, s60, 10
  s_cmp_ge_u32 s60, 10
  s_cselect_b32 s60, s63, s60
  s_lshl_b32 s60, s60, 13
  s_add_u32 s60, s60, 0
  v_add_u32 v1, s60, v5
  ds_read_b64_tr_b16 v[208:209], v1 offset:0
  ds_read_b64_tr_b16 v[210:211], v1 offset:256
  ds_read_b64_tr_b16 v[212:213], v1 offset:1024
  ds_read_b64_tr_b16 v[214:215], v1 offset:1280
  s_add_u32 s60, s32, 2
  s_and_b32 s60, s60, 3
  s_add_u32 s60, s60, 4
  s_add_u32 s60, s60, s39
  s_sub_u32 s63, s60, 10
  s_cmp_ge_u32 s60, 10
  s_cselect_b32 s60, s63, s60
  s_lshl_b32 s60, s60, 13
  s_add_u32 s60, s60, 0
  v_add_u32 v1, s60, v5
  ds_read_b64_tr_b16 v[216:217], v1 offset:0
  ds_read_b64_tr_b16 v[218:219], v1 offset:256
  ds_read_b64_tr_b16 v[220:221], v1 offset:1024
  ds_read_b64_tr_b16 v[222:223], v1 offset:1280
  s_waitcnt lgkmcnt(0)
  s_add_u32 s60, s32, 3
  s_and_b32 s60, s60, 3
  s_add_u32 s60, s60, 0
  s_add_u32 s60, s60, s39
  s_sub_u32 s63, s60, 10
  s_cmp_ge_u32 s60, 10
  s_cselect_b32 s60, s63, s60
  s_lshl_b32 s60, s60, 13
  s_add_u32 s60, s60, 0
  v_add_u32 v1, s60, v5
  ds_read_b64_tr_b16 v[224:225], v1 offset:0
  ds_read_b64_tr_b16 v[226:227], v1 offset:256
  ds_read_b64_tr_b16 v[228:229], v1 offset:1024
  ds_read_b64_tr_b16 v[230:231], v1 offset:1280
  s_add_u32 s60, s32, 3
  s_and_b32 s60, s60, 3
  s_add_u32 s60, s60, 4
  s_add_u32 s60, s60, s39
  s_sub_u32 s63, s60, 10
  s_cmp_ge_u32 s60, 10
  s_cselect_b32 s60, s63, s60
  s_lshl_b32 s60, s60, 13
  s_add_u32 s60, s60, 0
  v_add_u32 v1, s60, v5
  ds_read_b64_tr_b16 v[232:233], v1 offset:0
  ds_read_b64_tr_b16 v[234:235], v1 offset:256
  ds_read_b64_tr_b16 v[236:237], v1 offset:1024
  ds_read_b64_tr_b16 v[238:239], v1 offset:1280
  s_add_u32 s60, s39, 8
  s_sub_u32 s63, s60, 10
  s_cmp_ge_u32 s60, 10
  s_cselect_b32 s60, s63, s60
  s_lshl_b32 s60, s60, 13
  s_add_u32 s60, s60, 0
  v_add_u32 v1, s60, v5
  ds_read_b64_tr_b16 v[240:241], v1 offset:0
  ds_read_b64_tr_b16 v[242:243], v1 offset:256
  ds_read_b64_tr_b16 v[244:245], v1 offset:1024
  ds_read_b64_tr_b16 v[246:247], v1 offset:1280
  s_waitcnt lgkmcnt(0)
  s_add_u32 s60, s39, 9
  s_sub_u32 s63, s60, 10
  s_cmp_ge_u32 s60, 10
  s_cselect_b32 s60, s63, s60
  s_lshl_b32 s60, s60, 13
  s_add_u32 s60, s60, 0
  v_add_u32 v1, s60, v5
  ds_read_b64_tr_b16 v[248:249], v1 offset:0
  ds_read_b64_tr_b16 v[250:251], v1 offset:256
  ds_read_b64_tr_b16 v[252:253], v1 offset:1024
  ds_read_b64_tr_b16 v[254:255], v1 offset:1280
  s_waitcnt lgkmcnt(0)
  s_barrier
  s_lshl_b32 s61, s32, 10
  s_add_u32 m0, s61, 0
  s_mov_b32 s60, 1638400
  buffer_load_dwordx4 v4, s[24:27], s60 offen lds
  s_add_u32 m0, s61, 4096
  s_mov_b32 s60, 1720320
  buffer_load_dwordx4 v4, s[24:27], s60 offen lds
  s_add_u32 m0, s61, 8192
  s_mov_b32 s60, 1802240
  buffer_load_dwordx4 v4, s[24:27], s60 offen lds
  s_add_u32 m0, s61, 12288
  s_mov_b32 s60, 1884160
  buffer_load_dwordx4 v4, s[24:27], s60 offen lds
  s_call_b64 s[60:61], la_census
  s_waitcnt vmcnt(0)
  s_barrier
  s_add_u32 s60, s32, 1
  s_and_b32 s60, s60, 3
  s_mul_i32 s60, s60, 6
  s_add_u32 s60, s60, s34
  s_add_u32 s60, s60, 0
  s_sub_u32 s63, s60, 24
  s_cmp_ge_u32 s60, 24
  s_cselect_b32 s60, s63, s60
  s_lshl_b32 s60, s60, 12
  s_add_u32 s60, s60, 81920
  s_sub_u32 s63, s60, 163840
  s_cmp_ge_u32 s60, 163840
  s_cselect_b32 s60, s63, s60
  v_add_u32 v1, s60, v6
  ds_read_b64_tr_b16 a[160:161], v1 offset:0
  ds_read_b64_tr_b16 a[162:163], v1 offset:128
  ds_read_b64_tr_b16 a[164:165], v1 offset:512
  ds_read_b64_tr_b16 a[166:167], v1 offset:640
  ds_read_b64_tr_b16 a[168:169], v1 offset:32
  ds_read_b64_tr_b16 a[170:171], v1 offset:160
  ds_read_b64_tr_b16 a[172:173], v1 offset:544
  ds_read_b64_tr_b16 a[174:175], v1 offset:672
  s_waitcnt lgkmcnt(0)
  s_add_u32 s60, s32, 1
  s_and_b32 s60, s60, 3
  s_mul_i32 s60, s60, 6
  s_add_u32 s60, s60, s34
  s_add_u32 s60, s60, 1
  s_sub_u32 s63, s60, 24
  s_cmp_ge_u32 s60, 24
  s_cselect_b32 s60, s63, s60
  s_lshl_b32 s60, s60, 12
  s_add_u32 s60, s60, 81920
  s_sub_u32 s63, s60, 163840
  s_cmp_ge_u32 s60, 163840
  s_cselect_b32 s60, s63, s60
  v_add_u32 v1, s60, v6
  ds_read_b64_tr_b16 a[176:177], v1 offset:0
  ds_read_b64_tr_b16 a[178:179], v1 offset:128
  ds_read_b64_tr_b16 a[180:181], v1 offset:512
  ds_read_b64_tr_b16 a[182:183], v1 offset:640
  ds_read_b64_tr_b16 a[184:185], v1 offset:32
  ds_read_b64_tr_b16 a[186:187], v1 offset:160
  ds_read_b64_tr_b16 a[188:189], v1 offset:544
  ds_read_b64_tr_b16 a[190:191], v1 offset:672
  s_waitcnt lgkmcnt(0)
  s_add_u32 s60, s32, 1
  s_and_b32 s60, s60, 3
  s_mul_i32 s60, s60, 6
  s_add_u32 s60, s60, s34
  s_add_u32 s60, s60, 2
  s_sub_u32 s63, s60, 24
  s_cmp_ge_u32 s60, 24
  s_cselect_b32 s60, s63, s60
  s_lshl_b32 s60, s60, 12
  s_add_u32 s60, s60, 81920
  s_sub_u32 s63, s60, 163840
  s_cmp_ge_u32 s60, 163840
  s_cselect_b32 s60, s63, s60
  v_add_u32 v1, s60, v6
  ds_read_b64_tr_b16 a[192:193], v1 offset:0
  ds_read_b64_tr_b16 a[194:195], v1 offset:128
  ds_read_b64_tr_b16 a[196:197], v1 offset:512
  ds_read_b64_tr_b16 a[198:199], v1 offset:640
  ds_read_b64_tr_b16 a[200:201], v1 offset:32
  ds_read_b64_tr_b16 a[202:203], v1 offset:160
  ds_read_b64_tr_b16 a[204:205], v1 offset:544
  ds_read_b64_tr_b16 a[206:207], v1 offset:672
  s_waitcnt lgkmcnt(0)
  s_add_u32 s60, s32, 1
  s_and_b32 s60, s60, 3
  s_mul_i32 s60, s60, 6
  s_add_u32 s60, s60, s34
  s_add_u32 s60, s60, 3
  s_sub_u32 s63, s60, 24
  s_cmp_ge_u32 s60, 24
  s_cselect_b32 s60, s63, s60
  s_lshl_b32 s60, s60, 12
  s_add_u32 s60, s60, 81920
  s_sub_u32 s63, s60, 163840
  s_cmp_ge_u32 s60, 163840
  s_cselect_b32 s60, s63, s60
  v_add_u32 v1, s60, v6
  ds_read_b64_tr_b16 a[208:209], v1 offset:0
  ds_read_b64_tr_b16 a[210:211], v1 offset:128
  ds_read_b64_tr_b16 a[212:213], v1 offset:512
  ds_read_b64_tr_b16 a[214:215], v1 offset:640
  ds_read_b64_tr_b16 a[216:217], v1 offset:32
  ds_read_b64_tr_b16 a[218:219], v1 offset:160
  ds_read_b64_tr_b16 a[220:221], v1 offset:544
  ds_read_b64_tr_b16 a[222:223], v1 offset:672
  s_waitcnt lgkmcnt(0)
  s_add_u32 s60, s32, 1
  s_and_b32 s60, s60, 3
  s_mul_i32 s60, s60, 6
  s_add_u32 s60, s60, s34
  s_add_u32 s60, s60, 4
  s_sub_u32 s63, s60, 24
  s_cmp_ge_u32 s60, 24
  s_cselect_b32 s60, s63, s60
  s_lshl_b32 s60, s60, 12
  s_add_u32 s60, s60, 81920
  s_sub_u32 s63, s60, 163840
  s_cmp_ge_u32 s60, 163840
  s_cselect_b32 s60, s63, s60
  v_add_u32 v1, s60, v6
  ds_read_b64_tr_b16 a[224:225], v1 offset:0
  ds_read_b64_tr_b16 a[226:227], v1 offset:128
  ds_read_b64_tr_b16 a[228:229], v1 offset:512
  ds_read_b64_tr_b16 a[230:231], v1 offset:640
  ds_read_b64_tr_b16 a[232:233], v1 offset:32
  ds_read_b64_tr_b16 a[234:235], v1 offset:160
  ds_read_b64_tr_b16 a[236:237], v1 offset:544
  ds_read_b64_tr_b16 a[238:239], v1 offset:672
  s_waitcnt lgkmcnt(0)
  s_add_u32 s60, s32, 1
  s_and_b32 s60, s60, 3
  s_mul_i32 s60, s60, 6
  s_add_u32 s60, s60, s34
  s_add_u32 s60, s60, 5
  s_sub_u32 s63, s60, 24
  s_cmp_ge_u32 s60, 24
  s_cselect_b32 s60, s63, s60
  s_lshl_b32 s60, s60, 12
  s_add_u32 s60, s60, 81920
  s_sub_u32 s63, s60, 163840
  s_cmp_ge_u32 s60, 163840
  s_cselect_b32 s60, s63, s60
  v_add_u32 v1, s60, v6
  ds_read_b64_tr_b16 a[240:241], v1 offset:0
  ds_read_b64_tr_b16 a[242:243], v1 offset:128
  ds_read_b64_tr_b16 a[244:245], v1 offset:512
  ds_read_b64_tr_b16 a[246:247], v1 offset:640
  ds_read_b64_tr_b16 a[248:249], v1 offset:32
  ds_read_b64_tr_b16 a[250:251], v1 offset:160
  ds_read_b64_tr_b16 a[252:253], v1 offset:544
  ds_read_b64_tr_b16 a[254:255], v1 offset:672
  s_waitcnt lgkmcnt(0)
  s_barrier
L_lan_again_1:
  s_lshr_b32 s37, s33, 5
  s_and_b32 s34, s33, 31
  s_mul_i32 s60, s34, 86
  s_lshr_b32 s60, s60, 8
  s_mul_i32 s61, s60, 3
  s_sub_u32 s36, s34, s61
  s_lshl_b32 s35, s37, 3
  s_add_u32 s35, s35, s60
  s_mov_b32 s38, s34
  s_sub_u32 s63, s38, 20
  s_cmp_ge_u32 s38, 20
  s_cselect_b32 s38, s63, s38
  s_lshr_b32 s39, s38, 1
  s_add_u32 s39, s39, 1
  s_mov_b32 s54, 0xff00ff00
  s_mov_b32 s55, s54
  v_mov_b32 v3, 0x44444444
  v_mov_b32 v1, 0xeeeeeeee
  v_cndmask_b32 v3, v3, v1, s[54:55]
  s_add_u32 s60, s32, 0
  s_and_b32 s60, s60, 3
  s_add_u32 s60, s60, 0
  s_add_u32 s60, s60, s39
  s_sub_u32 s63, s60, 10
  s_cmp_ge_u32 s60, 10
  s_cselect_b32 s60, s63, s60
  s_lshl_b32 s62, s60, 10
  v_lshl_add_u32 v7, v2, 4, s62
  s_lshr_b32 s61, s60, 1
  s_lshl_b32 s61, s61, 14
  s_and_b32 s62, s60, 1
  s_lshl_b32 s62, s62, 12
  s_add_u32 s61, s61, s62
  v_bfe_u32 v4, v2, 5, 1
  v_mul_u32_u24 v4, 1024, v4
  v_bfe_u32 v1, v2, 4, 1
  v_mul_u32_u24 v1, 512, v1
  v_add_u32 v4, v4, v1
  v_bfe_u32 v1, v2, 0, 4
  v_mul_u32_u24 v1, 16, v1
  v_add_u32 v4, v4, v1
  s_mov_b32 s60, 0
  s_mul_i32 s63, s61, 1
  s_add_u32 s60, s60, s63
  v_add_u32 v4, s60, v4
  s_add_u32 s60, s32, 0
  s_and_b32 s60, s60, 3
  s_add_u32 s60, s60, 4
  s_add_u32 s60, s60, s39
  s_sub_u32 s63, s60, 10
  s_cmp_ge_u32 s60, 10
  s_cselect_b32 s60, s63, s60
  s_lshl_b32 s62, s60, 10
  v_lshl_add_u32 v8, v2, 4, s62
  s_lshr_b32 s61, s60, 1
  s_lshl_b32 s61, s61, 14
  s_and_b32 s62, s60, 1
  s_lshl_b32 s62, s62, 12
  s_add_u32 s61, s61, s62
  v_bfe_u32 v5, v2, 5, 1
  v_mul_u32_u24 v5, 1024, v5
  v_bfe_u32 v1, v2, 4, 1
  v_mul_u32_u24 v1, 512, v1
  v_add_u32 v5, v5, v1
  v_bfe_u32 v1, v2, 0, 4
  v_mul_u32_u24 v1, 16, v1
  v_add_u32 v5, v5, v1
  s_mov_b32 s60, 0
  s_mul_i32 s63, s61, 1
  s_add_u32 s60, s60, s63
  v_add_u32 v5, s60, v5
  s_add_u32 s60, s32, 1
  s_and_b32 s60, s60, 3
  s_add_u32 s60, s60, 0
  s_add_u32 s60, s60, s39
  s_sub_u32 s63, s60, 10
  s_cmp_ge_u32 s60, 10
  s_cselect_b32 s60, s63, s60
  s_lshl_b32 s62, s60, 10
  v_lshl_add_u32 v9, v2, 4, s62
  s_add_u32 s60, s32, 1
  s_and_b32 s60, s60, 3
  s_add_u32 s60, s60, 4
  s_add_u32 s60, s60, s39
  s_sub_u32 s63, s60, 10
  s_cmp_ge_u32 s60, 10
  s_cselect_b32 s60, s63, s60
  s_lshl_b32 s62, s60, 10
  v_lshl_add_u32 v10, v2, 4, s62
  s_add_u32 s60, s32, 2
  s_and_b32 s60, s60, 3
  s_add_u32 s60, s60, 0
  s_add_u32 s60, s60, s39
  s_sub_u32 s63, s60, 10
  s_cmp_ge_u32 s60, 10
  s_cselect_b32 s60, s63, s60
  s_lshl_b32 s62, s60, 10
  v_lshl_add_u32 v11, v2, 4, s62
  s_add_u32 s60, s32, 2
  s_and_b32 s60, s60, 3
  s_add_u32 s60, s60, 4
  s_add_u32 s60, s60, s39
  s_sub_u32 s63, s60, 10
  s_cmp_ge_u32 s60, 10
  s_cselect_b32 s60, s63, s60
  s_lshl_b32 s62, s60, 10
  v_lshl_add_u32 v12, v2, 4, s62
  s_add_u32 s60, s32, 3
  s_and_b32 s60, s60, 3
  s_add_u32 s60, s60, 0
  s_add_u32 s60, s60, s39
  s_sub_u32 s63, s60, 10
  s_cmp_ge_u32 s60, 10
  s_cselect_b32 s60, s63, s60
  s_lshl_b32 s62, s60, 10
  v_lshl_add_u32 v13, v2, 4, s62
  s_add_u32 s60, s32, 3
  s_and_b32 s60, s60, 3
  s_add_u32 s60, s60, 4
  s_add_u32 s60, s60, s39
  s_sub_u32 s63, s60, 10
  s_cmp_ge_u32 s60, 10
  s_cselect_b32 s60, s63, s60
  s_lshl_b32 s62, s60, 10
  v_lshl_add_u32 v14, v2, 4, s62
  s_add_u32 s60, s39, 8
  s_sub_u32 s63, s60, 10
  s_cmp_ge_u32 s60, 10
  s_cselect_b32 s60, s63, s60
  s_lshl_b32 s62, s60, 10
  v_lshl_add_u32 v15, v2, 4, s62
  s_add_u32 s60, s39, 9
  s_sub_u32 s63, s60, 10
  s_cmp_ge_u32 s60, 10
  s_cselect_b32 s60, s63, s60
  s_lshl_b32 s62, s60, 10
  v_lshl_add_u32 v16, v2, 4, s62
  s_lshr_b32 s60, s32, 1
  s_add_u32 s60, s60, s39
  s_add_u32 s60, s60, 8
  s_sub_u32 s63, s60, 10
  s_cmp_ge_u32 s60, 10
  s_cselect_b32 s60, s63, s60
  s_and_b32 s61, s32, 1
  s_lshl_b32 s61, s61, 3
  s_lshl_b32 s62, s60, 10
  s_add_u32 s62, s62, s61
  v_lshl_add_u32 v17, v2, 4, s62
  s_lshr_b32 s61, s60, 1
  s_lshl_b32 s61, s61, 14
  s_and_b32 s62, s60, 1
  s_lshl_b32 s62, s62, 12
  s_add_u32 s61, s61, s62
  s_and_b32 s62, s32, 1
  v_bfe_u32 v6, v2, 5, 1
  v_mul_u32_u24 v6, 1024, v6
  v_bfe_u32 v1, v2, 4, 1
  v_mul_u32_u24 v1, 512, v1
  v_add_u32 v6, v6, v1
  v_bfe_u32 v1, v2, 0, 4
  v_mul_u32_u24 v1, 16, v1
  v_add_u32 v6, v6, v1
  s_mov_b32 s60, 0
  s_mul_i32 s63, s61, 1
  s_add_u32 s60, s60, s63
  s_mul_i32 s63, s62, 256
  s_add_u32 s60, s60, s63
  v_add_u32 v6, s60, v6
  s_add_u32 s60, s32, 1
  s_and_b32 s60, s60, 3
  s_mul_i32 s60, s60, 6
  s_add_u32 s60, s60, s34
  s_add_u32 s60, s60, 0
  s_sub_u32 s63, s60, 24
  s_cmp_ge_u32 s60, 24
  s_cselect_b32 s60, s63, s60
  s_mov_b32 s61, s60
  v_bfe_u32 v18, v2, 0, 6
  v_mul_u32_u24 v18, 16, v18
  s_mov_b32 s60, 131072
  s_mul_i32 s63, s37, 24576
  s_add_u32 s60, s60, s63
  s_mul_i32 s63, s61, 1024
  s_add_u32 s60, s60, s63
  v_add_u32 v18, s60, v18
  s_add_u32 s60, s32, 1
  s_and_b32 s60, s60, 3
  s_mul_i32 s60, s60, 6
  s_add_u32 s60, s60, s34
  s_add_u32 s60, s60, 1
  s_sub_u32 s63, s60, 24
  s_cmp_ge_u32 s60, 24
  s_cselect_b32 s60, s63, s60
  s_mov_b32 s61, s60
  v_bfe_u32 v19, v2, 0, 6
  v_mul_u32_u24 v19, 16, v19
  s_mov_b32 s60, 131072
  s_mul_i32 s63, s37, 24576
  s_add_u32 s60, s60, s63
  s_mul_i32 s63, s61, 1024
  s_add_u32 s60, s60, s63
  v_add_u32 v19, s60, v19
  s_add_u32 s60, s32, 1
  s_and_b32 s60, s60, 3
  s_mul_i32 s60, s60, 6
  s_add_u32 s60, s60, s34
  s_add_u32 s60, s60, 2
  s_sub_u32 s63, s60, 24
  s_cmp_ge_u32 s60, 24
  s_cselect_b32 s60, s63, s60
  s_mov_b32 s61, s60
  v_bfe_u32 v20, v2, 0, 6
  v_mul_u32_u24 v20, 16, v20
  s_mov_b32 s60, 131072
  s_mul_i32 s63, s37, 24576
  s_add_u32 s60, s60, s63
  s_mul_i32 s63, s61, 1024
  s_add_u32 s60, s60, s63
  v_add_u32 v20, s60, v20
  s_add_u32 s60, s32, 1
  s_and_b32 s60, s60, 3
  s_mul_i32 s60, s60, 6
  s_add_u32 s60, s60, s34
  s_add_u32 s60, s60, 3
  s_sub_u32 s63, s60, 24
  s_cmp_ge_u32 s60, 24
  s_cselect_b32 s60, s63, s60
  s_mov_b32 s61, s60
  v_bfe_u32 v21, v2, 0, 6
  v_mul_u32_u24 v21, 16, v21
  s_mov_b32 s60, 131072
  s_mul_i32 s63, s37, 24576
  s_add_u32 s60, s60, s63
  s_mul_i32 s63, s61, 1024
  s_add_u32 s60, s60, s63
  v_add_u32 v21, s60, v21
  s_add_u32 s60, s32, 1
  s_and_b32 s60, s60, 3
  s_mul_i32 s60, s60, 6
  s_add_u32 s60, s60, s34
  s_add_u32 s60, s60, 4
  s_sub_u32 s63, s60, 24
  s_cmp_ge_u32 s60, 24
  s_cselect_b32 s60, s63, s60
  s_mov_b32 s61, s60
  v_bfe_u32 v22, v2, 0, 6
  v_mul_u32_u24 v22, 16, v22
  s_mov_b32 s60, 131072
  s_mul_i32 s63, s37, 24576
  s_add_u32 s60, s60, s63
  s_mul_i32 s63, s61, 1024
  s_add_u32 s60, s60, s63
  v_add_u32 v22, s60, v22
  s_add_u32 s60, s32, 1
  s_and_b32 s60, s60, 3
  s_mul_i32 s60, s60, 6
  s_add_u32 s60, s60, s34
  s_add_u32 s60, s60, 5
  s_sub_u32 s63, s60, 24
  s_cmp_ge_u32 s60, 24
  s_cselect_b32 s60, s63, s60
  s_mov_b32 s61, s60
  v_bfe_u32 v23, v2, 0, 6
  v_mul_u32_u24 v23, 16, v23
  s_mov_b32 s60, 131072
  s_mul_i32 s63, s37, 24576
  s_add_u32 s60, s60, s63
  s_mul_i32 s63, s61, 1024
  s_add_u32 s60, s60, s63
  v_add_u32 v23, s60, v23
  v_bfe_u32 v24, v2, 0, 4
  v_mul_u32_u24 v24, 40, v24
  v_bfe_u32 v1, v2, 4, 2
  v_mul_u32_u24 v1, 8, v1
  v_add_u32 v24, v24, v1
  s_mov_b32 s60, 24576
  s_mul_i32 s63, s32, 640
  s_add_u32 s60, s60, s63
  v_add_u32 v24, s60, v24
  v_bfe_u32 v25, v2, 0, 6
  v_mul_u32_u24 v25, 4, v25
  s_mov_b32 s60, 27648
  s_mul_i32 s63, s32, 256
  s_add_u32 s60, s60, s63
  v_add_u32 v25, s60, v25
  v_bfe_u32 v26, v2, 0, 6
  v_mul_u32_u24 v26, 4, v26
  s_mov_b32 s60, 41943040
  s_mul_i32 s63, s35, 3072
  s_add_u32 s60, s60, s63
  s_mul_i32 s63, s36, 1024
  s_add_u32 s60, s60, s63
  s_mul_i32 s63, s32, 256
  s_add_u32 s60, s60, s63
  v_add_u32 v26, s60, v26
  v_bfe_u32 v28, v2, 0, 6
  v_mul_u32_u24 v28, 16, v28
  s_mov_b32 s60, 12288
  s_mul_i32 s63, s32, 1024
  s_add_u32 s60, s60, s63
  v_add_u32 v28, s60, v28
  v_bfe_u32 v1, v2, 1, 2
  v_cmp_eq_u32 vcc, 0, v1
  v_and_b32 v1, 1, v2
  v_lshlrev_b32 v1, 4, v1
  v_mov_b32 v112, 0x3f80
  v_lshlrev_b32 v1, v1, v112
  v_cndmask_b32 v48, 0, v1, vcc
  v_lshrrev_b32 v1, 1, v2
  v_xor_b32 v1, v1, v2
  v_and_b32 v1, 8, v1
  v_cmp_eq_u32 vcc, 0, v1
  s_nop 1
  v_cndmask_b32 v48, 0, v48, vcc
  v_bfe_u32 v1, v2, 1, 2
  v_cmp_eq_u32 vcc, 1, v1
  v_and_b32 v1, 1, v2
  v_lshlrev_b32 v1, 4, v1
  v_mov_b32 v112, 0x3f80
  v_lshlrev_b32 v1, v1, v112
  v_cndmask_b32 v49, 0, v1, vcc
  v_lshrrev_b32 v1, 1, v2
  v_xor_b32 v1, v1, v2
  v_and_b32 v1, 8, v1
  v_cmp_eq_u32 vcc, 0, v1
  s_nop 1
  v_cndmask_b32 v49, 0, v49, vcc
  v_bfe_u32 v1, v2, 1, 2
  v_cmp_eq_u32 vcc, 2, v1
  v_and_b32 v1, 1, v2
  v_lshlrev_b32 v1, 4, v1
  v_mov_b32 v112, 0x3f80
  v_lshlrev_b32 v1, v1, v112
  v_cndmask_b32 v50, 0, v1, vcc
  v_lshrrev_b32 v1, 1, v2
  v_xor_b32 v1, v1, v2
  v_and_b32 v1, 8, v1
  v_cmp_eq_u32 vcc, 0, v1
  s_nop 1
  v_cndmask_b32 v50, 0, v50, vcc
  v_bfe_u32 v1, v2, 1, 2
  v_cmp_eq_u32 vcc, 3, v1
  v_and_b32 v1, 1, v2
  v_lshlrev_b32 v1, 4, v1
  v_mov_b32 v112, 0x3f80
  v_lshlrev_b32 v1, v1, v112
  v_cndmask_b32 v51, 0, v1, vcc
  v_lshrrev_b32 v1, 1, v2
  v_xor_b32 v1, v1, v2
  v_and_b32 v1, 8, v1
  v_cmp_eq_u32 vcc, 0, v1
  s_nop 1
  v_cndmask_b32 v51, 0, v51, vcc
  v_mov_b32 v44, -1
  v_mov_b32 v45, -1
  v_mov_b32 v46, -1
  v_mov_b32 v47, -1
  v_mov_b32 v60, 0
  v_mov_b32 v61, 0
  v_mov_b32 v62, 0
  v_mov_b32 v63, 0
  v_mov_b32 v64, 0
  v_mov_b32 v65, 0
  v_mov_b32 v66, 0
  v_mov_b32 v67, 0
  v_mov_b32 v68, 0
  v_mov_b32 v69, 0
  v_mov_b32 v70, 0
  v_mov_b32 v71, 0
  v_mov_b32 v72, 0
  v_mov_b32 v73, 0
  v_mov_b32 v74, 0
  v_mov_b32 v75, 0
  v_mov_b32 v76, 0
  v_mov_b32 v77, 0
  v_mov_b32 v78, 0
  v_mov_b32 v79, 0
  s_mov_b32 s53, 0x3dd53b95
  v_mov_b32 v29, 0
  s_mov_b32 s42, 4194304
  s_mul_i32 s63, s65, 1048576
  s_add_u32 s42, s42, s63
  s_mov_b32 s47, 218103808
  s_mul_i32 s63, s65, 8388608
  s_add_u32 s47, s47, s63
  s_mov_b32 s46, 218103808
  s_mul_i32 s63, s6, 8192
  s_add_u32 s46, s46, s63
  s_mul_i32 s63, s65, 8388608
  s_add_u32 s46, s46, s63
  s_mov_b32 s41, 0
  s_add_u32 s43, s42, 262144
  s_add_u32 s44, s43, 262144
  s_add_u32 s45, s44, 262144
  s_mov_b32 s48, 0
  s_mov_b32 s49, 0
  s_mov_b32 s64, 400000
  v_mov_b32 v27, 1
  s_mov_b32 s52, 1
  s_mov_b32 s56, 0
  s_mov_b32 s50, 0
  s_mov_b32 s60, 218202112
  s_mul_i32 s63, s6, 8192
  s_add_u32 s60, s60, s63
  s_mul_i32 s63, s34, 256
  s_add_u32 s60, s60, s63
  s_mul_i32 s63, s37, 131072
  s_add_u32 s60, s60, s63
  s_mul_i32 s63, s65, 16384
  s_add_u32 s60, s60, s63
  s_add_u32 s70, s4, s60
  s_addc_u32 s71, s5, 0
  s_mov_b32 s60, 0
  s_mul_i32 s63, s35, 128
  s_add_u32 s60, s60, s63
  s_mul_i32 s63, s65, 131072
  s_add_u32 s60, s60, s63
  s_add_u32 s100, s4, s60
  s_addc_u32 s101, s5, 0
  s_mov_b32 s72, 0
  s_mov_b32 s73, 0
  s_mov_b32 s74, 0
  s_mov_b32 s75, 0
  s_cmp_eq_u32 s32, 1
  s_cbranch_scc1 L_lan_w1_5
  s_cmp_eq_u32 s32, 2
  s_cbranch_scc1 L_lan_w2_6
  s_cmp_eq_u32 s32, 3
  s_cbranch_scc1 L_lan_w3_7
L_lan_w0_4:
  v_bfe_u32 v33, v2, 4, 2
  v_mul_u32_u24 v33, 320, v33
  v_bfe_u32 v1, v2, 2, 2
  v_mul_u32_u24 v1, 40, v1
  v_add_u32 v33, v33, v1
  v_bfe_u32 v1, v2, 0, 2
  v_mul_u32_u24 v1, 8, v1
  v_add_u32 v33, v33, v1
  s_mov_b32 s60, 24576
  v_add_u32 v33, s60, v33
  v_bfe_u32 v31, v2, 4, 1
  v_mul_u32_u24 v31, 16, v31
  v_bfe_u32 v1, v2, 0, 3
  v_mul_u32_u24 v1, 32, v1
  v_add_u32 v31, v31, v1
  s_mov_b32 s60, 3072
  s_mul_i32 s63, s35, 4096
  s_add_u32 s60, s60, s63
  s_mul_i32 s63, s36, 256
  s_add_u32 s60, s60, s63
  v_add_u32 v31, s60, v31
  v_bfe_u32 v1, v2, 3, 1
  v_cmp_eq_u32 vcc, 0, v1
  v_mov_b32 v1, 2147483632
  s_nop 0
  v_cndmask_b32 v31, v1, v31, vcc
  v_bfe_u32 v1, v2, 5, 1
  v_cmp_eq_u32 vcc, 1, v1
  v_mov_b32 v1, 2147483632
  s_nop 0
  v_cndmask_b32 v31, v1, v31, vcc
  v_bfe_u32 v32, v2, 4, 1
  v_mul_u32_u24 v32, 16, v32
  v_bfe_u32 v1, v2, 0, 3
  v_mul_u32_u24 v1, 32, v1
  v_add_u32 v32, v32, v1
  v_bfe_u32 v1, v2, 3, 1
  v_mul_u32_u24 v1, 2048, v1
  v_add_u32 v32, v32, v1
  v_bfe_u32 v1, v2, 5, 1
  v_mul_u32_u24 v1, 256, v1
  v_add_u32 v32, v32, v1
  s_mov_b32 s60, 29696
  v_add_u32 v32, s60, v32
  v_bfe_u32 v34, v2, 0, 6
  v_mul_u32_u24 v34, 4, v34
  s_mov_b32 s60, 65536
  s_mul_i32 s63, s37, 3072
  s_add_u32 s60, s60, s63
  s_mul_i32 s63, s34, 128
  s_add_u32 s60, s60, s63
  s_mul_i32 s63, s65, 131072
  s_add_u32 s60, s60, s63
  v_add_u32 v34, s60, v34
  s_lshl_b32 s61, 1, s34
  s_andn2_b32 s68, 0xffffff, s61
  s_mov_b32 s69, 0
  s_lshr_b32 s60, s34, 1
  s_lshr_b32 s61, s60, 1
  s_lshl_b32 s61, s61, 14
  s_and_b32 s62, s60, 1
  s_lshl_b32 s62, s62, 12
  s_add_u32 s61, s61, s62
  s_and_b32 s62, s34, 1
  v_bfe_u32 v35, v2, 5, 1
  v_mul_u32_u24 v35, 256, v35
  v_bfe_u32 v1, v2, 0, 4
  v_mul_u32_u24 v1, 16, v1
  v_add_u32 v35, v35, v1
  v_bfe_u32 v1, v2, 4, 1
  v_mul_u32_u24 v1, 8, v1
  v_add_u32 v35, v35, v1
  s_mov_b32 s60, 0
  s_mul_i32 s63, s61, 1
  s_add_u32 s60, s60, s63
  s_mul_i32 s63, s37, 1024
  s_add_u32 s60, s60, s63
  s_mul_i32 s63, s62, 512
  s_add_u32 s60, s60, s63
  v_add_u32 v35, s60, v35
  v_bfe_u32 v112, v2, 4, 1
  v_mul_u32_u24 v112, 5120, v112
  v_bfe_u32 v1, v2, 5, 1
  v_mul_u32_u24 v1, 32, v1
  v_add_u32 v112, v112, v1
  v_bfe_u32 v1, v2, 0, 4
  v_mul_u32_u24 v1, 2, v1
  v_add_u32 v112, v112, v1
  s_mov_b32 s60, 0
  s_mul_i32 s63, s38, 64
  s_add_u32 s60, s60, s63
  s_mul_i32 s63, s37, 1048576
  s_add_u32 s60, s60, s63
  v_add_u32 v112, s60, v112
  buffer_load_ushort v114, v112, s[28:31], 0 offen offset:0
  buffer_load_ushort v115, v112, s[28:31], 0 offen offset:1280
  buffer_load_ushort v116, v112, s[28:31], 0 offen offset:2560
  buffer_load_ushort v117, v112, s[28:31], 0 offen offset:3840
  s_waitcnt vmcnt(0)
  v_lshl_or_b32 v112, v115, 16, v114
  v_lshl_or_b32 v113, v117, 16, v116
  buffer_store_dwordx2 v[112:113], v35, s[8:11], s46 offen sc1
  s_branch L_lan_loop_8
.p2align 6
L_lan_loop_8:
  buffer_load_dwordx4 v[132:135], v4, s[8:11], s46 offen offset:0 sc1
  s_nop 5
  buffer_load_dwordx4 v[136:139], v4, s[8:11], s46 offen offset:2048 sc1
  s_nop 5
  buffer_load_dwordx4 v[140:143], v4, s[8:11], s46 offen offset:256 sc1
  s_nop 5
  buffer_load_dwordx4 v[144:147], v4, s[8:11], s46 offen offset:2304 sc1
  s_nop 5
  buffer_load_dwordx4 v[148:151], v5, s[8:11], s46 offen offset:0 sc1
  s_nop 5
  buffer_load_dwordx4 v[152:155], v5, s[8:11], s46 offen offset:2048 sc1
  s_nop 5
  buffer_load_dwordx4 v[156:159], v5, s[8:11], s46 offen offset:256 sc1
  s_nop 5
  buffer_load_dwordx4 v[160:163], v5, s[8:11], s46 offen offset:2304 sc1
  s_nop 5
  buffer_load_dwordx4 v[164:167], v6, s[8:11], s46 offen offset:0 sc1
  s_nop 5
  buffer_load_dwordx4 v[168:171], v6, s[8:11], s46 offen offset:2048 sc1
  s_waitcnt vmcnt(9)
  v_mfma_f32_16x16x32_bf16 v[104:107], v[132:135], v[48:51], 0
  v_max3_u32 v42, v132, v133, v134
  v_mov_b32 v43, v135
  s_waitcnt vmcnt(8)
  v_mfma_f32_16x16x32_bf16 v[104:107], v[136:139], v[48:51], v[104:107]
  v_max3_u32 v42, v42, v136, v137
  v_max3_u32 v43, v43, v138, v139
  s_waitcnt vmcnt(7)
  v_mfma_f32_16x16x32_bf16 v[108:111], v[140:143], v[48:51], 0
  v_max3_u32 v42, v42, v140, v141
  v_max3_u32 v43, v43, v142, v143
  s_waitcnt vmcnt(6)
  v_mfma_f32_16x16x32_bf16 v[108:111], v[144:147], v[48:51], v[108:111]
  v_max3_u32 v42, v42, v144, v145
  v_max3_u32 v43, v43, v146, v147
  v_max_u32 v42, v42, v43
  v_cmp_eq_u32 vcc, -1, v42
  s_cbranch_vccnz L_lan_bad_12
  s_nop 2
  v_cvt_pk_bf16_f32 v124, v104, v105
  v_cvt_pk_bf16_f32 v125, v106, v107
  v_cvt_pk_bf16_f32 v126, v108, v109
  v_cvt_pk_bf16_f32 v127, v110, v111
  ds_write_b128 v7, v[124:127]
  s_nop 0
  v_smfmac_f32_16x16x64_bf16 v[60:63], v[124:127], a[0:7], v3
  v_smfmac_f32_16x16x64_bf16 v[64:67], v[124:127], a[8:15], v3
  v_smfmac_f32_16x16x64_bf16 v[68:71], v[124:127], v[176:183], v3
L_lan_skip_13:
  s_waitcnt vmcnt(5)
  v_mfma_f32_16x16x32_bf16 v[104:107], v[148:151], v[48:51], 0
  v_max3_u32 v42, v148, v149, v150
  v_mov_b32 v43, v151
  s_waitcnt vmcnt(4)
  v_mfma_f32_16x16x32_bf16 v[104:107], v[152:155], v[48:51], v[104:107]
  v_max3_u32 v42, v42, v152, v153
  v_max3_u32 v43, v43, v154, v155
  s_waitcnt vmcnt(3)
  v_mfma_f32_16x16x32_bf16 v[108:111], v[156:159], v[48:51], 0
  v_max3_u32 v42, v42, v156, v157
  v_max3_u32 v43, v43, v158, v159
  s_waitcnt vmcnt(2)
  v_mfma_f32_16x16x32_bf16 v[108:111], v[160:163], v[48:51], v[108:111]
  v_max3_u32 v42, v42, v160, v161
  v_max3_u32 v43, v43, v162, v163
  v_max_u32 v42, v42, v43
  v_cmp_eq_u32 vcc, -1, v42
  s_cbranch_vccnz L_lan_bad_14
  s_nop 2
  v_cvt_pk_bf16_f32 v128, v104, v105
  v_cvt_pk_bf16_f32 v129, v106, v107
  v_cvt_pk_bf16_f32 v130, v108, v109
  v_cvt_pk_bf16_f32 v131, v110, v111
  ds_write_b128 v8, v[128:131]
  s_nop 0
  v_smfmac_f32_16x16x64_bf16 v[60:63], v[128:131], a[16:23], v3
  v_smfmac_f32_16x16x64_bf16 v[64:67], v[128:131], a[24:31], v3
  v_smfmac_f32_16x16x64_bf16 v[68:71], v[128:131], v[184:191], v3
L_lan_skip_15:
  s_waitcnt vmcnt(1)
  v_mfma_f32_16x16x32_bf16 v[104:107], v[164:167], v[48:51], 0
  v_max3_u32 v42, v164, v165, v166
  v_mov_b32 v43, v167
  s_waitcnt vmcnt(0)
  v_mfma_f32_16x16x32_bf16 v[104:107], v[168:171], v[48:51], v[104:107]
  v_max3_u32 v42, v42, v168, v169
  v_max3_u32 v43, v43, v170, v171
  v_max_u32 v42, v42, v43
  v_cmp_eq_u32 vcc, -1, v42
  s_cbranch_vccnz L_lan_bad_16
  s_nop 2
  v_cvt_pk_bf16_f32 v112, v104, v105
  v_cvt_pk_bf16_f32 v113, v106, v107
  ds_write_b64 v17, v[112:113]
L_lan_skip_17:
  s_cmp_lg_u32 s50, 0
  s_cbranch_scc1 L_lan_fix_10
L_lan_back_11:
  s_waitcnt lgkmcnt(0)
  s_barrier
  ds_read_b128 v[132:135], v9
  ds_read_b128 v[136:139], v10
  ds_read_b128 v[140:143], v11
  s_waitcnt lgkmcnt(2)
  v_smfmac_f32_16x16x64_bf16 v[60:63], v[132:135], a[32:39], v3
  ds_read_b128 v[144:147], v12
  v_smfmac_f32_16x16x64_bf16 v[64:67], v[132:135], a[40:47], v3
  s_waitcnt lgkmcnt(2)
  v_smfmac_f32_16x16x64_bf16 v[60:63], v[136:139], a[48:55], v3
  ds_read_b128 v[148:151], v13
  v_smfmac_f32_16x16x64_bf16 v[64:67], v[136:139], a[56:63], v3
  s_waitcnt lgkmcnt(2)
  v_smfmac_f32_16x16x64_bf16 v[60:63], v[140:143], a[64:71], v3
  ds_read_b128 v[152:155], v14
  v_smfmac_f32_16x16x64_bf16 v[64:67], v[140:143], a[72:79], v3
  s_waitcnt lgkmcnt(2)
  v_smfmac_f32_16x16x64_bf16 v[60:63], v[144:147], a[80:87], v3
  ds_read_b128 v[156:159], v15
  v_smfmac_f32_16x16x64_bf16 v[64:67], v[144:147], a[88:95], v3
  s_waitcnt lgkmcnt(2)
  v_smfmac_f32_16x16x64_bf16 v[60:63], v[148:151], a[96:103], v3
  ds_read_b128 v[160:163], v16
  v_smfmac_f32_16x16x64_bf16 v[64:67], v[148:151], a[104:111], v3
  s_waitcnt lgkmcnt(2)
  v_smfmac_f32_16x16x64_bf16 v[60:63], v[152:155], a[112:119], v3
  v_smfmac_f32_16x16x64_bf16 v[64:67], v[152:155], a[120:127], v3
  s_waitcnt lgkmcnt(1)
  v_smfmac_f32_16x16x64_bf16 v[60:63], v[156:159], a[128:135], v3
  v_smfmac_f32_16x16x64_bf16 v[64:67], v[156:159], a[136:143], v3
  s_waitcnt lgkmcnt(0)
  v_smfmac_f32_16x16x64_bf16 v[60:63], v[160:163], a[144:151], v3
  v_smfmac_f32_16x16x64_bf16 v[64:67], v[160:163], a[152:159], v3
  v_smfmac_f32_16x16x64_bf16 v[68:71], v[132:135], v[192:199], v3
  s_nop 6
  v_permlane32_swap_b32 v60, v64
  v_permlane32_swap_b32 v61, v65
  v_permlane32_swap_b32 v62, v66
  v_permlane32_swap_b32 v63, v67
  v_add_f32 v60, v60, v64
  v_add_f32 v61, v61, v65
  v_add_f32 v62, v62, v66
  v_add_f32 v63, v63, v67
  v_cvt_pk_bf16_f32 v112, v60, v61
  v_cvt_pk_bf16_f32 v113, v62, v63
  ds_write_b64 v24, v[112:113]
  v_smfmac_f32_16x16x64_bf16 v[68:71], v[136:139], v[200:207], v3
  v_smfmac_f32_16x16x64_bf16 v[68:71], v[140:143], v[208:215], v3
  v_smfmac_f32_16x16x64_bf16 v[68:71], v[144:147], v[216:223], v3
  s_waitcnt lgkmcnt(0)
  s_barrier
  ds_read_b64_tr_b16 v[96:97], v33 offset:0
  ds_read_b64_tr_b16 v[98:99], v33 offset:160
  ds_read_b64_tr_b16 v[100:101], v33 offset:1280
  ds_read_b64_tr_b16 v[102:103], v33 offset:1440
  v_smfmac_f32_16x16x64_bf16 v[68:71], v[148:151], v[224:231], v3
  v_smfmac_f32_16x16x64_bf16 v[68:71], v[152:155], v[232:239], v3
  s_waitcnt lgkmcnt(2)
  v_mfma_f32_16x16x32_bf16 v[116:119], v[96:99], v[96:99], 0
  s_waitcnt lgkmcnt(0)
  v_mfma_f32_16x16x32_bf16 v[116:119], v[100:103], v[100:103], v[116:119]
  s_nop 7
  buffer_store_dwordx4 v[116:119], v31, s[8:11], s42 offen
  ds_write_b128 v32, v[116:119]
  v_smfmac_f32_16x16x64_bf16 v[68:71], v[156:159], v[240:247], v3
  v_smfmac_f32_16x16x64_bf16 v[68:71], v[160:163], v[248:255], v3
  v_mov_b32 v60, 0
  v_mov_b32 v61, 0
  v_mov_b32 v62, 0
  v_mov_b32 v63, 0
  v_mov_b32 v64, 0
  v_mov_b32 v65, 0
  v_mov_b32 v66, 0
  v_mov_b32 v67, 0
  s_waitcnt lgkmcnt(0)
  s_barrier
  v_permlane32_swap_b32 v68, v70
  v_permlane32_swap_b32 v69, v71
  v_add_f32 v68, v68, v70
  v_add_f32 v69, v69, v71
  v_cvt_pk_bf16_f32 v120, v68, v69
  ds_write_b32 v25, v120
  s_cmp_eq_u32 s41, 63
  s_cbranch_scc1 L_lan_last_18
  s_waitcnt lgkmcnt(0)
  s_barrier
  v_mov_b32 v68, 0
  v_mov_b32 v69, 0
  v_mov_b32 v70, 0
  v_mov_b32 v71, 0
  buffer_store_dword v120, v26, s[8:11], s49 offen
  s_mov_b64 exec, s[68:69]
L_lan_sp_19:
  v_cmp_gt_u32 vcc, v27, v29
  s_cbranch_vccz L_lan_sd_20
  buffer_load_dword v29, v34, s[8:11], 0 offen sc1
  v_cmp_gt_u32 vcc, v27, v29
  s_cbranch_vccz L_lan_sd_20
  buffer_load_dword v29, v34, s[8:11], 0 offen sc1
  v_cmp_gt_u32 vcc, v27, v29
  s_cbranch_vccz L_lan_sd_20
  buffer_load_dword v29, v34, s[8:11], 0 offen sc1
  v_cmp_gt_u32 vcc, v27, v29
  s_cbranch_vccz L_lan_sd_20
  buffer_load_dword v29, v34, s[8:11], 0 offen sc1
  v_cmp_gt_u32 vcc, v27, v29
  s_cbranch_vccz L_lan_sd_20
  buffer_load_dword v29, v34, s[8:11], 0 offen sc1
  v_cmp_gt_u32 vcc, v27, v29
  s_cbranch_vccz L_lan_sd_20
  buffer_load_dword v29, v34, s[8:11], 0 offen sc1
  v_cmp_gt_u32 vcc, v27, v29
  s_cbranch_vccz L_lan_sd_20
  buffer_load_dword v29, v34, s[8:11], 0 offen sc1
  v_cmp_gt_u32 vcc, v27, v29
  s_cbranch_vccz L_lan_sd_20
  buffer_load_dword v29, v34, s[8:11], 0 offen sc1
  s_waitcnt vmcnt(40)
  s_sub_u32 s64, s64, 1
  s_cmp_lg_u32 s64, 0
  s_cbranch_scc1 L_lan_sp_19
  s_branch L_lan_fail_2
L_lan_sd_20:
  s_mov_b64 exec, -1
  s_barrier
L_lan_g_21:
  buffer_load_dwordx4 v[140:143], v18, s[8:11], s42 offen sc1
  s_nop 7
  buffer_load_dwordx4 v[144:147], v19, s[8:11], s42 offen sc1
  s_nop 7
  buffer_load_dwordx4 v[148:151], v20, s[8:11], s42 offen sc1
  s_nop 7
  buffer_load_dwordx4 v[152:155], v21, s[8:11], s42 offen sc1
  s_nop 7
  buffer_load_dwordx4 v[156:159], v22, s[8:11], s42 offen sc1
  s_nop 7
  buffer_load_dwordx4 v[160:163], v23, s[8:11], s42 offen sc1
  s_waitcnt vmcnt(5)
  v_smfmac_f32_16x16x64_bf16 v[72:75], v[140:143], a[160:167], v3
  v_smfmac_f32_16x16x64_bf16 v[76:79], v[140:143], a[168:175], v3
  v_max3_u32 v42, v140, v141, v142
  v_mov_b32 v43, v143
  s_waitcnt vmcnt(4)
  v_smfmac_f32_16x16x64_bf16 v[72:75], v[144:147], a[176:183], v3
  v_smfmac_f32_16x16x64_bf16 v[76:79], v[144:147], a[184:191], v3
  v_max3_u32 v42, v42, v144, v145
  v_max3_u32 v43, v43, v146, v147
  s_waitcnt vmcnt(3)
  v_smfmac_f32_16x16x64_bf16 v[72:75], v[148:151], a[192:199], v3
  v_smfmac_f32_16x16x64_bf16 v[76:79], v[148:151], a[200:207], v3
  v_max3_u32 v42, v42, v148, v149
  v_max3_u32 v43, v43, v150, v151
  s_waitcnt vmcnt(2)
  v_smfmac_f32_16x16x64_bf16 v[72:75], v[152:155], a[208:215], v3
  v_smfmac_f32_16x16x64_bf16 v[76:79], v[152:155], a[216:223], v3
  v_max3_u32 v42, v42, v152, v153
  v_max3_u32 v43, v43, v154, v155
  s_waitcnt vmcnt(1)
  v_smfmac_f32_16x16x64_bf16 v[72:75], v[156:159], a[224:231], v3
  v_smfmac_f32_16x16x64_bf16 v[76:79], v[156:159], a[232:239], v3
  v_max3_u32 v42, v42, v156, v157
  v_max3_u32 v43, v43, v158, v159
  s_waitcnt vmcnt(0)
  v_smfmac_f32_16x16x64_bf16 v[72:75], v[160:163], a[240:247], v3
  v_smfmac_f32_16x16x64_bf16 v[76:79], v[160:163], a[248:255], v3
  v_max3_u32 v42, v42, v160, v161
  v_max3_u32 v43, v43, v162, v163
  v_max_u32 v42, v42, v43
  v_cmp_eq_u32 vcc, -1, v42
  s_add_u32 s60, s41, 1
  s_lshr_b32 s61, s60, 4
  s_xor_b32 s61, s61, s6
  s_cbranch_vccnz L_lan_r_22
  v_permlane32_swap_b32 v72, v76
  v_permlane32_swap_b32 v73, v77
  v_permlane32_swap_b32 v74, v78
  v_permlane32_swap_b32 v75, v79
  v_add_f32 v116, v72, v76
  v_add_f32 v117, v73, v77
  v_add_f32 v118, v74, v78
  v_add_f32 v119, v75, v79
  s_and_b32 s61, s61, 1
  s_lshl_b32 s61, s61, 13
  s_mov_b32 s41, s60
  s_lshl_b32 s60, s60, 17
  s_add_u32 s60, s60, s61
  s_add_u32 s46, s60, s47
  s_add_u32 s48, s48, 393216
  s_mov_b32 s64, 400000
  s_waitcnt lgkmcnt(0)
  s_barrier
  ds_read_b128 v[124:127], v28 offset:1024
  ds_read_b128 v[128:131], v28 offset:2048
  ds_read_b128 v[132:135], v28 offset:3072
  s_waitcnt lgkmcnt(2)
  v_pk_add_f32 v[116:117], v[116:117], v[124:125]
  v_pk_add_f32 v[118:119], v[118:119], v[126:127]
  s_waitcnt lgkmcnt(1)
  v_pk_add_f32 v[116:117], v[116:117], v[128:129]
  v_pk_add_f32 v[118:119], v[118:119], v[130:131]
  s_waitcnt lgkmcnt(0)
  v_pk_add_f32 v[116:117], v[116:117], v[132:133]
  v_pk_add_f32 v[118:119], v[118:119], v[134:135]
  v_cvt_pk_bf16_f32 v112, v116, v117
  v_cvt_pk_bf16_f32 v113, v118, v119
  buffer_store_dwordx2 v[112:113], v35, s[8:11], s46 offen sc1
  v_mov_b32 v72, 0
  v_mov_b32 v73, 0
  v_mov_b32 v74, 0
  v_mov_b32 v75, 0
  v_mov_b32 v76, 0
  v_mov_b32 v77, 0
  v_mov_b32 v78, 0
  v_mov_b32 v79, 0
  s_mov_b32 s60, s42
  s_mov_b32 s42, s43
  s_mov_b32 s43, s44
  s_mov_b32 s44, s45
  s_mov_b32 s45, s60
  s_add_u32 s49, s49, 98304
  s_nop 15
  s_nop 15
  s_nop 7
  v_add_u32 v27, 1, v27
  s_add_u32 s52, s52, 1
  s_barrier
  s_branch L_lan_loop_8
L_lan_bad_12:
  buffer_load_dwordx4 v[132:135], v4, s[8:11], s46 offen offset:0 sc1
  buffer_load_dwordx4 v[136:139], v4, s[8:11], s46 offen offset:2048 sc1
  buffer_load_dwordx4 v[140:143], v4, s[8:11], s46 offen offset:256 sc1
  buffer_load_dwordx4 v[144:147], v4, s[8:11], s46 offen offset:2304 sc1
  s_bitset1_b32 s50, 0
  s_branch L_lan_skip_13
L_lan_bad_14:
  buffer_load_dwordx4 v[148:151], v5, s[8:11], s46 offen offset:0 sc1
  buffer_load_dwordx4 v[152:155], v5, s[8:11], s46 offen offset:2048 sc1
  buffer_load_dwordx4 v[156:159], v5, s[8:11], s46 offen offset:256 sc1
  buffer_load_dwordx4 v[160:163], v5, s[8:11], s46 offen offset:2304 sc1
  s_bitset1_b32 s50, 1
  s_branch L_lan_skip_15
L_lan_bad_16:
  buffer_load_dwordx4 v[164:167], v6, s[8:11], s46 offen offset:0 sc1
  buffer_load_dwordx4 v[168:171], v6, s[8:11], s46 offen offset:2048 sc1
  s_bitset1_b32 s50, 2
  s_branch L_lan_skip_17
L_lan_fix_10:
  s_waitcnt vmcnt(0)
  s_bitcmp1_b32 s50, 0
  s_cbranch_scc0 L_lan_n_23
  v_mfma_f32_16x16x32_bf16 v[104:107], v[132:135], v[48:51], 0
  v_max3_u32 v42, v132, v133, v134
  v_mov_b32 v43, v135
  v_mfma_f32_16x16x32_bf16 v[104:107], v[136:139], v[48:51], v[104:107]
  v_max3_u32 v42, v42, v136, v137
  v_max3_u32 v43, v43, v138, v139
  v_mfma_f32_16x16x32_bf16 v[108:111], v[140:143], v[48:51], 0
  v_max3_u32 v42, v42, v140, v141
  v_max3_u32 v43, v43, v142, v143
  v_mfma_f32_16x16x32_bf16 v[108:111], v[144:147], v[48:51], v[108:111]
  v_max3_u32 v42, v42, v144, v145
  v_max3_u32 v43, v43, v146, v147
  v_max_u32 v42, v42, v43
  v_cmp_eq_u32 vcc, -1, v42
  s_cbranch_vccnz L_lan_b_24
  s_nop 2
  v_cvt_pk_bf16_f32 v124, v104, v105
  v_cvt_pk_bf16_f32 v125, v106, v107
  v_cvt_pk_bf16_f32 v126, v108, v109
  v_cvt_pk_bf16_f32 v127, v110, v111
  ds_write_b128 v7, v[124:127]
  s_nop 0
  v_smfmac_f32_16x16x64_bf16 v[60:63], v[124:127], a[0:7], v3
  v_smfmac_f32_16x16x64_bf16 v[64:67], v[124:127], a[8:15], v3
  v_smfmac_f32_16x16x64_bf16 v[68:71], v[124:127], v[176:183], v3
  s_bitset0_b32 s50, 0
  s_branch L_lan_n_23
L_lan_b_24:
  buffer_load_dwordx4 v[132:135], v4, s[8:11], s46 offen offset:0 sc1
  buffer_load_dwordx4 v[136:139], v4, s[8:11], s46 offen offset:2048 sc1
  buffer_load_dwordx4 v[140:143], v4, s[8:11], s46 offen offset:256 sc1
  buffer_load_dwordx4 v[144:147], v4, s[8:11], s46 offen offset:2304 sc1
L_lan_n_23:
  s_bitcmp1_b32 s50, 1
  s_cbranch_scc0 L_lan_n_25
  v_mfma_f32_16x16x32_bf16 v[104:107], v[148:151], v[48:51], 0
  v_max3_u32 v42, v148, v149, v150
  v_mov_b32 v43, v151
  v_mfma_f32_16x16x32_bf16 v[104:107], v[152:155], v[48:51], v[104:107]
  v_max3_u32 v42, v42, v152, v153
  v_max3_u32 v43, v43, v154, v155
  v_mfma_f32_16x16x32_bf16 v[108:111], v[156:159], v[48:51], 0
  v_max3_u32 v42, v42, v156, v157
  v_max3_u32 v43, v43, v158, v159
  v_mfma_f32_16x16x32_bf16 v[108:111], v[160:163], v[48:51], v[108:111]
  v_max3_u32 v42, v42, v160, v161
  v_max3_u32 v43, v43, v162, v163
  v_max_u32 v42, v42, v43
  v_cmp_eq_u32 vcc, -1, v42
  s_cbranch_vccnz L_lan_b_26
  s_nop 2
  v_cvt_pk_bf16_f32 v128, v104, v105
  v_cvt_pk_bf16_f32 v129, v106, v107
  v_cvt_pk_bf16_f32 v130, v108, v109
  v_cvt_pk_bf16_f32 v131, v110, v111
  ds_write_b128 v8, v[128:131]
  s_nop 0
  v_smfmac_f32_16x16x64_bf16 v[60:63], v[128:131], a[16:23], v3
  v_smfmac_f32_16x16x64_bf16 v[64:67], v[128:131], a[24:31], v3
  v_smfmac_f32_16x16x64_bf16 v[68:71], v[128:131], v[184:191], v3
  s_bitset0_b32 s50, 1
  s_branch L_lan_n_25
L_lan_b_26:
  buffer_load_dwordx4 v[148:151], v5, s[8:11], s46 offen offset:0 sc1
  buffer_load_dwordx4 v[152:155], v5, s[8:11], s46 offen offset:2048 sc1
  buffer_load_dwordx4 v[156:159], v5, s[8:11], s46 offen offset:256 sc1
  buffer_load_dwordx4 v[160:163], v5, s[8:11], s46 offen offset:2304 sc1
L_lan_n_25:
  s_bitcmp1_b32 s50, 2
  s_cbranch_scc0 L_lan_n_27
  v_mfma_f32_16x16x32_bf16 v[104:107], v[164:167], v[48:51], 0
  v_max3_u32 v42, v164, v165, v166
  v_mov_b32 v43, v167
  v_mfma_f32_16x16x32_bf16 v[104:107], v[168:171], v[48:51], v[104:107]
  v_max3_u32 v42, v42, v168, v169
  v_max3_u32 v43, v43, v170, v171
  v_max_u32 v42, v42, v43
  v_cmp_eq_u32 vcc, -1, v42
  s_cbranch_vccnz L_lan_b_28
  s_nop 2
  v_cvt_pk_bf16_f32 v112, v104, v105
  v_cvt_pk_bf16_f32 v113, v106, v107
  ds_write_b64 v17, v[112:113]
  s_bitset0_b32 s50, 2
  s_branch L_lan_n_27
L_lan_b_28:
  buffer_load_dwordx4 v[164:167], v6, s[8:11], s46 offen offset:0 sc1
  buffer_load_dwordx4 v[168:171], v6, s[8:11], s46 offen offset:2048 sc1
L_lan_n_27:
  s_cmp_eq_u32 s50, 0
  s_cbranch_scc1 L_lan_back_11
  s_sub_u32 s64, s64, 1
  s_cmp_lg_u32 s64, 0
  s_cbranch_scc1 L_lan_fix_10
  s_branch L_lan_fail_2
L_lan_last_18:
  buffer_store_dword v120, v26, s[8:11], s49 offen
  s_waitcnt vmcnt(0)
  s_barrier
  s_branch L_lan_done_3
L_lan_r_22:
  s_nop 7
  v_mov_b32 v72, 0
  v_mov_b32 v73, 0
  v_mov_b32 v74, 0
  v_mov_b32 v75, 0
  v_mov_b32 v76, 0
  v_mov_b32 v77, 0
  v_mov_b32 v78, 0
  v_mov_b32 v79, 0
  s_sub_u32 s64, s64, 1
  s_cmp_lg_u32 s64, 0
  s_cbranch_scc1 L_lan_g_21
  s_branch L_lan_fail_2
L_lan_w1_5:
  v_bfe_u32 v30, v2, 0, 6
  v_mul_u32_u24 v30, 16, v30
  s_mov_b32 s60, 50331648
  s_mul_i32 s63, s35, 12288
  s_add_u32 s60, s60, s63
  s_mul_i32 s63, s36, 2048
  s_add_u32 s60, s60, s63
  v_add_u32 v30, s60, v30
  v_bfe_u32 v31, v2, 4, 2
  v_mul_u32_u24 v31, 256, v31
  v_bfe_u32 v1, v2, 0, 3
  v_mul_u32_u24 v1, 16, v1
  v_add_u32 v31, v31, v1
  s_mov_b32 s60, 0
  s_mul_i32 s63, s35, 4096
  s_add_u32 s60, s60, s63
  s_mul_i32 s63, s36, 1024
  s_add_u32 s60, s60, s63
  v_add_u32 v31, s60, v31
  v_bfe_u32 v1, v2, 3, 1
  v_cmp_eq_u32 vcc, 0, v1
  v_mov_b32 v1, 2147483632
  s_nop 0
  v_cndmask_b32 v31, v1, v31, vcc
  v_bfe_u32 v32, v2, 4, 2
  v_mul_u32_u24 v32, 256, v32
  v_bfe_u32 v1, v2, 0, 3
  v_mul_u32_u24 v1, 16, v1
  v_add_u32 v32, v32, v1
  v_bfe_u32 v1, v2, 3, 1
  v_mul_u32_u24 v1, 2048, v1
  v_add_u32 v32, v32, v1
  s_mov_b32 s60, 28672
  v_add_u32 v32, s60, v32
  v_bfe_u32 v33, v2, 4, 2
  v_mul_u32_u24 v33, 320, v33
  v_bfe_u32 v1, v2, 2, 2
  v_mul_u32_u24 v1, 40, v1
  v_add_u32 v33, v33, v1
  v_bfe_u32 v1, v2, 0, 2
  v_mul_u32_u24 v1, 8, v1
  v_add_u32 v33, v33, v1
  s_mov_b32 s60, 24576
  v_add_u32 v33, s60, v33
  v_bfe_u32 v35, v2, 0, 6
  v_mul_u32_u24 v35, 16, v35
  s_mov_b32 s60, 0
  s_mul_i32 s63, s35, 4096
  s_add_u32 s60, s60, s63
  s_mul_i32 s63, s36, 1024
  s_add_u32 s60, s60, s63
  v_add_u32 v35, s60, v35
  v_bfe_u32 v36, v2, 0, 6
  v_mul_u32_u24 v36, 16, v36
  s_mov_b32 s60, 131072
  s_mul_i32 s63, s35, 3072
  s_add_u32 s60, s60, s63
  s_mul_i32 s63, s36, 1024
  s_add_u32 s60, s60, s63
  v_add_u32 v36, s60, v36
  s_cmp_le_u32 s56, s41
  s_cbranch_scc1 L_lan_kvw_29
L_lan_kvb_30:
  buffer_load_dwordx4 v[80:83], v30, s[8:11], s48 offen offset:0 sc1
  buffer_load_dwordx4 v[84:87], v30, s[8:11], s48 offen offset:1024 sc1
  s_branch L_lan_loop_31
.p2align 6
L_lan_loop_31:
  buffer_load_dwordx4 v[132:135], v4, s[8:11], s46 offen offset:0 sc1
  s_nop 5
  buffer_load_dwordx4 v[136:139], v4, s[8:11], s46 offen offset:2048 sc1
  s_nop 5
  buffer_load_dwordx4 v[140:143], v4, s[8:11], s46 offen offset:256 sc1
  s_nop 5
  buffer_load_dwordx4 v[144:147], v4, s[8:11], s46 offen offset:2304 sc1
  s_nop 5
  buffer_load_dwordx4 v[148:151], v5, s[8:11], s46 offen offset:0 sc1
  s_nop 5
  buffer_load_dwordx4 v[152:155], v5, s[8:11], s46 offen offset:2048 sc1
  s_nop 5
  buffer_load_dwordx4 v[156:159], v5, s[8:11], s46 offen offset:256 sc1
  s_nop 5
  buffer_load_dwordx4 v[160:163], v5, s[8:11], s46 offen offset:2304 sc1
  s_nop 5
  buffer_load_dwordx4 v[164:167], v6, s[8:11], s46 offen offset:0 sc1
  s_nop 5
  buffer_load_dwordx4 v[168:171], v6, s[8:11], s46 offen offset:2048 sc1
  s_waitcnt vmcnt(9)
  v_mfma_f32_16x16x32_bf16 v[104:107], v[132:135], v[48:51], 0
  v_max3_u32 v42, v132, v133, v134
  v_mov_b32 v43, v135
  s_waitcnt vmcnt(8)
  v_mfma_f32_16x16x32_bf16 v[104:107], v[136:139], v[48:51], v[104:107]
  v_max3_u32 v42, v42, v136, v137
  v_max3_u32 v43, v43, v138, v139
  s_waitcnt vmcnt(7)
  v_mfma_f32_16x16x32_bf16 v[108:111], v[140:143], v[48:51], 0
  v_max3_u32 v42, v42, v140, v141
  v_max3_u32 v43, v43, v142, v143
  s_waitcnt vmcnt(6)
  v_mfma_f32_16x16x32_bf16 v[108:111], v[144:147], v[48:51], v[108:111]
  v_max3_u32 v42, v42, v144, v145
  v_max3_u32 v43, v43, v146, v147
  v_max_u32 v42, v42, v43
  v_cmp_eq_u32 vcc, -1, v42
  s_cbranch_vccnz L_lan_bad_35
  s_nop 2
  v_cvt_pk_bf16_f32 v124, v104, v105
  v_cvt_pk_bf16_f32 v125, v106, v107
  v_cvt_pk_bf16_f32 v126, v108, v109
  v_cvt_pk_bf16_f32 v127, v110, v111
  ds_write_b128 v7, v[124:127]
  s_nop 0
  v_smfmac_f32_16x16x64_bf16 v[60:63], v[124:127], a[0:7], v3
  v_smfmac_f32_16x16x64_bf16 v[64:67], v[124:127], a[8:15], v3
  v_smfmac_f32_16x16x64_bf16 v[68:71], v[124:127], v[176:183], v3
L_lan_skip_36:
  s_waitcnt vmcnt(5)
  v_mfma_f32_16x16x32_bf16 v[104:107], v[148:151], v[48:51], 0
  v_max3_u32 v42, v148, v149, v150
  v_mov_b32 v43, v151
  s_waitcnt vmcnt(4)
  v_mfma_f32_16x16x32_bf16 v[104:107], v[152:155], v[48:51], v[104:107]
  v_max3_u32 v42, v42, v152, v153
  v_max3_u32 v43, v43, v154, v155
  s_waitcnt vmcnt(3)
  v_mfma_f32_16x16x32_bf16 v[108:111], v[156:159], v[48:51], 0
  v_max3_u32 v42, v42, v156, v157
  v_max3_u32 v43, v43, v158, v159
  s_waitcnt vmcnt(2)
  v_mfma_f32_16x16x32_bf16 v[108:111], v[160:163], v[48:51], v[108:111]
  v_max3_u32 v42, v42, v160, v161
  v_max3_u32 v43, v43, v162, v163
  v_max_u32 v42, v42, v43
  v_cmp_eq_u32 vcc, -1, v42
  s_cbranch_vccnz L_lan_bad_37
  s_nop 2
  v_cvt_pk_bf16_f32 v128, v104, v105
  v_cvt_pk_bf16_f32 v129, v106, v107
  v_cvt_pk_bf16_f32 v130, v108, v109
  v_cvt_pk_bf16_f32 v131, v110, v111
  ds_write_b128 v8, v[128:131]
  s_nop 0
  v_smfmac_f32_16x16x64_bf16 v[60:63], v[128:131], a[16:23], v3
  v_smfmac_f32_16x16x64_bf16 v[64:67], v[128:131], a[24:31], v3
  v_smfmac_f32_16x16x64_bf16 v[68:71], v[128:131], v[184:191], v3
L_lan_skip_38:
  s_waitcnt vmcnt(1)
  v_mfma_f32_16x16x32_bf16 v[104:107], v[164:167], v[48:51], 0
  v_max3_u32 v42, v164, v165, v166
  v_mov_b32 v43, v167
  s_waitcnt vmcnt(0)
  v_mfma_f32_16x16x32_bf16 v[104:107], v[168:171], v[48:51], v[104:107]
  v_max3_u32 v42, v42, v168, v169
  v_max3_u32 v43, v43, v170, v171
  v_max_u32 v42, v42, v43
  v_cmp_eq_u32 vcc, -1, v42
  s_cbranch_vccnz L_lan_bad_39
  s_nop 2
  v_cvt_pk_bf16_f32 v112, v104, v105
  v_cvt_pk_bf16_f32 v113, v106, v107
  ds_write_b64 v17, v[112:113]
L_lan_skip_40:
  s_cmp_lg_u32 s50, 0
  s_cbranch_scc1 L_lan_fix_33
L_lan_back_34:
  s_waitcnt lgkmcnt(0)
  s_barrier
  ds_read_b128 v[132:135], v9
  ds_read_b128 v[136:139], v10
  ds_read_b128 v[140:143], v11
  s_waitcnt lgkmcnt(2)
  v_smfmac_f32_16x16x64_bf16 v[60:63], v[132:135], a[32:39], v3
  ds_read_b128 v[144:147], v12
  v_smfmac_f32_16x16x64_bf16 v[64:67], v[132:135], a[40:47], v3
  s_waitcnt lgkmcnt(2)
  v_smfmac_f32_16x16x64_bf16 v[60:63], v[136:139], a[48:55], v3
  ds_read_b128 v[148:151], v13
  v_smfmac_f32_16x16x64_bf16 v[64:67], v[136:139], a[56:63], v3
  s_waitcnt lgkmcnt(2)
  v_smfmac_f32_16x16x64_bf16 v[60:63], v[140:143], a[64:71], v3
  ds_read_b128 v[152:155], v14
  v_smfmac_f32_16x16x64_bf16 v[64:67], v[140:143], a[72:79], v3
  s_waitcnt lgkmcnt(2)
  v_smfmac_f32_16x16x64_bf16 v[60:63], v[144:147], a[80:87], v3
  ds_read_b128 v[156:159], v15
  v_smfmac_f32_16x16x64_bf16 v[64:67], v[144:147], a[88:95], v3
  s_waitcnt lgkmcnt(2)
  v_smfmac_f32_16x16x64_bf16 v[60:63], v[148:151], a[96:103], v3
  ds_read_b128 v[160:163], v16
  v_smfmac_f32_16x16x64_bf16 v[64:67], v[148:151], a[104:111], v3
  s_waitcnt lgkmcnt(2)
  v_smfmac_f32_16x16x64_bf16 v[60:63], v[152:155], a[112:119], v3
  v_smfmac_f32_16x16x64_bf16 v[64:67], v[152:155], a[120:127], v3
  s_waitcnt lgkmcnt(1)
  v_smfmac_f32_16x16x64_bf16 v[60:63], v[156:159], a[128:135], v3
  v_smfmac_f32_16x16x64_bf16 v[64:67], v[156:159], a[136:143], v3
  s_waitcnt lgkmcnt(0)
  v_smfmac_f32_16x16x64_bf16 v[60:63], v[160:163], a[144:151], v3
  v_smfmac_f32_16x16x64_bf16 v[64:67], v[160:163], a[152:159], v3
  v_smfmac_f32_16x16x64_bf16 v[68:71], v[132:135], v[192:199], v3
  s_nop 6
  v_permlane32_swap_b32 v60, v64
  v_permlane32_swap_b32 v61, v65
  v_permlane32_swap_b32 v62, v66
  v_permlane32_swap_b32 v63, v67
  v_add_f32 v60, v60, v64
  v_add_f32 v61, v61, v65
  v_add_f32 v62, v62, v66
  v_add_f32 v63, v63, v67
  v_cvt_pk_bf16_f32 v112, v60, v61
  v_cvt_pk_bf16_f32 v113, v62, v63
  ds_write_b64 v24, v[112:113]
  v_smfmac_f32_16x16x64_bf16 v[68:71], v[136:139], v[200:207], v3
  v_smfmac_f32_16x16x64_bf16 v[68:71], v[140:143], v[208:215], v3
  v_smfmac_f32_16x16x64_bf16 v[68:71], v[144:147], v[216:223], v3
  s_waitcnt lgkmcnt(0)
  s_barrier
  ds_read_b64_tr_b16 v[96:97], v33 offset:0
  ds_read_b64_tr_b16 v[98:99], v33 offset:160
  ds_read_b64_tr_b16 v[100:101], v33 offset:1280
  ds_read_b64_tr_b16 v[102:103], v33 offset:1440
  v_smfmac_f32_16x16x64_bf16 v[68:71], v[148:151], v[224:231], v3
  v_smfmac_f32_16x16x64_bf16 v[68:71], v[152:155], v[232:239], v3
  s_waitcnt lgkmcnt(2)
  v_mfma_f32_16x16x32_bf16 v[116:119], v[80:83], v[96:99], 0
  s_waitcnt lgkmcnt(0)
  v_mfma_f32_16x16x32_bf16 v[116:119], v[84:87], v[100:103], v[116:119]
  s_nop 7
  buffer_store_dwordx4 v[116:119], v31, s[8:11], s42 offen
  ds_write_b128 v32, v[116:119]
  v_smfmac_f32_16x16x64_bf16 v[68:71], v[156:159], v[240:247], v3
  v_smfmac_f32_16x16x64_bf16 v[68:71], v[160:163], v[248:255], v3
  v_mov_b32 v60, 0
  v_mov_b32 v61, 0
  v_mov_b32 v62, 0
  v_mov_b32 v63, 0
  v_mov_b32 v64, 0
  v_mov_b32 v65, 0
  v_mov_b32 v66, 0
  v_mov_b32 v67, 0
  s_waitcnt lgkmcnt(0)
  s_barrier
  v_permlane32_swap_b32 v68, v70
  v_permlane32_swap_b32 v69, v71
  v_add_f32 v68, v68, v70
  v_add_f32 v69, v69, v71
  v_cvt_pk_bf16_f32 v120, v68, v69
  ds_write_b32 v25, v120
  s_cmp_eq_u32 s41, 63
  s_cbranch_scc1 L_lan_last_41
  s_waitcnt lgkmcnt(0)
  s_barrier
  v_mov_b32 v68, 0
  v_mov_b32 v69, 0
  v_mov_b32 v70, 0
  v_mov_b32 v71, 0
  buffer_store_dword v120, v26, s[8:11], s49 offen
  buffer_store_dwordx4 v[44:47], v35, s[8:11], s44 offen
  buffer_store_dwordx4 v[44:47], v36, s[8:11], s44 offen
  s_barrier
L_lan_g_42:
  buffer_load_dwordx4 v[140:143], v18, s[8:11], s42 offen sc1
  s_nop 7
  buffer_load_dwordx4 v[144:147], v19, s[8:11], s42 offen sc1
  s_nop 7
  buffer_load_dwordx4 v[148:151], v20, s[8:11], s42 offen sc1
  s_nop 7
  buffer_load_dwordx4 v[152:155], v21, s[8:11], s42 offen sc1
  s_nop 7
  buffer_load_dwordx4 v[156:159], v22, s[8:11], s42 offen sc1
  s_nop 7
  buffer_load_dwordx4 v[160:163], v23, s[8:11], s42 offen sc1
  s_waitcnt vmcnt(5)
  v_smfmac_f32_16x16x64_bf16 v[72:75], v[140:143], a[160:167], v3
  v_smfmac_f32_16x16x64_bf16 v[76:79], v[140:143], a[168:175], v3
  v_max3_u32 v42, v140, v141, v142
  v_mov_b32 v43, v143
  s_waitcnt vmcnt(4)
  v_smfmac_f32_16x16x64_bf16 v[72:75], v[144:147], a[176:183], v3
  v_smfmac_f32_16x16x64_bf16 v[76:79], v[144:147], a[184:191], v3
  v_max3_u32 v42, v42, v144, v145
  v_max3_u32 v43, v43, v146, v147
  s_waitcnt vmcnt(3)
  v_smfmac_f32_16x16x64_bf16 v[72:75], v[148:151], a[192:199], v3
  v_smfmac_f32_16x16x64_bf16 v[76:79], v[148:151], a[200:207], v3
  v_max3_u32 v42, v42, v148, v149
  v_max3_u32 v43, v43, v150, v151
  s_waitcnt vmcnt(2)
  v_smfmac_f32_16x16x64_bf16 v[72:75], v[152:155], a[208:215], v3
  v_smfmac_f32_16x16x64_bf16 v[76:79], v[152:155], a[216:223], v3
  v_max3_u32 v42, v42, v152, v153
  v_max3_u32 v43, v43, v154, v155
  s_waitcnt vmcnt(1)
  v_smfmac_f32_16x16x64_bf16 v[72:75], v[156:159], a[224:231], v3
  v_smfmac_f32_16x16x64_bf16 v[76:79], v[156:159], a[232:239], v3
  v_max3_u32 v42, v42, v156, v157
  v_max3_u32 v43, v43, v158, v159
  s_waitcnt vmcnt(0)
  v_smfmac_f32_16x16x64_bf16 v[72:75], v[160:163], a[240:247], v3
  v_smfmac_f32_16x16x64_bf16 v[76:79], v[160:163], a[248:255], v3
  v_max3_u32 v42, v42, v160, v161
  v_max3_u32 v43, v43, v162, v163
  v_max_u32 v42, v42, v43
  v_cmp_eq_u32 vcc, -1, v42
  s_add_u32 s60, s41, 1
  s_lshr_b32 s61, s60, 4
  s_xor_b32 s61, s61, s6
  s_cbranch_vccnz L_lan_r_43
  v_permlane32_swap_b32 v72, v76
  v_permlane32_swap_b32 v73, v77
  v_permlane32_swap_b32 v74, v78
  v_permlane32_swap_b32 v75, v79
  v_add_f32 v116, v72, v76
  v_add_f32 v117, v73, v77
  v_add_f32 v118, v74, v78
  v_add_f32 v119, v75, v79
  ds_write_b128 v28, v[116:119]
  s_and_b32 s61, s61, 1
  s_lshl_b32 s61, s61, 13
  s_mov_b32 s41, s60
  s_lshl_b32 s60, s60, 17
  s_add_u32 s60, s60, s61
  s_add_u32 s46, s60, s47
  s_add_u32 s48, s48, 393216
  s_mov_b32 s64, 400000
  s_waitcnt lgkmcnt(0)
  s_barrier
  s_load_dword s72, s[70:71], 0 glc
  s_load_dword s73, s[70:71], 64 glc
  s_load_dword s74, s[70:71], 128 glc
  v_mov_b32 v72, 0
  v_mov_b32 v73, 0
  v_mov_b32 v74, 0
  v_mov_b32 v75, 0
  v_mov_b32 v76, 0
  v_mov_b32 v77, 0
  v_mov_b32 v78, 0
  v_mov_b32 v79, 0
  s_mov_b32 s60, s42
  s_mov_b32 s42, s43
  s_mov_b32 s43, s44
  s_mov_b32 s44, s45
  s_mov_b32 s45, s60
  s_add_u32 s49, s49, 98304
  s_cmp_le_u32 s56, s41
  s_cbranch_scc1 L_lan_kvw_44
L_lan_kvb_45:
  buffer_load_dwordx4 v[80:83], v30, s[8:11], s48 offen offset:0 sc1
  buffer_load_dwordx4 v[84:87], v30, s[8:11], s48 offen offset:1024 sc1
L_lan_xs_46:
  s_load_dword s72, s[70:71], 0 glc
  s_load_dword s73, s[70:71], 64 glc
  s_load_dword s74, s[70:71], 128 glc
  s_min_u32 s60, s72, s73
  s_min_u32 s60, s60, s74
  s_cmp_ge_u32 s60, s52
  s_cbranch_scc1 L_lan_xd_47
  s_min_u32 s60, s72, s73
  s_min_u32 s60, s60, s74
  s_cmp_ge_u32 s60, s52
  s_cbranch_scc1 L_lan_xd_47
  s_min_u32 s60, s72, s73
  s_min_u32 s60, s60, s74
  s_cmp_ge_u32 s60, s52
  s_cbranch_scc1 L_lan_xd_47
  s_min_u32 s60, s72, s73
  s_min_u32 s60, s60, s74
  s_cmp_ge_u32 s60, s52
  s_cbranch_scc1 L_lan_xd_47
  s_waitcnt lgkmcnt(12)
  s_sub_u32 s64, s64, 1
  s_cmp_lg_u32 s64, 0
  s_cbranch_scc1 L_lan_xs_46
  s_branch L_lan_fail_2
L_lan_xd_47:
  v_add_u32 v27, 1, v27
  s_add_u32 s52, s52, 1
  s_barrier
  s_branch L_lan_loop_31
L_lan_kvw_29:
  s_load_dwordx4 s[88:91], s[100:101], 0 glc
  s_waitcnt lgkmcnt(0)
  s_min_u32 s56, s88, s89
  s_min_u32 s56, s56, s90
  s_cmp_gt_u32 s56, s41
  s_cbranch_scc1 L_lan_kvb_30
  s_sub_u32 s64, s64, 1
  s_cmp_lg_u32 s64, 0
  s_cbranch_scc1 L_lan_kvw_29
  s_branch L_lan_fail_2
L_lan_bad_35:
  buffer_load_dwordx4 v[132:135], v4, s[8:11], s46 offen offset:0 sc1
  buffer_load_dwordx4 v[136:139], v4, s[8:11], s46 offen offset:2048 sc1
  buffer_load_dwordx4 v[140:143], v4, s[8:11], s46 offen offset:256 sc1
  buffer_load_dwordx4 v[144:147], v4, s[8:11], s46 offen offset:2304 sc1
  s_bitset1_b32 s50, 0
  s_branch L_lan_skip_36
L_lan_bad_37:
  buffer_load_dwordx4 v[148:151], v5, s[8:11], s46 offen offset:0 sc1
  buffer_load_dwordx4 v[152:155], v5, s[8:11], s46 offen offset:2048 sc1
  buffer_load_dwordx4 v[156:159], v5, s[8:11], s46 offen offset:256 sc1
  buffer_load_dwordx4 v[160:163], v5, s[8:11], s46 offen offset:2304 sc1
  s_bitset1_b32 s50, 1
  s_branch L_lan_skip_38
L_lan_bad_39:
  buffer_load_dwordx4 v[164:167], v6, s[8:11], s46 offen offset:0 sc1
  buffer_load_dwordx4 v[168:171], v6, s[8:11], s46 offen offset:2048 sc1
  s_bitset1_b32 s50, 2
  s_branch L_lan_skip_40
L_lan_fix_33:
  s_waitcnt vmcnt(0)
  s_bitcmp1_b32 s50, 0
  s_cbranch_scc0 L_lan_n_48
  v_mfma_f32_16x16x32_bf16 v[104:107], v[132:135], v[48:51], 0
  v_max3_u32 v42, v132, v133, v134
  v_mov_b32 v43, v135
  v_mfma_f32_16x16x32_bf16 v[104:107], v[136:139], v[48:51], v[104:107]
  v_max3_u32 v42, v42, v136, v137
  v_max3_u32 v43, v43, v138, v139
  v_mfma_f32_16x16x32_bf16 v[108:111], v[140:143], v[48:51], 0
  v_max3_u32 v42, v42, v140, v141
  v_max3_u32 v43, v43, v142, v143
  v_mfma_f32_16x16x32_bf16 v[108:111], v[144:147], v[48:51], v[108:111]
  v_max3_u32 v42, v42, v144, v145
  v_max3_u32 v43, v43, v146, v147
  v_max_u32 v42, v42, v43
  v_cmp_eq_u32 vcc, -1, v42
  s_cbranch_vccnz L_lan_b_49
  s_nop 2
  v_cvt_pk_bf16_f32 v124, v104, v105
  v_cvt_pk_bf16_f32 v125, v106, v107
  v_cvt_pk_bf16_f32 v126, v108, v109
  v_cvt_pk_bf16_f32 v127, v110, v111
  ds_write_b128 v7, v[124:127]
  s_nop 0
  v_smfmac_f32_16x16x64_bf16 v[60:63], v[124:127], a[0:7], v3
  v_smfmac_f32_16x16x64_bf16 v[64:67], v[124:127], a[8:15], v3
  v_smfmac_f32_16x16x64_bf16 v[68:71], v[124:127], v[176:183], v3
  s_bitset0_b32 s50, 0
  s_branch L_lan_n_48
L_lan_b_49:
  buffer_load_dwordx4 v[132:135], v4, s[8:11], s46 offen offset:0 sc1
  buffer_load_dwordx4 v[136:139], v4, s[8:11], s46 offen offset:2048 sc1
  buffer_load_dwordx4 v[140:143], v4, s[8:11], s46 offen offset:256 sc1
  buffer_load_dwordx4 v[144:147], v4, s[8:11], s46 offen offset:2304 sc1
L_lan_n_48:
  s_bitcmp1_b32 s50, 1
  s_cbranch_scc0 L_lan_n_50
  v_mfma_f32_16x16x32_bf16 v[104:107], v[148:151], v[48:51], 0
  v_max3_u32 v42, v148, v149, v150
  v_mov_b32 v43, v151
  v_mfma_f32_16x16x32_bf16 v[104:107], v[152:155], v[48:51], v[104:107]
  v_max3_u32 v42, v42, v152, v153
  v_max3_u32 v43, v43, v154, v155
  v_mfma_f32_16x16x32_bf16 v[108:111], v[156:159], v[48:51], 0
  v_max3_u32 v42, v42, v156, v157
  v_max3_u32 v43, v43, v158, v159
  v_mfma_f32_16x16x32_bf16 v[108:111], v[160:163], v[48:51], v[108:111]
  v_max3_u32 v42, v42, v160, v161
  v_max3_u32 v43, v43, v162, v163
  v_max_u32 v42, v42, v43
  v_cmp_eq_u32 vcc, -1, v42
  s_cbranch_vccnz L_lan_b_51
  s_nop 2
  v_cvt_pk_bf16_f32 v128, v104, v105
  v_cvt_pk_bf16_f32 v129, v106, v107
  v_cvt_pk_bf16_f32 v130, v108, v109
  v_cvt_pk_bf16_f32 v131, v110, v111
  ds_write_b128 v8, v[128:131]
  s_nop 0
  v_smfmac_f32_16x16x64_bf16 v[60:63], v[128:131], a[16:23], v3
  v_smfmac_f32_16x16x64_bf16 v[64:67], v[128:131], a[24:31], v3
  v_smfmac_f32_16x16x64_bf16 v[68:71], v[128:131], v[184:191], v3
  s_bitset0_b32 s50, 1
  s_branch L_lan_n_50
L_lan_b_51:
  buffer_load_dwordx4 v[148:151], v5, s[8:11], s46 offen offset:0 sc1
  buffer_load_dwordx4 v[152:155], v5, s[8:11], s46 offen offset:2048 sc1
  buffer_load_dwordx4 v[156:159], v5, s[8:11], s46 offen offset:256 sc1
  buffer_load_dwordx4 v[160:163], v5, s[8:11], s46 offen offset:2304 sc1
L_lan_n_50:
  s_bitcmp1_b32 s50, 2
  s_cbranch_scc0 L_lan_n_52
  v_mfma_f32_16x16x32_bf16 v[104:107], v[164:167], v[48:51], 0
  v_max3_u32 v42, v164, v165, v166
  v_mov_b32 v43, v167
  v_mfma_f32_16x16x32_bf16 v[104:107], v[168:171], v[48:51], v[104:107]
  v_max3_u32 v42, v42, v168, v169
  v_max3_u32 v43, v43, v170, v171
  v_max_u32 v42, v42, v43
  v_cmp_eq_u32 vcc, -1, v42
  s_cbranch_vccnz L_lan_b_53
  s_nop 2
  v_cvt_pk_bf16_f32 v112, v104, v105
  v_cvt_pk_bf16_f32 v113, v106, v107
  ds_write_b64 v17, v[112:113]
  s_bitset0_b32 s50, 2
  s_branch L_lan_n_52
L_lan_b_53:
  buffer_load_dwordx4 v[164:167], v6, s[8:11], s46 offen offset:0 sc1
  buffer_load_dwordx4 v[168:171], v6, s[8:11], s46 offen offset:2048 sc1
L_lan_n_52:
  s_cmp_eq_u32 s50, 0
  s_cbranch_scc1 L_lan_back_34
  s_sub_u32 s64, s64, 1
  s_cmp_lg_u32 s64, 0
  s_cbranch_scc1 L_lan_fix_33
  s_branch L_lan_fail_2
L_lan_last_41:
  buffer_store_dword v120, v26, s[8:11], s49 offen
  s_waitcnt vmcnt(0)
  s_barrier
  s_branch L_lan_done_3
L_lan_r_43:
  s_nop 7
  v_mov_b32 v72, 0
  v_mov_b32 v73, 0
  v_mov_b32 v74, 0
  v_mov_b32 v75, 0
  v_mov_b32 v76, 0
  v_mov_b32 v77, 0
  v_mov_b32 v78, 0
  v_mov_b32 v79, 0
  s_sub_u32 s64, s64, 1
  s_cmp_lg_u32 s64, 0
  s_cbranch_scc1 L_lan_g_42
  s_branch L_lan_fail_2
L_lan_kvw_44:
  s_load_dwordx4 s[88:91], s[100:101], 0 glc
  s_waitcnt lgkmcnt(0)
  s_min_u32 s56, s88, s89
  s_min_u32 s56, s56, s90
  s_cmp_gt_u32 s56, s41
  s_cbranch_scc1 L_lan_kvb_45
  s_sub_u32 s64, s64, 1
  s_cmp_lg_u32 s64, 0
  s_cbranch_scc1 L_lan_kvw_44
  s_branch L_lan_fail_2
L_lan_w2_6:
  v_bfe_u32 v30, v2, 0, 6
  v_mul_u32_u24 v30, 16, v30
  s_mov_b32 s60, 50337792
  s_mul_i32 s63, s35, 12288
  s_add_u32 s60, s60, s63
  s_mul_i32 s63, s36, 2048
  s_add_u32 s60, s60, s63
  v_add_u32 v30, s60, v30
  v_bfe_u32 v31, v2, 4, 2
  v_mul_u32_u24 v31, 256, v31
  v_bfe_u32 v1, v2, 0, 3
  v_mul_u32_u24 v1, 16, v1
  v_add_u32 v31, v31, v1
  s_mov_b32 s60, 128
  s_mul_i32 s63, s35, 4096
  s_add_u32 s60, s60, s63
  s_mul_i32 s63, s36, 1024
  s_add_u32 s60, s60, s63
  v_add_u32 v31, s60, v31
  v_bfe_u32 v1, v2, 3, 1
  v_cmp_eq_u32 vcc, 0, v1
  v_mov_b32 v1, 2147483632
  s_nop 0
  v_cndmask_b32 v31, v1, v31, vcc
  v_bfe_u32 v32, v2, 4, 2
  v_mul_u32_u24 v32, 256, v32
  v_bfe_u32 v1, v2, 0, 3
  v_mul_u32_u24 v1, 16, v1
  v_add_u32 v32, v32, v1
  v_bfe_u32 v1, v2, 3, 1
  v_mul_u32_u24 v1, 2048, v1
  v_add_u32 v32, v32, v1
  s_mov_b32 s60, 28800
  v_add_u32 v32, s60, v32
  v_bfe_u32 v33, v2, 4, 2
  v_mul_u32_u24 v33, 320, v33
  v_bfe_u32 v1, v2, 2, 2
  v_mul_u32_u24 v1, 40, v1
  v_add_u32 v33, v33, v1
  v_bfe_u32 v1, v2, 0, 2
  v_mul_u32_u24 v1, 8, v1
  v_add_u32 v33, v33, v1
  s_mov_b32 s60, 24576
  v_add_u32 v33, s60, v33
  v_bfe_u32 v37, v2, 0, 6
  v_mul_u32_u24 v37, 4, v37
  s_mov_b32 s60, 3072
  s_mul_i32 s63, s35, 4096
  s_add_u32 s60, s60, s63
  s_mul_i32 s63, s36, 256
  s_add_u32 s60, s60, s63
  v_add_u32 v37, s60, v37
  v_bfe_u32 v38, v2, 0, 6
  v_mul_u32_u24 v38, 4, v38
  s_mov_b32 s60, 4096
  s_mul_i32 s63, s35, 128
  s_add_u32 s60, s60, s63
  s_mul_i32 s63, s36, 4
  s_add_u32 s60, s60, s63
  s_mul_i32 s63, s65, 131072
  s_add_u32 s60, s60, s63
  v_add_u32 v38, s60, v38
  v_cmp_gt_u32 vcc, 1, v2
  v_mov_b32 v1, 2147483632
  s_nop 0
  v_cndmask_b32 v38, v1, v38, vcc
  v_bfe_u32 v35, v2, 0, 3
  v_mul_u32_u24 v35, 64, v35
  v_bfe_u32 v1, v2, 4, 2
  v_mul_u32_u24 v1, 16, v1
  v_add_u32 v35, v35, v1
  s_mov_b32 s60, 33554432
  s_mul_i32 s63, s35, 3072
  s_add_u32 s60, s60, s63
  s_mul_i32 s63, s36, 1024
  s_add_u32 s60, s60, s63
  v_add_u32 v35, s60, v35
  v_bfe_u32 v1, v2, 3, 1
  v_cmp_eq_u32 vcc, 1, v1
  v_mov_b32 v1, 2147483632
  s_nop 0
  v_cndmask_b32 v35, v1, v35, vcc
  v_add_u32 v36, s37, v2
  v_add_u32 v36, 1, v36
  v_and_b32 v36, 3, v36
  v_mul_u32_u24 v36, 131072, v36
  v_lshl_add_u32 v36, v2, 6, v36
  s_mov_b32 s60, 218202112
  s_mul_i32 s63, s6, 8192
  s_add_u32 s60, s60, s63
  s_mul_i32 s63, s34, 256
  s_add_u32 s60, s60, s63
  s_mul_i32 s63, s65, 16384
  s_add_u32 s60, s60, s63
  v_add_u32 v36, s60, v36
  v_cmp_gt_u32 vcc, 3, v2
  v_mov_b32 v1, 2147483632
  s_nop 0
  v_cndmask_b32 v36, v1, v36, vcc
  v_add_u32 v34, s36, v2
  v_add_u32 v34, 1, v34
  v_subrev_u32 v1, 3, v34
  v_min_u32 v34, v34, v1
  v_lshlrev_b32 v34, 7, v34
  v_lshl_add_u32 v34, v2, 2, v34
  s_mov_b32 s60, 98304
  s_mul_i32 s63, s35, 384
  s_add_u32 s60, s60, s63
  s_mul_i32 s63, s65, 131072
  s_add_u32 s60, s60, s63
  v_add_u32 v34, s60, v34
  v_cmp_gt_u32 vcc, 2, v2
  v_mov_b32 v1, 2147483632
  s_nop 0
  v_cndmask_b32 v34, v1, v34, vcc
  s_cmp_le_u32 s56, s41
  s_cbranch_scc1 L_lan_kvw_54
L_lan_kvb_55:
  buffer_load_dwordx4 v[80:83], v30, s[8:11], s48 offen offset:0 sc1
  buffer_load_dwordx4 v[84:87], v30, s[8:11], s48 offen offset:1024 sc1
  s_branch L_lan_loop_56
.p2align 6
L_lan_loop_56:
  buffer_load_dwordx4 v[132:135], v4, s[8:11], s46 offen offset:0 sc1
  s_nop 5
  buffer_load_dwordx4 v[136:139], v4, s[8:11], s46 offen offset:2048 sc1
  s_nop 5
  buffer_load_dwordx4 v[140:143], v4, s[8:11], s46 offen offset:256 sc1
  s_nop 5
  buffer_load_dwordx4 v[144:147], v4, s[8:11], s46 offen offset:2304 sc1
  s_nop 5
  buffer_load_dwordx4 v[148:151], v5, s[8:11], s46 offen offset:0 sc1
  s_nop 5
  buffer_load_dwordx4 v[152:155], v5, s[8:11], s46 offen offset:2048 sc1
  s_nop 5
  buffer_load_dwordx4 v[156:159], v5, s[8:11], s46 offen offset:256 sc1
  s_nop 5
  buffer_load_dwordx4 v[160:163], v5, s[8:11], s46 offen offset:2304 sc1
  s_nop 5
  buffer_load_dwordx4 v[164:167], v6, s[8:11], s46 offen offset:0 sc1
  s_nop 5
  buffer_load_dwordx4 v[168:171], v6, s[8:11], s46 offen offset:2048 sc1
  s_waitcnt vmcnt(9)
  v_mfma_f32_16x16x32_bf16 v[104:107], v[132:135], v[48:51], 0
  v_max3_u32 v42, v132, v133, v134
  v_mov_b32 v43, v135
  s_waitcnt vmcnt(8)
  v_mfma_f32_16x16x32_bf16 v[104:107], v[136:139], v[48:51], v[104:107]
  v_max3_u32 v42, v42, v136, v137
  v_max3_u32 v43, v43, v138, v139
  s_waitcnt vmcnt(7)
  v_mfma_f32_16x16x32_bf16 v[108:111], v[140:143], v[48:51], 0
  v_max3_u32 v42, v42, v140, v141
  v_max3_u32 v43, v43, v142, v143
  s_waitcnt vmcnt(6)
  v_mfma_f32_16x16x32_bf16 v[108:111], v[144:147], v[48:51], v[108:111]
  v_max3_u32 v42, v42, v144, v145
  v_max3_u32 v43, v43, v146, v147
  v_max_u32 v42, v42, v43
  v_cmp_eq_u32 vcc, -1, v42
  s_cbranch_vccnz L_lan_bad_60
  s_nop 2
  v_cvt_pk_bf16_f32 v124, v104, v105
  v_cvt_pk_bf16_f32 v125, v106, v107
  v_cvt_pk_bf16_f32 v126, v108, v109
  v_cvt_pk_bf16_f32 v127, v110, v111
  ds_write_b128 v7, v[124:127]
  s_nop 0
  v_smfmac_f32_16x16x64_bf16 v[60:63], v[124:127], a[0:7], v3
  v_smfmac_f32_16x16x64_bf16 v[64:67], v[124:127], a[8:15], v3
  v_smfmac_f32_16x16x64_bf16 v[68:71], v[124:127], v[176:183], v3
L_lan_skip_61:
  s_waitcnt vmcnt(5)
  v_mfma_f32_16x16x32_bf16 v[104:107], v[148:151], v[48:51], 0
  v_max3_u32 v42, v148, v149, v150
  v_mov_b32 v43, v151
  s_waitcnt vmcnt(4)
  v_mfma_f32_16x16x32_bf16 v[104:107], v[152:155], v[48:51], v[104:107]
  v_max3_u32 v42, v42, v152, v153
  v_max3_u32 v43, v43, v154, v155
  s_waitcnt vmcnt(3)
  v_mfma_f32_16x16x32_bf16 v[108:111], v[156:159], v[48:51], 0
  v_max3_u32 v42, v42, v156, v157
  v_max3_u32 v43, v43, v158, v159
  s_waitcnt vmcnt(2)
  v_mfma_f32_16x16x32_bf16 v[108:111], v[160:163], v[48:51], v[108:111]
  v_max3_u32 v42, v42, v160, v161
  v_max3_u32 v43, v43, v162, v163
  v_max_u32 v42, v42, v43
  v_cmp_eq_u32 vcc, -1, v42
  s_cbranch_vccnz L_lan_bad_62
  s_nop 2
  v_cvt_pk_bf16_f32 v128, v104, v105
  v_cvt_pk_bf16_f32 v129, v106, v107
  v_cvt_pk_bf16_f32 v130, v108, v109
  v_cvt_pk_bf16_f32 v131, v110, v111
  ds_write_b128 v8, v[128:131]
  s_nop 0
  v_smfmac_f32_16x16x64_bf16 v[60:63], v[128:131], a[16:23], v3
  v_smfmac_f32_16x16x64_bf16 v[64:67], v[128:131], a[24:31], v3
  v_smfmac_f32_16x16x64_bf16 v[68:71], v[128:131], v[184:191], v3
L_lan_skip_63:
  s_waitcnt vmcnt(1)
  v_mfma_f32_16x16x32_bf16 v[104:107], v[164:167], v[48:51], 0
  v_max3_u32 v42, v164, v165, v166
  v_mov_b32 v43, v167
  s_waitcnt vmcnt(0)
  v_mfma_f32_16x16x32_bf16 v[104:107], v[168:171], v[48:51], v[104:107]
  v_max3_u32 v42, v42, v168, v169
  v_max3_u32 v43, v43, v170, v171
  v_max_u32 v42, v42, v43
  v_cmp_eq_u32 vcc, -1, v42
  s_cbranch_vccnz L_lan_bad_64
  s_nop 2
  v_cvt_pk_bf16_f32 v112, v104, v105
  v_cvt_pk_bf16_f32 v113, v106, v107
  ds_write_b64 v17, v[112:113]
L_lan_skip_65:
  s_cmp_lg_u32 s50, 0
  s_cbranch_scc1 L_lan_fix_58
L_lan_back_59:
  s_waitcnt lgkmcnt(0)
  s_barrier
  ds_read_b128 v[132:135], v9
  ds_read_b128 v[136:139], v10
  ds_read_b128 v[140:143], v11
  s_waitcnt lgkmcnt(2)
  v_smfmac_f32_16x16x64_bf16 v[60:63], v[132:135], a[32:39], v3
  ds_read_b128 v[144:147], v12
  v_smfmac_f32_16x16x64_bf16 v[64:67], v[132:135], a[40:47], v3
  v_add_u32 v114, -1, v27
  s_waitcnt lgkmcnt(2)
  v_smfmac_f32_16x16x64_bf16 v[60:63], v[136:139], a[48:55], v3
  ds_read_b128 v[148:151], v13
  v_smfmac_f32_16x16x64_bf16 v[64:67], v[136:139], a[56:63], v3
  buffer_store_dword v114, v38, s[8:11], 0 offen
  s_waitcnt lgkmcnt(2)
  v_smfmac_f32_16x16x64_bf16 v[60:63], v[140:143], a[64:71], v3
  ds_read_b128 v[152:155], v14
  v_smfmac_f32_16x16x64_bf16 v[64:67], v[140:143], a[72:79], v3
  s_waitcnt lgkmcnt(2)
  v_smfmac_f32_16x16x64_bf16 v[60:63], v[144:147], a[80:87], v3
  ds_read_b128 v[156:159], v15
  v_smfmac_f32_16x16x64_bf16 v[64:67], v[144:147], a[88:95], v3
  s_waitcnt lgkmcnt(2)
  v_smfmac_f32_16x16x64_bf16 v[60:63], v[148:151], a[96:103], v3
  ds_read_b128 v[160:163], v16
  v_smfmac_f32_16x16x64_bf16 v[64:67], v[148:151], a[104:111], v3
  s_waitcnt lgkmcnt(2)
  v_smfmac_f32_16x16x64_bf16 v[60:63], v[152:155], a[112:119], v3
  v_smfmac_f32_16x16x64_bf16 v[64:67], v[152:155], a[120:127], v3
  s_waitcnt lgkmcnt(1)
  v_smfmac_f32_16x16x64_bf16 v[60:63], v[156:159], a[128:135], v3
  v_smfmac_f32_16x16x64_bf16 v[64:67], v[156:159], a[136:143], v3
  s_waitcnt lgkmcnt(0)
  v_smfmac_f32_16x16x64_bf16 v[60:63], v[160:163], a[144:151], v3
  v_smfmac_f32_16x16x64_bf16 v[64:67], v[160:163], a[152:159], v3
  v_smfmac_f32_16x16x64_bf16 v[68:71], v[132:135], v[192:199], v3
  s_nop 6
  v_permlane32_swap_b32 v60, v64
  v_permlane32_swap_b32 v61, v65
  v_permlane32_swap_b32 v62, v66
  v_permlane32_swap_b32 v63, v67
  v_add_f32 v60, v60, v64
  v_add_f32 v61, v61, v65
  v_add_f32 v62, v62, v66
  v_add_f32 v63, v63, v67
  v_cvt_pk_bf16_f32 v112, v60, v61
  v_cvt_pk_bf16_f32 v113, v62, v63
  ds_write_b64 v24, v[112:113]
  buffer_store_dword v27, v34, s[8:11], 0 offen
  v_smfmac_f32_16x16x64_bf16 v[68:71], v[136:139], v[200:207], v3
  v_smfmac_f32_16x16x64_bf16 v[68:71], v[140:143], v[208:215], v3
  v_smfmac_f32_16x16x64_bf16 v[68:71], v[144:147], v[216:223], v3
  s_waitcnt lgkmcnt(0)
  s_barrier
  ds_read_b64_tr_b16 v[96:97], v33 offset:0
  ds_read_b64_tr_b16 v[98:99], v33 offset:160
  ds_read_b64_tr_b16 v[100:101], v33 offset:1280
  ds_read_b64_tr_b16 v[102:103], v33 offset:1440
  v_smfmac_f32_16x16x64_bf16 v[68:71], v[148:151], v[224:231], v3
  v_smfmac_f32_16x16x64_bf16 v[68:71], v[152:155], v[232:239], v3
  s_waitcnt lgkmcnt(2)
  v_mfma_f32_16x16x32_bf16 v[116:119], v[80:83], v[96:99], 0
  s_waitcnt lgkmcnt(0)
  v_mfma_f32_16x16x32_bf16 v[116:119], v[84:87], v[100:103], v[116:119]
  s_nop 7
  buffer_store_dwordx4 v[116:119], v31, s[8:11], s42 offen
  ds_write_b128 v32, v[116:119]
  v_smfmac_f32_16x16x64_bf16 v[68:71], v[156:159], v[240:247], v3
  v_smfmac_f32_16x16x64_bf16 v[68:71], v[160:163], v[248:255], v3
  v_mov_b32 v60, 0
  v_mov_b32 v61, 0
  v_mov_b32 v62, 0
  v_mov_b32 v63, 0
  v_mov_b32 v64, 0
  v_mov_b32 v65, 0
  v_mov_b32 v66, 0
  v_mov_b32 v67, 0
  s_waitcnt lgkmcnt(0)
  s_barrier
  v_permlane32_swap_b32 v68, v70
  v_permlane32_swap_b32 v69, v71
  v_add_f32 v68, v68, v70
  v_add_f32 v69, v69, v71
  v_cvt_pk_bf16_f32 v120, v68, v69
  v_cvt_pk_bf16_f32 v121, v69, v68
  ds_write_b32 v25, v121
  s_cmp_eq_u32 s41, 63
  s_cbranch_scc1 L_lan_last_66
  s_waitcnt lgkmcnt(0)
  s_barrier
  v_mov_b32 v68, 0
  v_mov_b32 v69, 0
  v_mov_b32 v70, 0
  v_mov_b32 v71, 0
  buffer_store_dword v120, v26, s[8:11], s49 offen
  buffer_store_dwordx4 v[96:99], v35, s[8:11], s49 offen offset:0
  buffer_store_dwordx4 v[100:103], v35, s[8:11], s49 offen offset:512
  buffer_store_dword v44, v37, s[8:11], s44 offen
  s_barrier
L_lan_g_67:
  buffer_load_dwordx4 v[140:143], v18, s[8:11], s42 offen sc1
  s_nop 7
  buffer_load_dwordx4 v[144:147], v19, s[8:11], s42 offen sc1
  s_nop 7
  buffer_load_dwordx4 v[148:151], v20, s[8:11], s42 offen sc1
  s_nop 7
  buffer_load_dwordx4 v[152:155], v21, s[8:11], s42 offen sc1
  s_nop 7
  buffer_load_dwordx4 v[156:159], v22, s[8:11], s42 offen sc1
  s_nop 7
  buffer_load_dwordx4 v[160:163], v23, s[8:11], s42 offen sc1
  s_waitcnt vmcnt(5)
  v_smfmac_f32_16x16x64_bf16 v[72:75], v[140:143], a[160:167], v3
  v_smfmac_f32_16x16x64_bf16 v[76:79], v[140:143], a[168:175], v3
  v_max3_u32 v42, v140, v141, v142
  v_mov_b32 v43, v143
  s_waitcnt vmcnt(4)
  v_smfmac_f32_16x16x64_bf16 v[72:75], v[144:147], a[176:183], v3
  v_smfmac_f32_16x16x64_bf16 v[76:79], v[144:147], a[184:191], v3
  v_max3_u32 v42, v42, v144, v145
  v_max3_u32 v43, v43, v146, v147
  s_waitcnt vmcnt(3)
  v_smfmac_f32_16x16x64_bf16 v[72:75], v[148:151], a[192:199], v3
  v_smfmac_f32_16x16x64_bf16 v[76:79], v[148:151], a[200:207], v3
  v_max3_u32 v42, v42, v148, v149
  v_max3_u32 v43, v43, v150, v151
  s_waitcnt vmcnt(2)
  v_smfmac_f32_16x16x64_bf16 v[72:75], v[152:155], a[208:215], v3
  v_smfmac_f32_16x16x64_bf16 v[76:79], v[152:155], a[216:223], v3
  v_max3_u32 v42, v42, v152, v153
  v_max3_u32 v43, v43, v154, v155
  s_waitcnt vmcnt(1)
  v_smfmac_f32_16x16x64_bf16 v[72:75], v[156:159], a[224:231], v3
  v_smfmac_f32_16x16x64_bf16 v[76:79], v[156:159], a[232:239], v3
  v_max3_u32 v42, v42, v156, v157
  v_max3_u32 v43, v43, v158, v159
  s_waitcnt vmcnt(0)
  v_smfmac_f32_16x16x64_bf16 v[72:75], v[160:163], a[240:247], v3
  v_smfmac_f32_16x16x64_bf16 v[76:79], v[160:163], a[248:255], v3
  v_max3_u32 v42, v42, v160, v161
  v_max3_u32 v43, v43, v162, v163
  v_max_u32 v42, v42, v43
  v_cmp_eq_u32 vcc, -1, v42
  buffer_store_dword v27, v36, s[8:11], 0 offen sc1
  s_add_u32 s60, s41, 1
  s_lshr_b32 s61, s60, 4
  s_xor_b32 s61, s61, s6
  s_cbranch_vccnz L_lan_r_68
  v_permlane32_swap_b32 v72, v76
  v_permlane32_swap_b32 v73, v77
  v_permlane32_swap_b32 v74, v78
  v_permlane32_swap_b32 v75, v79
  v_add_f32 v116, v72, v76
  v_add_f32 v117, v73, v77
  v_add_f32 v118, v74, v78
  v_add_f32 v119, v75, v79
  ds_write_b128 v28, v[116:119]
  s_and_b32 s61, s61, 1
  s_lshl_b32 s61, s61, 13
  s_mov_b32 s41, s60
  s_lshl_b32 s60, s60, 17
  s_add_u32 s60, s60, s61
  s_add_u32 s46, s60, s47
  s_add_u32 s48, s48, 393216
  s_mov_b32 s64, 400000
  s_waitcnt lgkmcnt(0)
  s_barrier
  v_mov_b32 v72, 0
  v_mov_b32 v73, 0
  v_mov_b32 v74, 0
  v_mov_b32 v75, 0
  v_mov_b32 v76, 0
  v_mov_b32 v77, 0
  v_mov_b32 v78, 0
  v_mov_b32 v79, 0
  s_mov_b32 s60, s42
  s_mov_b32 s42, s43
  s_mov_b32 s43, s44
  s_mov_b32 s44, s45
  s_mov_b32 s45, s60
  s_add_u32 s49, s49, 98304
  s_cmp_le_u32 s56, s41
  s_cbranch_scc1 L_lan_kvw_69
L_lan_kvb_70:
  buffer_load_dwordx4 v[80:83], v30, s[8:11], s48 offen offset:0 sc1
  buffer_load_dwordx4 v[84:87], v30, s[8:11], s48 offen offset:1024 sc1
  v_add_u32 v27, 1, v27
  s_add_u32 s52, s52, 1
  s_barrier
  s_branch L_lan_loop_56
L_lan_kvw_54:
  s_load_dwordx4 s[88:91], s[100:101], 0 glc
  s_waitcnt lgkmcnt(0)
  s_min_u32 s56, s88, s89
  s_min_u32 s56, s56, s90
  s_cmp_gt_u32 s56, s41
  s_cbranch_scc1 L_lan_kvb_55
  s_sub_u32 s64, s64, 1
  s_cmp_lg_u32 s64, 0
  s_cbranch_scc1 L_lan_kvw_54
  s_branch L_lan_fail_2
L_lan_bad_60:
  buffer_load_dwordx4 v[132:135], v4, s[8:11], s46 offen offset:0 sc1
  buffer_load_dwordx4 v[136:139], v4, s[8:11], s46 offen offset:2048 sc1
  buffer_load_dwordx4 v[140:143], v4, s[8:11], s46 offen offset:256 sc1
  buffer_load_dwordx4 v[144:147], v4, s[8:11], s46 offen offset:2304 sc1
  s_bitset1_b32 s50, 0
  s_branch L_lan_skip_61
L_lan_bad_62:
  buffer_load_dwordx4 v[148:151], v5, s[8:11], s46 offen offset:0 sc1
  buffer_load_dwordx4 v[152:155], v5, s[8:11], s46 offen offset:2048 sc1
  buffer_load_dwordx4 v[156:159], v5, s[8:11], s46 offen offset:256 sc1
  buffer_load_dwordx4 v[160:163], v5, s[8:11], s46 offen offset:2304 sc1
  s_bitset1_b32 s50, 1
  s_branch L_lan_skip_63
L_lan_bad_64:
  buffer_load_dwordx4 v[164:167], v6, s[8:11], s46 offen offset:0 sc1
  buffer_load_dwordx4 v[168:171], v6, s[8:11], s46 offen offset:2048 sc1
  s_bitset1_b32 s50, 2
  s_branch L_lan_skip_65
L_lan_fix_58:
  s_waitcnt vmcnt(0)
  s_bitcmp1_b32 s50, 0
  s_cbranch_scc0 L_lan_n_71
  v_mfma_f32_16x16x32_bf16 v[104:107], v[132:135], v[48:51], 0
  v_max3_u32 v42, v132, v133, v134
  v_mov_b32 v43, v135
  v_mfma_f32_16x16x32_bf16 v[104:107], v[136:139], v[48:51], v[104:107]
  v_max3_u32 v42, v42, v136, v137
  v_max3_u32 v43, v43, v138, v139
  v_mfma_f32_16x16x32_bf16 v[108:111], v[140:143], v[48:51], 0
  v_max3_u32 v42, v42, v140, v141
  v_max3_u32 v43, v43, v142, v143
  v_mfma_f32_16x16x32_bf16 v[108:111], v[144:147], v[48:51], v[108:111]
  v_max3_u32 v42, v42, v144, v145
  v_max3_u32 v43, v43, v146, v147
  v_max_u32 v42, v42, v43
  v_cmp_eq_u32 vcc, -1, v42
  s_cbranch_vccnz L_lan_b_72
  s_nop 2
  v_cvt_pk_bf16_f32 v124, v104, v105
  v_cvt_pk_bf16_f32 v125, v106, v107
  v_cvt_pk_bf16_f32 v126, v108, v109
  v_cvt_pk_bf16_f32 v127, v110, v111
  ds_write_b128 v7, v[124:127]
  s_nop 0
  v_smfmac_f32_16x16x64_bf16 v[60:63], v[124:127], a[0:7], v3
  v_smfmac_f32_16x16x64_bf16 v[64:67], v[124:127], a[8:15], v3
  v_smfmac_f32_16x16x64_bf16 v[68:71], v[124:127], v[176:183], v3
  s_bitset0_b32 s50, 0
  s_branch L_lan_n_71
L_lan_b_72:
  buffer_load_dwordx4 v[132:135], v4, s[8:11], s46 offen offset:0 sc1
  buffer_load_dwordx4 v[136:139], v4, s[8:11], s46 offen offset:2048 sc1
  buffer_load_dwordx4 v[140:143], v4, s[8:11], s46 offen offset:256 sc1
  buffer_load_dwordx4 v[144:147], v4, s[8:11], s46 offen offset:2304 sc1
L_lan_n_71:
  s_bitcmp1_b32 s50, 1
  s_cbranch_scc0 L_lan_n_73
  v_mfma_f32_16x16x32_bf16 v[104:107], v[148:151], v[48:51], 0
  v_max3_u32 v42, v148, v149, v150
  v_mov_b32 v43, v151
  v_mfma_f32_16x16x32_bf16 v[104:107], v[152:155], v[48:51], v[104:107]
  v_max3_u32 v42, v42, v152, v153
  v_max3_u32 v43, v43, v154, v155
  v_mfma_f32_16x16x32_bf16 v[108:111], v[156:159], v[48:51], 0
  v_max3_u32 v42, v42, v156, v157
  v_max3_u32 v43, v43, v158, v159
  v_mfma_f32_16x16x32_bf16 v[108:111], v[160:163], v[48:51], v[108:111]
  v_max3_u32 v42, v42, v160, v161
  v_max3_u32 v43, v43, v162, v163
  v_max_u32 v42, v42, v43
  v_cmp_eq_u32 vcc, -1, v42
  s_cbranch_vccnz L_lan_b_74
  s_nop 2
  v_cvt_pk_bf16_f32 v128, v104, v105
  v_cvt_pk_bf16_f32 v129, v106, v107
  v_cvt_pk_bf16_f32 v130, v108, v109
  v_cvt_pk_bf16_f32 v131, v110, v111
  ds_write_b128 v8, v[128:131]
  s_nop 0
  v_smfmac_f32_16x16x64_bf16 v[60:63], v[128:131], a[16:23], v3
  v_smfmac_f32_16x16x64_bf16 v[64:67], v[128:131], a[24:31], v3
  v_smfmac_f32_16x16x64_bf16 v[68:71], v[128:131], v[184:191], v3
  s_bitset0_b32 s50, 1
  s_branch L_lan_n_73
L_lan_b_74:
  buffer_load_dwordx4 v[148:151], v5, s[8:11], s46 offen offset:0 sc1
  buffer_load_dwordx4 v[152:155], v5, s[8:11], s46 offen offset:2048 sc1
  buffer_load_dwordx4 v[156:159], v5, s[8:11], s46 offen offset:256 sc1
  buffer_load_dwordx4 v[160:163], v5, s[8:11], s46 offen offset:2304 sc1
L_lan_n_73:
  s_bitcmp1_b32 s50, 2
  s_cbranch_scc0 L_lan_n_75
  v_mfma_f32_16x16x32_bf16 v[104:107], v[164:167], v[48:51], 0
  v_max3_u32 v42, v164, v165, v166
  v_mov_b32 v43, v167
  v_mfma_f32_16x16x32_bf16 v[104:107], v[168:171], v[48:51], v[104:107]
  v_max3_u32 v42, v42, v168, v169
  v_max3_u32 v43, v43, v170, v171
  v_max_u32 v42, v42, v43
  v_cmp_eq_u32 vcc, -1, v42
  s_cbranch_vccnz L_lan_b_76
  s_nop 2
  v_cvt_pk_bf16_f32 v112, v104, v105
  v_cvt_pk_bf16_f32 v113, v106, v107
  ds_write_b64 v17, v[112:113]
  s_bitset0_b32 s50, 2
  s_branch L_lan_n_75
L_lan_b_76:
  buffer_load_dwordx4 v[164:167], v6, s[8:11], s46 offen offset:0 sc1
  buffer_load_dwordx4 v[168:171], v6, s[8:11], s46 offen offset:2048 sc1
L_lan_n_75:
  s_cmp_eq_u32 s50, 0
  s_cbranch_scc1 L_lan_back_59
  s_sub_u32 s64, s64, 1
  s_cmp_lg_u32 s64, 0
  s_cbranch_scc1 L_lan_fix_58
  s_branch L_lan_fail_2
L_lan_last_66:
  buffer_store_dword v120, v26, s[8:11], s49 offen
  buffer_store_dwordx4 v[96:99], v35, s[8:11], s49 offen offset:0
  buffer_store_dwordx4 v[100:103], v35, s[8:11], s49 offen offset:512
  s_waitcnt vmcnt(0)
  s_barrier
  buffer_store_dword v27, v38, s[8:11], 0 offen
  s_branch L_lan_done_3
L_lan_r_68:
  s_nop 7
  v_mov_b32 v72, 0
  v_mov_b32 v73, 0
  v_mov_b32 v74, 0
  v_mov_b32 v75, 0
  v_mov_b32 v76, 0
  v_mov_b32 v77, 0
  v_mov_b32 v78, 0
  v_mov_b32 v79, 0
  s_sub_u32 s64, s64, 1
  s_cmp_lg_u32 s64, 0
  s_cbranch_scc1 L_lan_g_67
  s_branch L_lan_fail_2
L_lan_kvw_69:
  s_load_dwordx4 s[88:91], s[100:101], 0 glc
  s_waitcnt lgkmcnt(0)
  s_min_u32 s56, s88, s89
  s_min_u32 s56, s56, s90
  s_cmp_gt_u32 s56, s41
  s_cbranch_scc1 L_lan_kvb_70
  s_sub_u32 s64, s64, 1
  s_cmp_lg_u32 s64, 0
  s_cbranch_scc1 L_lan_kvw_69
  s_branch L_lan_fail_2
L_lan_w3_7:
  v_bfe_u32 v30, v2, 0, 6
  v_mul_u32_u24 v30, 16, v30
  s_mov_b32 s60, 117440512
  s_mul_i32 s63, s35, 12288
  s_add_u32 s60, s60, s63
  s_mul_i32 s63, s36, 4096
  s_add_u32 s60, s60, s63
  v_add_u32 v30, s60, v30
  s_add_u32 s62, s36, 1
  s_sub_u32 s63, s62, 3
  s_cmp_ge_u32 s62, 3
  s_cselect_b32 s62, s63, s62
  v_bfe_u32 v31, v2, 0, 6
  v_mul_u32_u24 v31, 16, v31
  s_mov_b32 s60, 0
  s_mul_i32 s63, s35, 4096
  s_add_u32 s60, s60, s63
  s_mul_i32 s63, s62, 1024
  s_add_u32 s60, s60, s63
  v_add_u32 v31, s60, v31
  v_bfe_u32 v33, v2, 0, 3
  v_mul_u32_u24 v33, 32, v33
  v_bfe_u32 v1, v2, 4, 1
  v_mul_u32_u24 v1, 16, v1
  v_add_u32 v33, v33, v1
  v_bfe_u32 v1, v2, 5, 1
  v_mul_u32_u24 v1, 8, v1
  v_add_u32 v33, v33, v1
  v_bfe_u32 v1, v2, 3, 1
  v_mul_u32_u24 v1, 4, v1
  v_add_u32 v33, v33, v1
  s_mov_b32 s60, 3072
  s_mul_i32 s63, s35, 4096
  s_add_u32 s60, s60, s63
  s_mul_i32 s63, s62, 256
  s_add_u32 s60, s60, s63
  v_add_u32 v33, s60, v33
  s_add_u32 s62, s36, 2
  s_sub_u32 s63, s62, 3
  s_cmp_ge_u32 s62, 3
  s_cselect_b32 s62, s63, s62
  v_bfe_u32 v32, v2, 0, 6
  v_mul_u32_u24 v32, 16, v32
  s_mov_b32 s60, 0
  s_mul_i32 s63, s35, 4096
  s_add_u32 s60, s60, s63
  s_mul_i32 s63, s62, 1024
  s_add_u32 s60, s60, s63
  v_add_u32 v32, s60, v32
  v_bfe_u32 v35, v2, 0, 3
  v_mul_u32_u24 v35, 32, v35
  v_bfe_u32 v1, v2, 4, 1
  v_mul_u32_u24 v1, 16, v1
  v_add_u32 v35, v35, v1
  v_bfe_u32 v1, v2, 5, 1
  v_mul_u32_u24 v1, 8, v1
  v_add_u32 v35, v35, v1
  v_bfe_u32 v1, v2, 3, 1
  v_mul_u32_u24 v1, 4, v1
  v_add_u32 v35, v35, v1
  s_mov_b32 s60, 3072
  s_mul_i32 s63, s35, 4096
  s_add_u32 s60, s60, s63
  s_mul_i32 s63, s62, 256
  s_add_u32 s60, s60, s63
  v_add_u32 v35, s60, v35
  v_bfe_u32 v36, v2, 0, 6
  v_mul_u32_u24 v36, 16, v36
  s_mov_b32 s60, 28672
  v_add_u32 v36, s60, v36
  v_bfe_u32 v37, v2, 0, 3
  v_mul_u32_u24 v37, 32, v37
  v_bfe_u32 v1, v2, 4, 1
  v_mul_u32_u24 v1, 16, v1
  v_add_u32 v37, v37, v1
  v_bfe_u32 v1, v2, 5, 1
  v_mul_u32_u24 v1, 8, v1
  v_add_u32 v37, v37, v1
  v_bfe_u32 v1, v2, 3, 1
  v_mul_u32_u24 v1, 4, v1
  v_add_u32 v37, v37, v1
  s_mov_b32 s60, 29952
  v_add_u32 v37, s60, v37
  v_bfe_u32 v38, v2, 0, 6
  v_mul_u32_u24 v38, 4, v38
  s_mov_b32 s60, 27648
  v_add_u32 v38, s60, v38
  v_bfe_u32 v39, v2, 0, 1
  v_mul_u32_u24 v39, 4, v39
  s_mov_b32 s60, 98304
  s_mul_i32 s63, s35, 384
  s_add_u32 s60, s60, s63
  s_mul_i32 s63, s36, 128
  s_add_u32 s60, s60, s63
  s_mul_i32 s63, s65, 131072
  s_add_u32 s60, s60, s63
  v_add_u32 v39, s60, v39
  s_add_u32 s62, s34, 1
  v_add_u32 v34, s62, v2
  v_subrev_u32 v1, 24, v34
  v_min_u32 v34, v34, v1
  v_lshlrev_b32 v34, 7, v34
  s_mov_b32 s60, 65536
  s_mul_i32 s63, s37, 3072
  s_add_u32 s60, s60, s63
  s_mul_i32 s63, s34, 4
  s_add_u32 s60, s60, s63
  s_mul_i32 s63, s65, 131072
  s_add_u32 s60, s60, s63
  v_add_u32 v34, s60, v34
  v_cmp_gt_u32 vcc, 23, v2
  v_mov_b32 v1, 2147483632
  s_nop 0
  v_cndmask_b32 v34, v1, v34, vcc
  v_mov_b32 v97, 0
  v_mov_b32 v99, 0
  v_mov_b32 v101, 0
  v_mov_b32 v103, 0
  v_mov_b32 v57, 0
  s_cmp_le_u32 s56, s41
  s_cbranch_scc1 L_lan_kvw_77
L_lan_kvb_78:
  s_branch L_lan_loop_79
.p2align 6
L_lan_loop_79:
  buffer_load_dwordx4 v[132:135], v4, s[8:11], s46 offen offset:0 sc1
  s_nop 5
  buffer_load_dwordx4 v[136:139], v4, s[8:11], s46 offen offset:2048 sc1
  s_nop 5
  buffer_load_dwordx4 v[140:143], v4, s[8:11], s46 offen offset:256 sc1
  s_nop 5
  buffer_load_dwordx4 v[144:147], v4, s[8:11], s46 offen offset:2304 sc1
  s_nop 5
  buffer_load_dwordx4 v[148:151], v5, s[8:11], s46 offen offset:0 sc1
  s_nop 5
  buffer_load_dwordx4 v[152:155], v5, s[8:11], s46 offen offset:2048 sc1
  s_nop 5
  buffer_load_dwordx4 v[156:159], v5, s[8:11], s46 offen offset:256 sc1
  s_nop 5
  buffer_load_dwordx4 v[160:163], v5, s[8:11], s46 offen offset:2304 sc1
  s_nop 5
  buffer_load_dwordx4 v[164:167], v6, s[8:11], s46 offen offset:0 sc1
  s_nop 5
  buffer_load_dwordx4 v[168:171], v6, s[8:11], s46 offen offset:2048 sc1
  s_waitcnt vmcnt(9)
  v_mfma_f32_16x16x32_bf16 v[104:107], v[132:135], v[48:51], 0
  v_max3_u32 v42, v132, v133, v134
  v_mov_b32 v43, v135
  s_waitcnt vmcnt(8)
  v_mfma_f32_16x16x32_bf16 v[104:107], v[136:139], v[48:51], v[104:107]
  v_max3_u32 v42, v42, v136, v137
  v_max3_u32 v43, v43, v138, v139
  s_waitcnt vmcnt(7)
  v_mfma_f32_16x16x32_bf16 v[108:111], v[140:143], v[48:51], 0
  v_max3_u32 v42, v42, v140, v141
  v_max3_u32 v43, v43, v142, v143
  s_waitcnt vmcnt(6)
  v_mfma_f32_16x16x32_bf16 v[108:111], v[144:147], v[48:51], v[108:111]
  v_max3_u32 v42, v42, v144, v145
  v_max3_u32 v43, v43, v146, v147
  v_max_u32 v42, v42, v43
  v_cmp_eq_u32 vcc, -1, v42
  s_cbranch_vccnz L_lan_bad_83
  s_nop 2
  v_cvt_pk_bf16_f32 v124, v104, v105
  v_cvt_pk_bf16_f32 v125, v106, v107
  v_cvt_pk_bf16_f32 v126, v108, v109
  v_cvt_pk_bf16_f32 v127, v110, v111
  ds_write_b128 v7, v[124:127]
  s_nop 0
  v_smfmac_f32_16x16x64_bf16 v[60:63], v[124:127], a[0:7], v3
  v_smfmac_f32_16x16x64_bf16 v[64:67], v[124:127], a[8:15], v3
  v_smfmac_f32_16x16x64_bf16 v[68:71], v[124:127], v[176:183], v3
L_lan_skip_84:
  s_waitcnt vmcnt(5)
  v_mfma_f32_16x16x32_bf16 v[104:107], v[148:151], v[48:51], 0
  v_max3_u32 v42, v148, v149, v150
  v_mov_b32 v43, v151
  s_waitcnt vmcnt(4)
  v_mfma_f32_16x16x32_bf16 v[104:107], v[152:155], v[48:51], v[104:107]
  v_max3_u32 v42, v42, v152, v153
  v_max3_u32 v43, v43, v154, v155
  s_waitcnt vmcnt(3)
  v_mfma_f32_16x16x32_bf16 v[108:111], v[156:159], v[48:51], 0
  v_max3_u32 v42, v42, v156, v157
  v_max3_u32 v43, v43, v158, v159
  s_waitcnt vmcnt(2)
  v_mfma_f32_16x16x32_bf16 v[108:111], v[160:163], v[48:51], v[108:111]
  v_max3_u32 v42, v42, v160, v161
  v_max3_u32 v43, v43, v162, v163
  v_max_u32 v42, v42, v43
  v_cmp_eq_u32 vcc, -1, v42
  s_cbranch_vccnz L_lan_bad_85
  s_nop 2
  v_cvt_pk_bf16_f32 v128, v104, v105
  v_cvt_pk_bf16_f32 v129, v106, v107
  v_cvt_pk_bf16_f32 v130, v108, v109
  v_cvt_pk_bf16_f32 v131, v110, v111
  ds_write_b128 v8, v[128:131]
  s_nop 0
  v_smfmac_f32_16x16x64_bf16 v[60:63], v[128:131], a[16:23], v3
  v_smfmac_f32_16x16x64_bf16 v[64:67], v[128:131], a[24:31], v3
  v_smfmac_f32_16x16x64_bf16 v[68:71], v[128:131], v[184:191], v3
L_lan_skip_86:
  s_waitcnt vmcnt(1)
  v_mfma_f32_16x16x32_bf16 v[104:107], v[164:167], v[48:51], 0
  v_max3_u32 v42, v164, v165, v166
  v_mov_b32 v43, v167
  s_waitcnt vmcnt(0)
  v_mfma_f32_16x16x32_bf16 v[104:107], v[168:171], v[48:51], v[104:107]
  v_max3_u32 v42, v42, v168, v169
  v_max3_u32 v43, v43, v170, v171
  v_max_u32 v42, v42, v43
  v_cmp_eq_u32 vcc, -1, v42
  s_cbranch_vccnz L_lan_bad_87
  s_nop 2
  v_cvt_pk_bf16_f32 v112, v104, v105
  v_cvt_pk_bf16_f32 v113, v106, v107
  ds_write_b64 v17, v[112:113]
L_lan_skip_88:
  s_cmp_lg_u32 s50, 0
  s_cbranch_scc1 L_lan_fix_81
L_lan_back_82:
  s_waitcnt lgkmcnt(0)
  s_barrier
  ds_read_b128 v[132:135], v9
  ds_read_b128 v[136:139], v10
  ds_read_b128 v[140:143], v11
  s_waitcnt lgkmcnt(2)
  v_smfmac_f32_16x16x64_bf16 v[60:63], v[132:135], a[32:39], v3
  ds_read_b128 v[144:147], v12
  v_smfmac_f32_16x16x64_bf16 v[64:67], v[132:135], a[40:47], v3
  buffer_load_dwordx4 v[80:83], v30, s[8:11], s48 offen offset:0 sc1
  s_waitcnt lgkmcnt(2)
  v_smfmac_f32_16x16x64_bf16 v[60:63], v[136:139], a[48:55], v3
  ds_read_b128 v[148:151], v13
  v_smfmac_f32_16x16x64_bf16 v[64:67], v[136:139], a[56:63], v3
  buffer_load_dwordx4 v[84:87], v30, s[8:11], s48 offen offset:1024 sc1
  s_waitcnt lgkmcnt(2)
  v_smfmac_f32_16x16x64_bf16 v[60:63], v[140:143], a[64:71], v3
  ds_read_b128 v[152:155], v14
  v_smfmac_f32_16x16x64_bf16 v[64:67], v[140:143], a[72:79], v3
  buffer_load_dwordx4 v[88:91], v30, s[8:11], s48 offen offset:2048 sc1
  s_waitcnt lgkmcnt(2)
  v_smfmac_f32_16x16x64_bf16 v[60:63], v[144:147], a[80:87], v3
  ds_read_b128 v[156:159], v15
  v_smfmac_f32_16x16x64_bf16 v[64:67], v[144:147], a[88:95], v3
  buffer_load_dwordx4 v[92:95], v30, s[8:11], s48 offen offset:3072 sc1
  s_waitcnt lgkmcnt(2)
  v_smfmac_f32_16x16x64_bf16 v[60:63], v[148:151], a[96:103], v3
  ds_read_b128 v[160:163], v16
  v_smfmac_f32_16x16x64_bf16 v[64:67], v[148:151], a[104:111], v3
  s_waitcnt lgkmcnt(2)
  v_smfmac_f32_16x16x64_bf16 v[60:63], v[152:155], a[112:119], v3
  v_smfmac_f32_16x16x64_bf16 v[64:67], v[152:155], a[120:127], v3
  s_waitcnt lgkmcnt(1)
  v_smfmac_f32_16x16x64_bf16 v[60:63], v[156:159], a[128:135], v3
  v_smfmac_f32_16x16x64_bf16 v[64:67], v[156:159], a[136:143], v3
  s_waitcnt lgkmcnt(0)
  v_smfmac_f32_16x16x64_bf16 v[60:63], v[160:163], a[144:151], v3
  v_smfmac_f32_16x16x64_bf16 v[64:67], v[160:163], a[152:159], v3
  v_smfmac_f32_16x16x64_bf16 v[68:71], v[132:135], v[192:199], v3
  s_nop 6
  v_permlane32_swap_b32 v60, v64
  v_permlane32_swap_b32 v61, v65
  v_permlane32_swap_b32 v62, v66
  v_permlane32_swap_b32 v63, v67
  v_add_f32 v60, v60, v64
  v_add_f32 v61, v61, v65
  v_add_f32 v62, v62, v66
  v_add_f32 v63, v63, v67
  v_cvt_pk_bf16_f32 v112, v60, v61
  v_cvt_pk_bf16_f32 v113, v62, v63
  ds_write_b64 v24, v[112:113]
  v_smfmac_f32_16x16x64_bf16 v[68:71], v[136:139], v[200:207], v3
  v_smfmac_f32_16x16x64_bf16 v[68:71], v[140:143], v[208:215], v3
  v_smfmac_f32_16x16x64_bf16 v[68:71], v[144:147], v[216:223], v3
  s_waitcnt lgkmcnt(0)
  s_barrier
  v_smfmac_f32_16x16x64_bf16 v[68:71], v[148:151], v[224:231], v3
  v_smfmac_f32_16x16x64_bf16 v[68:71], v[152:155], v[232:239], v3
  buffer_load_dword v29, v39, s[8:11], 0 offen sc1
  v_smfmac_f32_16x16x64_bf16 v[68:71], v[156:159], v[240:247], v3
  v_smfmac_f32_16x16x64_bf16 v[68:71], v[160:163], v[248:255], v3
  buffer_load_dword v29, v39, s[8:11], 0 offen sc1
  s_nop 5
  buffer_load_dword v29, v39, s[8:11], 0 offen sc1
  v_permlane32_swap_b32 v68, v70
  v_permlane32_swap_b32 v69, v71
  v_add_f32 v68, v68, v70
  v_add_f32 v69, v69, v71
  v_cvt_pk_bf16_f32 v120, v68, v69
  v_cvt_pk_bf16_f32 v121, v69, v68
  ds_write_b32 v25, v121
  buffer_load_dword v29, v39, s[8:11], 0 offen sc1
  s_mov_b64 exec, 3
L_lan_sp_90:
  v_cmp_gt_u32 vcc, v27, v29
  s_cbranch_vccz L_lan_sd_91
  buffer_load_dword v29, v39, s[8:11], 0 offen sc1
  v_cmp_gt_u32 vcc, v27, v29
  s_cbranch_vccz L_lan_sd_91
  buffer_load_dword v29, v39, s[8:11], 0 offen sc1
  v_cmp_gt_u32 vcc, v27, v29
  s_cbranch_vccz L_lan_sd_91
  buffer_load_dword v29, v39, s[8:11], 0 offen sc1
  v_cmp_gt_u32 vcc, v27, v29
  s_cbranch_vccz L_lan_sd_91
  buffer_load_dword v29, v39, s[8:11], 0 offen sc1
  v_cmp_gt_u32 vcc, v27, v29
  s_cbranch_vccz L_lan_sd_91
  buffer_load_dword v29, v39, s[8:11], 0 offen sc1
  v_cmp_gt_u32 vcc, v27, v29
  s_cbranch_vccz L_lan_sd_91
  buffer_load_dword v29, v39, s[8:11], 0 offen sc1
  v_cmp_gt_u32 vcc, v27, v29
  s_cbranch_vccz L_lan_sd_91
  buffer_load_dword v29, v39, s[8:11], 0 offen sc1
  v_cmp_gt_u32 vcc, v27, v29
  s_cbranch_vccz L_lan_sd_91
  buffer_load_dword v29, v39, s[8:11], 0 offen sc1
  s_waitcnt vmcnt(40)
  s_sub_u32 s64, s64, 1
  s_cmp_lg_u32 s64, 0
  s_cbranch_scc1 L_lan_sp_90
  s_branch L_lan_fail_2
L_lan_sd_91:
  s_mov_b64 exec, -1
  s_cmp_eq_u32 s41, 63
  s_barrier
  s_cbranch_scc1 L_lan_last_89
  buffer_load_dwordx4 v[124:127], v31, s[8:11], s42 offen sc1
  buffer_load_dwordx4 v[128:131], v32, s[8:11], s42 offen sc1
  buffer_load_dword v136, v33, s[8:11], s42 offen sc1
  buffer_load_dword v137, v35, s[8:11], s42 offen sc1
  ds_read_b128 v[132:135], v36
  ds_read_b32 v138, v37
  s_waitcnt lgkmcnt(0)
  s_barrier
  ds_read_b32 v96, v38 offset:0
  ds_read_b32 v98, v38 offset:256
  ds_read_b32 v100, v38 offset:512
  ds_read_b32 v102, v38 offset:768
  s_waitcnt vmcnt(4)
  v_swap_b32 v88, v90
  v_swap_b32 v89, v91
  v_swap_b32 v92, v94
  v_swap_b32 v93, v95
L_lan_poll_92:
  s_waitcnt vmcnt(0)
  v_max3_u32 v42, v124, v125, v126
  v_max3_u32 v43, v127, v128, v129
  v_max3_u32 v42, v42, v130, v131
  v_max3_u32 v43, v43, v136, v137
  v_pk_add_f32 v[144:145], v[132:133], v[124:125]
  v_max_u32 v42, v42, v43
  v_pk_add_f32 v[146:147], v[134:135], v[126:127]
  v_cmp_eq_u32 vcc, -1, v42
  v_add_f32 v148, v138, v136
  v_pk_add_f32 v[144:145], v[144:145], v[128:129]
  v_pk_add_f32 v[146:147], v[146:147], v[130:131]
  v_add_f32 v148, v148, v137
  s_cbranch_vccnz L_lan_sr_93
  v_max3_f32 v112, v144, v145, v148
  v_max3_f32 v112, v112, v146, v147
  s_nop 1
  v_max_f32_dpp v114, v112, v112 row_ror:8 row_mask:0xf bank_mask:0xf
  v_max_f32_dpp v115, v112, v112 row_ror:8 row_mask:0xf bank_mask:0xf
  s_nop 1
  v_permlane16_swap_b32 v115, v114
  v_max_f32 v112, v114, v115
  v_max_f32 v113, v114, v115
  s_nop 1
  v_permlane32_swap_b32 v113, v112
  v_max_f32 v112, v112, v113
  v_mul_f32 v112, s53, v112
  v_fma_f32 v150, v144, s53, -v112
  v_fma_f32 v151, v145, s53, -v112
  v_fma_f32 v152, v146, s53, -v112
  v_fma_f32 v153, v147, s53, -v112
  v_fma_f32 v154, v148, s53, -v112
  v_exp_f32 v150, v150
  v_exp_f32 v151, v151
  v_exp_f32 v152, v152
  v_cvt_pk_bf16_f32 v156, v150, v151
  v_exp_f32 v153, v153
  v_exp_f32 v154, v154
  v_cvt_pk_bf16_f32 v157, v152, v153
  v_mov_b32_dpp v158, v156 row_ror:8 row_mask:0xf bank_mask:0xf
  v_mov_b32_dpp v115, v154 row_ror:8 row_mask:0xf bank_mask:0xf
  v_mov_b32_dpp v159, v157 row_ror:8 row_mask:0xf bank_mask:0xf
  v_add_f32 v112, v150, v151
  v_cvt_pk_bf16_f32 v56, v154, v115
  v_mfma_f32_16x16x32_bf16 v[124:127], v[80:83], v[156:159], 0
  v_add_f32 v113, v152, v153
  v_add_f32 v112, v112, v154
  v_mfma_f32_16x16x32_bf16 v[132:135], v[88:91], v[156:159], 0
  v_add_f32 v112, v112, v113
  buffer_store_dword v27, v34, s[8:11], 0 offen
  s_waitcnt lgkmcnt(0)
  v_mfma_f32_16x16x16_bf16 v[124:127], v[96:97], v[56:57], v[124:127]
  v_add_f32_dpp v114, v112, v112 row_ror:8 row_mask:0xf bank_mask:0xf
  v_add_f32_dpp v115, v112, v112 row_ror:8 row_mask:0xf bank_mask:0xf
  v_mfma_f32_16x16x16_bf16 v[132:135], v[100:101], v[56:57], v[132:135]
  s_nop 0
  v_permlane16_swap_b32 v115, v114
  v_mfma_f32_16x16x32_bf16 v[128:131], v[84:87], v[156:159], 0
  v_add_f32 v112, v114, v115
  v_add_f32 v113, v114, v115
  v_mfma_f32_16x16x32_bf16 v[136:139], v[92:95], v[156:159], 0
  s_nop 0
  v_permlane32_swap_b32 v113, v112
  v_mfma_f32_16x16x16_bf16 v[128:131], v[98:99], v[56:57], v[128:131]
  v_add_f32 v112, v112, v113
  v_rcp_f32 v112, v112
  v_mfma_f32_16x16x16_bf16 v[136:139], v[102:103], v[56:57], v[136:139]
  v_cndmask_b32 v104, v124, v132, s[54:55]
  v_cndmask_b32 v105, v125, v133, s[54:55]
  v_cndmask_b32 v106, v126, v134, s[54:55]
  v_cndmask_b32 v107, v127, v135, s[54:55]
  v_mul_f32 v104, v104, v112
  v_mul_f32 v105, v105, v112
  v_mul_f32 v106, v106, v112
  v_mul_f32 v107, v107, v112
  v_cndmask_b32 v108, v128, v136, s[54:55]
  v_cndmask_b32 v109, v129, v137, s[54:55]
  v_cndmask_b32 v110, v130, v138, s[54:55]
  v_cndmask_b32 v111, v131, v139, s[54:55]
  v_mul_f32 v108, v108, v112
  v_mul_f32 v109, v109, v112
  v_mul_f32 v110, v110, v112
  v_mul_f32 v111, v111, v112
  v_cvt_pk_bf16_f32 v140, v104, v105
  v_cvt_pk_bf16_f32 v141, v106, v107
  v_cvt_pk_bf16_f32 v142, v108, v109
  v_cvt_pk_bf16_f32 v143, v110, v111
  buffer_store_dwordx4 v[140:143], v18, s[8:11], s42 offen
  s_barrier
L_lan_g_94:
  buffer_load_dwordx4 v[144:147], v19, s[8:11], s42 offen sc1
  s_nop 7
  buffer_load_dwordx4 v[148:151], v20, s[8:11], s42 offen sc1
  s_nop 7
  buffer_load_dwordx4 v[152:155], v21, s[8:11], s42 offen sc1
  s_nop 7
  buffer_load_dwordx4 v[156:159], v22, s[8:11], s42 offen sc1
  s_nop 7
  buffer_load_dwordx4 v[160:163], v23, s[8:11], s42 offen sc1
  v_smfmac_f32_16x16x64_bf16 v[72:75], v[140:143], a[160:167], v3
  v_smfmac_f32_16x16x64_bf16 v[76:79], v[140:143], a[168:175], v3
  s_waitcnt vmcnt(4)
  v_smfmac_f32_16x16x64_bf16 v[72:75], v[144:147], a[176:183], v3
  v_smfmac_f32_16x16x64_bf16 v[76:79], v[144:147], a[184:191], v3
  v_max3_u32 v42, v144, v145, v146
  v_mov_b32 v43, v147
  s_waitcnt vmcnt(3)
  v_smfmac_f32_16x16x64_bf16 v[72:75], v[148:151], a[192:199], v3
  v_smfmac_f32_16x16x64_bf16 v[76:79], v[148:151], a[200:207], v3
  v_max3_u32 v42, v42, v148, v149
  v_max3_u32 v43, v43, v150, v151
  s_waitcnt vmcnt(2)
  v_smfmac_f32_16x16x64_bf16 v[72:75], v[152:155], a[208:215], v3
  v_smfmac_f32_16x16x64_bf16 v[76:79], v[152:155], a[216:223], v3
  v_max3_u32 v42, v42, v152, v153
  v_max3_u32 v43, v43, v154, v155
  s_waitcnt vmcnt(1)
  v_smfmac_f32_16x16x64_bf16 v[72:75], v[156:159], a[224:231], v3
  v_smfmac_f32_16x16x64_bf16 v[76:79], v[156:159], a[232:239], v3
  v_max3_u32 v42, v42, v156, v157
  v_max3_u32 v43, v43, v158, v159
  s_waitcnt vmcnt(0)
  v_smfmac_f32_16x16x64_bf16 v[72:75], v[160:163], a[240:247], v3
  v_smfmac_f32_16x16x64_bf16 v[76:79], v[160:163], a[248:255], v3
  v_max3_u32 v42, v42, v160, v161
  v_max3_u32 v43, v43, v162, v163
  v_max_u32 v42, v42, v43
  v_cmp_eq_u32 vcc, -1, v42
  s_add_u32 s60, s41, 1
  s_lshr_b32 s61, s60, 4
  s_xor_b32 s61, s61, s6
  s_cbranch_vccnz L_lan_r_95
  v_permlane32_swap_b32 v72, v76
  v_permlane32_swap_b32 v73, v77
  v_permlane32_swap_b32 v74, v78
  v_permlane32_swap_b32 v75, v79
  v_add_f32 v116, v72, v76
  v_add_f32 v117, v73, v77
  v_add_f32 v118, v74, v78
  v_add_f32 v119, v75, v79
  ds_write_b128 v28, v[116:119]
  s_and_b32 s61, s61, 1
  s_lshl_b32 s61, s61, 13
  s_mov_b32 s41, s60
  s_lshl_b32 s60, s60, 17
  s_add_u32 s60, s60, s61
  s_add_u32 s46, s60, s47
  s_add_u32 s48, s48, 393216
  s_mov_b32 s64, 400000
  s_waitcnt lgkmcnt(0)
  s_barrier
  v_mov_b32 v72, 0
  v_mov_b32 v73, 0
  v_mov_b32 v74, 0
  v_mov_b32 v75, 0
  v_mov_b32 v76, 0
  v_mov_b32 v77, 0
  v_mov_b32 v78, 0
  v_mov_b32 v79, 0
  buffer_store_dword v120, v26, s[8:11], s49 offen
  v_mov_b32 v60, 0
  v_mov_b32 v61, 0
  v_mov_b32 v62, 0
  v_mov_b32 v63, 0
  v_mov_b32 v64, 0
  v_mov_b32 v65, 0
  v_mov_b32 v66, 0
  v_mov_b32 v67, 0
  v_mov_b32 v68, 0
  v_mov_b32 v69, 0
  v_mov_b32 v70, 0
  v_mov_b32 v71, 0
  s_mov_b32 s60, s42
  s_mov_b32 s42, s43
  s_mov_b32 s43, s44
  s_mov_b32 s44, s45
  s_mov_b32 s45, s60
  s_add_u32 s49, s49, 98304
  s_cmp_le_u32 s56, s41
  s_cbranch_scc1 L_lan_kvw_96
L_lan_kvb_97:
  v_add_u32 v27, 1, v27
  s_add_u32 s52, s52, 1
  s_barrier
  s_branch L_lan_loop_79
L_lan_kvw_77:
  s_load_dwordx4 s[88:91], s[100:101], 0 glc
  s_waitcnt lgkmcnt(0)
  s_min_u32 s56, s88, s89
  s_min_u32 s56, s56, s90
  s_cmp_gt_u32 s56, s41
  s_cbranch_scc1 L_lan_kvb_78
  s_sub_u32 s64, s64, 1
  s_cmp_lg_u32 s64, 0
  s_cbranch_scc1 L_lan_kvw_77
  s_branch L_lan_fail_2
L_lan_bad_83:
  buffer_load_dwordx4 v[132:135], v4, s[8:11], s46 offen offset:0 sc1
  buffer_load_dwordx4 v[136:139], v4, s[8:11], s46 offen offset:2048 sc1
  buffer_load_dwordx4 v[140:143], v4, s[8:11], s46 offen offset:256 sc1
  buffer_load_dwordx4 v[144:147], v4, s[8:11], s46 offen offset:2304 sc1
  s_bitset1_b32 s50, 0
  s_branch L_lan_skip_84
L_lan_bad_85:
  buffer_load_dwordx4 v[148:151], v5, s[8:11], s46 offen offset:0 sc1
  buffer_load_dwordx4 v[152:155], v5, s[8:11], s46 offen offset:2048 sc1
  buffer_load_dwordx4 v[156:159], v5, s[8:11], s46 offen offset:256 sc1
  buffer_load_dwordx4 v[160:163], v5, s[8:11], s46 offen offset:2304 sc1
  s_bitset1_b32 s50, 1
  s_branch L_lan_skip_86
L_lan_bad_87:
  buffer_load_dwordx4 v[164:167], v6, s[8:11], s46 offen offset:0 sc1
  buffer_load_dwordx4 v[168:171], v6, s[8:11], s46 offen offset:2048 sc1
  s_bitset1_b32 s50, 2
  s_branch L_lan_skip_88
L_lan_fix_81:
  s_waitcnt vmcnt(0)
  s_bitcmp1_b32 s50, 0
  s_cbranch_scc0 L_lan_n_98
  v_mfma_f32_16x16x32_bf16 v[104:107], v[132:135], v[48:51], 0
  v_max3_u32 v42, v132, v133, v134
  v_mov_b32 v43, v135
  v_mfma_f32_16x16x32_bf16 v[104:107], v[136:139], v[48:51], v[104:107]
  v_max3_u32 v42, v42, v136, v137
  v_max3_u32 v43, v43, v138, v139
  v_mfma_f32_16x16x32_bf16 v[108:111], v[140:143], v[48:51], 0
  v_max3_u32 v42, v42, v140, v141
  v_max3_u32 v43, v43, v142, v143
  v_mfma_f32_16x16x32_bf16 v[108:111], v[144:147], v[48:51], v[108:111]
  v_max3_u32 v42, v42, v144, v145
  v_max3_u32 v43, v43, v146, v147
  v_max_u32 v42, v42, v43
  v_cmp_eq_u32 vcc, -1, v42
  s_cbranch_vccnz L_lan_b_99
  s_nop 2
  v_cvt_pk_bf16_f32 v124, v104, v105
  v_cvt_pk_bf16_f32 v125, v106, v107
  v_cvt_pk_bf16_f32 v126, v108, v109
  v_cvt_pk_bf16_f32 v127, v110, v111
  ds_write_b128 v7, v[124:127]
  s_nop 0
  v_smfmac_f32_16x16x64_bf16 v[60:63], v[124:127], a[0:7], v3
  v_smfmac_f32_16x16x64_bf16 v[64:67], v[124:127], a[8:15], v3
  v_smfmac_f32_16x16x64_bf16 v[68:71], v[124:127], v[176:183], v3
  s_bitset0_b32 s50, 0
  s_branch L_lan_n_98
L_lan_b_99:
  buffer_load_dwordx4 v[132:135], v4, s[8:11], s46 offen offset:0 sc1
  buffer_load_dwordx4 v[136:139], v4, s[8:11], s46 offen offset:2048 sc1
  buffer_load_dwordx4 v[140:143], v4, s[8:11], s46 offen offset:256 sc1
  buffer_load_dwordx4 v[144:147], v4, s[8:11], s46 offen offset:2304 sc1
L_lan_n_98:
  s_bitcmp1_b32 s50, 1
  s_cbranch_scc0 L_lan_n_100
  v_mfma_f32_16x16x32_bf16 v[104:107], v[148:151], v[48:51], 0
  v_max3_u32 v42, v148, v149, v150
  v_mov_b32 v43, v151
  v_mfma_f32_16x16x32_bf16 v[104:107], v[152:155], v[48:51], v[104:107]
  v_max3_u32 v42, v42, v152, v153
  v_max3_u32 v43, v43, v154, v155
  v_mfma_f32_16x16x32_bf16 v[108:111], v[156:159], v[48:51], 0
  v_max3_u32 v42, v42, v156, v157
  v_max3_u32 v43, v43, v158, v159
  v_mfma_f32_16x16x32_bf16 v[108:111], v[160:163], v[48:51], v[108:111]
  v_max3_u32 v42, v42, v160, v161
  v_max3_u32 v43, v43, v162, v163
  v_max_u32 v42, v42, v43
  v_cmp_eq_u32 vcc, -1, v42
  s_cbranch_vccnz L_lan_b_101
  s_nop 2
  v_cvt_pk_bf16_f32 v128, v104, v105
  v_cvt_pk_bf16_f32 v129, v106, v107
  v_cvt_pk_bf16_f32 v130, v108, v109
  v_cvt_pk_bf16_f32 v131, v110, v111
  ds_write_b128 v8, v[128:131]
  s_nop 0
  v_smfmac_f32_16x16x64_bf16 v[60:63], v[128:131], a[16:23], v3
  v_smfmac_f32_16x16x64_bf16 v[64:67], v[128:131], a[24:31], v3
  v_smfmac_f32_16x16x64_bf16 v[68:71], v[128:131], v[184:191], v3
  s_bitset0_b32 s50, 1
  s_branch L_lan_n_100
L_lan_b_101:
  buffer_load_dwordx4 v[148:151], v5, s[8:11], s46 offen offset:0 sc1
  buffer_load_dwordx4 v[152:155], v5, s[8:11], s46 offen offset:2048 sc1
  buffer_load_dwordx4 v[156:159], v5, s[8:11], s46 offen offset:256 sc1
  buffer_load_dwordx4 v[160:163], v5, s[8:11], s46 offen offset:2304 sc1
L_lan_n_100:
  s_bitcmp1_b32 s50, 2
  s_cbranch_scc0 L_lan_n_102
  v_mfma_f32_16x16x32_bf16 v[104:107], v[164:167], v[48:51], 0
  v_max3_u32 v42, v164, v165, v166
  v_mov_b32 v43, v167
  v_mfma_f32_16x16x32_bf16 v[104:107], v[168:171], v[48:51], v[104:107]
  v_max3_u32 v42, v42, v168, v169
  v_max3_u32 v43, v43, v170, v171
  v_max_u32 v42, v42, v43
  v_cmp_eq_u32 vcc, -1, v42
  s_cbranch_vccnz L_lan_b_103
  s_nop 2
  v_cvt_pk_bf16_f32 v112, v104, v105
  v_cvt_pk_bf16_f32 v113, v106, v107
  ds_write_b64 v17, v[112:113]
  s_bitset0_b32 s50, 2
  s_branch L_lan_n_102
L_lan_b_103:
  buffer_load_dwordx4 v[164:167], v6, s[8:11], s46 offen offset:0 sc1
  buffer_load_dwordx4 v[168:171], v6, s[8:11], s46 offen offset:2048 sc1
L_lan_n_102:
  s_cmp_eq_u32 s50, 0
  s_cbranch_scc1 L_lan_back_82
  s_sub_u32 s64, s64, 1
  s_cmp_lg_u32 s64, 0
  s_cbranch_scc1 L_lan_fix_81
  s_branch L_lan_fail_2
L_lan_last_89:
  buffer_store_dword v120, v26, s[8:11], s49 offen
  s_waitcnt vmcnt(0)
  s_barrier
  s_branch L_lan_done_3
L_lan_sr_93:
  buffer_load_dwordx4 v[124:127], v31, s[8:11], s42 offen sc1
  buffer_load_dwordx4 v[128:131], v32, s[8:11], s42 offen sc1
  buffer_load_dword v136, v33, s[8:11], s42 offen sc1
  buffer_load_dword v137, v35, s[8:11], s42 offen sc1
  s_sub_u32 s64, s64, 1
  s_cmp_lg_u32 s64, 0
  s_cbranch_scc1 L_lan_poll_92
  s_branch L_lan_fail_2
L_lan_r_95:
  s_nop 7
  v_mov_b32 v72, 0
  v_mov_b32 v73, 0
  v_mov_b32 v74, 0
  v_mov_b32 v75, 0
  v_mov_b32 v76, 0
  v_mov_b32 v77, 0
  v_mov_b32 v78, 0
  v_mov_b32 v79, 0
  s_sub_u32 s64, s64, 1
  s_cmp_lg_u32 s64, 0
  s_cbranch_scc1 L_lan_g_94
  s_branch L_lan_fail_2
L_lan_kvw_96:
  s_load_dwordx4 s[88:91], s[100:101], 0 glc
  s_waitcnt lgkmcnt(0)
  s_min_u32 s56, s88, s89
  s_min_u32 s56, s56, s90
  s_cmp_gt_u32 s56, s41
  s_cbranch_scc1 L_lan_kvb_97
  s_sub_u32 s64, s64, 1
  s_cmp_lg_u32 s64, 0
  s_cbranch_scc1 L_lan_kvw_96
  s_branch L_lan_fail_2
L_lan_fail_2:
  s_mov_b64 exec, 1
  v_mov_b32 v1, 262144
  v_mov_b32 v112, 1
  buffer_atomic_add v112, v1, s[8:11], 0 offen
  s_endpgm
L_lan_done_3:
  s_call_b64 s[66:67], la_mixer
  s_branch L_lan_again_1
la_fb:
  s_lshr_b32 s37, s33, 5
  s_and_b32 s34, s33, 31
  s_mul_i32 s60, s34, 86
  s_lshr_b32 s60, s60, 8
  s_mul_i32 s61, s60, 3
  s_sub_u32 s36, s34, s61
  s_lshl_b32 s35, s37, 3
  s_add_u32 s35, s35, s60
  s_mov_b32 s38, s34
  s_sub_u32 s63, s38, 20
  s_cmp_ge_u32 s38, 20
  s_cselect_b32 s38, s63, s38
  s_lshr_b32 s39, s38, 1
  s_add_u32 s39, s39, 1
  s_mov_b32 s54, 0xff00ff00
  s_mov_b32 s55, s54
  v_bfe_u32 v3, v2, 3, 3
  v_mul_u32_u24 v3, 12288, v3
  v_bfe_u32 v1, v2, 0, 3
  v_mul_u32_u24 v1, 16, v1
  v_add_u32 v3, v3, v1
  s_mov_b32 s60, 0
  s_mul_i32 s63, s35, 384
  s_add_u32 s60, s60, s63
  s_mul_i32 s63, s36, 128
  s_add_u32 s60, s60, s63
  s_mul_i32 s63, s32, 98304
  s_add_u32 s60, s60, s63
  v_add_u32 v3, s60, v3
  v_bfe_u32 v4, v2, 2, 4
  v_mul_u32_u24 v4, 1280, v4
  v_bfe_u32 v1, v2, 0, 2
  v_mul_u32_u24 v1, 16, v1
  v_add_u32 v4, v4, v1
  s_mov_b32 s60, 0
  s_mul_i32 s63, s37, 1966080
  s_add_u32 s60, s60, s63
  s_mul_i32 s63, s38, 64
  s_add_u32 s60, s60, s63
  s_mul_i32 s63, s32, 20480
  s_add_u32 s60, s60, s63
  v_add_u32 v4, s60, v4
  v_bfe_u32 v5, v2, 4, 1
  v_mul_u32_u24 v5, 2048, v5
  v_bfe_u32 v1, v2, 5, 1
  v_mul_u32_u24 v1, 512, v1
  v_add_u32 v5, v5, v1
  v_bfe_u32 v1, v2, 3, 1
  v_mul_u32_u24 v1, 4096, v1
  v_add_u32 v5, v5, v1
  v_bfe_u32 v1, v2, 2, 1
  v_mul_u32_u24 v1, 128, v1
  v_add_u32 v5, v5, v1
  v_bfe_u32 v1, v2, 0, 2
  v_mul_u32_u24 v1, 8, v1
  v_add_u32 v5, v5, v1
  s_mov_b32 s60, 0
  s_mul_i32 s63, s32, 32
  s_add_u32 s60, s60, s63
  v_add_u32 v5, s60, v5
  v_bfe_u32 v6, v2, 4, 1
  v_mul_u32_u24 v6, 1024, v6
  v_bfe_u32 v1, v2, 5, 1
  v_mul_u32_u24 v1, 256, v1
  v_add_u32 v6, v6, v1
  v_bfe_u32 v1, v2, 3, 1
  v_mul_u32_u24 v1, 2048, v1
  v_add_u32 v6, v6, v1
  v_bfe_u32 v1, v2, 2, 1
  v_mul_u32_u24 v1, 64, v1
  v_add_u32 v6, v6, v1
  v_bfe_u32 v1, v2, 0, 2
  v_mul_u32_u24 v1, 8, v1
  v_add_u32 v6, v6, v1
  s_lshl_b32 s61, s32, 10
  s_add_u32 m0, s61, 0
  s_mov_b32 s60, 0
  buffer_load_dwordx4 v3, s[12:15], s60 offen lds
  s_add_u32 m0, s61, 4096
  s_mov_b32 s60, 393216
  buffer_load_dwordx4 v3, s[12:15], s60 offen lds
  s_add_u32 m0, s61, 8192
  s_mov_b32 s60, 786432
  buffer_load_dwordx4 v3, s[12:15], s60 offen lds
  s_add_u32 m0, s61, 12288
  s_mov_b32 s60, 1179648
  buffer_load_dwordx4 v3, s[12:15], s60 offen lds
  s_add_u32 m0, s61, 16384
  s_mov_b32 s60, 1572864
  buffer_load_dwordx4 v3, s[12:15], s60 offen lds
  s_add_u32 m0, s61, 20480
  s_mov_b32 s60, 1966080
  buffer_load_dwordx4 v3, s[12:15], s60 offen lds
  s_add_u32 m0, s61, 24576
  s_mov_b32 s60, 2359296
  buffer_load_dwordx4 v3, s[12:15], s60 offen lds
  s_add_u32 m0, s61, 28672
  s_mov_b32 s60, 2752512
  buffer_load_dwordx4 v3, s[12:15], s60 offen lds
  s_add_u32 m0, s61, 32768
  s_mov_b32 s60, 3145728
  buffer_load_dwordx4 v3, s[12:15], s60 offen lds
  s_add_u32 m0, s61, 36864
  s_mov_b32 s60, 3538944
  buffer_load_dwordx4 v3, s[12:15], s60 offen lds
  s_add_u32 m0, s61, 40960
  s_mov_b32 s60, 3932160
  buffer_load_dwordx4 v3, s[12:15], s60 offen lds
  s_add_u32 m0, s61, 45056
  s_mov_b32 s60, 4325376
  buffer_load_dwordx4 v3, s[12:15], s60 offen lds
  s_add_u32 m0, s61, 49152
  s_mov_b32 s60, 4718592
  buffer_load_dwordx4 v3, s[12:15], s60 offen lds
  s_add_u32 m0, s61, 53248
  s_mov_b32 s60, 5111808
  buffer_load_dwordx4 v3, s[12:15], s60 offen lds
  s_add_u32 m0, s61, 57344
  s_mov_b32 s60, 5505024
  buffer_load_dwordx4 v3, s[12:15], s60 offen lds
  s_add_u32 m0, s61, 61440
  s_mov_b32 s60, 5898240
  buffer_load_dwordx4 v3, s[12:15], s60 offen lds
  s_add_u32 m0, s61, 65536
  s_mov_b32 s60, 6291456
  buffer_load_dwordx4 v3, s[12:15], s60 offen lds
  s_add_u32 m0, s61, 69632
  s_mov_b32 s60, 6684672
  buffer_load_dwordx4 v3, s[12:15], s60 offen lds
  s_add_u32 m0, s61, 73728
  s_mov_b32 s60, 7077888
  buffer_load_dwordx4 v3, s[12:15], s60 offen lds
  s_add_u32 m0, s61, 77824
  s_mov_b32 s60, 7471104
  buffer_load_dwordx4 v3, s[12:15], s60 offen lds
  s_lshl_b32 s61, s32, 10
  s_add_u32 m0, s61, 81920
  s_mov_b32 s60, 0
  buffer_load_dwordx4 v3, s[16:19], s60 offen lds
  s_add_u32 m0, s61, 86016
  s_mov_b32 s60, 393216
  buffer_load_dwordx4 v3, s[16:19], s60 offen lds
  s_add_u32 m0, s61, 90112
  s_mov_b32 s60, 786432
  buffer_load_dwordx4 v3, s[16:19], s60 offen lds
  s_add_u32 m0, s61, 94208
  s_mov_b32 s60, 1179648
  buffer_load_dwordx4 v3, s[16:19], s60 offen lds
  s_add_u32 m0, s61, 98304
  s_mov_b32 s60, 1572864
  buffer_load_dwordx4 v3, s[16:19], s60 offen lds
  s_add_u32 m0, s61, 102400
  s_mov_b32 s60, 1966080
  buffer_load_dwordx4 v3, s[16:19], s60 offen lds
  s_add_u32 m0, s61, 106496
  s_mov_b32 s60, 2359296
  buffer_load_dwordx4 v3, s[16:19], s60 offen lds
  s_add_u32 m0, s61, 110592
  s_mov_b32 s60, 2752512
  buffer_load_dwordx4 v3, s[16:19], s60 offen lds
  s_add_u32 m0, s61, 114688
  s_mov_b32 s60, 3145728
  buffer_load_dwordx4 v3, s[16:19], s60 offen lds
  s_add_u32 m0, s61, 118784
  s_mov_b32 s60, 3538944
  buffer_load_dwordx4 v3, s[16:19], s60 offen lds
  s_add_u32 m0, s61, 122880
  s_mov_b32 s60, 3932160
  buffer_load_dwordx4 v3, s[16:19], s60 offen lds
  s_add_u32 m0, s61, 126976
  s_mov_b32 s60, 4325376
  buffer_load_dwordx4 v3, s[16:19], s60 offen lds
  s_add_u32 m0, s61, 131072
  s_mov_b32 s60, 4718592
  buffer_load_dwordx4 v3, s[16:19], s60 offen lds
  s_add_u32 m0, s61, 135168
  s_mov_b32 s60, 5111808
  buffer_load_dwordx4 v3, s[16:19], s60 offen lds
  s_add_u32 m0, s61, 139264
  s_mov_b32 s60, 5505024
  buffer_load_dwordx4 v3, s[16:19], s60 offen lds
  s_add_u32 m0, s61, 143360
  s_mov_b32 s60, 5898240
  buffer_load_dwordx4 v3, s[16:19], s60 offen lds
  s_add_u32 m0, s61, 147456
  s_mov_b32 s60, 6291456
  buffer_load_dwordx4 v3, s[16:19], s60 offen lds
  s_add_u32 m0, s61, 151552
  s_mov_b32 s60, 6684672
  buffer_load_dwordx4 v3, s[16:19], s60 offen lds
  s_add_u32 m0, s61, 155648
  s_mov_b32 s60, 7077888
  buffer_load_dwordx4 v3, s[16:19], s60 offen lds
  s_add_u32 m0, s61, 159744
  s_mov_b32 s60, 7471104
  buffer_load_dwordx4 v3, s[16:19], s60 offen lds
  s_waitcnt vmcnt(20)
  s_barrier
  s_add_u32 s60, s32, 0
  s_and_b32 s60, s60, 3
  s_add_u32 s60, s60, 0
  s_add_u32 s60, s60, s39
  s_sub_u32 s63, s60, 10
  s_cmp_ge_u32 s60, 10
  s_cselect_b32 s60, s63, s60
  s_lshl_b32 s60, s60, 13
  s_add_u32 s60, s60, 0
  v_add_u32 v1, s60, v5
  ds_read_b64_tr_b16 a[0:1], v1 offset:0
  ds_read_b64_tr_b16 a[2:3], v1 offset:256
  ds_read_b64_tr_b16 a[4:5], v1 offset:1024
  ds_read_b64_tr_b16 a[6:7], v1 offset:1280
  s_add_u32 s60, s32, 0
  s_and_b32 s60, s60, 3
  s_add_u32 s60, s60, 4
  s_add_u32 s60, s60, s39
  s_sub_u32 s63, s60, 10
  s_cmp_ge_u32 s60, 10
  s_cselect_b32 s60, s63, s60
  s_lshl_b32 s60, s60, 13
  s_add_u32 s60, s60, 0
  v_add_u32 v1, s60, v5
  ds_read_b64_tr_b16 a[16:17], v1 offset:0
  ds_read_b64_tr_b16 a[18:19], v1 offset:256
  ds_read_b64_tr_b16 a[20:21], v1 offset:1024
  ds_read_b64_tr_b16 a[22:23], v1 offset:1280
  s_add_u32 s60, s32, 1
  s_and_b32 s60, s60, 3
  s_add_u32 s60, s60, 0
  s_add_u32 s60, s60, s39
  s_sub_u32 s63, s60, 10
  s_cmp_ge_u32 s60, 10
  s_cselect_b32 s60, s63, s60
  s_lshl_b32 s60, s60, 13
  s_add_u32 s60, s60, 0
  v_add_u32 v1, s60, v5
  ds_read_b64_tr_b16 a[32:33], v1 offset:0
  ds_read_b64_tr_b16 a[34:35], v1 offset:256
  ds_read_b64_tr_b16 a[36:37], v1 offset:1024
  ds_read_b64_tr_b16 a[38:39], v1 offset:1280
  s_waitcnt lgkmcnt(0)
  s_add_u32 s60, s32, 1
  s_and_b32 s60, s60, 3
  s_add_u32 s60, s60, 4
  s_add_u32 s60, s60, s39
  s_sub_u32 s63, s60, 10
  s_cmp_ge_u32 s60, 10
  s_cselect_b32 s60, s63, s60
  s_lshl_b32 s60, s60, 13
  s_add_u32 s60, s60, 0
  v_add_u32 v1, s60, v5
  ds_read_b64_tr_b16 a[48:49], v1 offset:0
  ds_read_b64_tr_b16 a[50:51], v1 offset:256
  ds_read_b64_tr_b16 a[52:53], v1 offset:1024
  ds_read_b64_tr_b16 a[54:55], v1 offset:1280
  s_add_u32 s60, s32, 2
  s_and_b32 s60, s60, 3
  s_add_u32 s60, s60, 0
  s_add_u32 s60, s60, s39
  s_sub_u32 s63, s60, 10
  s_cmp_ge_u32 s60, 10
  s_cselect_b32 s60, s63, s60
  s_lshl_b32 s60, s60, 13
  s_add_u32 s60, s60, 0
  v_add_u32 v1, s60, v5
  ds_read_b64_tr_b16 a[64:65], v1 offset:0
  ds_read_b64_tr_b16 a[66:67], v1 offset:256
  ds_read_b64_tr_b16 a[68:69], v1 offset:1024
  ds_read_b64_tr_b16 a[70:71], v1 offset:1280
  s_add_u32 s60, s32, 2
  s_and_b32 s60, s60, 3
  s_add_u32 s60, s60, 4
  s_add_u32 s60, s60, s39
  s_sub_u32 s63, s60, 10
  s_cmp_ge_u32 s60, 10
  s_cselect_b32 s60, s63, s60
  s_lshl_b32 s60, s60, 13
  s_add_u32 s60, s60, 0
  v_add_u32 v1, s60, v5
  ds_read_b64_tr_b16 a[80:81], v1 offset:0
  ds_read_b64_tr_b16 a[82:83], v1 offset:256
  ds_read_b64_tr_b16 a[84:85], v1 offset:1024
  ds_read_b64_tr_b16 a[86:87], v1 offset:1280
  s_waitcnt lgkmcnt(0)
  s_add_u32 s60, s32, 3
  s_and_b32 s60, s60, 3
  s_add_u32 s60, s60, 0
  s_add_u32 s60, s60, s39
  s_sub_u32 s63, s60, 10
  s_cmp_ge_u32 s60, 10
  s_cselect_b32 s60, s63, s60
  s_lshl_b32 s60, s60, 13
  s_add_u32 s60, s60, 0
  v_add_u32 v1, s60, v5
  ds_read_b64_tr_b16 a[96:97], v1 offset:0
  ds_read_b64_tr_b16 a[98:99], v1 offset:256
  ds_read_b64_tr_b16 a[100:101], v1 offset:1024
  ds_read_b64_tr_b16 a[102:103], v1 offset:1280
  s_add_u32 s60, s32, 3
  s_and_b32 s60, s60, 3
  s_add_u32 s60, s60, 4
  s_add_u32 s60, s60, s39
  s_sub_u32 s63, s60, 10
  s_cmp_ge_u32 s60, 10
  s_cselect_b32 s60, s63, s60
  s_lshl_b32 s60, s60, 13
  s_add_u32 s60, s60, 0
  v_add_u32 v1, s60, v5
  ds_read_b64_tr_b16 a[112:113], v1 offset:0
  ds_read_b64_tr_b16 a[114:115], v1 offset:256
  ds_read_b64_tr_b16 a[116:117], v1 offset:1024
  ds_read_b64_tr_b16 a[118:119], v1 offset:1280
  s_add_u32 s60, s39, 8
  s_sub_u32 s63, s60, 10
  s_cmp_ge_u32 s60, 10
  s_cselect_b32 s60, s63, s60
  s_lshl_b32 s60, s60, 13
  s_add_u32 s60, s60, 0
  v_add_u32 v1, s60, v5
  ds_read_b64_tr_b16 a[128:129], v1 offset:0
  ds_read_b64_tr_b16 a[130:131], v1 offset:256
  ds_read_b64_tr_b16 a[132:133], v1 offset:1024
  ds_read_b64_tr_b16 a[134:135], v1 offset:1280
  s_waitcnt lgkmcnt(0)
  s_add_u32 s60, s39, 9
  s_sub_u32 s63, s60, 10
  s_cmp_ge_u32 s60, 10
  s_cselect_b32 s60, s63, s60
  s_lshl_b32 s60, s60, 13
  s_add_u32 s60, s60, 0
  v_add_u32 v1, s60, v5
  ds_read_b64_tr_b16 a[144:145], v1 offset:0
  ds_read_b64_tr_b16 a[146:147], v1 offset:256
  ds_read_b64_tr_b16 a[148:149], v1 offset:1024
  ds_read_b64_tr_b16 a[150:151], v1 offset:1280
  s_waitcnt lgkmcnt(0)
  s_barrier
  s_call_b64 s[60:61], la_arrive
  s_lshl_b32 s61, s32, 10
  s_add_u32 m0, s61, 0
  s_mov_b32 s60, 0
  buffer_load_dwordx4 v3, s[20:23], s60 offen lds
  s_add_u32 m0, s61, 4096
  s_mov_b32 s60, 393216
  buffer_load_dwordx4 v3, s[20:23], s60 offen lds
  s_add_u32 m0, s61, 8192
  s_mov_b32 s60, 786432
  buffer_load_dwordx4 v3, s[20:23], s60 offen lds
  s_add_u32 m0, s61, 12288
  s_mov_b32 s60, 1179648
  buffer_load_dwordx4 v3, s[20:23], s60 offen lds
  s_add_u32 m0, s61, 16384
  s_mov_b32 s60, 1572864
  buffer_load_dwordx4 v3, s[20:23], s60 offen lds
  s_add_u32 m0, s61, 20480
  s_mov_b32 s60, 1966080
  buffer_load_dwordx4 v3, s[20:23], s60 offen lds
  s_add_u32 m0, s61, 24576
  s_mov_b32 s60, 2359296
  buffer_load_dwordx4 v3, s[20:23], s60 offen lds
  s_add_u32 m0, s61, 28672
  s_mov_b32 s60, 2752512
  buffer_load_dwordx4 v3, s[20:23], s60 offen lds
  s_add_u32 m0, s61, 32768
  s_mov_b32 s60, 3145728
  buffer_load_dwordx4 v3, s[20:23], s60 offen lds
  s_add_u32 m0, s61, 36864
  s_mov_b32 s60, 3538944
  buffer_load_dwordx4 v3, s[20:23], s60 offen lds
  s_add_u32 m0, s61, 40960
  s_mov_b32 s60, 3932160
  buffer_load_dwordx4 v3, s[20:23], s60 offen lds
  s_add_u32 m0, s61, 45056
  s_mov_b32 s60, 4325376
  buffer_load_dwordx4 v3, s[20:23], s60 offen lds
  s_add_u32 m0, s61, 49152
  s_mov_b32 s60, 4718592
  buffer_load_dwordx4 v3, s[20:23], s60 offen lds
  s_add_u32 m0, s61, 53248
  s_mov_b32 s60, 5111808
  buffer_load_dwordx4 v3, s[20:23], s60 offen lds
  s_add_u32 m0, s61, 57344
  s_mov_b32 s60, 5505024
  buffer_load_dwordx4 v3, s[20:23], s60 offen lds
  s_add_u32 m0, s61, 61440
  s_mov_b32 s60, 5898240
  buffer_load_dwordx4 v3, s[20:23], s60 offen lds
  s_add_u32 m0, s61, 65536
  s_mov_b32 s60, 6291456
  buffer_load_dwordx4 v3, s[20:23], s60 offen lds
  s_add_u32 m0, s61, 69632
  s_mov_b32 s60, 6684672
  buffer_load_dwordx4 v3, s[20:23], s60 offen lds
  s_add_u32 m0, s61, 73728
  s_mov_b32 s60, 7077888
  buffer_load_dwordx4 v3, s[20:23], s60 offen lds
  s_add_u32 m0, s61, 77824
  s_mov_b32 s60, 7471104
  buffer_load_dwordx4 v3, s[20:23], s60 offen lds
  s_waitcnt vmcnt(20)
  s_barrier
  s_add_u32 s60, s32, 0
  s_and_b32 s60, s60, 3
  s_add_u32 s60, s60, 0
  s_add_u32 s60, s60, s39
  s_sub_u32 s63, s60, 10
  s_cmp_ge_u32 s60, 10
  s_cselect_b32 s60, s63, s60
  s_lshl_b32 s60, s60, 13
  s_add_u32 s60, s60, 81920
  v_add_u32 v1, s60, v5
  ds_read_b64_tr_b16 a[8:9], v1 offset:0
  ds_read_b64_tr_b16 a[10:11], v1 offset:256
  ds_read_b64_tr_b16 a[12:13], v1 offset:1024
  ds_read_b64_tr_b16 a[14:15], v1 offset:1280
  s_add_u32 s60, s32, 0
  s_and_b32 s60, s60, 3
  s_add_u32 s60, s60, 4
  s_add_u32 s60, s60, s39
  s_sub_u32 s63, s60, 10
  s_cmp_ge_u32 s60, 10
  s_cselect_b32 s60, s63, s60
  s_lshl_b32 s60, s60, 13
  s_add_u32 s60, s60, 81920
  v_add_u32 v1, s60, v5
  ds_read_b64_tr_b16 a[24:25], v1 offset:0
  ds_read_b64_tr_b16 a[26:27], v1 offset:256
  ds_read_b64_tr_b16 a[28:29], v1 offset:1024
  ds_read_b64_tr_b16 a[30:31], v1 offset:1280
  s_add_u32 s60, s32, 1
  s_and_b32 s60, s60, 3
  s_add_u32 s60, s60, 0
  s_add_u32 s60, s60, s39
  s_sub_u32 s63, s60, 10
  s_cmp_ge_u32 s60, 10
  s_cselect_b32 s60, s63, s60
  s_lshl_b32 s60, s60, 13
  s_add_u32 s60, s60, 81920
  v_add_u32 v1, s60, v5
  ds_read_b64_tr_b16 a[40:41], v1 offset:0
  ds_read_b64_tr_b16 a[42:43], v1 offset:256
  ds_read_b64_tr_b16 a[44:45], v1 offset:1024
  ds_read_b64_tr_b16 a[46:47], v1 offset:1280
  s_waitcnt lgkmcnt(0)
  s_add_u32 s60, s32, 1
  s_and_b32 s60, s60, 3
  s_add_u32 s60, s60, 4
  s_add_u32 s60, s60, s39
  s_sub_u32 s63, s60, 10
  s_cmp_ge_u32 s60, 10
  s_cselect_b32 s60, s63, s60
  s_lshl_b32 s60, s60, 13
  s_add_u32 s60, s60, 81920
  v_add_u32 v1, s60, v5
  ds_read_b64_tr_b16 a[56:57], v1 offset:0
  ds_read_b64_tr_b16 a[58:59], v1 offset:256
  ds_read_b64_tr_b16 a[60:61], v1 offset:1024
  ds_read_b64_tr_b16 a[62:63], v1 offset:1280
  s_add_u32 s60, s32, 2
  s_and_b32 s60, s60, 3
  s_add_u32 s60, s60, 0
  s_add_u32 s60, s60, s39
  s_sub_u32 s63, s60, 10
  s_cmp_ge_u32 s60, 10
  s_cselect_b32 s60, s63, s60
  s_lshl_b32 s60, s60, 13
  s_add_u32 s60, s60, 81920
  v_add_u32 v1, s60, v5
  ds_read_b64_tr_b16 a[72:73], v1 offset:0
  ds_read_b64_tr_b16 a[74:75], v1 offset:256
  ds_read_b64_tr_b16 a[76:77], v1 offset:1024
  ds_read_b64_tr_b16 a[78:79], v1 offset:1280
  s_add_u32 s60, s32, 2
  s_and_b32 s60, s60, 3
  s_add_u32 s60, s60, 4
  s_add_u32 s60, s60, s39
  s_sub_u32 s63, s60, 10
  s_cmp_ge_u32 s60, 10
  s_cselect_b32 s60, s63, s60
  s_lshl_b32 s60, s60, 13
  s_add_u32 s60, s60, 81920
  v_add_u32 v1, s60, v5
  ds_read_b64_tr_b16 a[88:89], v1 offset:0
  ds_read_b64_tr_b16 a[90:91], v1 offset:256
  ds_read_b64_tr_b16 a[92:93], v1 offset:1024
  ds_read_b64_tr_b16 a[94:95], v1 offset:1280
  s_waitcnt lgkmcnt(0)
  s_add_u32 s60, s32, 3
  s_and_b32 s60, s60, 3
  s_add_u32 s60, s60, 0
  s_add_u32 s60, s60, s39
  s_sub_u32 s63, s60, 10
  s_cmp_ge_u32 s60, 10
  s_cselect_b32 s60, s63, s60
  s_lshl_b32 s60, s60, 13
  s_add_u32 s60, s60, 81920
  v_add_u32 v1, s60, v5
  ds_read_b64_tr_b16 a[104:105], v1 offset:0
  ds_read_b64_tr_b16 a[106:107], v1 offset:256
  ds_read_b64_tr_b16 a[108:109], v1 offset:1024
  ds_read_b64_tr_b16 a[110:111], v1 offset:1280
  s_add_u32 s60, s32, 3
  s_and_b32 s60, s60, 3
  s_add_u32 s60, s60, 4
  s_add_u32 s60, s60, s39
  s_sub_u32 s63, s60, 10
  s_cmp_ge_u32 s60, 10
  s_cselect_b32 s60, s63, s60
  s_lshl_b32 s60, s60, 13
  s_add_u32 s60, s60, 81920
  v_add_u32 v1, s60, v5
  ds_read_b64_tr_b16 a[120:121], v1 offset:0
  ds_read_b64_tr_b16 a[122:123], v1 offset:256
  ds_read_b64_tr_b16 a[124:125], v1 offset:1024
  ds_read_b64_tr_b16 a[126:127], v1 offset:1280
  s_add_u32 s60, s39, 8
  s_sub_u32 s63, s60, 10
  s_cmp_ge_u32 s60, 10
  s_cselect_b32 s60, s63, s60
  s_lshl_b32 s60, s60, 13
  s_add_u32 s60, s60, 81920
  v_add_u32 v1, s60, v5
  ds_read_b64_tr_b16 a[136:137], v1 offset:0
  ds_read_b64_tr_b16 a[138:139], v1 offset:256
  ds_read_b64_tr_b16 a[140:141], v1 offset:1024
  ds_read_b64_tr_b16 a[142:143], v1 offset:1280
  s_waitcnt lgkmcnt(0)
  s_add_u32 s60, s39, 9
  s_sub_u32 s63, s60, 10
  s_cmp_ge_u32 s60, 10
  s_cselect_b32 s60, s63, s60
  s_lshl_b32 s60, s60, 13
  s_add_u32 s60, s60, 81920
  v_add_u32 v1, s60, v5
  ds_read_b64_tr_b16 a[152:153], v1 offset:0
  ds_read_b64_tr_b16 a[154:155], v1 offset:256
  ds_read_b64_tr_b16 a[156:157], v1 offset:1024
  ds_read_b64_tr_b16 a[158:159], v1 offset:1280
  s_waitcnt lgkmcnt(0)
  s_barrier
  s_lshl_b32 s61, s32, 10
  s_add_u32 m0, s61, 81920
  s_mov_b32 s60, 0
  buffer_load_dwordx4 v4, s[24:27], s60 offen lds
  s_add_u32 m0, s61, 86016
  s_mov_b32 s60, 81920
  buffer_load_dwordx4 v4, s[24:27], s60 offen lds
  s_add_u32 m0, s61, 90112
  s_mov_b32 s60, 163840
  buffer_load_dwordx4 v4, s[24:27], s60 offen lds
  s_add_u32 m0, s61, 94208
  s_mov_b32 s60, 245760
  buffer_load_dwordx4 v4, s[24:27], s60 offen lds
  s_add_u32 m0, s61, 98304
  s_mov_b32 s60, 327680
  buffer_load_dwordx4 v4, s[24:27], s60 offen lds
  s_add_u32 m0, s61, 102400
  s_mov_b32 s60, 409600
  buffer_load_dwordx4 v4, s[24:27], s60 offen lds
  s_add_u32 m0, s61, 106496
  s_mov_b32 s60, 491520
  buffer_load_dwordx4 v4, s[24:27], s60 offen lds
  s_add_u32 m0, s61, 110592
  s_mov_b32 s60, 573440
  buffer_load_dwordx4 v4, s[24:27], s60 offen lds
  s_add_u32 m0, s61, 114688
  s_mov_b32 s60, 655360
  buffer_load_dwordx4 v4, s[24:27], s60 offen lds
  s_add_u32 m0, s61, 118784
  s_mov_b32 s60, 737280
  buffer_load_dwordx4 v4, s[24:27], s60 offen lds
  s_add_u32 m0, s61, 122880
  s_mov_b32 s60, 819200
  buffer_load_dwordx4 v4, s[24:27], s60 offen lds
  s_add_u32 m0, s61, 126976
  s_mov_b32 s60, 901120
  buffer_load_dwordx4 v4, s[24:27], s60 offen lds
  s_add_u32 m0, s61, 131072
  s_mov_b32 s60, 983040
  buffer_load_dwordx4 v4, s[24:27], s60 offen lds
  s_add_u32 m0, s61, 135168
  s_mov_b32 s60, 1064960
  buffer_load_dwordx4 v4, s[24:27], s60 offen lds
  s_add_u32 m0, s61, 139264
  s_mov_b32 s60, 1146880
  buffer_load_dwordx4 v4, s[24:27], s60 offen lds
  s_add_u32 m0, s61, 143360
  s_mov_b32 s60, 1228800
  buffer_load_dwordx4 v4, s[24:27], s60 offen lds
  s_add_u32 m0, s61, 147456
  s_mov_b32 s60, 1310720
  buffer_load_dwordx4 v4, s[24:27], s60 offen lds
  s_add_u32 m0, s61, 151552
  s_mov_b32 s60, 1392640
  buffer_load_dwordx4 v4, s[24:27], s60 offen lds
  s_add_u32 m0, s61, 155648
  s_mov_b32 s60, 1474560
  buffer_load_dwordx4 v4, s[24:27], s60 offen lds
  s_add_u32 m0, s61, 159744
  s_mov_b32 s60, 1556480
  buffer_load_dwordx4 v4, s[24:27], s60 offen lds
  s_waitcnt vmcnt(20)
  s_barrier
  s_add_u32 s60, s32, 0
  s_and_b32 s60, s60, 3
  s_add_u32 s60, s60, 0
  s_add_u32 s60, s60, s39
  s_sub_u32 s63, s60, 10
  s_cmp_ge_u32 s60, 10
  s_cselect_b32 s60, s63, s60
  s_lshl_b32 s60, s60, 13
  s_add_u32 s60, s60, 0
  v_add_u32 v1, s60, v5
  ds_read_b64_tr_b16 v[176:177], v1 offset:0
  ds_read_b64_tr_b16 v[178:179], v1 offset:256
  ds_read_b64_tr_b16 v[180:181], v1 offset:1024
  ds_read_b64_tr_b16 v[182:183], v1 offset:1280
  s_add_u32 s60, s32, 0
  s_and_b32 s60, s60, 3
  s_add_u32 s60, s60, 4
  s_add_u32 s60, s60, s39
  s_sub_u32 s63, s60, 10
  s_cmp_ge_u32 s60, 10
  s_cselect_b32 s60, s63, s60
  s_lshl_b32 s60, s60, 13
  s_add_u32 s60, s60, 0
  v_add_u32 v1, s60, v5
  ds_read_b64_tr_b16 v[184:185], v1 offset:0
  ds_read_b64_tr_b16 v[186:187], v1 offset:256
  ds_read_b64_tr_b16 v[188:189], v1 offset:1024
  ds_read_b64_tr_b16 v[190:191], v1 offset:1280
  s_add_u32 s60, s32, 1
  s_and_b32 s60, s60, 3
  s_add_u32 s60, s60, 0
  s_add_u32 s60, s60, s39
  s_sub_u32 s63, s60, 10
  s_cmp_ge_u32 s60, 10
  s_cselect_b32 s60, s63, s60
  s_lshl_b32 s60, s60, 13
  s_add_u32 s60, s60, 0
  v_add_u32 v1, s60, v5
  ds_read_b64_tr_b16 v[192:193], v1 offset:0
  ds_read_b64_tr_b16 v[194:195], v1 offset:256
  ds_read_b64_tr_b16 v[196:197], v1 offset:1024
  ds_read_b64_tr_b16 v[198:199], v1 offset:1280
  s_waitcnt lgkmcnt(0)
  s_add_u32 s60, s32, 1
  s_and_b32 s60, s60, 3
  s_add_u32 s60, s60, 4
  s_add_u32 s60, s60, s39
  s_sub_u32 s63, s60, 10
  s_cmp_ge_u32 s60, 10
  s_cselect_b32 s60, s63, s60
  s_lshl_b32 s60, s60, 13
  s_add_u32 s60, s60, 0
  v_add_u32 v1, s60, v5
  ds_read_b64_tr_b16 v[200:201], v1 offset:0
  ds_read_b64_tr_b16 v[202:203], v1 offset:256
  ds_read_b64_tr_b16 v[204:205], v1 offset:1024
  ds_read_b64_tr_b16 v[206:207], v1 offset:1280
  s_add_u32 s60, s32, 2
  s_and_b32 s60, s60, 3
  s_add_u32 s60, s60, 0
  s_add_u32 s60, s60, s39
  s_sub_u32 s63, s60, 10
  s_cmp_ge_u32 s60, 10
  s_cselect_b32 s60, s63, s60
  s_lshl_b32 s60, s60, 13
  s_add_u32 s60, s60, 0
  v_add_u32 v1, s60, v5
  ds_read_b64_tr_b16 v[208:209], v1 offset:0
  ds_read_b64_tr_b16 v[210:211], v1 offset:256
  ds_read_b64_tr_b16 v[212:213], v1 offset:1024
  ds_read_b64_tr_b16 v[214:215], v1 offset:1280
  s_add_u32 s60, s32, 2
  s_and_b32 s60, s60, 3
  s_add_u32 s60, s60, 4
  s_add_u32 s60, s60, s39
  s_sub_u32 s63, s60, 10
  s_cmp_ge_u32 s60, 10
  s_cselect_b32 s60, s63, s60
  s_lshl_b32 s60, s60, 13
  s_add_u32 s60, s60, 0
  v_add_u32 v1, s60, v5
  ds_read_b64_tr_b16 v[216:217], v1 offset:0
  ds_read_b64_tr_b16 v[218:219], v1 offset:256
  ds_read_b64_tr_b16 v[220:221], v1 offset:1024
  ds_read_b64_tr_b16 v[222:223], v1 offset:1280
  s_waitcnt lgkmcnt(0)
  s_add_u32 s60, s32, 3
  s_and_b32 s60, s60, 3
  s_add_u32 s60, s60, 0
  s_add_u32 s60, s60, s39
  s_sub_u32 s63, s60, 10
  s_cmp_ge_u32 s60, 10
  s_cselect_b32 s60, s63, s60
  s_lshl_b32 s60, s60, 13
  s_add_u32 s60, s60, 0
  v_add_u32 v1, s60, v5
  ds_read_b64_tr_b16 v[224:225], v1 offset:0
  ds_read_b64_tr_b16 v[226:227], v1 offset:256
  ds_read_b64_tr_b16 v[228:229], v1 offset:1024
  ds_read_b64_tr_b16 v[230:231], v1 offset:1280
  s_add_u32 s60, s32, 3
  s_and_b32 s60, s60, 3
  s_add_u32 s60, s60, 4
  s_add_u32 s60, s60, s39
  s_sub_u32 s63, s60, 10
  s_cmp_ge_u32 s60, 10
  s_cselect_b32 s60, s63, s60
  s_lshl_b32 s60, s60, 13
  s_add_u32 s60, s60, 0
  v_add_u32 v1, s60, v5
  ds_read_b64_tr_b16 v[232:233], v1 offset:0
  ds_read_b64_tr_b16 v[234:235], v1 offset:256
  ds_read_b64_tr_b16 v[236:237], v1 offset:1024
  ds_read_b64_tr_b16 v[238:239], v1 offset:1280
  s_add_u32 s60, s39, 8
  s_sub_u32 s63, s60, 10
  s_cmp_ge_u32 s60, 10
  s_cselect_b32 s60, s63, s60
  s_lshl_b32 s60, s60, 13
  s_add_u32 s60, s60, 0
  v_add_u32 v1, s60, v5
  ds_read_b64_tr_b16 v[240:241], v1 offset:0
  ds_read_b64_tr_b16 v[242:243], v1 offset:256
  ds_read_b64_tr_b16 v[244:245], v1 offset:1024
  ds_read_b64_tr_b16 v[246:247], v1 offset:1280
  s_waitcnt lgkmcnt(0)
  s_add_u32 s60, s39, 9
  s_sub_u32 s63, s60, 10
  s_cmp_ge_u32 s60, 10
  s_cselect_b32 s60, s63, s60
  s_lshl_b32 s60, s60, 13
  s_add_u32 s60, s60, 0
  v_add_u32 v1, s60, v5
  ds_read_b64_tr_b16 v[248:249], v1 offset:0
  ds_read_b64_tr_b16 v[250:251], v1 offset:256
  ds_read_b64_tr_b16 v[252:253], v1 offset:1024
  ds_read_b64_tr_b16 v[254:255], v1 offset:1280
  s_waitcnt lgkmcnt(0)
  s_barrier
  s_lshl_b32 s61, s32, 10
  s_add_u32 m0, s61, 0
  s_mov_b32 s60, 1638400
  buffer_load_dwordx4 v4, s[24:27], s60 offen lds
  s_add_u32 m0, s61, 4096
  s_mov_b32 s60, 1720320
  buffer_load_dwordx4 v4, s[24:27], s60 offen lds
  s_add_u32 m0, s61, 8192
  s_mov_b32 s60, 1802240
  buffer_load_dwordx4 v4, s[24:27], s60 offen lds
  s_add_u32 m0, s61, 12288
  s_mov_b32 s60, 1884160
  buffer_load_dwordx4 v4, s[24:27], s60 offen lds
  s_call_b64 s[60:61], la_census
  s_waitcnt vmcnt(0)
  s_barrier
  s_add_u32 s60, s32, 1
  s_and_b32 s60, s60, 3
  s_mul_i32 s60, s60, 6
  s_add_u32 s60, s60, s34
  s_add_u32 s60, s60, 0
  s_sub_u32 s63, s60, 24
  s_cmp_ge_u32 s60, 24
  s_cselect_b32 s60, s63, s60
  s_lshl_b32 s60, s60, 12
  s_add_u32 s60, s60, 81920
  s_sub_u32 s63, s60, 163840
  s_cmp_ge_u32 s60, 163840
  s_cselect_b32 s60, s63, s60
  v_add_u32 v1, s60, v6
  ds_read_b64_tr_b16 a[160:161], v1 offset:0
  ds_read_b64_tr_b16 a[162:163], v1 offset:128
  ds_read_b64_tr_b16 a[164:165], v1 offset:512
  ds_read_b64_tr_b16 a[166:167], v1 offset:640
  ds_read_b64_tr_b16 a[168:169], v1 offset:32
  ds_read_b64_tr_b16 a[170:171], v1 offset:160
  ds_read_b64_tr_b16 a[172:173], v1 offset:544
  ds_read_b64_tr_b16 a[174:175], v1 offset:672
  s_waitcnt lgkmcnt(0)
  s_add_u32 s60, s32, 1
  s_and_b32 s60, s60, 3
  s_mul_i32 s60, s60, 6
  s_add_u32 s60, s60, s34
  s_add_u32 s60, s60, 1
  s_sub_u32 s63, s60, 24
  s_cmp_ge_u32 s60, 24
  s_cselect_b32 s60, s63, s60
  s_lshl_b32 s60, s60, 12
  s_add_u32 s60, s60, 81920
  s_sub_u32 s63, s60, 163840
  s_cmp_ge_u32 s60, 163840
  s_cselect_b32 s60, s63, s60
  v_add_u32 v1, s60, v6
  ds_read_b64_tr_b16 a[176:177], v1 offset:0
  ds_read_b64_tr_b16 a[178:179], v1 offset:128
  ds_read_b64_tr_b16 a[180:181], v1 offset:512
  ds_read_b64_tr_b16 a[182:183], v1 offset:640
  ds_read_b64_tr_b16 a[184:185], v1 offset:32
  ds_read_b64_tr_b16 a[186:187], v1 offset:160
  ds_read_b64_tr_b16 a[188:189], v1 offset:544
  ds_read_b64_tr_b16 a[190:191], v1 offset:672
  s_waitcnt lgkmcnt(0)
  s_add_u32 s60, s32, 1
  s_and_b32 s60, s60, 3
  s_mul_i32 s60, s60, 6
  s_add_u32 s60, s60, s34
  s_add_u32 s60, s60, 2
  s_sub_u32 s63, s60, 24
  s_cmp_ge_u32 s60, 24
  s_cselect_b32 s60, s63, s60
  s_lshl_b32 s60, s60, 12
  s_add_u32 s60, s60, 81920
  s_sub_u32 s63, s60, 163840
  s_cmp_ge_u32 s60, 163840
  s_cselect_b32 s60, s63, s60
  v_add_u32 v1, s60, v6
  ds_read_b64_tr_b16 a[192:193], v1 offset:0
  ds_read_b64_tr_b16 a[194:195], v1 offset:128
  ds_read_b64_tr_b16 a[196:197], v1 offset:512
  ds_read_b64_tr_b16 a[198:199], v1 offset:640
  ds_read_b64_tr_b16 a[200:201], v1 offset:32
  ds_read_b64_tr_b16 a[202:203], v1 offset:160
  ds_read_b64_tr_b16 a[204:205], v1 offset:544
  ds_read_b64_tr_b16 a[206:207], v1 offset:672
  s_waitcnt lgkmcnt(0)
  s_add_u32 s60, s32, 1
  s_and_b32 s60, s60, 3
  s_mul_i32 s60, s60, 6
  s_add_u32 s60, s60, s34
  s_add_u32 s60, s60, 3
  s_sub_u32 s63, s60, 24
  s_cmp_ge_u32 s60, 24
  s_cselect_b32 s60, s63, s60
  s_lshl_b32 s60, s60, 12
  s_add_u32 s60, s60, 81920
  s_sub_u32 s63, s60, 163840
  s_cmp_ge_u32 s60, 163840
  s_cselect_b32 s60, s63, s60
  v_add_u32 v1, s60, v6
  ds_read_b64_tr_b16 a[208:209], v1 offset:0
  ds_read_b64_tr_b16 a[210:211], v1 offset:128
  ds_read_b64_tr_b16 a[212:213], v1 offset:512
  ds_read_b64_tr_b16 a[214:215], v1 offset:640
  ds_read_b64_tr_b16 a[216:217], v1 offset:32
  ds_read_b64_tr_b16 a[218:219], v1 offset:160
  ds_read_b64_tr_b16 a[220:221], v1 offset:544
  ds_read_b64_tr_b16 a[222:223], v1 offset:672
  s_waitcnt lgkmcnt(0)
  s_add_u32 s60, s32, 1
  s_and_b32 s60, s60, 3
  s_mul_i32 s60, s60, 6
  s_add_u32 s60, s60, s34
  s_add_u32 s60, s60, 4
  s_sub_u32 s63, s60, 24
  s_cmp_ge_u32 s60, 24
  s_cselect_b32 s60, s63, s60
  s_lshl_b32 s60, s60, 12
  s_add_u32 s60, s60, 81920
  s_sub_u32 s63, s60, 163840
  s_cmp_ge_u32 s60, 163840
  s_cselect_b32 s60, s63, s60
  v_add_u32 v1, s60, v6
  ds_read_b64_tr_b16 a[224:225], v1 offset:0
  ds_read_b64_tr_b16 a[226:227], v1 offset:128
  ds_read_b64_tr_b16 a[228:229], v1 offset:512
  ds_read_b64_tr_b16 a[230:231], v1 offset:640
  ds_read_b64_tr_b16 a[232:233], v1 offset:32
  ds_read_b64_tr_b16 a[234:235], v1 offset:160
  ds_read_b64_tr_b16 a[236:237], v1 offset:544
  ds_read_b64_tr_b16 a[238:239], v1 offset:672
  s_waitcnt lgkmcnt(0)
  s_add_u32 s60, s32, 1
  s_and_b32 s60, s60, 3
  s_mul_i32 s60, s60, 6
  s_add_u32 s60, s60, s34
  s_add_u32 s60, s60, 5
  s_sub_u32 s63, s60, 24
  s_cmp_ge_u32 s60, 24
  s_cselect_b32 s60, s63, s60
  s_lshl_b32 s60, s60, 12
  s_add_u32 s60, s60, 81920
  s_sub_u32 s63, s60, 163840
  s_cmp_ge_u32 s60, 163840
  s_cselect_b32 s60, s63, s60
  v_add_u32 v1, s60, v6
  ds_read_b64_tr_b16 a[240:241], v1 offset:0
  ds_read_b64_tr_b16 a[242:243], v1 offset:128
  ds_read_b64_tr_b16 a[244:245], v1 offset:512
  ds_read_b64_tr_b16 a[246:247], v1 offset:640
  ds_read_b64_tr_b16 a[248:249], v1 offset:32
  ds_read_b64_tr_b16 a[250:251], v1 offset:160
  ds_read_b64_tr_b16 a[252:253], v1 offset:544
  ds_read_b64_tr_b16 a[254:255], v1 offset:672
  s_waitcnt lgkmcnt(0)
  s_barrier
L_laf_again_104:
  s_lshr_b32 s37, s33, 5
  s_and_b32 s34, s33, 31
  s_mul_i32 s60, s34, 86
  s_lshr_b32 s60, s60, 8
  s_mul_i32 s61, s60, 3
  s_sub_u32 s36, s34, s61
  s_lshl_b32 s35, s37, 3
  s_add_u32 s35, s35, s60
  s_mov_b32 s38, s34
  s_sub_u32 s63, s38, 20
  s_cmp_ge_u32 s38, 20
  s_cselect_b32 s38, s63, s38
  s_lshr_b32 s39, s38, 1
  s_add_u32 s39, s39, 1
  s_mov_b32 s54, 0xff00ff00
  s_mov_b32 s55, s54
  v_mov_b32 v3, 0x44444444
  v_mov_b32 v1, 0xeeeeeeee
  v_cndmask_b32 v3, v3, v1, s[54:55]
  s_add_u32 s60, s32, 0
  s_and_b32 s60, s60, 3
  s_add_u32 s60, s60, 0
  s_add_u32 s60, s60, s39
  s_sub_u32 s63, s60, 10
  s_cmp_ge_u32 s60, 10
  s_cselect_b32 s60, s63, s60
  s_lshl_b32 s62, s60, 10
  v_lshl_add_u32 v7, v2, 4, s62
  s_lshr_b32 s61, s60, 1
  s_lshl_b32 s61, s61, 14
  s_and_b32 s62, s60, 1
  s_lshl_b32 s62, s62, 12
  s_add_u32 s61, s61, s62
  v_bfe_u32 v4, v2, 5, 1
  v_mul_u32_u24 v4, 1024, v4
  v_bfe_u32 v1, v2, 4, 1
  v_mul_u32_u24 v1, 512, v1
  v_add_u32 v4, v4, v1
  v_bfe_u32 v1, v2, 0, 4
  v_mul_u32_u24 v1, 16, v1
  v_add_u32 v4, v4, v1
  s_mov_b32 s60, 0
  s_mul_i32 s63, s61, 1
  s_add_u32 s60, s60, s63
  v_add_u32 v4, s60, v4
  s_add_u32 s60, s32, 0
  s_and_b32 s60, s60, 3
  s_add_u32 s60, s60, 4
  s_add_u32 s60, s60, s39
  s_sub_u32 s63, s60, 10
  s_cmp_ge_u32 s60, 10
  s_cselect_b32 s60, s63, s60
  s_lshl_b32 s62, s60, 10
  v_lshl_add_u32 v8, v2, 4, s62
  s_lshr_b32 s61, s60, 1
  s_lshl_b32 s61, s61, 14
  s_and_b32 s62, s60, 1
  s_lshl_b32 s62, s62, 12
  s_add_u32 s61, s61, s62
  v_bfe_u32 v5, v2, 5, 1
  v_mul_u32_u24 v5, 1024, v5
  v_bfe_u32 v1, v2, 4, 1
  v_mul_u32_u24 v1, 512, v1
  v_add_u32 v5, v5, v1
  v_bfe_u32 v1, v2, 0, 4
  v_mul_u32_u24 v1, 16, v1
  v_add_u32 v5, v5, v1
  s_mov_b32 s60, 0
  s_mul_i32 s63, s61, 1
  s_add_u32 s60, s60, s63
  v_add_u32 v5, s60, v5
  s_add_u32 s60, s32, 1
  s_and_b32 s60, s60, 3
  s_add_u32 s60, s60, 0
  s_add_u32 s60, s60, s39
  s_sub_u32 s63, s60, 10
  s_cmp_ge_u32 s60, 10
  s_cselect_b32 s60, s63, s60
  s_lshl_b32 s62, s60, 10
  v_lshl_add_u32 v9, v2, 4, s62
  s_add_u32 s60, s32, 1
  s_and_b32 s60, s60, 3
  s_add_u32 s60, s60, 4
  s_add_u32 s60, s60, s39
  s_sub_u32 s63, s60, 10
  s_cmp_ge_u32 s60, 10
  s_cselect_b32 s60, s63, s60
  s_lshl_b32 s62, s60, 10
  v_lshl_add_u32 v10, v2, 4, s62
  s_add_u32 s60, s32, 2
  s_and_b32 s60, s60, 3
  s_add_u32 s60, s60, 0
  s_add_u32 s60, s60, s39
  s_sub_u32 s63, s60, 10
  s_cmp_ge_u32 s60, 10
  s_cselect_b32 s60, s63, s60
  s_lshl_b32 s62, s60, 10
  v_lshl_add_u32 v11, v2, 4, s62
  s_add_u32 s60, s32, 2
  s_and_b32 s60, s60, 3
  s_add_u32 s60, s60, 4
  s_add_u32 s60, s60, s39
  s_sub_u32 s63, s60, 10
  s_cmp_ge_u32 s60, 10
  s_cselect_b32 s60, s63, s60
  s_lshl_b32 s62, s60, 10
  v_lshl_add_u32 v12, v2, 4, s62
  s_add_u32 s60, s32, 3
  s_and_b32 s60, s60, 3
  s_add_u32 s60, s60, 0
  s_add_u32 s60, s60, s39
  s_sub_u32 s63, s60, 10
  s_cmp_ge_u32 s60, 10
  s_cselect_b32 s60, s63, s60
  s_lshl_b32 s62, s60, 10
  v_lshl_add_u32 v13, v2, 4, s62
  s_add_u32 s60, s32, 3
  s_and_b32 s60, s60, 3
  s_add_u32 s60, s60, 4
  s_add_u32 s60, s60, s39
  s_sub_u32 s63, s60, 10
  s_cmp_ge_u32 s60, 10
  s_cselect_b32 s60, s63, s60
  s_lshl_b32 s62, s60, 10
  v_lshl_add_u32 v14, v2, 4, s62
  s_add_u32 s60, s39, 8
  s_sub_u32 s63, s60, 10
  s_cmp_ge_u32 s60, 10
  s_cselect_b32 s60, s63, s60
  s_lshl_b32 s62, s60, 10
  v_lshl_add_u32 v15, v2, 4, s62
  s_add_u32 s60, s39, 9
  s_sub_u32 s63, s60, 10
  s_cmp_ge_u32 s60, 10
  s_cselect_b32 s60, s63, s60
  s_lshl_b32 s62, s60, 10
  v_lshl_add_u32 v16, v2, 4, s62
  s_lshr_b32 s60, s32, 1
  s_add_u32 s60, s60, s39
  s_add_u32 s60, s60, 8
  s_sub_u32 s63, s60, 10
  s_cmp_ge_u32 s60, 10
  s_cselect_b32 s60, s63, s60
  s_and_b32 s61, s32, 1
  s_lshl_b32 s61, s61, 3
  s_lshl_b32 s62, s60, 10
  s_add_u32 s62, s62, s61
  v_lshl_add_u32 v17, v2, 4, s62
  s_lshr_b32 s61, s60, 1
  s_lshl_b32 s61, s61, 14
  s_and_b32 s62, s60, 1
  s_lshl_b32 s62, s62, 12
  s_add_u32 s61, s61, s62
  s_and_b32 s62, s32, 1
  v_bfe_u32 v6, v2, 5, 1
  v_mul_u32_u24 v6, 1024, v6
  v_bfe_u32 v1, v2, 4, 1
  v_mul_u32_u24 v1, 512, v1
  v_add_u32 v6, v6, v1
  v_bfe_u32 v1, v2, 0, 4
  v_mul_u32_u24 v1, 16, v1
  v_add_u32 v6, v6, v1
  s_mov_b32 s60, 0
  s_mul_i32 s63, s61, 1
  s_add_u32 s60, s60, s63
  s_mul_i32 s63, s62, 256
  s_add_u32 s60, s60, s63
  v_add_u32 v6, s60, v6
  s_add_u32 s60, s32, 1
  s_and_b32 s60, s60, 3
  s_mul_i32 s60, s60, 6
  s_add_u32 s60, s60, s34
  s_add_u32 s60, s60, 0
  s_sub_u32 s63, s60, 24
  s_cmp_ge_u32 s60, 24
  s_cselect_b32 s60, s63, s60
  s_mov_b32 s61, s60
  v_bfe_u32 v18, v2, 0, 6
  v_mul_u32_u24 v18, 16, v18
  s_mov_b32 s60, 131072
  s_mul_i32 s63, s37, 24576
  s_add_u32 s60, s60, s63
  s_mul_i32 s63, s61, 1024
  s_add_u32 s60, s60, s63
  v_add_u32 v18, s60, v18
  s_add_u32 s60, s32, 1
  s_and_b32 s60, s60, 3
  s_mul_i32 s60, s60, 6
  s_add_u32 s60, s60, s34
  s_add_u32 s60, s60, 1
  s_sub_u32 s63, s60, 24
  s_cmp_ge_u32 s60, 24
  s_cselect_b32 s60, s63, s60
  s_mov_b32 s61, s60
  v_bfe_u32 v19, v2, 0, 6
  v_mul_u32_u24 v19, 16, v19
  s_mov_b32 s60, 131072
  s_mul_i32 s63, s37, 24576
  s_add_u32 s60, s60, s63
  s_mul_i32 s63, s61, 1024
  s_add_u32 s60, s60, s63
  v_add_u32 v19, s60, v19
  s_add_u32 s60, s32, 1
  s_and_b32 s60, s60, 3
  s_mul_i32 s60, s60, 6
  s_add_u32 s60, s60, s34
  s_add_u32 s60, s60, 2
  s_sub_u32 s63, s60, 24
  s_cmp_ge_u32 s60, 24
  s_cselect_b32 s60, s63, s60
  s_mov_b32 s61, s60
  v_bfe_u32 v20, v2, 0, 6
  v_mul_u32_u24 v20, 16, v20
  s_mov_b32 s60, 131072
  s_mul_i32 s63, s37, 24576
  s_add_u32 s60, s60, s63
  s_mul_i32 s63, s61, 1024
  s_add_u32 s60, s60, s63
  v_add_u32 v20, s60, v20
  s_add_u32 s60, s32, 1
  s_and_b32 s60, s60, 3
  s_mul_i32 s60, s60, 6
  s_add_u32 s60, s60, s34
  s_add_u32 s60, s60, 3
  s_sub_u32 s63, s60, 24
  s_cmp_ge_u32 s60, 24
  s_cselect_b32 s60, s63, s60
  s_mov_b32 s61, s60
  v_bfe_u32 v21, v2, 0, 6
  v_mul_u32_u24 v21, 16, v21
  s_mov_b32 s60, 131072
  s_mul_i32 s63, s37, 24576
  s_add_u32 s60, s60, s63
  s_mul_i32 s63, s61, 1024
  s_add_u32 s60, s60, s63
  v_add_u32 v21, s60, v21
  s_add_u32 s60, s32, 1
  s_and_b32 s60, s60, 3
  s_mul_i32 s60, s60, 6
  s_add_u32 s60, s60, s34
  s_add_u32 s60, s60, 4
  s_sub_u32 s63, s60, 24
  s_cmp_ge_u32 s60, 24
  s_cselect_b32 s60, s63, s60
  s_mov_b32 s61, s60
  v_bfe_u32 v22, v2, 0, 6
  v_mul_u32_u24 v22, 16, v22
  s_mov_b32 s60, 131072
  s_mul_i32 s63, s37, 24576
  s_add_u32 s60, s60, s63
  s_mul_i32 s63, s61, 1024
  s_add_u32 s60, s60, s63
  v_add_u32 v22, s60, v22
  s_add_u32 s60, s32, 1
  s_and_b32 s60, s60, 3
  s_mul_i32 s60, s60, 6
  s_add_u32 s60, s60, s34
  s_add_u32 s60, s60, 5
  s_sub_u32 s63, s60, 24
  s_cmp_ge_u32 s60, 24
  s_cselect_b32 s60, s63, s60
  s_mov_b32 s61, s60
  v_bfe_u32 v23, v2, 0, 6
  v_mul_u32_u24 v23, 16, v23
  s_mov_b32 s60, 131072
  s_mul_i32 s63, s37, 24576
  s_add_u32 s60, s60, s63
  s_mul_i32 s63, s61, 1024
  s_add_u32 s60, s60, s63
  v_add_u32 v23, s60, v23
  v_bfe_u32 v24, v2, 0, 4
  v_mul_u32_u24 v24, 40, v24
  v_bfe_u32 v1, v2, 4, 2
  v_mul_u32_u24 v1, 8, v1
  v_add_u32 v24, v24, v1
  s_mov_b32 s60, 24576
  s_mul_i32 s63, s32, 640
  s_add_u32 s60, s60, s63
  v_add_u32 v24, s60, v24
  v_bfe_u32 v25, v2, 0, 6
  v_mul_u32_u24 v25, 4, v25
  s_mov_b32 s60, 27648
  s_mul_i32 s63, s32, 256
  s_add_u32 s60, s60, s63
  v_add_u32 v25, s60, v25
  v_bfe_u32 v26, v2, 0, 6
  v_mul_u32_u24 v26, 4, v26
  s_mov_b32 s60, 41943040
  s_mul_i32 s63, s35, 3072
  s_add_u32 s60, s60, s63
  s_mul_i32 s63, s36, 1024
  s_add_u32 s60, s60, s63
  s_mul_i32 s63, s32, 256
  s_add_u32 s60, s60, s63
  v_add_u32 v26, s60, v26
  v_bfe_u32 v28, v2, 0, 6
  v_mul_u32_u24 v28, 16, v28
  s_mov_b32 s60, 12288
  s_mul_i32 s63, s32, 1024
  s_add_u32 s60, s60, s63
  v_add_u32 v28, s60, v28
  v_bfe_u32 v1, v2, 1, 2
  v_cmp_eq_u32 vcc, 0, v1
  v_and_b32 v1, 1, v2
  v_lshlrev_b32 v1, 4, v1
  v_mov_b32 v112, 0x3f80
  v_lshlrev_b32 v1, v1, v112
  v_cndmask_b32 v48, 0, v1, vcc
  v_lshrrev_b32 v1, 1, v2
  v_xor_b32 v1, v1, v2
  v_and_b32 v1, 8, v1
  v_cmp_eq_u32 vcc, 0, v1
  s_nop 1
  v_cndmask_b32 v48, 0, v48, vcc
  v_bfe_u32 v1, v2, 1, 2
  v_cmp_eq_u32 vcc, 1, v1
  v_and_b32 v1, 1, v2
  v_lshlrev_b32 v1, 4, v1
  v_mov_b32 v112, 0x3f80
  v_lshlrev_b32 v1, v1, v112
  v_cndmask_b32 v49, 0, v1, vcc
  v_lshrrev_b32 v1, 1, v2
  v_xor_b32 v1, v1, v2
  v_and_b32 v1, 8, v1
  v_cmp_eq_u32 vcc, 0, v1
  s_nop 1
  v_cndmask_b32 v49, 0, v49, vcc
  v_bfe_u32 v1, v2, 1, 2
  v_cmp_eq_u32 vcc, 2, v1
  v_and_b32 v1, 1, v2
  v_lshlrev_b32 v1, 4, v1
  v_mov_b32 v112, 0x3f80
  v_lshlrev_b32 v1, v1, v112
  v_cndmask_b32 v50, 0, v1, vcc
  v_lshrrev_b32 v1, 1, v2
  v_xor_b32 v1, v1, v2
  v_and_b32 v1, 8, v1
  v_cmp_eq_u32 vcc, 0, v1
  s_nop 1
  v_cndmask_b32 v50, 0, v50, vcc
  v_bfe_u32 v1, v2, 1, 2
  v_cmp_eq_u32 vcc, 3, v1
  v_and_b32 v1, 1, v2
  v_lshlrev_b32 v1, 4, v1
  v_mov_b32 v112, 0x3f80
  v_lshlrev_b32 v1, v1, v112
  v_cndmask_b32 v51, 0, v1, vcc
  v_lshrrev_b32 v1, 1, v2
  v_xor_b32 v1, v1, v2
  v_and_b32 v1, 8, v1
  v_cmp_eq_u32 vcc, 0, v1
  s_nop 1
  v_cndmask_b32 v51, 0, v51, vcc
  v_mov_b32 v44, -1
  v_mov_b32 v45, -1
  v_mov_b32 v46, -1
  v_mov_b32 v47, -1
  v_mov_b32 v60, 0
  v_mov_b32 v61, 0
  v_mov_b32 v62, 0
  v_mov_b32 v63, 0
  v_mov_b32 v64, 0
  v_mov_b32 v65, 0
  v_mov_b32 v66, 0
  v_mov_b32 v67, 0
  v_mov_b32 v68, 0
  v_mov_b32 v69, 0
  v_mov_b32 v70, 0
  v_mov_b32 v71, 0
  v_mov_b32 v72, 0
  v_mov_b32 v73, 0
  v_mov_b32 v74, 0
  v_mov_b32 v75, 0
  v_mov_b32 v76, 0
  v_mov_b32 v77, 0
  v_mov_b32 v78, 0
  v_mov_b32 v79, 0
  s_mov_b32 s53, 0x3dd53b95
  v_mov_b32 v29, 0
  s_mov_b32 s42, 4194304
  s_mul_i32 s63, s65, 1048576
  s_add_u32 s42, s42, s63
  s_mov_b32 s47, 218103808
  s_mul_i32 s63, s65, 8388608
  s_add_u32 s47, s47, s63
  s_mov_b32 s46, 218103808
  s_mul_i32 s63, s6, 8192
  s_add_u32 s46, s46, s63
  s_mul_i32 s63, s65, 8388608
  s_add_u32 s46, s46, s63
  s_mov_b32 s41, 0
  s_add_u32 s43, s42, 262144
  s_add_u32 s44, s43, 262144
  s_add_u32 s45, s44, 262144
  s_mov_b32 s48, 0
  s_mov_b32 s49, 0
  s_mov_b32 s64, 400000
  v_mov_b32 v27, 1
  s_mov_b32 s52, 1
  s_mov_b32 s56, 0
  s_mov_b32 s50, 0
  s_mov_b32 s60, 218202112
  s_mul_i32 s63, s6, 8192
  s_add_u32 s60, s60, s63
  s_mul_i32 s63, s34, 256
  s_add_u32 s60, s60, s63
  s_mul_i32 s63, s37, 131072
  s_add_u32 s60, s60, s63
  s_mul_i32 s63, s65, 16384
  s_add_u32 s60, s60, s63
  s_add_u32 s70, s4, s60
  s_addc_u32 s71, s5, 0
  s_mov_b32 s60, 0
  s_mul_i32 s63, s35, 128
  s_add_u32 s60, s60, s63
  s_mul_i32 s63, s65, 131072
  s_add_u32 s60, s60, s63
  s_add_u32 s100, s4, s60
  s_addc_u32 s101, s5, 0
  s_mov_b32 s72, 0
  s_mov_b32 s73, 0
  s_mov_b32 s74, 0
  s_mov_b32 s75, 0
  s_cmp_eq_u32 s32, 1
  s_cbranch_scc1 L_laf_w1_108
  s_cmp_eq_u32 s32, 2
  s_cbranch_scc1 L_laf_w2_109
  s_cmp_eq_u32 s32, 3
  s_cbranch_scc1 L_laf_w3_110
L_laf_w0_107:
  v_bfe_u32 v33, v2, 4, 2
  v_mul_u32_u24 v33, 320, v33
  v_bfe_u32 v1, v2, 2, 2
  v_mul_u32_u24 v1, 40, v1
  v_add_u32 v33, v33, v1
  v_bfe_u32 v1, v2, 0, 2
  v_mul_u32_u24 v1, 8, v1
  v_add_u32 v33, v33, v1
  s_mov_b32 s60, 24576
  v_add_u32 v33, s60, v33
  v_bfe_u32 v31, v2, 4, 1
  v_mul_u32_u24 v31, 16, v31
  v_bfe_u32 v1, v2, 0, 3
  v_mul_u32_u24 v1, 32, v1
  v_add_u32 v31, v31, v1
  s_mov_b32 s60, 3072
  s_mul_i32 s63, s35, 4096
  s_add_u32 s60, s60, s63
  s_mul_i32 s63, s36, 256
  s_add_u32 s60, s60, s63
  v_add_u32 v31, s60, v31
  v_bfe_u32 v1, v2, 3, 1
  v_cmp_eq_u32 vcc, 0, v1
  v_mov_b32 v1, 2147483632
  s_nop 0
  v_cndmask_b32 v31, v1, v31, vcc
  v_bfe_u32 v1, v2, 5, 1
  v_cmp_eq_u32 vcc, 1, v1
  v_mov_b32 v1, 2147483632
  s_nop 0
  v_cndmask_b32 v31, v1, v31, vcc
  v_bfe_u32 v32, v2, 4, 1
  v_mul_u32_u24 v32, 16, v32
  v_bfe_u32 v1, v2, 0, 3
  v_mul_u32_u24 v1, 32, v1
  v_add_u32 v32, v32, v1
  v_bfe_u32 v1, v2, 3, 1
  v_mul_u32_u24 v1, 2048, v1
  v_add_u32 v32, v32, v1
  v_bfe_u32 v1, v2, 5, 1
  v_mul_u32_u24 v1, 256, v1
  v_add_u32 v32, v32, v1
  s_mov_b32 s60, 29696
  v_add_u32 v32, s60, v32
  v_bfe_u32 v34, v2, 0, 6
  v_mul_u32_u24 v34, 4, v34
  s_mov_b32 s60, 65536
  s_mul_i32 s63, s37, 3072
  s_add_u32 s60, s60, s63
  s_mul_i32 s63, s34, 128
  s_add_u32 s60, s60, s63
  s_mul_i32 s63, s65, 131072
  s_add_u32 s60, s60, s63
  v_add_u32 v34, s60, v34
  s_lshl_b32 s61, 1, s34
  s_andn2_b32 s68, 0xffffff, s61
  s_mov_b32 s69, 0
  s_lshr_b32 s60, s34, 1
  s_lshr_b32 s61, s60, 1
  s_lshl_b32 s61, s61, 14
  s_and_b32 s62, s60, 1
  s_lshl_b32 s62, s62, 12
  s_add_u32 s61, s61, s62
  s_and_b32 s62, s34, 1
  v_bfe_u32 v35, v2, 5, 1
  v_mul_u32_u24 v35, 256, v35
  v_bfe_u32 v1, v2, 0, 4
  v_mul_u32_u24 v1, 16, v1
  v_add_u32 v35, v35, v1
  v_bfe_u32 v1, v2, 4, 1
  v_mul_u32_u24 v1, 8, v1
  v_add_u32 v35, v35, v1
  s_mov_b32 s60, 0
  s_mul_i32 s63, s61, 1
  s_add_u32 s60, s60, s63
  s_mul_i32 s63, s37, 1024
  s_add_u32 s60, s60, s63
  s_mul_i32 s63, s62, 512
  s_add_u32 s60, s60, s63
  v_add_u32 v35, s60, v35
  v_bfe_u32 v112, v2, 4, 1
  v_mul_u32_u24 v112, 5120, v112
  v_bfe_u32 v1, v2, 5, 1
  v_mul_u32_u24 v1, 32, v1
  v_add_u32 v112, v112, v1
  v_bfe_u32 v1, v2, 0, 4
  v_mul_u32_u24 v1, 2, v1
  v_add_u32 v112, v112, v1
  s_mov_b32 s60, 0
  s_mul_i32 s63, s38, 64
  s_add_u32 s60, s60, s63
  s_mul_i32 s63, s37, 1048576
  s_add_u32 s60, s60, s63
  v_add_u32 v112, s60, v112
  buffer_load_ushort v114, v112, s[28:31], 0 offen offset:0
  buffer_load_ushort v115, v112, s[28:31], 0 offen offset:1280
  buffer_load_ushort v116, v112, s[28:31], 0 offen offset:2560
  buffer_load_ushort v117, v112, s[28:31], 0 offen offset:3840
  s_waitcnt vmcnt(0)
  v_lshl_or_b32 v112, v115, 16, v114
  v_lshl_or_b32 v113, v117, 16, v116
  buffer_store_dwordx2 v[112:113], v35, s[8:11], s46 offen sc1
  s_branch L_laf_loop_111
.p2align 6
L_laf_loop_111:
  buffer_load_dwordx4 v[132:135], v4, s[8:11], s46 offen offset:0 sc1
  s_nop 5
  buffer_load_dwordx4 v[136:139], v4, s[8:11], s46 offen offset:2048 sc1
  s_nop 5
  buffer_load_dwordx4 v[140:143], v4, s[8:11], s46 offen offset:256 sc1
  s_nop 5
  buffer_load_dwordx4 v[144:147], v4, s[8:11], s46 offen offset:2304 sc1
  s_nop 5
  buffer_load_dwordx4 v[148:151], v5, s[8:11], s46 offen offset:0 sc1
  s_nop 5
  buffer_load_dwordx4 v[152:155], v5, s[8:11], s46 offen offset:2048 sc1
  s_nop 5
  buffer_load_dwordx4 v[156:159], v5, s[8:11], s46 offen offset:256 sc1
  s_nop 5
  buffer_load_dwordx4 v[160:163], v5, s[8:11], s46 offen offset:2304 sc1
  s_nop 5
  buffer_load_dwordx4 v[164:167], v6, s[8:11], s46 offen offset:0 sc1
  s_nop 5
  buffer_load_dwordx4 v[168:171], v6, s[8:11], s46 offen offset:2048 sc1
  s_waitcnt vmcnt(9)
  v_mfma_f32_16x16x32_bf16 v[104:107], v[132:135], v[48:51], 0
  v_max3_u32 v42, v132, v133, v134
  v_mov_b32 v43, v135
  s_waitcnt vmcnt(8)
  v_mfma_f32_16x16x32_bf16 v[104:107], v[136:139], v[48:51], v[104:107]
  v_max3_u32 v42, v42, v136, v137
  v_max3_u32 v43, v43, v138, v139
  s_waitcnt vmcnt(7)
  v_mfma_f32_16x16x32_bf16 v[108:111], v[140:143], v[48:51], 0
  v_max3_u32 v42, v42, v140, v141
  v_max3_u32 v43, v43, v142, v143
  s_waitcnt vmcnt(6)
  v_mfma_f32_16x16x32_bf16 v[108:111], v[144:147], v[48:51], v[108:111]
  v_max3_u32 v42, v42, v144, v145
  v_max3_u32 v43, v43, v146, v147
  v_max_u32 v42, v42, v43
  v_cmp_eq_u32 vcc, -1, v42
  s_cbranch_vccnz L_laf_bad_115
  s_nop 2
  v_cvt_pk_bf16_f32 v124, v104, v105
  v_cvt_pk_bf16_f32 v125, v106, v107
  v_cvt_pk_bf16_f32 v126, v108, v109
  v_cvt_pk_bf16_f32 v127, v110, v111
  ds_write_b128 v7, v[124:127]
  s_nop 0
  v_smfmac_f32_16x16x64_bf16 v[60:63], v[124:127], a[0:7], v3
  v_smfmac_f32_16x16x64_bf16 v[64:67], v[124:127], a[8:15], v3
  v_smfmac_f32_16x16x64_bf16 v[68:71], v[124:127], v[176:183], v3
L_laf_skip_116:
  s_waitcnt vmcnt(5)
  v_mfma_f32_16x16x32_bf16 v[104:107], v[148:151], v[48:51], 0
  v_max3_u32 v42, v148, v149, v150
  v_mov_b32 v43, v151
  s_waitcnt vmcnt(4)
  v_mfma_f32_16x16x32_bf16 v[104:107], v[152:155], v[48:51], v[104:107]
  v_max3_u32 v42, v42, v152, v153
  v_max3_u32 v43, v43, v154, v155
  s_waitcnt vmcnt(3)
  v_mfma_f32_16x16x32_bf16 v[108:111], v[156:159], v[48:51], 0
  v_max3_u32 v42, v42, v156, v157
  v_max3_u32 v43, v43, v158, v159
  s_waitcnt vmcnt(2)
  v_mfma_f32_16x16x32_bf16 v[108:111], v[160:163], v[48:51], v[108:111]
  v_max3_u32 v42, v42, v160, v161
  v_max3_u32 v43, v43, v162, v163
  v_max_u32 v42, v42, v43
  v_cmp_eq_u32 vcc, -1, v42
  s_cbranch_vccnz L_laf_bad_117
  s_nop 2
  v_cvt_pk_bf16_f32 v128, v104, v105
  v_cvt_pk_bf16_f32 v129, v106, v107
  v_cvt_pk_bf16_f32 v130, v108, v109
  v_cvt_pk_bf16_f32 v131, v110, v111
  ds_write_b128 v8, v[128:131]
  s_nop 0
  v_smfmac_f32_16x16x64_bf16 v[60:63], v[128:131], a[16:23], v3
  v_smfmac_f32_16x16x64_bf16 v[64:67], v[128:131], a[24:31], v3
  v_smfmac_f32_16x16x64_bf16 v[68:71], v[128:131], v[184:191], v3
L_laf_skip_118:
  s_waitcnt vmcnt(1)
  v_mfma_f32_16x16x32_bf16 v[104:107], v[164:167], v[48:51], 0
  v_max3_u32 v42, v164, v165, v166
  v_mov_b32 v43, v167
  s_waitcnt vmcnt(0)
  v_mfma_f32_16x16x32_bf16 v[104:107], v[168:171], v[48:51], v[104:107]
  v_max3_u32 v42, v42, v168, v169
  v_max3_u32 v43, v43, v170, v171
  v_max_u32 v42, v42, v43
  v_cmp_eq_u32 vcc, -1, v42
  s_cbranch_vccnz L_laf_bad_119
  s_nop 2
  v_cvt_pk_bf16_f32 v112, v104, v105
  v_cvt_pk_bf16_f32 v113, v106, v107
  ds_write_b64 v17, v[112:113]
L_laf_skip_120:
  s_cmp_lg_u32 s50, 0
  s_cbranch_scc1 L_laf_fix_113
L_laf_back_114:
  s_waitcnt lgkmcnt(0)
  s_barrier
  ds_read_b128 v[132:135], v9
  ds_read_b128 v[136:139], v10
  ds_read_b128 v[140:143], v11
  s_waitcnt lgkmcnt(2)
  v_smfmac_f32_16x16x64_bf16 v[60:63], v[132:135], a[32:39], v3
  ds_read_b128 v[144:147], v12
  v_smfmac_f32_16x16x64_bf16 v[64:67], v[132:135], a[40:47], v3
  s_waitcnt lgkmcnt(2)
  v_smfmac_f32_16x16x64_bf16 v[60:63], v[136:139], a[48:55], v3
  ds_read_b128 v[148:151], v13
  v_smfmac_f32_16x16x64_bf16 v[64:67], v[136:139], a[56:63], v3
  s_waitcnt lgkmcnt(2)
  v_smfmac_f32_16x16x64_bf16 v[60:63], v[140:143], a[64:71], v3
  ds_read_b128 v[152:155], v14
  v_smfmac_f32_16x16x64_bf16 v[64:67], v[140:143], a[72:79], v3
  s_waitcnt lgkmcnt(2)
  v_smfmac_f32_16x16x64_bf16 v[60:63], v[144:147], a[80:87], v3
  ds_read_b128 v[156:159], v15
  v_smfmac_f32_16x16x64_bf16 v[64:67], v[144:147], a[88:95], v3
  s_waitcnt lgkmcnt(2)
  v_smfmac_f32_16x16x64_bf16 v[60:63], v[148:151], a[96:103], v3
  ds_read_b128 v[160:163], v16
  v_smfmac_f32_16x16x64_bf16 v[64:67], v[148:151], a[104:111], v3
  s_waitcnt lgkmcnt(2)
  v_smfmac_f32_16x16x64_bf16 v[60:63], v[152:155], a[112:119], v3
  v_smfmac_f32_16x16x64_bf16 v[64:67], v[152:155], a[120:127], v3
  s_waitcnt lgkmcnt(1)
  v_smfmac_f32_16x16x64_bf16 v[60:63], v[156:159], a[128:135], v3
  v_smfmac_f32_16x16x64_bf16 v[64:67], v[156:159], a[136:143], v3
  s_waitcnt lgkmcnt(0)
  v_smfmac_f32_16x16x64_bf16 v[60:63], v[160:163], a[144:151], v3
  v_smfmac_f32_16x16x64_bf16 v[64:67], v[160:163], a[152:159], v3
  v_smfmac_f32_16x16x64_bf16 v[68:71], v[132:135], v[192:199], v3
  s_nop 6
  v_permlane32_swap_b32 v60, v64
  v_permlane32_swap_b32 v61, v65
  v_permlane32_swap_b32 v62, v66
  v_permlane32_swap_b32 v63, v67
  v_add_f32 v60, v60, v64
  v_add_f32 v61, v61, v65
  v_add_f32 v62, v62, v66
  v_add_f32 v63, v63, v67
  v_cvt_pk_bf16_f32 v112, v60, v61
  v_cvt_pk_bf16_f32 v113, v62, v63
  ds_write_b64 v24, v[112:113]
  v_smfmac_f32_16x16x64_bf16 v[68:71], v[136:139], v[200:207], v3
  v_smfmac_f32_16x16x64_bf16 v[68:71], v[140:143], v[208:215], v3
  v_smfmac_f32_16x16x64_bf16 v[68:71], v[144:147], v[216:223], v3
  s_waitcnt lgkmcnt(0)
  s_barrier
  ds_read_b64_tr_b16 v[96:97], v33 offset:0
  ds_read_b64_tr_b16 v[98:99], v33 offset:160
  ds_read_b64_tr_b16 v[100:101], v33 offset:1280
  ds_read_b64_tr_b16 v[102:103], v33 offset:1440
  v_smfmac_f32_16x16x64_bf16 v[68:71], v[148:151], v[224:231], v3
  v_smfmac_f32_16x16x64_bf16 v[68:71], v[152:155], v[232:239], v3
  s_waitcnt lgkmcnt(2)
  v_mfma_f32_16x16x32_bf16 v[116:119], v[96:99], v[96:99], 0
  s_waitcnt lgkmcnt(0)
  v_mfma_f32_16x16x32_bf16 v[116:119], v[100:103], v[100:103], v[116:119]
  s_nop 7
  buffer_store_dwordx4 v[116:119], v31, s[8:11], s42 offen sc1
  ds_write_b128 v32, v[116:119]
  v_smfmac_f32_16x16x64_bf16 v[68:71], v[156:159], v[240:247], v3
  v_smfmac_f32_16x16x64_bf16 v[68:71], v[160:163], v[248:255], v3
  v_mov_b32 v60, 0
  v_mov_b32 v61, 0
  v_mov_b32 v62, 0
  v_mov_b32 v63, 0
  v_mov_b32 v64, 0
  v_mov_b32 v65, 0
  v_mov_b32 v66, 0
  v_mov_b32 v67, 0
  s_waitcnt lgkmcnt(0)
  s_barrier
  v_permlane32_swap_b32 v68, v70
  v_permlane32_swap_b32 v69, v71
  v_add_f32 v68, v68, v70
  v_add_f32 v69, v69, v71
  v_cvt_pk_bf16_f32 v120, v68, v69
  ds_write_b32 v25, v120
  s_cmp_eq_u32 s41, 63
  s_cbranch_scc1 L_laf_last_121
  s_waitcnt lgkmcnt(0)
  s_barrier
  v_mov_b32 v68, 0
  v_mov_b32 v69, 0
  v_mov_b32 v70, 0
  v_mov_b32 v71, 0
  buffer_store_dword v120, v26, s[8:11], s49 offen sc1
  s_mov_b64 exec, s[68:69]
L_laf_sp_122:
  v_cmp_gt_u32 vcc, v27, v29
  s_cbranch_vccz L_laf_sd_123
  buffer_load_dword v29, v34, s[8:11], 0 offen sc1
  v_cmp_gt_u32 vcc, v27, v29
  s_cbranch_vccz L_laf_sd_123
  buffer_load_dword v29, v34, s[8:11], 0 offen sc1
  v_cmp_gt_u32 vcc, v27, v29
  s_cbranch_vccz L_laf_sd_123
  buffer_load_dword v29, v34, s[8:11], 0 offen sc1
  v_cmp_gt_u32 vcc, v27, v29
  s_cbranch_vccz L_laf_sd_123
  buffer_load_dword v29, v34, s[8:11], 0 offen sc1
  v_cmp_gt_u32 vcc, v27, v29
  s_cbranch_vccz L_laf_sd_123
  buffer_load_dword v29, v34, s[8:11], 0 offen sc1
  v_cmp_gt_u32 vcc, v27, v29
  s_cbranch_vccz L_laf_sd_123
  buffer_load_dword v29, v34, s[8:11], 0 offen sc1
  v_cmp_gt_u32 vcc, v27, v29
  s_cbranch_vccz L_laf_sd_123
  buffer_load_dword v29, v34, s[8:11], 0 offen sc1
  v_cmp_gt_u32 vcc, v27, v29
  s_cbranch_vccz L_laf_sd_123
  buffer_load_dword v29, v34, s[8:11], 0 offen sc1
  s_waitcnt vmcnt(40)
  s_sub_u32 s64, s64, 1
  s_cmp_lg_u32 s64, 0
  s_cbranch_scc1 L_laf_sp_122
  s_branch L_laf_fail_105
L_laf_sd_123:
  s_mov_b64 exec, -1
  s_barrier
L_laf_g_124:
  buffer_load_dwordx4 v[140:143], v18, s[8:11], s42 offen sc1
  s_nop 7
  buffer_load_dwordx4 v[144:147], v19, s[8:11], s42 offen sc1
  s_nop 7
  buffer_load_dwordx4 v[148:151], v20, s[8:11], s42 offen sc1
  s_nop 7
  buffer_load_dwordx4 v[152:155], v21, s[8:11], s42 offen sc1
  s_nop 7
  buffer_load_dwordx4 v[156:159], v22, s[8:11], s42 offen sc1
  s_nop 7
  buffer_load_dwordx4 v[160:163], v23, s[8:11], s42 offen sc1
  s_waitcnt vmcnt(5)
  v_smfmac_f32_16x16x64_bf16 v[72:75], v[140:143], a[160:167], v3
  v_smfmac_f32_16x16x64_bf16 v[76:79], v[140:143], a[168:175], v3
  v_max3_u32 v42, v140, v141, v142
  v_mov_b32 v43, v143
  s_waitcnt vmcnt(4)
  v_smfmac_f32_16x16x64_bf16 v[72:75], v[144:147], a[176:183], v3
  v_smfmac_f32_16x16x64_bf16 v[76:79], v[144:147], a[184:191], v3
  v_max3_u32 v42, v42, v144, v145
  v_max3_u32 v43, v43, v146, v147
  s_waitcnt vmcnt(3)
  v_smfmac_f32_16x16x64_bf16 v[72:75], v[148:151], a[192:199], v3
  v_smfmac_f32_16x16x64_bf16 v[76:79], v[148:151], a[200:207], v3
  v_max3_u32 v42, v42, v148, v149
  v_max3_u32 v43, v43, v150, v151
  s_waitcnt vmcnt(2)
  v_smfmac_f32_16x16x64_bf16 v[72:75], v[152:155], a[208:215], v3
  v_smfmac_f32_16x16x64_bf16 v[76:79], v[152:155], a[216:223], v3
  v_max3_u32 v42, v42, v152, v153
  v_max3_u32 v43, v43, v154, v155
  s_waitcnt vmcnt(1)
  v_smfmac_f32_16x16x64_bf16 v[72:75], v[156:159], a[224:231], v3
  v_smfmac_f32_16x16x64_bf16 v[76:79], v[156:159], a[232:239], v3
  v_max3_u32 v42, v42, v156, v157
  v_max3_u32 v43, v43, v158, v159
  s_waitcnt vmcnt(0)
  v_smfmac_f32_16x16x64_bf16 v[72:75], v[160:163], a[240:247], v3
  v_smfmac_f32_16x16x64_bf16 v[76:79], v[160:163], a[248:255], v3
  v_max3_u32 v42, v42, v160, v161
  v_max3_u32 v43, v43, v162, v163
  v_max_u32 v42, v42, v43
  v_cmp_eq_u32 vcc, -1, v42
  s_add_u32 s60, s41, 1
  s_lshr_b32 s61, s60, 4
  s_xor_b32 s61, s61, s6
  s_cbranch_vccnz L_laf_r_125
  v_permlane32_swap_b32 v72, v76
  v_permlane32_swap_b32 v73, v77
  v_permlane32_swap_b32 v74, v78
  v_permlane32_swap_b32 v75, v79
  v_add_f32 v116, v72, v76
  v_add_f32 v117, v73, v77
  v_add_f32 v118, v74, v78
  v_add_f32 v119, v75, v79
  s_and_b32 s61, s61, 1
  s_lshl_b32 s61, s61, 13
  s_mov_b32 s41, s60
  s_lshl_b32 s60, s60, 17
  s_add_u32 s60, s60, s61
  s_add_u32 s46, s60, s47
  s_add_u32 s48, s48, 393216
  s_mov_b32 s64, 400000
  s_waitcnt lgkmcnt(0)
  s_barrier
  ds_read_b128 v[124:127], v28 offset:1024
  ds_read_b128 v[128:131], v28 offset:2048
  ds_read_b128 v[132:135], v28 offset:3072
  s_waitcnt lgkmcnt(2)
  v_pk_add_f32 v[116:117], v[116:117], v[124:125]
  v_pk_add_f32 v[118:119], v[118:119], v[126:127]
  s_waitcnt lgkmcnt(1)
  v_pk_add_f32 v[116:117], v[116:117], v[128:129]
  v_pk_add_f32 v[118:119], v[118:119], v[130:131]
  s_waitcnt lgkmcnt(0)
  v_pk_add_f32 v[116:117], v[116:117], v[132:133]
  v_pk_add_f32 v[118:119], v[118:119], v[134:135]
  v_cvt_pk_bf16_f32 v112, v116, v117
  v_cvt_pk_bf16_f32 v113, v118, v119
  buffer_store_dwordx2 v[112:113], v35, s[8:11], s46 offen sc1
  v_mov_b32 v72, 0
  v_mov_b32 v73, 0
  v_mov_b32 v74, 0
  v_mov_b32 v75, 0
  v_mov_b32 v76, 0
  v_mov_b32 v77, 0
  v_mov_b32 v78, 0
  v_mov_b32 v79, 0
  s_mov_b32 s60, s42
  s_mov_b32 s42, s43
  s_mov_b32 s43, s44
  s_mov_b32 s44, s45
  s_mov_b32 s45, s60
  s_add_u32 s49, s49, 98304
  s_nop 15
  s_nop 15
  s_nop 7
  v_add_u32 v27, 1, v27
  s_add_u32 s52, s52, 1
  s_barrier
  s_branch L_laf_loop_111
L_laf_bad_115:
  buffer_load_dwordx4 v[132:135], v4, s[8:11], s46 offen offset:0 sc1
  buffer_load_dwordx4 v[136:139], v4, s[8:11], s46 offen offset:2048 sc1
  buffer_load_dwordx4 v[140:143], v4, s[8:11], s46 offen offset:256 sc1
  buffer_load_dwordx4 v[144:147], v4, s[8:11], s46 offen offset:2304 sc1
  s_bitset1_b32 s50, 0
  s_branch L_laf_skip_116
L_laf_bad_117:
  buffer_load_dwordx4 v[148:151], v5, s[8:11], s46 offen offset:0 sc1
  buffer_load_dwordx4 v[152:155], v5, s[8:11], s46 offen offset:2048 sc1
  buffer_load_dwordx4 v[156:159], v5, s[8:11], s46 offen offset:256 sc1
  buffer_load_dwordx4 v[160:163], v5, s[8:11], s46 offen offset:2304 sc1
  s_bitset1_b32 s50, 1
  s_branch L_laf_skip_118
L_laf_bad_119:
  buffer_load_dwordx4 v[164:167], v6, s[8:11], s46 offen offset:0 sc1
  buffer_load_dwordx4 v[168:171], v6, s[8:11], s46 offen offset:2048 sc1
  s_bitset1_b32 s50, 2
  s_branch L_laf_skip_120
L_laf_fix_113:
  s_waitcnt vmcnt(0)
  s_bitcmp1_b32 s50, 0
  s_cbranch_scc0 L_laf_n_126
  v_mfma_f32_16x16x32_bf16 v[104:107], v[132:135], v[48:51], 0
  v_max3_u32 v42, v132, v133, v134
  v_mov_b32 v43, v135
  v_mfma_f32_16x16x32_bf16 v[104:107], v[136:139], v[48:51], v[104:107]
  v_max3_u32 v42, v42, v136, v137
  v_max3_u32 v43, v43, v138, v139
  v_mfma_f32_16x16x32_bf16 v[108:111], v[140:143], v[48:51], 0
  v_max3_u32 v42, v42, v140, v141
  v_max3_u32 v43, v43, v142, v143
  v_mfma_f32_16x16x32_bf16 v[108:111], v[144:147], v[48:51], v[108:111]
  v_max3_u32 v42, v42, v144, v145
  v_max3_u32 v43, v43, v146, v147
  v_max_u32 v42, v42, v43
  v_cmp_eq_u32 vcc, -1, v42
  s_cbranch_vccnz L_laf_b_127
  s_nop 2
  v_cvt_pk_bf16_f32 v124, v104, v105
  v_cvt_pk_bf16_f32 v125, v106, v107
  v_cvt_pk_bf16_f32 v126, v108, v109
  v_cvt_pk_bf16_f32 v127, v110, v111
  ds_write_b128 v7, v[124:127]
  s_nop 0
  v_smfmac_f32_16x16x64_bf16 v[60:63], v[124:127], a[0:7], v3
  v_smfmac_f32_16x16x64_bf16 v[64:67], v[124:127], a[8:15], v3
  v_smfmac_f32_16x16x64_bf16 v[68:71], v[124:127], v[176:183], v3
  s_bitset0_b32 s50, 0
  s_branch L_laf_n_126
L_laf_b_127:
  buffer_load_dwordx4 v[132:135], v4, s[8:11], s46 offen offset:0 sc1
  buffer_load_dwordx4 v[136:139], v4, s[8:11], s46 offen offset:2048 sc1
  buffer_load_dwordx4 v[140:143], v4, s[8:11], s46 offen offset:256 sc1
  buffer_load_dwordx4 v[144:147], v4, s[8:11], s46 offen offset:2304 sc1
L_laf_n_126:
  s_bitcmp1_b32 s50, 1
  s_cbranch_scc0 L_laf_n_128
  v_mfma_f32_16x16x32_bf16 v[104:107], v[148:151], v[48:51], 0
  v_max3_u32 v42, v148, v149, v150
  v_mov_b32 v43, v151
  v_mfma_f32_16x16x32_bf16 v[104:107], v[152:155], v[48:51], v[104:107]
  v_max3_u32 v42, v42, v152, v153
  v_max3_u32 v43, v43, v154, v155
  v_mfma_f32_16x16x32_bf16 v[108:111], v[156:159], v[48:51], 0
  v_max3_u32 v42, v42, v156, v157
  v_max3_u32 v43, v43, v158, v159
  v_mfma_f32_16x16x32_bf16 v[108:111], v[160:163], v[48:51], v[108:111]
  v_max3_u32 v42, v42, v160, v161
  v_max3_u32 v43, v43, v162, v163
  v_max_u32 v42, v42, v43
  v_cmp_eq_u32 vcc, -1, v42
  s_cbranch_vccnz L_laf_b_129
  s_nop 2
  v_cvt_pk_bf16_f32 v128, v104, v105
  v_cvt_pk_bf16_f32 v129, v106, v107
  v_cvt_pk_bf16_f32 v130, v108, v109
  v_cvt_pk_bf16_f32 v131, v110, v111
  ds_write_b128 v8, v[128:131]
  s_nop 0
  v_smfmac_f32_16x16x64_bf16 v[60:63], v[128:131], a[16:23], v3
  v_smfmac_f32_16x16x64_bf16 v[64:67], v[128:131], a[24:31], v3
  v_smfmac_f32_16x16x64_bf16 v[68:71], v[128:131], v[184:191], v3
  s_bitset0_b32 s50, 1
  s_branch L_laf_n_128
L_laf_b_129:
  buffer_load_dwordx4 v[148:151], v5, s[8:11], s46 offen offset:0 sc1
  buffer_load_dwordx4 v[152:155], v5, s[8:11], s46 offen offset:2048 sc1
  buffer_load_dwordx4 v[156:159], v5, s[8:11], s46 offen offset:256 sc1
  buffer_load_dwordx4 v[160:163], v5, s[8:11], s46 offen offset:2304 sc1
L_laf_n_128:
  s_bitcmp1_b32 s50, 2
  s_cbranch_scc0 L_laf_n_130
  v_mfma_f32_16x16x32_bf16 v[104:107], v[164:167], v[48:51], 0
  v_max3_u32 v42, v164, v165, v166
  v_mov_b32 v43, v167
  v_mfma_f32_16x16x32_bf16 v[104:107], v[168:171], v[48:51], v[104:107]
  v_max3_u32 v42, v42, v168, v169
  v_max3_u32 v43, v43, v170, v171
  v_max_u32 v42, v42, v43
  v_cmp_eq_u32 vcc, -1, v42
  s_cbranch_vccnz L_laf_b_131
  s_nop 2
  v_cvt_pk_bf16_f32 v112, v104, v105
  v_cvt_pk_bf16_f32 v113, v106, v107
  ds_write_b64 v17, v[112:113]
  s_bitset0_b32 s50, 2
  s_branch L_laf_n_130
L_laf_b_131:
  buffer_load_dwordx4 v[164:167], v6, s[8:11], s46 offen offset:0 sc1
  buffer_load_dwordx4 v[168:171], v6, s[8:11], s46 offen offset:2048 sc1
L_laf_n_130:
  s_cmp_eq_u32 s50, 0
  s_cbranch_scc1 L_laf_back_114
  s_sub_u32 s64, s64, 1
  s_cmp_lg_u32 s64, 0
  s_cbranch_scc1 L_laf_fix_113
  s_branch L_laf_fail_105
L_laf_last_121:
  buffer_store_dword v120, v26, s[8:11], s49 offen sc1
  s_waitcnt vmcnt(0)
  s_barrier
  s_branch L_laf_done_106
L_laf_r_125:
  s_nop 7
  v_mov_b32 v72, 0
  v_mov_b32 v73, 0
  v_mov_b32 v74, 0
  v_mov_b32 v75, 0
  v_mov_b32 v76, 0
  v_mov_b32 v77, 0
  v_mov_b32 v78, 0
  v_mov_b32 v79, 0
  s_sub_u32 s64, s64, 1
  s_cmp_lg_u32 s64, 0
  s_cbranch_scc1 L_laf_g_124
  s_branch L_laf_fail_105
L_laf_w1_108:
  v_bfe_u32 v30, v2, 0, 6
  v_mul_u32_u24 v30, 16, v30
  s_mov_b32 s60, 50331648
  s_mul_i32 s63, s35, 12288
  s_add_u32 s60, s60, s63
  s_mul_i32 s63, s36, 2048
  s_add_u32 s60, s60, s63
  v_add_u32 v30, s60, v30
  v_bfe_u32 v31, v2, 4, 2
  v_mul_u32_u24 v31, 256, v31
  v_bfe_u32 v1, v2, 0, 3
  v_mul_u32_u24 v1, 16, v1
  v_add_u32 v31, v31, v1
  s_mov_b32 s60, 0
  s_mul_i32 s63, s35, 4096
  s_add_u32 s60, s60, s63
  s_mul_i32 s63, s36, 1024
  s_add_u32 s60, s60, s63
  v_add_u32 v31, s60, v31
  v_bfe_u32 v1, v2, 3, 1
  v_cmp_eq_u32 vcc, 0, v1
  v_mov_b32 v1, 2147483632
  s_nop 0
  v_cndmask_b32 v31, v1, v31, vcc
  v_bfe_u32 v32, v2, 4, 2
  v_mul_u32_u24 v32, 256, v32
  v_bfe_u32 v1, v2, 0, 3
  v_mul_u32_u24 v1, 16, v1
  v_add_u32 v32, v32, v1
  v_bfe_u32 v1, v2, 3, 1
  v_mul_u32_u24 v1, 2048, v1
  v_add_u32 v32, v32, v1
  s_mov_b32 s60, 28672
  v_add_u32 v32, s60, v32
  v_bfe_u32 v33, v2, 4, 2
  v_mul_u32_u24 v33, 320, v33
  v_bfe_u32 v1, v2, 2, 2
  v_mul_u32_u24 v1, 40, v1
  v_add_u32 v33, v33, v1
  v_bfe_u32 v1, v2, 0, 2
  v_mul_u32_u24 v1, 8, v1
  v_add_u32 v33, v33, v1
  s_mov_b32 s60, 24576
  v_add_u32 v33, s60, v33
  v_bfe_u32 v35, v2, 0, 6
  v_mul_u32_u24 v35, 16, v35
  s_mov_b32 s60, 0
  s_mul_i32 s63, s35, 4096
  s_add_u32 s60, s60, s63
  s_mul_i32 s63, s36, 1024
  s_add_u32 s60, s60, s63
  v_add_u32 v35, s60, v35
  v_bfe_u32 v36, v2, 0, 6
  v_mul_u32_u24 v36, 16, v36
  s_mov_b32 s60, 131072
  s_mul_i32 s63, s35, 3072
  s_add_u32 s60, s60, s63
  s_mul_i32 s63, s36, 1024
  s_add_u32 s60, s60, s63
  v_add_u32 v36, s60, v36
  s_cmp_le_u32 s56, s41
  s_cbranch_scc1 L_laf_kvw_132
L_laf_kvb_133:
  buffer_load_dwordx4 v[80:83], v30, s[8:11], s48 offen offset:0 sc1
  buffer_load_dwordx4 v[84:87], v30, s[8:11], s48 offen offset:1024 sc1
  s_branch L_laf_loop_134
.p2align 6
L_laf_loop_134:
  buffer_load_dwordx4 v[132:135], v4, s[8:11], s46 offen offset:0 sc1
  s_nop 5
  buffer_load_dwordx4 v[136:139], v4, s[8:11], s46 offen offset:2048 sc1
  s_nop 5
  buffer_load_dwordx4 v[140:143], v4, s[8:11], s46 offen offset:256 sc1
  s_nop 5
  buffer_load_dwordx4 v[144:147], v4, s[8:11], s46 offen offset:2304 sc1
  s_nop 5
  buffer_load_dwordx4 v[148:151], v5, s[8:11], s46 offen offset:0 sc1
  s_nop 5
  buffer_load_dwordx4 v[152:155], v5, s[8:11], s46 offen offset:2048 sc1
  s_nop 5
  buffer_load_dwordx4 v[156:159], v5, s[8:11], s46 offen offset:256 sc1
  s_nop 5
  buffer_load_dwordx4 v[160:163], v5, s[8:11], s46 offen offset:2304 sc1
  s_nop 5
  buffer_load_dwordx4 v[164:167], v6, s[8:11], s46 offen offset:0 sc1
  s_nop 5
  buffer_load_dwordx4 v[168:171], v6, s[8:11], s46 offen offset:2048 sc1
  s_waitcnt vmcnt(9)
  v_mfma_f32_16x16x32_bf16 v[104:107], v[132:135], v[48:51], 0
  v_max3_u32 v42, v132, v133, v134
  v_mov_b32 v43, v135
  s_waitcnt vmcnt(8)
  v_mfma_f32_16x16x32_bf16 v[104:107], v[136:139], v[48:51], v[104:107]
  v_max3_u32 v42, v42, v136, v137
  v_max3_u32 v43, v43, v138, v139
  s_waitcnt vmcnt(7)
  v_mfma_f32_16x16x32_bf16 v[108:111], v[140:143], v[48:51], 0
  v_max3_u32 v42, v42, v140, v141
  v_max3_u32 v43, v43, v142, v143
  s_waitcnt vmcnt(6)
  v_mfma_f32_16x16x32_bf16 v[108:111], v[144:147], v[48:51], v[108:111]
  v_max3_u32 v42, v42, v144, v145
  v_max3_u32 v43, v43, v146, v147
  v_max_u32 v42, v42, v43
  v_cmp_eq_u32 vcc, -1, v42
  s_cbranch_vccnz L_laf_bad_138
  s_nop 2
  v_cvt_pk_bf16_f32 v124, v104, v105
  v_cvt_pk_bf16_f32 v125, v106, v107
  v_cvt_pk_bf16_f32 v126, v108, v109
  v_cvt_pk_bf16_f32 v127, v110, v111
  ds_write_b128 v7, v[124:127]
  s_nop 0
  v_smfmac_f32_16x16x64_bf16 v[60:63], v[124:127], a[0:7], v3
  v_smfmac_f32_16x16x64_bf16 v[64:67], v[124:127], a[8:15], v3
  v_smfmac_f32_16x16x64_bf16 v[68:71], v[124:127], v[176:183], v3
L_laf_skip_139:
  s_waitcnt vmcnt(5)
  v_mfma_f32_16x16x32_bf16 v[104:107], v[148:151], v[48:51], 0
  v_max3_u32 v42, v148, v149, v150
  v_mov_b32 v43, v151
  s_waitcnt vmcnt(4)
  v_mfma_f32_16x16x32_bf16 v[104:107], v[152:155], v[48:51], v[104:107]
  v_max3_u32 v42, v42, v152, v153
  v_max3_u32 v43, v43, v154, v155
  s_waitcnt vmcnt(3)
  v_mfma_f32_16x16x32_bf16 v[108:111], v[156:159], v[48:51], 0
  v_max3_u32 v42, v42, v156, v157
  v_max3_u32 v43, v43, v158, v159
  s_waitcnt vmcnt(2)
  v_mfma_f32_16x16x32_bf16 v[108:111], v[160:163], v[48:51], v[108:111]
  v_max3_u32 v42, v42, v160, v161
  v_max3_u32 v43, v43, v162, v163
  v_max_u32 v42, v42, v43
  v_cmp_eq_u32 vcc, -1, v42
  s_cbranch_vccnz L_laf_bad_140
  s_nop 2
  v_cvt_pk_bf16_f32 v128, v104, v105
  v_cvt_pk_bf16_f32 v129, v106, v107
  v_cvt_pk_bf16_f32 v130, v108, v109
  v_cvt_pk_bf16_f32 v131, v110, v111
  ds_write_b128 v8, v[128:131]
  s_nop 0
  v_smfmac_f32_16x16x64_bf16 v[60:63], v[128:131], a[16:23], v3
  v_smfmac_f32_16x16x64_bf16 v[64:67], v[128:131], a[24:31], v3
  v_smfmac_f32_16x16x64_bf16 v[68:71], v[128:131], v[184:191], v3
L_laf_skip_141:
  s_waitcnt vmcnt(1)
  v_mfma_f32_16x16x32_bf16 v[104:107], v[164:167], v[48:51], 0
  v_max3_u32 v42, v164, v165, v166
  v_mov_b32 v43, v167
  s_waitcnt vmcnt(0)
  v_mfma_f32_16x16x32_bf16 v[104:107], v[168:171], v[48:51], v[104:107]
  v_max3_u32 v42, v42, v168, v169
  v_max3_u32 v43, v43, v170, v171
  v_max_u32 v42, v42, v43
  v_cmp_eq_u32 vcc, -1, v42
  s_cbranch_vccnz L_laf_bad_142
  s_nop 2
  v_cvt_pk_bf16_f32 v112, v104, v105
  v_cvt_pk_bf16_f32 v113, v106, v107
  ds_write_b64 v17, v[112:113]
L_laf_skip_143:
  s_cmp_lg_u32 s50, 0
  s_cbranch_scc1 L_laf_fix_136
L_laf_back_137:
  s_waitcnt lgkmcnt(0)
  s_barrier
  ds_read_b128 v[132:135], v9
  ds_read_b128 v[136:139], v10
  ds_read_b128 v[140:143], v11
  s_waitcnt lgkmcnt(2)
  v_smfmac_f32_16x16x64_bf16 v[60:63], v[132:135], a[32:39], v3
  ds_read_b128 v[144:147], v12
  v_smfmac_f32_16x16x64_bf16 v[64:67], v[132:135], a[40:47], v3
  s_waitcnt lgkmcnt(2)
  v_smfmac_f32_16x16x64_bf16 v[60:63], v[136:139], a[48:55], v3
  ds_read_b128 v[148:151], v13
  v_smfmac_f32_16x16x64_bf16 v[64:67], v[136:139], a[56:63], v3
  s_waitcnt lgkmcnt(2)
  v_smfmac_f32_16x16x64_bf16 v[60:63], v[140:143], a[64:71], v3
  ds_read_b128 v[152:155], v14
  v_smfmac_f32_16x16x64_bf16 v[64:67], v[140:143], a[72:79], v3
  s_waitcnt lgkmcnt(2)
  v_smfmac_f32_16x16x64_bf16 v[60:63], v[144:147], a[80:87], v3
  ds_read_b128 v[156:159], v15
  v_smfmac_f32_16x16x64_bf16 v[64:67], v[144:147], a[88:95], v3
  s_waitcnt lgkmcnt(2)
  v_smfmac_f32_16x16x64_bf16 v[60:63], v[148:151], a[96:103], v3
  ds_read_b128 v[160:163], v16
  v_smfmac_f32_16x16x64_bf16 v[64:67], v[148:151], a[104:111], v3
  s_waitcnt lgkmcnt(2)
  v_smfmac_f32_16x16x64_bf16 v[60:63], v[152:155], a[112:119], v3
  v_smfmac_f32_16x16x64_bf16 v[64:67], v[152:155], a[120:127], v3
  s_waitcnt lgkmcnt(1)
  v_smfmac_f32_16x16x64_bf16 v[60:63], v[156:159], a[128:135], v3
  v_smfmac_f32_16x16x64_bf16 v[64:67], v[156:159], a[136:143], v3
  s_waitcnt lgkmcnt(0)
  v_smfmac_f32_16x16x64_bf16 v[60:63], v[160:163], a[144:151], v3
  v_smfmac_f32_16x16x64_bf16 v[64:67], v[160:163], a[152:159], v3
  v_smfmac_f32_16x16x64_bf16 v[68:71], v[132:135], v[192:199], v3
  s_nop 6
  v_permlane32_swap_b32 v60, v64
  v_permlane32_swap_b32 v61, v65
  v_permlane32_swap_b32 v62, v66
  v_permlane32_swap_b32 v63, v67
  v_add_f32 v60, v60, v64
  v_add_f32 v61, v61, v65
  v_add_f32 v62, v62, v66
  v_add_f32 v63, v63, v67
  v_cvt_pk_bf16_f32 v112, v60, v61
  v_cvt_pk_bf16_f32 v113, v62, v63
  ds_write_b64 v24, v[112:113]
  v_smfmac_f32_16x16x64_bf16 v[68:71], v[136:139], v[200:207], v3
  v_smfmac_f32_16x16x64_bf16 v[68:71], v[140:143], v[208:215], v3
  v_smfmac_f32_16x16x64_bf16 v[68:71], v[144:147], v[216:223], v3
  s_waitcnt lgkmcnt(0)
  s_barrier
  ds_read_b64_tr_b16 v[96:97], v33 offset:0
  ds_read_b64_tr_b16 v[98:99], v33 offset:160
  ds_read_b64_tr_b16 v[100:101], v33 offset:1280
  ds_read_b64_tr_b16 v[102:103], v33 offset:1440
  v_smfmac_f32_16x16x64_bf16 v[68:71], v[148:151], v[224:231], v3
  v_smfmac_f32_16x16x64_bf16 v[68:71], v[152:155], v[232:239], v3
  s_waitcnt lgkmcnt(2)
  v_mfma_f32_16x16x32_bf16 v[116:119], v[80:83], v[96:99], 0
  s_waitcnt lgkmcnt(0)
  v_mfma_f32_16x16x32_bf16 v[116:119], v[84:87], v[100:103], v[116:119]
  s_nop 7
  buffer_store_dwordx4 v[116:119], v31, s[8:11], s42 offen sc1
  ds_write_b128 v32, v[116:119]
  v_smfmac_f32_16x16x64_bf16 v[68:71], v[156:159], v[240:247], v3
  v_smfmac_f32_16x16x64_bf16 v[68:71], v[160:163], v[248:255], v3
  v_mov_b32 v60, 0
  v_mov_b32 v61, 0
  v_mov_b32 v62, 0
  v_mov_b32 v63, 0
  v_mov_b32 v64, 0
  v_mov_b32 v65, 0
  v_mov_b32 v66, 0
  v_mov_b32 v67, 0
  s_waitcnt lgkmcnt(0)
  s_barrier
  v_permlane32_swap_b32 v68, v70
  v_permlane32_swap_b32 v69, v71
  v_add_f32 v68, v68, v70
  v_add_f32 v69, v69, v71
  v_cvt_pk_bf16_f32 v120, v68, v69
  ds_write_b32 v25, v120
  s_cmp_eq_u32 s41, 63
  s_cbranch_scc1 L_laf_last_144
  s_waitcnt lgkmcnt(0)
  s_barrier
  v_mov_b32 v68, 0
  v_mov_b32 v69, 0
  v_mov_b32 v70, 0
  v_mov_b32 v71, 0
  buffer_store_dword v120, v26, s[8:11], s49 offen sc1
  buffer_store_dwordx4 v[44:47], v35, s[8:11], s44 offen sc1
  buffer_store_dwordx4 v[44:47], v36, s[8:11], s44 offen sc1
  s_barrier
L_laf_g_145:
  buffer_load_dwordx4 v[140:143], v18, s[8:11], s42 offen sc1
  s_nop 7
  buffer_load_dwordx4 v[144:147], v19, s[8:11], s42 offen sc1
  s_nop 7
  buffer_load_dwordx4 v[148:151], v20, s[8:11], s42 offen sc1
  s_nop 7
  buffer_load_dwordx4 v[152:155], v21, s[8:11], s42 offen sc1
  s_nop 7
  buffer_load_dwordx4 v[156:159], v22, s[8:11], s42 offen sc1
  s_nop 7
  buffer_load_dwordx4 v[160:163], v23, s[8:11], s42 offen sc1
  s_waitcnt vmcnt(5)
  v_smfmac_f32_16x16x64_bf16 v[72:75], v[140:143], a[160:167], v3
  v_smfmac_f32_16x16x64_bf16 v[76:79], v[140:143], a[168:175], v3
  v_max3_u32 v42, v140, v141, v142
  v_mov_b32 v43, v143
  s_waitcnt vmcnt(4)
  v_smfmac_f32_16x16x64_bf16 v[72:75], v[144:147], a[176:183], v3
  v_smfmac_f32_16x16x64_bf16 v[76:79], v[144:147], a[184:191], v3
  v_max3_u32 v42, v42, v144, v145
  v_max3_u32 v43, v43, v146, v147
  s_waitcnt vmcnt(3)
  v_smfmac_f32_16x16x64_bf16 v[72:75], v[148:151], a[192:199], v3
  v_smfmac_f32_16x16x64_bf16 v[76:79], v[148:151], a[200:207], v3
  v_max3_u32 v42, v42, v148, v149
  v_max3_u32 v43, v43, v150, v151
  s_waitcnt vmcnt(2)
  v_smfmac_f32_16x16x64_bf16 v[72:75], v[152:155], a[208:215], v3
  v_smfmac_f32_16x16x64_bf16 v[76:79], v[152:155], a[216:223], v3
  v_max3_u32 v42, v42, v152, v153
  v_max3_u32 v43, v43, v154, v155
  s_waitcnt vmcnt(1)
  v_smfmac_f32_16x16x64_bf16 v[72:75], v[156:159], a[224:231], v3
  v_smfmac_f32_16x16x64_bf16 v[76:79], v[156:159], a[232:239], v3
  v_max3_u32 v42, v42, v156, v157
  v_max3_u32 v43, v43, v158, v159
  s_waitcnt vmcnt(0)
  v_smfmac_f32_16x16x64_bf16 v[72:75], v[160:163], a[240:247], v3
  v_smfmac_f32_16x16x64_bf16 v[76:79], v[160:163], a[248:255], v3
  v_max3_u32 v42, v42, v160, v161
  v_max3_u32 v43, v43, v162, v163
  v_max_u32 v42, v42, v43
  v_cmp_eq_u32 vcc, -1, v42
  s_add_u32 s60, s41, 1
  s_lshr_b32 s61, s60, 4
  s_xor_b32 s61, s61, s6
  s_cbranch_vccnz L_laf_r_146
  v_permlane32_swap_b32 v72, v76
  v_permlane32_swap_b32 v73, v77
  v_permlane32_swap_b32 v74, v78
  v_permlane32_swap_b32 v75, v79
  v_add_f32 v116, v72, v76
  v_add_f32 v117, v73, v77
  v_add_f32 v118, v74, v78
  v_add_f32 v119, v75, v79
  ds_write_b128 v28, v[116:119]
  s_and_b32 s61, s61, 1
  s_lshl_b32 s61, s61, 13
  s_mov_b32 s41, s60
  s_lshl_b32 s60, s60, 17
  s_add_u32 s60, s60, s61
  s_add_u32 s46, s60, s47
  s_add_u32 s48, s48, 393216
  s_mov_b32 s64, 400000
  s_waitcnt lgkmcnt(0)
  s_barrier
  s_load_dword s72, s[70:71], 0 glc
  s_load_dword s73, s[70:71], 64 glc
  s_load_dword s74, s[70:71], 128 glc
  v_mov_b32 v72, 0
  v_mov_b32 v73, 0
  v_mov_b32 v74, 0
  v_mov_b32 v75, 0
  v_mov_b32 v76, 0
  v_mov_b32 v77, 0
  v_mov_b32 v78, 0
  v_mov_b32 v79, 0
  s_mov_b32 s60, s42
  s_mov_b32 s42, s43
  s_mov_b32 s43, s44
  s_mov_b32 s44, s45
  s_mov_b32 s45, s60
  s_add_u32 s49, s49, 98304
  s_cmp_le_u32 s56, s41
  s_cbranch_scc1 L_laf_kvw_147
L_laf_kvb_148:
  buffer_load_dwordx4 v[80:83], v30, s[8:11], s48 offen offset:0 sc1
  buffer_load_dwordx4 v[84:87], v30, s[8:11], s48 offen offset:1024 sc1
L_laf_xs_149:
  s_load_dword s72, s[70:71], 0 glc
  s_load_dword s73, s[70:71], 64 glc
  s_load_dword s74, s[70:71], 128 glc
  s_min_u32 s60, s72, s73
  s_min_u32 s60, s60, s74
  s_cmp_ge_u32 s60, s52
  s_cbranch_scc1 L_laf_xd_150
  s_min_u32 s60, s72, s73
  s_min_u32 s60, s60, s74
  s_cmp_ge_u32 s60, s52
  s_cbranch_scc1 L_laf_xd_150
  s_min_u32 s60, s72, s73
  s_min_u32 s60, s60, s74
  s_cmp_ge_u32 s60, s52
  s_cbranch_scc1 L_laf_xd_150
  s_min_u32 s60, s72, s73
  s_min_u32 s60, s60, s74
  s_cmp_ge_u32 s60, s52
  s_cbranch_scc1 L_laf_xd_150
  s_waitcnt lgkmcnt(12)
  s_sub_u32 s64, s64, 1
  s_cmp_lg_u32 s64, 0
  s_cbranch_scc1 L_laf_xs_149
  s_branch L_laf_fail_105
L_laf_xd_150:
  v_add_u32 v27, 1, v27
  s_add_u32 s52, s52, 1
  s_barrier
  s_branch L_laf_loop_134
L_laf_kvw_132:
  s_load_dwordx4 s[88:91], s[100:101], 0 glc
  s_waitcnt lgkmcnt(0)
  s_min_u32 s56, s88, s89
  s_min_u32 s56, s56, s90
  s_cmp_gt_u32 s56, s41
  s_cbranch_scc1 L_laf_kvb_133
  s_sub_u32 s64, s64, 1
  s_cmp_lg_u32 s64, 0
  s_cbranch_scc1 L_laf_kvw_132
  s_branch L_laf_fail_105
L_laf_bad_138:
  buffer_load_dwordx4 v[132:135], v4, s[8:11], s46 offen offset:0 sc1
  buffer_load_dwordx4 v[136:139], v4, s[8:11], s46 offen offset:2048 sc1
  buffer_load_dwordx4 v[140:143], v4, s[8:11], s46 offen offset:256 sc1
  buffer_load_dwordx4 v[144:147], v4, s[8:11], s46 offen offset:2304 sc1
  s_bitset1_b32 s50, 0
  s_branch L_laf_skip_139
L_laf_bad_140:
  buffer_load_dwordx4 v[148:151], v5, s[8:11], s46 offen offset:0 sc1
  buffer_load_dwordx4 v[152:155], v5, s[8:11], s46 offen offset:2048 sc1
  buffer_load_dwordx4 v[156:159], v5, s[8:11], s46 offen offset:256 sc1
  buffer_load_dwordx4 v[160:163], v5, s[8:11], s46 offen offset:2304 sc1
  s_bitset1_b32 s50, 1
  s_branch L_laf_skip_141
L_laf_bad_142:
  buffer_load_dwordx4 v[164:167], v6, s[8:11], s46 offen offset:0 sc1
  buffer_load_dwordx4 v[168:171], v6, s[8:11], s46 offen offset:2048 sc1
  s_bitset1_b32 s50, 2
  s_branch L_laf_skip_143
L_laf_fix_136:
  s_waitcnt vmcnt(0)
  s_bitcmp1_b32 s50, 0
  s_cbranch_scc0 L_laf_n_151
  v_mfma_f32_16x16x32_bf16 v[104:107], v[132:135], v[48:51], 0
  v_max3_u32 v42, v132, v133, v134
  v_mov_b32 v43, v135
  v_mfma_f32_16x16x32_bf16 v[104:107], v[136:139], v[48:51], v[104:107]
  v_max3_u32 v42, v42, v136, v137
  v_max3_u32 v43, v43, v138, v139
  v_mfma_f32_16x16x32_bf16 v[108:111], v[140:143], v[48:51], 0
  v_max3_u32 v42, v42, v140, v141
  v_max3_u32 v43, v43, v142, v143
  v_mfma_f32_16x16x32_bf16 v[108:111], v[144:147], v[48:51], v[108:111]
  v_max3_u32 v42, v42, v144, v145
  v_max3_u32 v43, v43, v146, v147
  v_max_u32 v42, v42, v43
  v_cmp_eq_u32 vcc, -1, v42
  s_cbranch_vccnz L_laf_b_152
  s_nop 2
  v_cvt_pk_bf16_f32 v124, v104, v105
  v_cvt_pk_bf16_f32 v125, v106, v107
  v_cvt_pk_bf16_f32 v126, v108, v109
  v_cvt_pk_bf16_f32 v127, v110, v111
  ds_write_b128 v7, v[124:127]
  s_nop 0
  v_smfmac_f32_16x16x64_bf16 v[60:63], v[124:127], a[0:7], v3
  v_smfmac_f32_16x16x64_bf16 v[64:67], v[124:127], a[8:15], v3
  v_smfmac_f32_16x16x64_bf16 v[68:71], v[124:127], v[176:183], v3
  s_bitset0_b32 s50, 0
  s_branch L_laf_n_151
L_laf_b_152:
  buffer_load_dwordx4 v[132:135], v4, s[8:11], s46 offen offset:0 sc1
  buffer_load_dwordx4 v[136:139], v4, s[8:11], s46 offen offset:2048 sc1
  buffer_load_dwordx4 v[140:143], v4, s[8:11], s46 offen offset:256 sc1
  buffer_load_dwordx4 v[144:147], v4, s[8:11], s46 offen offset:2304 sc1
L_laf_n_151:
  s_bitcmp1_b32 s50, 1
  s_cbranch_scc0 L_laf_n_153
  v_mfma_f32_16x16x32_bf16 v[104:107], v[148:151], v[48:51], 0
  v_max3_u32 v42, v148, v149, v150
  v_mov_b32 v43, v151
  v_mfma_f32_16x16x32_bf16 v[104:107], v[152:155], v[48:51], v[104:107]
  v_max3_u32 v42, v42, v152, v153
  v_max3_u32 v43, v43, v154, v155
  v_mfma_f32_16x16x32_bf16 v[108:111], v[156:159], v[48:51], 0
  v_max3_u32 v42, v42, v156, v157
  v_max3_u32 v43, v43, v158, v159
  v_mfma_f32_16x16x32_bf16 v[108:111], v[160:163], v[48:51], v[108:111]
  v_max3_u32 v42, v42, v160, v161
  v_max3_u32 v43, v43, v162, v163
  v_max_u32 v42, v42, v43
  v_cmp_eq_u32 vcc, -1, v42
  s_cbranch_vccnz L_laf_b_154
  s_nop 2
  v_cvt_pk_bf16_f32 v128, v104, v105
  v_cvt_pk_bf16_f32 v129, v106, v107
  v_cvt_pk_bf16_f32 v130, v108, v109
  v_cvt_pk_bf16_f32 v131, v110, v111
  ds_write_b128 v8, v[128:131]
  s_nop 0
  v_smfmac_f32_16x16x64_bf16 v[60:63], v[128:131], a[16:23], v3
  v_smfmac_f32_16x16x64_bf16 v[64:67], v[128:131], a[24:31], v3
  v_smfmac_f32_16x16x64_bf16 v[68:71], v[128:131], v[184:191], v3
  s_bitset0_b32 s50, 1
  s_branch L_laf_n_153
L_laf_b_154:
  buffer_load_dwordx4 v[148:151], v5, s[8:11], s46 offen offset:0 sc1
  buffer_load_dwordx4 v[152:155], v5, s[8:11], s46 offen offset:2048 sc1
  buffer_load_dwordx4 v[156:159], v5, s[8:11], s46 offen offset:256 sc1
  buffer_load_dwordx4 v[160:163], v5, s[8:11], s46 offen offset:2304 sc1
L_laf_n_153:
  s_bitcmp1_b32 s50, 2
  s_cbranch_scc0 L_laf_n_155
  v_mfma_f32_16x16x32_bf16 v[104:107], v[164:167], v[48:51], 0
  v_max3_u32 v42, v164, v165, v166
  v_mov_b32 v43, v167
  v_mfma_f32_16x16x32_bf16 v[104:107], v[168:171], v[48:51], v[104:107]
  v_max3_u32 v42, v42, v168, v169
  v_max3_u32 v43, v43, v170, v171
  v_max_u32 v42, v42, v43
  v_cmp_eq_u32 vcc, -1, v42
  s_cbranch_vccnz L_laf_b_156
  s_nop 2
  v_cvt_pk_bf16_f32 v112, v104, v105
  v_cvt_pk_bf16_f32 v113, v106, v107
  ds_write_b64 v17, v[112:113]
  s_bitset0_b32 s50, 2
  s_branch L_laf_n_155
L_laf_b_156:
  buffer_load_dwordx4 v[164:167], v6, s[8:11], s46 offen offset:0 sc1
  buffer_load_dwordx4 v[168:171], v6, s[8:11], s46 offen offset:2048 sc1
L_laf_n_155:
  s_cmp_eq_u32 s50, 0
  s_cbranch_scc1 L_laf_back_137
  s_sub_u32 s64, s64, 1
  s_cmp_lg_u32 s64, 0
  s_cbranch_scc1 L_laf_fix_136
  s_branch L_laf_fail_105
L_laf_last_144:
  buffer_store_dword v120, v26, s[8:11], s49 offen sc1
  s_waitcnt vmcnt(0)
  s_barrier
  s_branch L_laf_done_106
L_laf_r_146:
  s_nop 7
  v_mov_b32 v72, 0
  v_mov_b32 v73, 0
  v_mov_b32 v74, 0
  v_mov_b32 v75, 0
  v_mov_b32 v76, 0
  v_mov_b32 v77, 0
  v_mov_b32 v78, 0
  v_mov_b32 v79, 0
  s_sub_u32 s64, s64, 1
  s_cmp_lg_u32 s64, 0
  s_cbranch_scc1 L_laf_g_145
  s_branch L_laf_fail_105
L_laf_kvw_147:
  s_load_dwordx4 s[88:91], s[100:101], 0 glc
  s_waitcnt lgkmcnt(0)
  s_min_u32 s56, s88, s89
  s_min_u32 s56, s56, s90
  s_cmp_gt_u32 s56, s41
  s_cbranch_scc1 L_laf_kvb_148
  s_sub_u32 s64, s64, 1
  s_cmp_lg_u32 s64, 0
  s_cbranch_scc1 L_laf_kvw_147
  s_branch L_laf_fail_105
L_laf_w2_109:
  v_bfe_u32 v30, v2, 0, 6
  v_mul_u32_u24 v30, 16, v30
  s_mov_b32 s60, 50337792
  s_mul_i32 s63, s35, 12288
  s_add_u32 s60, s60, s63
  s_mul_i32 s63, s36, 2048
  s_add_u32 s60, s60, s63
  v_add_u32 v30, s60, v30
  v_bfe_u32 v31, v2, 4, 2
  v_mul_u32_u24 v31, 256, v31
  v_bfe_u32 v1, v2, 0, 3
  v_mul_u32_u24 v1, 16, v1
  v_add_u32 v31, v31, v1
  s_mov_b32 s60, 128
  s_mul_i32 s63, s35, 4096
  s_add_u32 s60, s60, s63
  s_mul_i32 s63, s36, 1024
  s_add_u32 s60, s60, s63
  v_add_u32 v31, s60, v31
  v_bfe_u32 v1, v2, 3, 1
  v_cmp_eq_u32 vcc, 0, v1
  v_mov_b32 v1, 2147483632
  s_nop 0
  v_cndmask_b32 v31, v1, v31, vcc
  v_bfe_u32 v32, v2, 4, 2
  v_mul_u32_u24 v32, 256, v32
  v_bfe_u32 v1, v2, 0, 3
  v_mul_u32_u24 v1, 16, v1
  v_add_u32 v32, v32, v1
  v_bfe_u32 v1, v2, 3, 1
  v_mul_u32_u24 v1, 2048, v1
  v_add_u32 v32, v32, v1
  s_mov_b32 s60, 28800
  v_add_u32 v32, s60, v32
  v_bfe_u32 v33, v2, 4, 2
  v_mul_u32_u24 v33, 320, v33
  v_bfe_u32 v1, v2, 2, 2
  v_mul_u32_u24 v1, 40, v1
  v_add_u32 v33, v33, v1
  v_bfe_u32 v1, v2, 0, 2
  v_mul_u32_u24 v1, 8, v1
  v_add_u32 v33, v33, v1
  s_mov_b32 s60, 24576
  v_add_u32 v33, s60, v33
  v_bfe_u32 v37, v2, 0, 6
  v_mul_u32_u24 v37, 4, v37
  s_mov_b32 s60, 3072
  s_mul_i32 s63, s35, 4096
  s_add_u32 s60, s60, s63
  s_mul_i32 s63, s36, 256
  s_add_u32 s60, s60, s63
  v_add_u32 v37, s60, v37
  v_bfe_u32 v38, v2, 0, 6
  v_mul_u32_u24 v38, 4, v38
  s_mov_b32 s60, 4096
  s_mul_i32 s63, s35, 128
  s_add_u32 s60, s60, s63
  s_mul_i32 s63, s36, 4
  s_add_u32 s60, s60, s63
  s_mul_i32 s63, s65, 131072
  s_add_u32 s60, s60, s63
  v_add_u32 v38, s60, v38
  v_cmp_gt_u32 vcc, 1, v2
  v_mov_b32 v1, 2147483632
  s_nop 0
  v_cndmask_b32 v38, v1, v38, vcc
  v_bfe_u32 v35, v2, 0, 3
  v_mul_u32_u24 v35, 64, v35
  v_bfe_u32 v1, v2, 4, 2
  v_mul_u32_u24 v1, 16, v1
  v_add_u32 v35, v35, v1
  s_mov_b32 s60, 33554432
  s_mul_i32 s63, s35, 3072
  s_add_u32 s60, s60, s63
  s_mul_i32 s63, s36, 1024
  s_add_u32 s60, s60, s63
  v_add_u32 v35, s60, v35
  v_bfe_u32 v1, v2, 3, 1
  v_cmp_eq_u32 vcc, 1, v1
  v_mov_b32 v1, 2147483632
  s_nop 0
  v_cndmask_b32 v35, v1, v35, vcc
  v_add_u32 v36, s37, v2
  v_add_u32 v36, 1, v36
  v_and_b32 v36, 3, v36
  v_mul_u32_u24 v36, 131072, v36
  v_lshl_add_u32 v36, v2, 6, v36
  s_mov_b32 s60, 218202112
  s_mul_i32 s63, s6, 8192
  s_add_u32 s60, s60, s63
  s_mul_i32 s63, s34, 256
  s_add_u32 s60, s60, s63
  s_mul_i32 s63, s65, 16384
  s_add_u32 s60, s60, s63
  v_add_u32 v36, s60, v36
  v_cmp_gt_u32 vcc, 3, v2
  v_mov_b32 v1, 2147483632
  s_nop 0
  v_cndmask_b32 v36, v1, v36, vcc
  v_add_u32 v34, s36, v2
  v_add_u32 v34, 1, v34
  v_subrev_u32 v1, 3, v34
  v_min_u32 v34, v34, v1
  v_lshlrev_b32 v34, 7, v34
  v_lshl_add_u32 v34, v2, 2, v34
  s_mov_b32 s60, 98304
  s_mul_i32 s63, s35, 384
  s_add_u32 s60, s60, s63
  s_mul_i32 s63, s65, 131072
  s_add_u32 s60, s60, s63
  v_add_u32 v34, s60, v34
  v_cmp_gt_u32 vcc, 2, v2
  v_mov_b32 v1, 2147483632
  s_nop 0
  v_cndmask_b32 v34, v1, v34, vcc
  s_cmp_le_u32 s56, s41
  s_cbranch_scc1 L_laf_kvw_157
L_laf_kvb_158:
  buffer_load_dwordx4 v[80:83], v30, s[8:11], s48 offen offset:0 sc1
  buffer_load_dwordx4 v[84:87], v30, s[8:11], s48 offen offset:1024 sc1
  s_branch L_laf_loop_159
.p2align 6
L_laf_loop_159:
  buffer_load_dwordx4 v[132:135], v4, s[8:11], s46 offen offset:0 sc1
  s_nop 5
  buffer_load_dwordx4 v[136:139], v4, s[8:11], s46 offen offset:2048 sc1
  s_nop 5
  buffer_load_dwordx4 v[140:143], v4, s[8:11], s46 offen offset:256 sc1
  s_nop 5
  buffer_load_dwordx4 v[144:147], v4, s[8:11], s46 offen offset:2304 sc1
  s_nop 5
  buffer_load_dwordx4 v[148:151], v5, s[8:11], s46 offen offset:0 sc1
  s_nop 5
  buffer_load_dwordx4 v[152:155], v5, s[8:11], s46 offen offset:2048 sc1
  s_nop 5
  buffer_load_dwordx4 v[156:159], v5, s[8:11], s46 offen offset:256 sc1
  s_nop 5
  buffer_load_dwordx4 v[160:163], v5, s[8:11], s46 offen offset:2304 sc1
  s_nop 5
  buffer_load_dwordx4 v[164:167], v6, s[8:11], s46 offen offset:0 sc1
  s_nop 5
  buffer_load_dwordx4 v[168:171], v6, s[8:11], s46 offen offset:2048 sc1
  s_waitcnt vmcnt(9)
  v_mfma_f32_16x16x32_bf16 v[104:107], v[132:135], v[48:51], 0
  v_max3_u32 v42, v132, v133, v134
  v_mov_b32 v43, v135
  s_waitcnt vmcnt(8)
  v_mfma_f32_16x16x32_bf16 v[104:107], v[136:139], v[48:51], v[104:107]
  v_max3_u32 v42, v42, v136, v137
  v_max3_u32 v43, v43, v138, v139
  s_waitcnt vmcnt(7)
  v_mfma_f32_16x16x32_bf16 v[108:111], v[140:143], v[48:51], 0
  v_max3_u32 v42, v42, v140, v141
  v_max3_u32 v43, v43, v142, v143
  s_waitcnt vmcnt(6)
  v_mfma_f32_16x16x32_bf16 v[108:111], v[144:147], v[48:51], v[108:111]
  v_max3_u32 v42, v42, v144, v145
  v_max3_u32 v43, v43, v146, v147
  v_max_u32 v42, v42, v43
  v_cmp_eq_u32 vcc, -1, v42
  s_cbranch_vccnz L_laf_bad_163
  s_nop 2
  v_cvt_pk_bf16_f32 v124, v104, v105
  v_cvt_pk_bf16_f32 v125, v106, v107
  v_cvt_pk_bf16_f32 v126, v108, v109
  v_cvt_pk_bf16_f32 v127, v110, v111
  ds_write_b128 v7, v[124:127]
  s_nop 0
  v_smfmac_f32_16x16x64_bf16 v[60:63], v[124:127], a[0:7], v3
  v_smfmac_f32_16x16x64_bf16 v[64:67], v[124:127], a[8:15], v3
  v_smfmac_f32_16x16x64_bf16 v[68:71], v[124:127], v[176:183], v3
L_laf_skip_164:
  s_waitcnt vmcnt(5)
  v_mfma_f32_16x16x32_bf16 v[104:107], v[148:151], v[48:51], 0
  v_max3_u32 v42, v148, v149, v150
  v_mov_b32 v43, v151
  s_waitcnt vmcnt(4)
  v_mfma_f32_16x16x32_bf16 v[104:107], v[152:155], v[48:51], v[104:107]
  v_max3_u32 v42, v42, v152, v153
  v_max3_u32 v43, v43, v154, v155
  s_waitcnt vmcnt(3)
  v_mfma_f32_16x16x32_bf16 v[108:111], v[156:159], v[48:51], 0
  v_max3_u32 v42, v42, v156, v157
  v_max3_u32 v43, v43, v158, v159
  s_waitcnt vmcnt(2)
  v_mfma_f32_16x16x32_bf16 v[108:111], v[160:163], v[48:51], v[108:111]
  v_max3_u32 v42, v42, v160, v161
  v_max3_u32 v43, v43, v162, v163
  v_max_u32 v42, v42, v43
  v_cmp_eq_u32 vcc, -1, v42
  s_cbranch_vccnz L_laf_bad_165
  s_nop 2
  v_cvt_pk_bf16_f32 v128, v104, v105
  v_cvt_pk_bf16_f32 v129, v106, v107
  v_cvt_pk_bf16_f32 v130, v108, v109
  v_cvt_pk_bf16_f32 v131, v110, v111
  ds_write_b128 v8, v[128:131]
  s_nop 0
  v_smfmac_f32_16x16x64_bf16 v[60:63], v[128:131], a[16:23], v3
  v_smfmac_f32_16x16x64_bf16 v[64:67], v[128:131], a[24:31], v3
  v_smfmac_f32_16x16x64_bf16 v[68:71], v[128:131], v[184:191], v3
L_laf_skip_166:
  s_waitcnt vmcnt(1)
  v_mfma_f32_16x16x32_bf16 v[104:107], v[164:167], v[48:51], 0
  v_max3_u32 v42, v164, v165, v166
  v_mov_b32 v43, v167
  s_waitcnt vmcnt(0)
  v_mfma_f32_16x16x32_bf16 v[104:107], v[168:171], v[48:51], v[104:107]
  v_max3_u32 v42, v42, v168, v169
  v_max3_u32 v43, v43, v170, v171
  v_max_u32 v42, v42, v43
  v_cmp_eq_u32 vcc, -1, v42
  s_cbranch_vccnz L_laf_bad_167
  s_nop 2
  v_cvt_pk_bf16_f32 v112, v104, v105
  v_cvt_pk_bf16_f32 v113, v106, v107
  ds_write_b64 v17, v[112:113]
L_laf_skip_168:
  s_cmp_lg_u32 s50, 0
  s_cbranch_scc1 L_laf_fix_161
L_laf_back_162:
  s_waitcnt lgkmcnt(0)
  s_barrier
  ds_read_b128 v[132:135], v9
  ds_read_b128 v[136:139], v10
  ds_read_b128 v[140:143], v11
  s_waitcnt lgkmcnt(2)
  v_smfmac_f32_16x16x64_bf16 v[60:63], v[132:135], a[32:39], v3
  ds_read_b128 v[144:147], v12
  v_smfmac_f32_16x16x64_bf16 v[64:67], v[132:135], a[40:47], v3
  v_add_u32 v114, -1, v27
  s_waitcnt lgkmcnt(2)
  v_smfmac_f32_16x16x64_bf16 v[60:63], v[136:139], a[48:55], v3
  ds_read_b128 v[148:151], v13
  v_smfmac_f32_16x16x64_bf16 v[64:67], v[136:139], a[56:63], v3
  buffer_store_dword v114, v38, s[8:11], 0 offen sc1
  s_waitcnt lgkmcnt(2)
  v_smfmac_f32_16x16x64_bf16 v[60:63], v[140:143], a[64:71], v3
  ds_read_b128 v[152:155], v14
  v_smfmac_f32_16x16x64_bf16 v[64:67], v[140:143], a[72:79], v3
  s_waitcnt lgkmcnt(2)
  v_smfmac_f32_16x16x64_bf16 v[60:63], v[144:147], a[80:87], v3
  ds_read_b128 v[156:159], v15
  v_smfmac_f32_16x16x64_bf16 v[64:67], v[144:147], a[88:95], v3
  s_waitcnt lgkmcnt(2)
  v_smfmac_f32_16x16x64_bf16 v[60:63], v[148:151], a[96:103], v3
  ds_read_b128 v[160:163], v16
  v_smfmac_f32_16x16x64_bf16 v[64:67], v[148:151], a[104:111], v3
  s_waitcnt lgkmcnt(2)
  v_smfmac_f32_16x16x64_bf16 v[60:63], v[152:155], a[112:119], v3
  v_smfmac_f32_16x16x64_bf16 v[64:67], v[152:155], a[120:127], v3
  s_waitcnt lgkmcnt(1)
  v_smfmac_f32_16x16x64_bf16 v[60:63], v[156:159], a[128:135], v3
  v_smfmac_f32_16x16x64_bf16 v[64:67], v[156:159], a[136:143], v3
  s_waitcnt lgkmcnt(0)
  v_smfmac_f32_16x16x64_bf16 v[60:63], v[160:163], a[144:151], v3
  v_smfmac_f32_16x16x64_bf16 v[64:67], v[160:163], a[152:159], v3
  v_smfmac_f32_16x16x64_bf16 v[68:71], v[132:135], v[192:199], v3
  s_nop 6
  v_permlane32_swap_b32 v60, v64
  v_permlane32_swap_b32 v61, v65
  v_permlane32_swap_b32 v62, v66
  v_permlane32_swap_b32 v63, v67
  v_add_f32 v60, v60, v64
  v_add_f32 v61, v61, v65
  v_add_f32 v62, v62, v66
  v_add_f32 v63, v63, v67
  v_cvt_pk_bf16_f32 v112, v60, v61
  v_cvt_pk_bf16_f32 v113, v62, v63
  ds_write_b64 v24, v[112:113]
  buffer_store_dword v27, v34, s[8:11], 0 offen sc1
  v_smfmac_f32_16x16x64_bf16 v[68:71], v[136:139], v[200:207], v3
  v_smfmac_f32_16x16x64_bf16 v[68:71], v[140:143], v[208:215], v3
  v_smfmac_f32_16x16x64_bf16 v[68:71], v[144:147], v[216:223], v3
  s_waitcnt lgkmcnt(0)
  s_barrier
  ds_read_b64_tr_b16 v[96:97], v33 offset:0
  ds_read_b64_tr_b16 v[98:99], v33 offset:160
  ds_read_b64_tr_b16 v[100:101], v33 offset:1280
  ds_read_b64_tr_b16 v[102:103], v33 offset:1440
  v_smfmac_f32_16x16x64_bf16 v[68:71], v[148:151], v[224:231], v3
  v_smfmac_f32_16x16x64_bf16 v[68:71], v[152:155], v[232:239], v3
  s_waitcnt lgkmcnt(2)
  v_mfma_f32_16x16x32_bf16 v[116:119], v[80:83], v[96:99], 0
  s_waitcnt lgkmcnt(0)
  v_mfma_f32_16x16x32_bf16 v[116:119], v[84:87], v[100:103], v[116:119]
  s_nop 7
  buffer_store_dwordx4 v[116:119], v31, s[8:11], s42 offen sc1
  ds_write_b128 v32, v[116:119]
  v_smfmac_f32_16x16x64_bf16 v[68:71], v[156:159], v[240:247], v3
  v_smfmac_f32_16x16x64_bf16 v[68:71], v[160:163], v[248:255], v3
  v_mov_b32 v60, 0
  v_mov_b32 v61, 0
  v_mov_b32 v62, 0
  v_mov_b32 v63, 0
  v_mov_b32 v64, 0
  v_mov_b32 v65, 0
  v_mov_b32 v66, 0
  v_mov_b32 v67, 0
  s_waitcnt lgkmcnt(0)
  s_barrier
  v_permlane32_swap_b32 v68, v70
  v_permlane32_swap_b32 v69, v71
  v_add_f32 v68, v68, v70
  v_add_f32 v69, v69, v71
  v_cvt_pk_bf16_f32 v120, v68, v69
  v_cvt_pk_bf16_f32 v121, v69, v68
  ds_write_b32 v25, v121
  s_cmp_eq_u32 s41, 63
  s_cbranch_scc1 L_laf_last_169
  s_waitcnt lgkmcnt(0)
  s_barrier
  v_mov_b32 v68, 0
  v_mov_b32 v69, 0
  v_mov_b32 v70, 0
  v_mov_b32 v71, 0
  buffer_store_dword v120, v26, s[8:11], s49 offen sc1
  buffer_store_dwordx4 v[96:99], v35, s[8:11], s49 offen offset:0 sc1
  buffer_store_dwordx4 v[100:103], v35, s[8:11], s49 offen offset:512 sc1
  buffer_store_dword v44, v37, s[8:11], s44 offen sc1
  s_barrier
L_laf_g_170:
  buffer_load_dwordx4 v[140:143], v18, s[8:11], s42 offen sc1
  s_nop 7
  buffer_load_dwordx4 v[144:147], v19, s[8:11], s42 offen sc1
  s_nop 7
  buffer_load_dwordx4 v[148:151], v20, s[8:11], s42 offen sc1
  s_nop 7
  buffer_load_dwordx4 v[152:155], v21, s[8:11], s42 offen sc1
  s_nop 7
  buffer_load_dwordx4 v[156:159], v22, s[8:11], s42 offen sc1
  s_nop 7
  buffer_load_dwordx4 v[160:163], v23, s[8:11], s42 offen sc1
  s_waitcnt vmcnt(5)
  v_smfmac_f32_16x16x64_bf16 v[72:75], v[140:143], a[160:167], v3
  v_smfmac_f32_16x16x64_bf16 v[76:79], v[140:143], a[168:175], v3
  v_max3_u32 v42, v140, v141, v142
  v_mov_b32 v43, v143
  s_waitcnt vmcnt(4)
  v_smfmac_f32_16x16x64_bf16 v[72:75], v[144:147], a[176:183], v3
  v_smfmac_f32_16x16x64_bf16 v[76:79], v[144:147], a[184:191], v3
  v_max3_u32 v42, v42, v144, v145
  v_max3_u32 v43, v43, v146, v147
  s_waitcnt vmcnt(3)
  v_smfmac_f32_16x16x64_bf16 v[72:75], v[148:151], a[192:199], v3
  v_smfmac_f32_16x16x64_bf16 v[76:79], v[148:151], a[200:207], v3
  v_max3_u32 v42, v42, v148, v149
  v_max3_u32 v43, v43, v150, v151
  s_waitcnt vmcnt(2)
  v_smfmac_f32_16x16x64_bf16 v[72:75], v[152:155], a[208:215], v3
  v_smfmac_f32_16x16x64_bf16 v[76:79], v[152:155], a[216:223], v3
  v_max3_u32 v42, v42, v152, v153
  v_max3_u32 v43, v43, v154, v155
  s_waitcnt vmcnt(1)
  v_smfmac_f32_16x16x64_bf16 v[72:75], v[156:159], a[224:231], v3
  v_smfmac_f32_16x16x64_bf16 v[76:79], v[156:159], a[232:239], v3
  v_max3_u32 v42, v42, v156, v157
  v_max3_u32 v43, v43, v158, v159
  s_waitcnt vmcnt(0)
  v_smfmac_f32_16x16x64_bf16 v[72:75], v[160:163], a[240:247], v3
  v_smfmac_f32_16x16x64_bf16 v[76:79], v[160:163], a[248:255], v3
  v_max3_u32 v42, v42, v160, v161
  v_max3_u32 v43, v43, v162, v163
  v_max_u32 v42, v42, v43
  v_cmp_eq_u32 vcc, -1, v42
  buffer_store_dword v27, v36, s[8:11], 0 offen sc1
  s_add_u32 s60, s41, 1
  s_lshr_b32 s61, s60, 4
  s_xor_b32 s61, s61, s6
  s_cbranch_vccnz L_laf_r_171
  v_permlane32_swap_b32 v72, v76
  v_permlane32_swap_b32 v73, v77
  v_permlane32_swap_b32 v74, v78
  v_permlane32_swap_b32 v75, v79
  v_add_f32 v116, v72, v76
  v_add_f32 v117, v73, v77
  v_add_f32 v118, v74, v78
  v_add_f32 v119, v75, v79
  ds_write_b128 v28, v[116:119]
  s_and_b32 s61, s61, 1
  s_lshl_b32 s61, s61, 13
  s_mov_b32 s41, s60
  s_lshl_b32 s60, s60, 17
  s_add_u32 s60, s60, s61
  s_add_u32 s46, s60, s47
  s_add_u32 s48, s48, 393216
  s_mov_b32 s64, 400000
  s_waitcnt lgkmcnt(0)
  s_barrier
  v_mov_b32 v72, 0
  v_mov_b32 v73, 0
  v_mov_b32 v74, 0
  v_mov_b32 v75, 0
  v_mov_b32 v76, 0
  v_mov_b32 v77, 0
  v_mov_b32 v78, 0
  v_mov_b32 v79, 0
  s_mov_b32 s60, s42
  s_mov_b32 s42, s43
  s_mov_b32 s43, s44
  s_mov_b32 s44, s45
  s_mov_b32 s45, s60
  s_add_u32 s49, s49, 98304
  s_cmp_le_u32 s56, s41
  s_cbranch_scc1 L_laf_kvw_172
L_laf_kvb_173:
  buffer_load_dwordx4 v[80:83], v30, s[8:11], s48 offen offset:0 sc1
  buffer_load_dwordx4 v[84:87], v30, s[8:11], s48 offen offset:1024 sc1
  v_add_u32 v27, 1, v27
  s_add_u32 s52, s52, 1
  s_barrier
  s_branch L_laf_loop_159
L_laf_kvw_157:
  s_load_dwordx4 s[88:91], s[100:101], 0 glc
  s_waitcnt lgkmcnt(0)
  s_min_u32 s56, s88, s89
  s_min_u32 s56, s56, s90
  s_cmp_gt_u32 s56, s41
  s_cbranch_scc1 L_laf_kvb_158
  s_sub_u32 s64, s64, 1
  s_cmp_lg_u32 s64, 0
  s_cbranch_scc1 L_laf_kvw_157
  s_branch L_laf_fail_105
L_laf_bad_163:
  buffer_load_dwordx4 v[132:135], v4, s[8:11], s46 offen offset:0 sc1
  buffer_load_dwordx4 v[136:139], v4, s[8:11], s46 offen offset:2048 sc1
  buffer_load_dwordx4 v[140:143], v4, s[8:11], s46 offen offset:256 sc1
  buffer_load_dwordx4 v[144:147], v4, s[8:11], s46 offen offset:2304 sc1
  s_bitset1_b32 s50, 0
  s_branch L_laf_skip_164
L_laf_bad_165:
  buffer_load_dwordx4 v[148:151], v5, s[8:11], s46 offen offset:0 sc1
  buffer_load_dwordx4 v[152:155], v5, s[8:11], s46 offen offset:2048 sc1
  buffer_load_dwordx4 v[156:159], v5, s[8:11], s46 offen offset:256 sc1
  buffer_load_dwordx4 v[160:163], v5, s[8:11], s46 offen offset:2304 sc1
  s_bitset1_b32 s50, 1
  s_branch L_laf_skip_166
L_laf_bad_167:
  buffer_load_dwordx4 v[164:167], v6, s[8:11], s46 offen offset:0 sc1
  buffer_load_dwordx4 v[168:171], v6, s[8:11], s46 offen offset:2048 sc1
  s_bitset1_b32 s50, 2
  s_branch L_laf_skip_168
L_laf_fix_161:
  s_waitcnt vmcnt(0)
  s_bitcmp1_b32 s50, 0
  s_cbranch_scc0 L_laf_n_174
  v_mfma_f32_16x16x32_bf16 v[104:107], v[132:135], v[48:51], 0
  v_max3_u32 v42, v132, v133, v134
  v_mov_b32 v43, v135
  v_mfma_f32_16x16x32_bf16 v[104:107], v[136:139], v[48:51], v[104:107]
  v_max3_u32 v42, v42, v136, v137
  v_max3_u32 v43, v43, v138, v139
  v_mfma_f32_16x16x32_bf16 v[108:111], v[140:143], v[48:51], 0
  v_max3_u32 v42, v42, v140, v141
  v_max3_u32 v43, v43, v142, v143
  v_mfma_f32_16x16x32_bf16 v[108:111], v[144:147], v[48:51], v[108:111]
  v_max3_u32 v42, v42, v144, v145
  v_max3_u32 v43, v43, v146, v147
  v_max_u32 v42, v42, v43
  v_cmp_eq_u32 vcc, -1, v42
  s_cbranch_vccnz L_laf_b_175
  s_nop 2
  v_cvt_pk_bf16_f32 v124, v104, v105
  v_cvt_pk_bf16_f32 v125, v106, v107
  v_cvt_pk_bf16_f32 v126, v108, v109
  v_cvt_pk_bf16_f32 v127, v110, v111
  ds_write_b128 v7, v[124:127]
  s_nop 0
  v_smfmac_f32_16x16x64_bf16 v[60:63], v[124:127], a[0:7], v3
  v_smfmac_f32_16x16x64_bf16 v[64:67], v[124:127], a[8:15], v3
  v_smfmac_f32_16x16x64_bf16 v[68:71], v[124:127], v[176:183], v3
  s_bitset0_b32 s50, 0
  s_branch L_laf_n_174
L_laf_b_175:
  buffer_load_dwordx4 v[132:135], v4, s[8:11], s46 offen offset:0 sc1
  buffer_load_dwordx4 v[136:139], v4, s[8:11], s46 offen offset:2048 sc1
  buffer_load_dwordx4 v[140:143], v4, s[8:11], s46 offen offset:256 sc1
  buffer_load_dwordx4 v[144:147], v4, s[8:11], s46 offen offset:2304 sc1
L_laf_n_174:
  s_bitcmp1_b32 s50, 1
  s_cbranch_scc0 L_laf_n_176
  v_mfma_f32_16x16x32_bf16 v[104:107], v[148:151], v[48:51], 0
  v_max3_u32 v42, v148, v149, v150
  v_mov_b32 v43, v151
  v_mfma_f32_16x16x32_bf16 v[104:107], v[152:155], v[48:51], v[104:107]
  v_max3_u32 v42, v42, v152, v153
  v_max3_u32 v43, v43, v154, v155
  v_mfma_f32_16x16x32_bf16 v[108:111], v[156:159], v[48:51], 0
  v_max3_u32 v42, v42, v156, v157
  v_max3_u32 v43, v43, v158, v159
  v_mfma_f32_16x16x32_bf16 v[108:111], v[160:163], v[48:51], v[108:111]
  v_max3_u32 v42, v42, v160, v161
  v_max3_u32 v43, v43, v162, v163
  v_max_u32 v42, v42, v43
  v_cmp_eq_u32 vcc, -1, v42
  s_cbranch_vccnz L_laf_b_177
  s_nop 2
  v_cvt_pk_bf16_f32 v128, v104, v105
  v_cvt_pk_bf16_f32 v129, v106, v107
  v_cvt_pk_bf16_f32 v130, v108, v109
  v_cvt_pk_bf16_f32 v131, v110, v111
  ds_write_b128 v8, v[128:131]
  s_nop 0
  v_smfmac_f32_16x16x64_bf16 v[60:63], v[128:131], a[16:23], v3
  v_smfmac_f32_16x16x64_bf16 v[64:67], v[128:131], a[24:31], v3
  v_smfmac_f32_16x16x64_bf16 v[68:71], v[128:131], v[184:191], v3
  s_bitset0_b32 s50, 1
  s_branch L_laf_n_176
L_laf_b_177:
  buffer_load_dwordx4 v[148:151], v5, s[8:11], s46 offen offset:0 sc1
  buffer_load_dwordx4 v[152:155], v5, s[8:11], s46 offen offset:2048 sc1
  buffer_load_dwordx4 v[156:159], v5, s[8:11], s46 offen offset:256 sc1
  buffer_load_dwordx4 v[160:163], v5, s[8:11], s46 offen offset:2304 sc1
L_laf_n_176:
  s_bitcmp1_b32 s50, 2
  s_cbranch_scc0 L_laf_n_178
  v_mfma_f32_16x16x32_bf16 v[104:107], v[164:167], v[48:51], 0
  v_max3_u32 v42, v164, v165, v166
  v_mov_b32 v43, v167
  v_mfma_f32_16x16x32_bf16 v[104:107], v[168:171], v[48:51], v[104:107]
  v_max3_u32 v42, v42, v168, v169
  v_max3_u32 v43, v43, v170, v171
  v_max_u32 v42, v42, v43
  v_cmp_eq_u32 vcc, -1, v42
  s_cbranch_vccnz L_laf_b_179
  s_nop 2
  v_cvt_pk_bf16_f32 v112, v104, v105
  v_cvt_pk_bf16_f32 v113, v106, v107
  ds_write_b64 v17, v[112:113]
  s_bitset0_b32 s50, 2
  s_branch L_laf_n_178
L_laf_b_179:
  buffer_load_dwordx4 v[164:167], v6, s[8:11], s46 offen offset:0 sc1
  buffer_load_dwordx4 v[168:171], v6, s[8:11], s46 offen offset:2048 sc1
L_laf_n_178:
  s_cmp_eq_u32 s50, 0
  s_cbranch_scc1 L_laf_back_162
  s_sub_u32 s64, s64, 1
  s_cmp_lg_u32 s64, 0
  s_cbranch_scc1 L_laf_fix_161
  s_branch L_laf_fail_105
L_laf_last_169:
  buffer_store_dword v120, v26, s[8:11], s49 offen sc1
  buffer_store_dwordx4 v[96:99], v35, s[8:11], s49 offen offset:0 sc1
  buffer_store_dwordx4 v[100:103], v35, s[8:11], s49 offen offset:512 sc1
  s_waitcnt vmcnt(0)
  s_barrier
  buffer_store_dword v27, v38, s[8:11], 0 offen sc1
  s_branch L_laf_done_106
L_laf_r_171:
  s_nop 7
  v_mov_b32 v72, 0
  v_mov_b32 v73, 0
  v_mov_b32 v74, 0
  v_mov_b32 v75, 0
  v_mov_b32 v76, 0
  v_mov_b32 v77, 0
  v_mov_b32 v78, 0
  v_mov_b32 v79, 0
  s_sub_u32 s64, s64, 1
  s_cmp_lg_u32 s64, 0
  s_cbranch_scc1 L_laf_g_170
  s_branch L_laf_fail_105
L_laf_kvw_172:
  s_load_dwordx4 s[88:91], s[100:101], 0 glc
  s_waitcnt lgkmcnt(0)
  s_min_u32 s56, s88, s89
  s_min_u32 s56, s56, s90
  s_cmp_gt_u32 s56, s41
  s_cbranch_scc1 L_laf_kvb_173
  s_sub_u32 s64, s64, 1
  s_cmp_lg_u32 s64, 0
  s_cbranch_scc1 L_laf_kvw_172
  s_branch L_laf_fail_105
L_laf_w3_110:
  v_bfe_u32 v30, v2, 0, 6
  v_mul_u32_u24 v30, 16, v30
  s_mov_b32 s60, 117440512
  s_mul_i32 s63, s35, 12288
  s_add_u32 s60, s60, s63
  s_mul_i32 s63, s36, 4096
  s_add_u32 s60, s60, s63
  v_add_u32 v30, s60, v30
  s_add_u32 s62, s36, 1
  s_sub_u32 s63, s62, 3
  s_cmp_ge_u32 s62, 3
  s_cselect_b32 s62, s63, s62
  v_bfe_u32 v31, v2, 0, 6
  v_mul_u32_u24 v31, 16, v31
  s_mov_b32 s60, 0
  s_mul_i32 s63, s35, 4096
  s_add_u32 s60, s60, s63
  s_mul_i32 s63, s62, 1024
  s_add_u32 s60, s60, s63
  v_add_u32 v31, s60, v31
  v_bfe_u32 v33, v2, 0, 3
  v_mul_u32_u24 v33, 32, v33
  v_bfe_u32 v1, v2, 4, 1
  v_mul_u32_u24 v1, 16, v1
  v_add_u32 v33, v33, v1
  v_bfe_u32 v1, v2, 5, 1
  v_mul_u32_u24 v1, 8, v1
  v_add_u32 v33, v33, v1
  v_bfe_u32 v1, v2, 3, 1
  v_mul_u32_u24 v1, 4, v1
  v_add_u32 v33, v33, v1
  s_mov_b32 s60, 3072
  s_mul_i32 s63, s35, 4096
  s_add_u32 s60, s60, s63
  s_mul_i32 s63, s62, 256
  s_add_u32 s60, s60, s63
  v_add_u32 v33, s60, v33
  s_add_u32 s62, s36, 2
  s_sub_u32 s63, s62, 3
  s_cmp_ge_u32 s62, 3
  s_cselect_b32 s62, s63, s62
  v_bfe_u32 v32, v2, 0, 6
  v_mul_u32_u24 v32, 16, v32
  s_mov_b32 s60, 0
  s_mul_i32 s63, s35, 4096
  s_add_u32 s60, s60, s63
  s_mul_i32 s63, s62, 1024
  s_add_u32 s60, s60, s63
  v_add_u32 v32, s60, v32
  v_bfe_u32 v35, v2, 0, 3
  v_mul_u32_u24 v35, 32, v35
  v_bfe_u32 v1, v2, 4, 1
  v_mul_u32_u24 v1, 16, v1
  v_add_u32 v35, v35, v1
  v_bfe_u32 v1, v2, 5, 1
  v_mul_u32_u24 v1, 8, v1
  v_add_u32 v35, v35, v1
  v_bfe_u32 v1, v2, 3, 1
  v_mul_u32_u24 v1, 4, v1
  v_add_u32 v35, v35, v1
  s_mov_b32 s60, 3072
  s_mul_i32 s63, s35, 4096
  s_add_u32 s60, s60, s63
  s_mul_i32 s63, s62, 256
  s_add_u32 s60, s60, s63
  v_add_u32 v35, s60, v35
  v_bfe_u32 v36, v2, 0, 6
  v_mul_u32_u24 v36, 16, v36
  s_mov_b32 s60, 28672
  v_add_u32 v36, s60, v36
  v_bfe_u32 v37, v2, 0, 3
  v_mul_u32_u24 v37, 32, v37
  v_bfe_u32 v1, v2, 4, 1
  v_mul_u32_u24 v1, 16, v1
  v_add_u32 v37, v37, v1
  v_bfe_u32 v1, v2, 5, 1
  v_mul_u32_u24 v1, 8, v1
  v_add_u32 v37, v37, v1
  v_bfe_u32 v1, v2, 3, 1
  v_mul_u32_u24 v1, 4, v1
  v_add_u32 v37, v37, v1
  s_mov_b32 s60, 29952
  v_add_u32 v37, s60, v37
  v_bfe_u32 v38, v2, 0, 6
  v_mul_u32_u24 v38, 4, v38
  s_mov_b32 s60, 27648
  v_add_u32 v38, s60, v38
  v_bfe_u32 v39, v2, 0, 1
  v_mul_u32_u24 v39, 4, v39
  s_mov_b32 s60, 98304
  s_mul_i32 s63, s35, 384
  s_add_u32 s60, s60, s63
  s_mul_i32 s63, s36, 128
  s_add_u32 s60, s60, s63
  s_mul_i32 s63, s65, 131072
  s_add_u32 s60, s60, s63
  v_add_u32 v39, s60, v39
  s_add_u32 s62, s34, 1
  v_add_u32 v34, s62, v2
  v_subrev_u32 v1, 24, v34
  v_min_u32 v34, v34, v1
  v_lshlrev_b32 v34, 7, v34
  s_mov_b32 s60, 65536
  s_mul_i32 s63, s37, 3072
  s_add_u32 s60, s60, s63
  s_mul_i32 s63, s34, 4
  s_add_u32 s60, s60, s63
  s_mul_i32 s63, s65, 131072
  s_add_u32 s60, s60, s63
  v_add_u32 v34, s60, v34
  v_cmp_gt_u32 vcc, 23, v2
  v_mov_b32 v1, 2147483632
  s_nop 0
  v_cndmask_b32 v34, v1, v34, vcc
  v_mov_b32 v97, 0
  v_mov_b32 v99, 0
  v_mov_b32 v101, 0
  v_mov_b32 v103, 0
  v_mov_b32 v57, 0
  s_cmp_le_u32 s56, s41
  s_cbranch_scc1 L_laf_kvw_180
L_laf_kvb_181:
  s_branch L_laf_loop_182
.p2align 6
L_laf_loop_182:
  buffer_load_dwordx4 v[132:135], v4, s[8:11], s46 offen offset:0 sc1
  s_nop 5
  buffer_load_dwordx4 v[136:139], v4, s[8:11], s46 offen offset:2048 sc1
  s_nop 5
  buffer_load_dwordx4 v[140:143], v4, s[8:11], s46 offen offset:256 sc1
  s_nop 5
  buffer_load_dwordx4 v[144:147], v4, s[8:11], s46 offen offset:2304 sc1
  s_nop 5
  buffer_load_dwordx4 v[148:151], v5, s[8:11], s46 offen offset:0 sc1
  s_nop 5
  buffer_load_dwordx4 v[152:155], v5, s[8:11], s46 offen offset:2048 sc1
  s_nop 5
  buffer_load_dwordx4 v[156:159], v5, s[8:11], s46 offen offset:256 sc1
  s_nop 5
  buffer_load_dwordx4 v[160:163], v5, s[8:11], s46 offen offset:2304 sc1
  s_nop 5
  buffer_load_dwordx4 v[164:167], v6, s[8:11], s46 offen offset:0 sc1
  s_nop 5
  buffer_load_dwordx4 v[168:171], v6, s[8:11], s46 offen offset:2048 sc1
  s_waitcnt vmcnt(9)
  v_mfma_f32_16x16x32_bf16 v[104:107], v[132:135], v[48:51], 0
  v_max3_u32 v42, v132, v133, v134
  v_mov_b32 v43, v135
  s_waitcnt vmcnt(8)
  v_mfma_f32_16x16x32_bf16 v[104:107], v[136:139], v[48:51], v[104:107]
  v_max3_u32 v42, v42, v136, v137
  v_max3_u32 v43, v43, v138, v139
  s_waitcnt vmcnt(7)
  v_mfma_f32_16x16x32_bf16 v[108:111], v[140:143], v[48:51], 0
  v_max3_u32 v42, v42, v140, v141
  v_max3_u32 v43, v43, v142, v143
  s_waitcnt vmcnt(6)
  v_mfma_f32_16x16x32_bf16 v[108:111], v[144:147], v[48:51], v[108:111]
  v_max3_u32 v42, v42, v144, v145
  v_max3_u32 v43, v43, v146, v147
  v_max_u32 v42, v42, v43
  v_cmp_eq_u32 vcc, -1, v42
  s_cbranch_vccnz L_laf_bad_186
  s_nop 2
  v_cvt_pk_bf16_f32 v124, v104, v105
  v_cvt_pk_bf16_f32 v125, v106, v107
  v_cvt_pk_bf16_f32 v126, v108, v109
  v_cvt_pk_bf16_f32 v127, v110, v111
  ds_write_b128 v7, v[124:127]
  s_nop 0
  v_smfmac_f32_16x16x64_bf16 v[60:63], v[124:127], a[0:7], v3
  v_smfmac_f32_16x16x64_bf16 v[64:67], v[124:127], a[8:15], v3
  v_smfmac_f32_16x16x64_bf16 v[68:71], v[124:127], v[176:183], v3
L_laf_skip_187:
  s_waitcnt vmcnt(5)
  v_mfma_f32_16x16x32_bf16 v[104:107], v[148:151], v[48:51], 0
  v_max3_u32 v42, v148, v149, v150
  v_mov_b32 v43, v151
  s_waitcnt vmcnt(4)
  v_mfma_f32_16x16x32_bf16 v[104:107], v[152:155], v[48:51], v[104:107]
  v_max3_u32 v42, v42, v152, v153
  v_max3_u32 v43, v43, v154, v155
  s_waitcnt vmcnt(3)
  v_mfma_f32_16x16x32_bf16 v[108:111], v[156:159], v[48:51], 0
  v_max3_u32 v42, v42, v156, v157
  v_max3_u32 v43, v43, v158, v159
  s_waitcnt vmcnt(2)
  v_mfma_f32_16x16x32_bf16 v[108:111], v[160:163], v[48:51], v[108:111]
  v_max3_u32 v42, v42, v160, v161
  v_max3_u32 v43, v43, v162, v163
  v_max_u32 v42, v42, v43
  v_cmp_eq_u32 vcc, -1, v42
  s_cbranch_vccnz L_laf_bad_188
  s_nop 2
  v_cvt_pk_bf16_f32 v128, v104, v105
  v_cvt_pk_bf16_f32 v129, v106, v107
  v_cvt_pk_bf16_f32 v130, v108, v109
  v_cvt_pk_bf16_f32 v131, v110, v111
  ds_write_b128 v8, v[128:131]
  s_nop 0
  v_smfmac_f32_16x16x64_bf16 v[60:63], v[128:131], a[16:23], v3
  v_smfmac_f32_16x16x64_bf16 v[64:67], v[128:131], a[24:31], v3
  v_smfmac_f32_16x16x64_bf16 v[68:71], v[128:131], v[184:191], v3
L_laf_skip_189:
  s_waitcnt vmcnt(1)
  v_mfma_f32_16x16x32_bf16 v[104:107], v[164:167], v[48:51], 0
  v_max3_u32 v42, v164, v165, v166
  v_mov_b32 v43, v167
  s_waitcnt vmcnt(0)
  v_mfma_f32_16x16x32_bf16 v[104:107], v[168:171], v[48:51], v[104:107]
  v_max3_u32 v42, v42, v168, v169
  v_max3_u32 v43, v43, v170, v171
  v_max_u32 v42, v42, v43
  v_cmp_eq_u32 vcc, -1, v42
  s_cbranch_vccnz L_laf_bad_190
  s_nop 2
  v_cvt_pk_bf16_f32 v112, v104, v105
  v_cvt_pk_bf16_f32 v113, v106, v107
  ds_write_b64 v17, v[112:113]
L_laf_skip_191:
  s_cmp_lg_u32 s50, 0
  s_cbranch_scc1 L_laf_fix_184
L_laf_back_185:
  s_waitcnt lgkmcnt(0)
  s_barrier
  ds_read_b128 v[132:135], v9
  ds_read_b128 v[136:139], v10
  ds_read_b128 v[140:143], v11
  s_waitcnt lgkmcnt(2)
  v_smfmac_f32_16x16x64_bf16 v[60:63], v[132:135], a[32:39], v3
  ds_read_b128 v[144:147], v12
  v_smfmac_f32_16x16x64_bf16 v[64:67], v[132:135], a[40:47], v3
  buffer_load_dwordx4 v[80:83], v30, s[8:11], s48 offen offset:0 sc1
  s_waitcnt lgkmcnt(2)
  v_smfmac_f32_16x16x64_bf16 v[60:63], v[136:139], a[48:55], v3
  ds_read_b128 v[148:151], v13
  v_smfmac_f32_16x16x64_bf16 v[64:67], v[136:139], a[56:63], v3
  buffer_load_dwordx4 v[84:87], v30, s[8:11], s48 offen offset:1024 sc1
  s_waitcnt lgkmcnt(2)
  v_smfmac_f32_16x16x64_bf16 v[60:63], v[140:143], a[64:71], v3
  ds_read_b128 v[152:155], v14
  v_smfmac_f32_16x16x64_bf16 v[64:67], v[140:143], a[72:79], v3
  buffer_load_dwordx4 v[88:91], v30, s[8:11], s48 offen offset:2048 sc1
  s_waitcnt lgkmcnt(2)
  v_smfmac_f32_16x16x64_bf16 v[60:63], v[144:147], a[80:87], v3
  ds_read_b128 v[156:159], v15
  v_smfmac_f32_16x16x64_bf16 v[64:67], v[144:147], a[88:95], v3
  buffer_load_dwordx4 v[92:95], v30, s[8:11], s48 offen offset:3072 sc1
  s_waitcnt lgkmcnt(2)
  v_smfmac_f32_16x16x64_bf16 v[60:63], v[148:151], a[96:103], v3
  ds_read_b128 v[160:163], v16
  v_smfmac_f32_16x16x64_bf16 v[64:67], v[148:151], a[104:111], v3
  s_waitcnt lgkmcnt(2)
  v_smfmac_f32_16x16x64_bf16 v[60:63], v[152:155], a[112:119], v3
  v_smfmac_f32_16x16x64_bf16 v[64:67], v[152:155], a[120:127], v3
  s_waitcnt lgkmcnt(1)
  v_smfmac_f32_16x16x64_bf16 v[60:63], v[156:159], a[128:135], v3
  v_smfmac_f32_16x16x64_bf16 v[64:67], v[156:159], a[136:143], v3
  s_waitcnt lgkmcnt(0)
  v_smfmac_f32_16x16x64_bf16 v[60:63], v[160:163], a[144:151], v3
  v_smfmac_f32_16x16x64_bf16 v[64:67], v[160:163], a[152:159], v3
  v_smfmac_f32_16x16x64_bf16 v[68:71], v[132:135], v[192:199], v3
  s_nop 6
  v_permlane32_swap_b32 v60, v64
  v_permlane32_swap_b32 v61, v65
  v_permlane32_swap_b32 v62, v66
  v_permlane32_swap_b32 v63, v67
  v_add_f32 v60, v60, v64
  v_add_f32 v61, v61, v65
  v_add_f32 v62, v62, v66
  v_add_f32 v63, v63, v67
  v_cvt_pk_bf16_f32 v112, v60, v61
  v_cvt_pk_bf16_f32 v113, v62, v63
  ds_write_b64 v24, v[112:113]
  v_smfmac_f32_16x16x64_bf16 v[68:71], v[136:139], v[200:207], v3
  v_smfmac_f32_16x16x64_bf16 v[68:71], v[140:143], v[208:215], v3
  v_smfmac_f32_16x16x64_bf16 v[68:71], v[144:147], v[216:223], v3
  s_waitcnt lgkmcnt(0)
  s_barrier
  v_smfmac_f32_16x16x64_bf16 v[68:71], v[148:151], v[224:231], v3
  v_smfmac_f32_16x16x64_bf16 v[68:71], v[152:155], v[232:239], v3
  buffer_load_dword v29, v39, s[8:11], 0 offen sc1
  v_smfmac_f32_16x16x64_bf16 v[68:71], v[156:159], v[240:247], v3
  v_smfmac_f32_16x16x64_bf16 v[68:71], v[160:163], v[248:255], v3
  buffer_load_dword v29, v39, s[8:11], 0 offen sc1
  s_nop 5
  buffer_load_dword v29, v39, s[8:11], 0 offen sc1
  v_permlane32_swap_b32 v68, v70
  v_permlane32_swap_b32 v69, v71
  v_add_f32 v68, v68, v70
  v_add_f32 v69, v69, v71
  v_cvt_pk_bf16_f32 v120, v68, v69
  v_cvt_pk_bf16_f32 v121, v69, v68
  ds_write_b32 v25, v121
  buffer_load_dword v29, v39, s[8:11], 0 offen sc1
  s_mov_b64 exec, 3
L_laf_sp_193:
  v_cmp_gt_u32 vcc, v27, v29
  s_cbranch_vccz L_laf_sd_194
  buffer_load_dword v29, v39, s[8:11], 0 offen sc1
  v_cmp_gt_u32 vcc, v27, v29
  s_cbranch_vccz L_laf_sd_194
  buffer_load_dword v29, v39, s[8:11], 0 offen sc1
  v_cmp_gt_u32 vcc, v27, v29
  s_cbranch_vccz L_laf_sd_194
  buffer_load_dword v29, v39, s[8:11], 0 offen sc1
  v_cmp_gt_u32 vcc, v27, v29
  s_cbranch_vccz L_laf_sd_194
  buffer_load_dword v29, v39, s[8:11], 0 offen sc1
  v_cmp_gt_u32 vcc, v27, v29
  s_cbranch_vccz L_laf_sd_194
  buffer_load_dword v29, v39, s[8:11], 0 offen sc1
  v_cmp_gt_u32 vcc, v27, v29
  s_cbranch_vccz L_laf_sd_194
  buffer_load_dword v29, v39, s[8:11], 0 offen sc1
  v_cmp_gt_u32 vcc, v27, v29
  s_cbranch_vccz L_laf_sd_194
  buffer_load_dword v29, v39, s[8:11], 0 offen sc1
  v_cmp_gt_u32 vcc, v27, v29
  s_cbranch_vccz L_laf_sd_194
  buffer_load_dword v29, v39, s[8:11], 0 offen sc1
  s_waitcnt vmcnt(40)
  s_sub_u32 s64, s64, 1
  s_cmp_lg_u32 s64, 0
  s_cbranch_scc1 L_laf_sp_193
  s_branch L_laf_fail_105
L_laf_sd_194:
  s_mov_b64 exec, -1
  s_cmp_eq_u32 s41, 63
  s_barrier
  s_cbranch_scc1 L_laf_last_192
  buffer_load_dwordx4 v[124:127], v31, s[8:11], s42 offen sc1
  buffer_load_dwordx4 v[128:131], v32, s[8:11], s42 offen sc1
  buffer_load_dword v136, v33, s[8:11], s42 offen sc1
  buffer_load_dword v137, v35, s[8:11], s42 offen sc1
  ds_read_b128 v[132:135], v36
  ds_read_b32 v138, v37
  s_waitcnt lgkmcnt(0)
  s_barrier
  ds_read_b32 v96, v38 offset:0
  ds_read_b32 v98, v38 offset:256
  ds_read_b32 v100, v38 offset:512
  ds_read_b32 v102, v38 offset:768
  s_waitcnt vmcnt(4)
  v_swap_b32 v88, v90
  v_swap_b32 v89, v91
  v_swap_b32 v92, v94
  v_swap_b32 v93, v95
L_laf_poll_195:
  s_waitcnt vmcnt(0)
  v_max3_u32 v42, v124, v125, v126
  v_max3_u32 v43, v127, v128, v129
  v_max3_u32 v42, v42, v130, v131
  v_max3_u32 v43, v43, v136, v137
  v_pk_add_f32 v[144:145], v[132:133], v[124:125]
  v_max_u32 v42, v42, v43
  v_pk_add_f32 v[146:147], v[134:135], v[126:127]
  v_cmp_eq_u32 vcc, -1, v42
  v_add_f32 v148, v138, v136
  v_pk_add_f32 v[144:145], v[144:145], v[128:129]
  v_pk_add_f32 v[146:147], v[146:147], v[130:131]
  v_add_f32 v148, v148, v137
  s_cbranch_vccnz L_laf_sr_196
  v_max3_f32 v112, v144, v145, v148
  v_max3_f32 v112, v112, v146, v147
  s_nop 1
  v_max_f32_dpp v114, v112, v112 row_ror:8 row_mask:0xf bank_mask:0xf
  v_max_f32_dpp v115, v112, v112 row_ror:8 row_mask:0xf bank_mask:0xf
  s_nop 1
  v_permlane16_swap_b32 v115, v114
  v_max_f32 v112, v114, v115
  v_max_f32 v113, v114, v115
  s_nop 1
  v_permlane32_swap_b32 v113, v112
  v_max_f32 v112, v112, v113
  v_mul_f32 v112, s53, v112
  v_fma_f32 v150, v144, s53, -v112
  v_fma_f32 v151, v145, s53, -v112
  v_fma_f32 v152, v146, s53, -v112
  v_fma_f32 v153, v147, s53, -v112
  v_fma_f32 v154, v148, s53, -v112
  v_exp_f32 v150, v150
  v_exp_f32 v151, v151
  v_exp_f32 v152, v152
  v_cvt_pk_bf16_f32 v156, v150, v151
  v_exp_f32 v153, v153
  v_exp_f32 v154, v154
  v_cvt_pk_bf16_f32 v157, v152, v153
  v_mov_b32_dpp v158, v156 row_ror:8 row_mask:0xf bank_mask:0xf
  v_mov_b32_dpp v115, v154 row_ror:8 row_mask:0xf bank_mask:0xf
  v_mov_b32_dpp v159, v157 row_ror:8 row_mask:0xf bank_mask:0xf
  v_add_f32 v112, v150, v151
  v_cvt_pk_bf16_f32 v56, v154, v115
  v_mfma_f32_16x16x32_bf16 v[124:127], v[80:83], v[156:159], 0
  v_add_f32 v113, v152, v153
  v_add_f32 v112, v112, v154
  v_mfma_f32_16x16x32_bf16 v[132:135], v[88:91], v[156:159], 0
  v_add_f32 v112, v112, v113
  buffer_store_dword v27, v34, s[8:11], 0 offen sc1
  s_waitcnt lgkmcnt(0)
  v_mfma_f32_16x16x16_bf16 v[124:127], v[96:97], v[56:57], v[124:127]
  v_add_f32_dpp v114, v112, v112 row_ror:8 row_mask:0xf bank_mask:0xf
  v_add_f32_dpp v115, v112, v112 row_ror:8 row_mask:0xf bank_mask:0xf
  v_mfma_f32_16x16x16_bf16 v[132:135], v[100:101], v[56:57], v[132:135]
  s_nop 0
  v_permlane16_swap_b32 v115, v114
  v_mfma_f32_16x16x32_bf16 v[128:131], v[84:87], v[156:159], 0
  v_add_f32 v112, v114, v115
  v_add_f32 v113, v114, v115
  v_mfma_f32_16x16x32_bf16 v[136:139], v[92:95], v[156:159], 0
  s_nop 0
  v_permlane32_swap_b32 v113, v112
  v_mfma_f32_16x16x16_bf16 v[128:131], v[98:99], v[56:57], v[128:131]
  v_add_f32 v112, v112, v113
  v_rcp_f32 v112, v112
  v_mfma_f32_16x16x16_bf16 v[136:139], v[102:103], v[56:57], v[136:139]
  v_cndmask_b32 v104, v124, v132, s[54:55]
  v_cndmask_b32 v105, v125, v133, s[54:55]
  v_cndmask_b32 v106, v126, v134, s[54:55]
  v_cndmask_b32 v107, v127, v135, s[54:55]
  v_mul_f32 v104, v104, v112
  v_mul_f32 v105, v105, v112
  v_mul_f32 v106, v106, v112
  v_mul_f32 v107, v107, v112
  v_cndmask_b32 v108, v128, v136, s[54:55]
  v_cndmask_b32 v109, v129, v137, s[54:55]
  v_cndmask_b32 v110, v130, v138, s[54:55]
  v_cndmask_b32 v111, v131, v139, s[54:55]
  v_mul_f32 v108, v108, v112
  v_mul_f32 v109, v109, v112
  v_mul_f32 v110, v110, v112
  v_mul_f32 v111, v111, v112
  v_cvt_pk_bf16_f32 v140, v104, v105
  v_cvt_pk_bf16_f32 v141, v106, v107
  v_cvt_pk_bf16_f32 v142, v108, v109
  v_cvt_pk_bf16_f32 v143, v110, v111
  buffer_store_dwordx4 v[140:143], v18, s[8:11], s42 offen sc1
  s_barrier
L_laf_g_197:
  buffer_load_dwordx4 v[144:147], v19, s[8:11], s42 offen sc1
  s_nop 7
  buffer_load_dwordx4 v[148:151], v20, s[8:11], s42 offen sc1
  s_nop 7
  buffer_load_dwordx4 v[152:155], v21, s[8:11], s42 offen sc1
  s_nop 7
  buffer_load_dwordx4 v[156:159], v22, s[8:11], s42 offen sc1
  s_nop 7
  buffer_load_dwordx4 v[160:163], v23, s[8:11], s42 offen sc1
  v_smfmac_f32_16x16x64_bf16 v[72:75], v[140:143], a[160:167], v3
  v_smfmac_f32_16x16x64_bf16 v[76:79], v[140:143], a[168:175], v3
  s_waitcnt vmcnt(4)
  v_smfmac_f32_16x16x64_bf16 v[72:75], v[144:147], a[176:183], v3
  v_smfmac_f32_16x16x64_bf16 v[76:79], v[144:147], a[184:191], v3
  v_max3_u32 v42, v144, v145, v146
  v_mov_b32 v43, v147
  s_waitcnt vmcnt(3)
  v_smfmac_f32_16x16x64_bf16 v[72:75], v[148:151], a[192:199], v3
  v_smfmac_f32_16x16x64_bf16 v[76:79], v[148:151], a[200:207], v3
  v_max3_u32 v42, v42, v148, v149
  v_max3_u32 v43, v43, v150, v151
  s_waitcnt vmcnt(2)
  v_smfmac_f32_16x16x64_bf16 v[72:75], v[152:155], a[208:215], v3
  v_smfmac_f32_16x16x64_bf16 v[76:79], v[152:155], a[216:223], v3
  v_max3_u32 v42, v42, v152, v153
  v_max3_u32 v43, v43, v154, v155
  s_waitcnt vmcnt(1)
  v_smfmac_f32_16x16x64_bf16 v[72:75], v[156:159], a[224:231], v3
  v_smfmac_f32_16x16x64_bf16 v[76:79], v[156:159], a[232:239], v3
  v_max3_u32 v42, v42, v156, v157
  v_max3_u32 v43, v43, v158, v159
  s_waitcnt vmcnt(0)
  v_smfmac_f32_16x16x64_bf16 v[72:75], v[160:163], a[240:247], v3
  v_smfmac_f32_16x16x64_bf16 v[76:79], v[160:163], a[248:255], v3
  v_max3_u32 v42, v42, v160, v161
  v_max3_u32 v43, v43, v162, v163
  v_max_u32 v42, v42, v43
  v_cmp_eq_u32 vcc, -1, v42
  s_add_u32 s60, s41, 1
  s_lshr_b32 s61, s60, 4
  s_xor_b32 s61, s61, s6
  s_cbranch_vccnz L_laf_r_198
  v_permlane32_swap_b32 v72, v76
  v_permlane32_swap_b32 v73, v77
  v_permlane32_swap_b32 v74, v78
  v_permlane32_swap_b32 v75, v79
  v_add_f32 v116, v72, v76
  v_add_f32 v117, v73, v77
  v_add_f32 v118, v74, v78
  v_add_f32 v119, v75, v79
  ds_write_b128 v28, v[116:119]
  s_and_b32 s61, s61, 1
  s_lshl_b32 s61, s61, 13
  s_mov_b32 s41, s60
  s_lshl_b32 s60, s60, 17
  s_add_u32 s60, s60, s61
  s_add_u32 s46, s60, s47
  s_add_u32 s48, s48, 393216
  s_mov_b32 s64, 400000
  s_waitcnt lgkmcnt(0)
  s_barrier
  v_mov_b32 v72, 0
  v_mov_b32 v73, 0
  v_mov_b32 v74, 0
  v_mov_b32 v75, 0
  v_mov_b32 v76, 0
  v_mov_b32 v77, 0
  v_mov_b32 v78, 0
  v_mov_b32 v79, 0
  buffer_store_dword v120, v26, s[8:11], s49 offen sc1
  v_mov_b32 v60, 0
  v_mov_b32 v61, 0
  v_mov_b32 v62, 0
  v_mov_b32 v63, 0
  v_mov_b32 v64, 0
  v_mov_b32 v65, 0
  v_mov_b32 v66, 0
  v_mov_b32 v67, 0
  v_mov_b32 v68, 0
  v_mov_b32 v69, 0
  v_mov_b32 v70, 0
  v_mov_b32 v71, 0
  s_mov_b32 s60, s42
  s_mov_b32 s42, s43
  s_mov_b32 s43, s44
  s_mov_b32 s44, s45
  s_mov_b32 s45, s60
  s_add_u32 s49, s49, 98304
  s_cmp_le_u32 s56, s41
  s_cbranch_scc1 L_laf_kvw_199
L_laf_kvb_200:
  v_add_u32 v27, 1, v27
  s_add_u32 s52, s52, 1
  s_barrier
  s_branch L_laf_loop_182
L_laf_kvw_180:
  s_load_dwordx4 s[88:91], s[100:101], 0 glc
  s_waitcnt lgkmcnt(0)
  s_min_u32 s56, s88, s89
  s_min_u32 s56, s56, s90
  s_cmp_gt_u32 s56, s41
  s_cbranch_scc1 L_laf_kvb_181
  s_sub_u32 s64, s64, 1
  s_cmp_lg_u32 s64, 0
  s_cbranch_scc1 L_laf_kvw_180
  s_branch L_laf_fail_105
L_laf_bad_186:
  buffer_load_dwordx4 v[132:135], v4, s[8:11], s46 offen offset:0 sc1
  buffer_load_dwordx4 v[136:139], v4, s[8:11], s46 offen offset:2048 sc1
  buffer_load_dwordx4 v[140:143], v4, s[8:11], s46 offen offset:256 sc1
  buffer_load_dwordx4 v[144:147], v4, s[8:11], s46 offen offset:2304 sc1
  s_bitset1_b32 s50, 0
  s_branch L_laf_skip_187
L_laf_bad_188:
  buffer_load_dwordx4 v[148:151], v5, s[8:11], s46 offen offset:0 sc1
  buffer_load_dwordx4 v[152:155], v5, s[8:11], s46 offen offset:2048 sc1
  buffer_load_dwordx4 v[156:159], v5, s[8:11], s46 offen offset:256 sc1
  buffer_load_dwordx4 v[160:163], v5, s[8:11], s46 offen offset:2304 sc1
  s_bitset1_b32 s50, 1
  s_branch L_laf_skip_189
L_laf_bad_190:
  buffer_load_dwordx4 v[164:167], v6, s[8:11], s46 offen offset:0 sc1
  buffer_load_dwordx4 v[168:171], v6, s[8:11], s46 offen offset:2048 sc1
  s_bitset1_b32 s50, 2
  s_branch L_laf_skip_191
L_laf_fix_184:
  s_waitcnt vmcnt(0)
  s_bitcmp1_b32 s50, 0
  s_cbranch_scc0 L_laf_n_201
  v_mfma_f32_16x16x32_bf16 v[104:107], v[132:135], v[48:51], 0
  v_max3_u32 v42, v132, v133, v134
  v_mov_b32 v43, v135
  v_mfma_f32_16x16x32_bf16 v[104:107], v[136:139], v[48:51], v[104:107]
  v_max3_u32 v42, v42, v136, v137
  v_max3_u32 v43, v43, v138, v139
  v_mfma_f32_16x16x32_bf16 v[108:111], v[140:143], v[48:51], 0
  v_max3_u32 v42, v42, v140, v141
  v_max3_u32 v43, v43, v142, v143
  v_mfma_f32_16x16x32_bf16 v[108:111], v[144:147], v[48:51], v[108:111]
  v_max3_u32 v42, v42, v144, v145
  v_max3_u32 v43, v43, v146, v147
  v_max_u32 v42, v42, v43
  v_cmp_eq_u32 vcc, -1, v42
  s_cbranch_vccnz L_laf_b_202
  s_nop 2
  v_cvt_pk_bf16_f32 v124, v104, v105
  v_cvt_pk_bf16_f32 v125, v106, v107
  v_cvt_pk_bf16_f32 v126, v108, v109
  v_cvt_pk_bf16_f32 v127, v110, v111
  ds_write_b128 v7, v[124:127]
  s_nop 0
  v_smfmac_f32_16x16x64_bf16 v[60:63], v[124:127], a[0:7], v3
  v_smfmac_f32_16x16x64_bf16 v[64:67], v[124:127], a[8:15], v3
  v_smfmac_f32_16x16x64_bf16 v[68:71], v[124:127], v[176:183], v3
  s_bitset0_b32 s50, 0
  s_branch L_laf_n_201
L_laf_b_202:
  buffer_load_dwordx4 v[132:135], v4, s[8:11], s46 offen offset:0 sc1
  buffer_load_dwordx4 v[136:139], v4, s[8:11], s46 offen offset:2048 sc1
  buffer_load_dwordx4 v[140:143], v4, s[8:11], s46 offen offset:256 sc1
  buffer_load_dwordx4 v[144:147], v4, s[8:11], s46 offen offset:2304 sc1
L_laf_n_201:
  s_bitcmp1_b32 s50, 1
  s_cbranch_scc0 L_laf_n_203
  v_mfma_f32_16x16x32_bf16 v[104:107], v[148:151], v[48:51], 0
  v_max3_u32 v42, v148, v149, v150
  v_mov_b32 v43, v151
  v_mfma_f32_16x16x32_bf16 v[104:107], v[152:155], v[48:51], v[104:107]
  v_max3_u32 v42, v42, v152, v153
  v_max3_u32 v43, v43, v154, v155
  v_mfma_f32_16x16x32_bf16 v[108:111], v[156:159], v[48:51], 0
  v_max3_u32 v42, v42, v156, v157
  v_max3_u32 v43, v43, v158, v159
  v_mfma_f32_16x16x32_bf16 v[108:111], v[160:163], v[48:51], v[108:111]
  v_max3_u32 v42, v42, v160, v161
  v_max3_u32 v43, v43, v162, v163
  v_max_u32 v42, v42, v43
  v_cmp_eq_u32 vcc, -1, v42
  s_cbranch_vccnz L_laf_b_204
  s_nop 2
  v_cvt_pk_bf16_f32 v128, v104, v105
  v_cvt_pk_bf16_f32 v129, v106, v107
  v_cvt_pk_bf16_f32 v130, v108, v109
  v_cvt_pk_bf16_f32 v131, v110, v111
  ds_write_b128 v8, v[128:131]
  s_nop 0
  v_smfmac_f32_16x16x64_bf16 v[60:63], v[128:131], a[16:23], v3
  v_smfmac_f32_16x16x64_bf16 v[64:67], v[128:131], a[24:31], v3
  v_smfmac_f32_16x16x64_bf16 v[68:71], v[128:131], v[184:191], v3
  s_bitset0_b32 s50, 1
  s_branch L_laf_n_203
L_laf_b_204:
  buffer_load_dwordx4 v[148:151], v5, s[8:11], s46 offen offset:0 sc1
  buffer_load_dwordx4 v[152:155], v5, s[8:11], s46 offen offset:2048 sc1
  buffer_load_dwordx4 v[156:159], v5, s[8:11], s46 offen offset:256 sc1
  buffer_load_dwordx4 v[160:163], v5, s[8:11], s46 offen offset:2304 sc1
L_laf_n_203:
  s_bitcmp1_b32 s50, 2
  s_cbranch_scc0 L_laf_n_205
  v_mfma_f32_16x16x32_bf16 v[104:107], v[164:167], v[48:51], 0
  v_max3_u32 v42, v164, v165, v166
  v_mov_b32 v43, v167
  v_mfma_f32_16x16x32_bf16 v[104:107], v[168:171], v[48:51], v[104:107]
  v_max3_u32 v42, v42, v168, v169
  v_max3_u32 v43, v43, v170, v171
  v_max_u32 v42, v42, v43
  v_cmp_eq_u32 vcc, -1, v42
  s_cbranch_vccnz L_laf_b_206
  s_nop 2
  v_cvt_pk_bf16_f32 v112, v104, v105
  v_cvt_pk_bf16_f32 v113, v106, v107
  ds_write_b64 v17, v[112:113]
  s_bitset0_b32 s50, 2
  s_branch L_laf_n_205
L_laf_b_206:
  buffer_load_dwordx4 v[164:167], v6, s[8:11], s46 offen offset:0 sc1
  buffer_load_dwordx4 v[168:171], v6, s[8:11], s46 offen offset:2048 sc1
L_laf_n_205:
  s_cmp_eq_u32 s50, 0
  s_cbranch_scc1 L_laf_back_185
  s_sub_u32 s64, s64, 1
  s_cmp_lg_u32 s64, 0
  s_cbranch_scc1 L_laf_fix_184
  s_branch L_laf_fail_105
L_laf_last_192:
  buffer_store_dword v120, v26, s[8:11], s49 offen sc1
  s_waitcnt vmcnt(0)
  s_barrier
  s_branch L_laf_done_106
L_laf_sr_196:
  buffer_load_dwordx4 v[124:127], v31, s[8:11], s42 offen sc1
  buffer_load_dwordx4 v[128:131], v32, s[8:11], s42 offen sc1
  buffer_load_dword v136, v33, s[8:11], s42 offen sc1
  buffer_load_dword v137, v35, s[8:11], s42 offen sc1
  s_sub_u32 s64, s64, 1
  s_cmp_lg_u32 s64, 0
  s_cbranch_scc1 L_laf_poll_195
  s_branch L_laf_fail_105
L_laf_r_198:
  s_nop 7
  v_mov_b32 v72, 0
  v_mov_b32 v73, 0
  v_mov_b32 v74, 0
  v_mov_b32 v75, 0
  v_mov_b32 v76, 0
  v_mov_b32 v77, 0
  v_mov_b32 v78, 0
  v_mov_b32 v79, 0
  s_sub_u32 s64, s64, 1
  s_cmp_lg_u32 s64, 0
  s_cbranch_scc1 L_laf_g_197
  s_branch L_laf_fail_105
L_laf_kvw_199:
  s_load_dwordx4 s[88:91], s[100:101], 0 glc
  s_waitcnt lgkmcnt(0)
  s_min_u32 s56, s88, s89
  s_min_u32 s56, s56, s90
  s_cmp_gt_u32 s56, s41
  s_cbranch_scc1 L_laf_kvb_200
  s_sub_u32 s64, s64, 1
  s_cmp_lg_u32 s64, 0
  s_cbranch_scc1 L_laf_kvw_199
  s_branch L_laf_fail_105
L_laf_fail_105:
  s_mov_b64 exec, 1
  v_mov_b32 v1, 262144
  v_mov_b32 v112, 1
  buffer_atomic_add v112, v1, s[8:11], 0 offen
  s_endpgm
L_laf_done_106:
  s_call_b64 s[66:67], la_mixer
  s_branch L_laf_again_104
la_att:
  s_lshr_b32 s60, s33, 5
  s_lshl_b32 s60, s60, 3
  s_and_b32 s34, s33, 7
  s_add_u32 s34, s34, s60
  s_waitcnt vmcnt(0)
  s_barrier
  s_call_b64 s[60:61], la_arrive
  s_call_b64 s[60:61], la_census
L_laa_again_208:
  s_lshr_b32 s60, s33, 5
  s_lshl_b32 s60, s60, 3
  s_and_b32 s34, s33, 7
  s_add_u32 s34, s34, s60
  v_bfe_u32 v4, v2, 0, 6
  v_mul_u32_u24 v4, 16, v4
  s_mov_b32 s60, 0
  s_mul_i32 s63, s34, 12288
  s_add_u32 s60, s60, s63
  v_add_u32 v4, s60, v4
  v_bfe_u32 v5, v2, 2, 1
  v_mul_u32_u24 v5, 256, v5
  v_bfe_u32 v1, v2, 3, 1
  v_mul_u32_u24 v1, 128, v1
  v_add_u32 v5, v5, v1
  v_bfe_u32 v1, v2, 0, 1
  v_mul_u32_u24 v1, 64, v1
  v_add_u32 v5, v5, v1
  v_bfe_u32 v1, v2, 4, 2
  v_mul_u32_u24 v1, 16, v1
  v_add_u32 v5, v5, v1
  s_mov_b32 s60, 33554432
  s_mul_i32 s63, s34, 3072
  s_add_u32 s60, s60, s63
  v_add_u32 v5, s60, v5
  v_bfe_u32 v6, v2, 0, 6
  v_mul_u32_u24 v6, 4, v6
  s_mov_b32 s60, 41943040
  s_mul_i32 s63, s34, 3072
  s_add_u32 s60, s60, s63
  v_add_u32 v6, s60, v6
  v_bfe_u32 v7, v2, 0, 6
  v_mul_u32_u24 v7, 4, v7
  s_mov_b32 s60, 4096
  s_mul_i32 s63, s34, 128
  s_add_u32 s60, s60, s63
  s_mul_i32 s63, s65, 131072
  s_add_u32 s60, s60, s63
  v_add_u32 v7, s60, v7
  v_bfe_u32 v8, v2, 0, 6
  v_mul_u32_u24 v8, 4, v8
  s_mov_b32 s60, 8192
  s_mul_i32 s63, s34, 128
  s_add_u32 s60, s60, s63
  s_mul_i32 s63, s32, 4
  s_add_u32 s60, s60, s63
  s_mul_i32 s63, s65, 131072
  s_add_u32 s60, s60, s63
  v_add_u32 v8, s60, v8
  v_cmp_gt_u32 vcc, 1, v2
  v_mov_b32 v1, 2147483632
  s_nop 0
  v_cndmask_b32 v8, v1, v8, vcc
  s_mov_b32 s60, 0
  s_mul_i32 s63, s34, 128
  s_add_u32 s60, s60, s63
  s_mul_i32 s63, s65, 131072
  s_add_u32 s60, s60, s63
  s_add_u32 s40, s4, s60
  s_addc_u32 s41, s5, 0
  s_lshr_b32 s61, s34, 3
  s_mov_b32 s60, 12288
  s_mul_i32 s63, s61, 512
  s_add_u32 s60, s60, s63
  s_mul_i32 s63, s65, 131072
  s_add_u32 s60, s60, s63
  s_add_u32 s48, s4, s60
  s_addc_u32 s49, s5, 0
  v_add_u32 v1, 0, v2
  v_mul_u32_u24 v3, 1639, v1
  v_lshrrev_b32 v3, 16, v3
  v_mul_u32_u24 v144, 40, v3
  v_sub_u32 v1, v1, v144
  v_mul_u32_u24 v144, 327680, v3
  v_lshl_add_u32 v144, v1, 2, v144
  s_mul_i32 s62, s34, 160
  v_add_u32 v144, s62, v144
  v_add_u32 v1, 64, v2
  v_mul_u32_u24 v3, 1639, v1
  v_lshrrev_b32 v3, 16, v3
  v_mul_u32_u24 v145, 40, v3
  v_sub_u32 v1, v1, v145
  v_mul_u32_u24 v145, 327680, v3
  v_lshl_add_u32 v145, v1, 2, v145
  s_mul_i32 s62, s34, 160
  v_add_u32 v145, s62, v145
  v_add_u32 v1, 128, v2
  v_mul_u32_u24 v3, 1639, v1
  v_lshrrev_b32 v3, 16, v3
  v_mul_u32_u24 v146, 40, v3
  v_sub_u32 v1, v1, v146
  v_mul_u32_u24 v146, 327680, v3
  v_lshl_add_u32 v146, v1, 2, v146
  s_mul_i32 s62, s34, 160
  v_add_u32 v146, s62, v146
  v_add_u32 v1, 192, v2
  v_mul_u32_u24 v3, 1639, v1
  v_lshrrev_b32 v3, 16, v3
  v_mul_u32_u24 v147, 40, v3
  v_sub_u32 v1, v1, v147
  v_mul_u32_u24 v147, 327680, v3
  v_lshl_add_u32 v147, v1, 2, v147
  s_mul_i32 s62, s34, 160
  v_add_u32 v147, s62, v147
  v_add_u32 v1, 256, v2
  v_mul_u32_u24 v3, 1639, v1
  v_lshrrev_b32 v3, 16, v3
  v_mul_u32_u24 v148, 40, v3
  v_sub_u32 v1, v1, v148
  v_mul_u32_u24 v148, 327680, v3
  v_lshl_add_u32 v148, v1, 2, v148
  s_mul_i32 s62, s34, 160
  v_add_u32 v148, s62, v148
  s_and_b32 s62, s34, 7
  s_xor_b32 s42, s32, 2
  v_bfe_u32 v15, v2, 0, 6
  v_mul_u32_u24 v15, 4, v15
  s_mov_b32 s60, 16384
  s_mul_i32 s63, s42, 512
  s_add_u32 s60, s60, s63
  s_mul_i32 s63, s61, 128
  s_add_u32 s60, s60, s63
  s_mul_i32 s63, s62, 4
  s_add_u32 s60, s60, s63
  s_mul_i32 s63, s65, 131072
  s_add_u32 s60, s60, s63
  v_add_u32 v15, s60, v15
  v_cmp_gt_u32 vcc, 1, v2
  v_mov_b32 v1, 2147483632
  s_nop 0
  v_cndmask_b32 v15, v1, v15, vcc
  v_bfe_u32 v14, v2, 0, 6
  v_mul_u32_u24 v14, 4, v14
  s_mov_b32 s60, 0
  s_mul_i32 s63, s34, 1280
  s_add_u32 s60, s60, s63
  v_add_u32 v14, s60, v14
  s_mul_i32 s50, s65, 3
  s_cmp_eq_u32 s65, 0
  s_cselect_b64 vcc, -1, 0
  v_add_u32 v1, 0, v14
  v_cndmask_b32 v149, v144, v1, vcc
  v_add_u32 v1, 256, v14
  v_cndmask_b32 v150, v145, v1, vcc
  v_add_u32 v1, 512, v14
  v_cndmask_b32 v151, v146, v1, vcc
  v_add_u32 v1, 768, v14
  v_cndmask_b32 v152, v147, v1, vcc
  v_add_u32 v1, 1024, v14
  v_cndmask_b32 v153, v148, v1, vcc
  v_bfe_u32 v10, v2, 2, 2
  v_mul_u32_u24 v10, 8, v10
  v_bfe_u32 v1, v2, 0, 2
  v_mul_u32_u24 v1, 1, v1
  v_add_u32 v10, v10, v1
  v_bfe_u32 v11, v2, 4, 2
  v_mul_u32_u24 v11, 8, v11
  v_sub_u32 v10, v10, v11
  v_mov_b32 v11, 0xf149f2ca
  v_cmp_gt_i32 vcc, 0, v10
  s_nop 1
  v_cndmask_b32 v20, 0, v11, vcc
  v_cmp_gt_i32 vcc, 1, v10
  s_nop 1
  v_cndmask_b32 v21, 0, v11, vcc
  v_cmp_gt_i32 vcc, 2, v10
  s_nop 1
  v_cndmask_b32 v22, 0, v11, vcc
  v_cmp_gt_i32 vcc, 3, v10
  s_nop 1
  v_cndmask_b32 v23, 0, v11, vcc
  v_cmp_gt_i32 vcc, 4, v10
  s_nop 1
  v_cndmask_b32 v24, 0, v11, vcc
  v_cmp_gt_i32 vcc, 5, v10
  s_nop 1
  v_cndmask_b32 v25, 0, v11, vcc
  v_cmp_gt_i32 vcc, 6, v10
  s_nop 1
  v_cndmask_b32 v26, 0, v11, vcc
  v_cmp_gt_i32 vcc, 7, v10
  s_nop 1
  v_cndmask_b32 v27, 0, v11, vcc
  v_cmp_gt_i32 vcc, -4, v10
  s_nop 1
  v_cndmask_b32 v28, 0, v11, vcc
  v_cmp_gt_i32 vcc, -3, v10
  s_nop 1
  v_cndmask_b32 v29, 0, v11, vcc
  v_cmp_gt_i32 vcc, -2, v10
  s_nop 1
  v_cndmask_b32 v30, 0, v11, vcc
  v_cmp_gt_i32 vcc, -1, v10
  s_nop 1
  v_cndmask_b32 v31, 0, v11, vcc
  v_cmp_gt_i32 vcc, 0, v10
  s_nop 1
  v_cndmask_b32 v32, 0, v11, vcc
  v_cmp_gt_i32 vcc, 1, v10
  s_nop 1
  v_cndmask_b32 v33, 0, v11, vcc
  v_cmp_gt_i32 vcc, 2, v10
  s_nop 1
  v_cndmask_b32 v34, 0, v11, vcc
  v_cmp_gt_i32 vcc, 3, v10
  s_nop 1
  v_cndmask_b32 v35, 0, v11, vcc
  v_mov_b32 v121, 0
  v_mov_b32 v123, 0
  v_mov_b32 v125, 0
  v_mov_b32 v127, 0
  v_mov_b32 v129, 0
  v_mov_b32 v131, 0
  v_mov_b32 v133, 0
  v_mov_b32 v135, 0
  v_mov_b32 v137, 0
  v_mov_b32 v139, 0
  v_mov_b32 v141, 0
  v_mov_b32 v143, 0
  v_mov_b32 v69, 0
  v_mov_b32 v71, 0
  s_mov_b32 s39, 0x3dd53b95
  s_mov_b32 s35, s32
  s_mov_b32 s38, 0
  s_mov_b32 s42, s35
  s_mov_b32 s64, 400000
  s_mul_i32 s43, s42, 393216
L_laa_w_212:
  s_cmp_gt_u32 s38, s42
  s_cbranch_scc1 L_laa_g_213
  s_load_dwordx4 s[44:47], s[40:41], 0 glc
  s_waitcnt lgkmcnt(0)
  s_min_u32 s38, s44, s45
  s_min_u32 s38, s38, s46
  s_sub_u32 s64, s64, 1
  s_cmp_lg_u32 s64, 0
  s_cbranch_scc1 L_laa_w_212
  s_branch L_laa_fail_207
L_laa_g_213:
  s_add_u32 s60, s43, 50331648
  buffer_load_dwordx4 a[0:3], v4, s[8:11], s60 offen offset:0 sc1
  buffer_load_dwordx4 a[4:7], v4, s[8:11], s60 offen offset:1024 sc1
  buffer_load_dwordx4 a[8:11], v4, s[8:11], s60 offen offset:2048 sc1
  buffer_load_dwordx4 a[12:15], v4, s[8:11], s60 offen offset:3072 sc1
  s_add_u32 s60, s43, 50335744
  buffer_load_dwordx4 a[16:19], v4, s[8:11], s60 offen offset:0 sc1
  buffer_load_dwordx4 a[20:23], v4, s[8:11], s60 offen offset:1024 sc1
  buffer_load_dwordx4 a[24:27], v4, s[8:11], s60 offen offset:2048 sc1
  buffer_load_dwordx4 a[28:31], v4, s[8:11], s60 offen offset:3072 sc1
  s_add_u32 s60, s43, 50339840
  buffer_load_dwordx4 a[32:35], v4, s[8:11], s60 offen offset:0 sc1
  buffer_load_dwordx4 a[36:39], v4, s[8:11], s60 offen offset:1024 sc1
  buffer_load_dwordx4 a[40:43], v4, s[8:11], s60 offen offset:2048 sc1
  buffer_load_dwordx4 a[44:47], v4, s[8:11], s60 offen offset:3072 sc1
  s_add_u32 s60, s43, 117440512
  buffer_load_dwordx4 a[96:99], v4, s[8:11], s60 offen offset:0 sc1
  buffer_load_dwordx4 a[100:103], v4, s[8:11], s60 offen offset:1024 sc1
  buffer_load_dwordx4 a[104:107], v4, s[8:11], s60 offen offset:2048 sc1
  buffer_load_dwordx4 a[108:111], v4, s[8:11], s60 offen offset:3072 sc1
  s_add_u32 s60, s43, 117444608
  buffer_load_dwordx4 a[112:115], v4, s[8:11], s60 offen offset:0 sc1
  buffer_load_dwordx4 a[116:119], v4, s[8:11], s60 offen offset:1024 sc1
  buffer_load_dwordx4 a[120:123], v4, s[8:11], s60 offen offset:2048 sc1
  buffer_load_dwordx4 a[124:127], v4, s[8:11], s60 offen offset:3072 sc1
  s_add_u32 s60, s43, 117448704
  buffer_load_dwordx4 a[128:131], v4, s[8:11], s60 offen offset:0 sc1
  buffer_load_dwordx4 a[132:135], v4, s[8:11], s60 offen offset:1024 sc1
  buffer_load_dwordx4 a[136:139], v4, s[8:11], s60 offen offset:2048 sc1
  buffer_load_dwordx4 a[140:143], v4, s[8:11], s60 offen offset:3072 sc1
  s_add_u32 s60, s43, 83886080
  buffer_load_dwordx4 a[48:51], v4, s[8:11], s60 offen offset:0 sc1
  buffer_load_dwordx4 a[52:55], v4, s[8:11], s60 offen offset:1024 sc1
  buffer_load_dwordx4 a[56:59], v4, s[8:11], s60 offen offset:2048 sc1
  buffer_load_dwordx4 a[60:63], v4, s[8:11], s60 offen offset:3072 sc1
  s_add_u32 s60, s43, 83890176
  buffer_load_dwordx4 a[64:67], v4, s[8:11], s60 offen offset:0 sc1
  buffer_load_dwordx4 a[68:71], v4, s[8:11], s60 offen offset:1024 sc1
  buffer_load_dwordx4 a[72:75], v4, s[8:11], s60 offen offset:2048 sc1
  buffer_load_dwordx4 a[76:79], v4, s[8:11], s60 offen offset:3072 sc1
  s_add_u32 s60, s43, 83894272
  buffer_load_dwordx4 a[80:83], v4, s[8:11], s60 offen offset:0 sc1
  buffer_load_dwordx4 a[84:87], v4, s[8:11], s60 offen offset:1024 sc1
  buffer_load_dwordx4 a[88:91], v4, s[8:11], s60 offen offset:2048 sc1
  buffer_load_dwordx4 a[92:95], v4, s[8:11], s60 offen offset:3072 sc1
L_laa_loop_209:
  s_cmp_ge_u32 s35, 64
  s_cbranch_scc1 L_laa_nf_214
  s_mov_b32 s64, 400000
  s_mul_i32 s36, s35, 393216
  s_mul_i32 s37, s35, 98304
  s_waitcnt vmcnt(0)
  v_mfma_f32_16x16x32_bf16 v[36:39], a[0:3], a[48:51], v[20:23]
  v_mfma_f32_16x16x32_bf16 v[40:43], a[24:27], a[48:51], v[24:27]
  v_mfma_f32_16x16x32_bf16 v[44:47], a[0:3], a[72:75], v[28:31]
  v_mfma_f32_16x16x32_bf16 v[48:51], a[24:27], a[72:75], v[32:35]
  v_mfma_f32_16x16x32_bf16 v[36:39], a[4:7], a[52:55], v[36:39]
  v_mfma_f32_16x16x32_bf16 v[40:43], a[28:31], a[52:55], v[40:43]
  v_mfma_f32_16x16x32_bf16 v[44:47], a[4:7], a[76:79], v[44:47]
  v_mfma_f32_16x16x32_bf16 v[48:51], a[28:31], a[76:79], v[48:51]
  v_mfma_f32_16x16x32_bf16 v[36:39], a[8:11], a[56:59], v[36:39]
  v_mfma_f32_16x16x32_bf16 v[40:43], a[32:35], a[56:59], v[40:43]
  v_mfma_f32_16x16x32_bf16 v[44:47], a[8:11], a[80:83], v[44:47]
  v_mfma_f32_16x16x32_bf16 v[48:51], a[32:35], a[80:83], v[48:51]
  v_mfma_f32_16x16x32_bf16 v[36:39], a[12:15], a[60:63], v[36:39]
  v_mfma_f32_16x16x32_bf16 v[40:43], a[36:39], a[60:63], v[40:43]
  v_mfma_f32_16x16x32_bf16 v[44:47], a[12:15], a[84:87], v[44:47]
  v_mfma_f32_16x16x32_bf16 v[48:51], a[36:39], a[84:87], v[48:51]
  v_mfma_f32_16x16x32_bf16 v[36:39], a[16:19], a[64:67], v[36:39]
  v_mfma_f32_16x16x32_bf16 v[40:43], a[40:43], a[64:67], v[40:43]
  v_mfma_f32_16x16x32_bf16 v[44:47], a[16:19], a[88:91], v[44:47]
  v_mfma_f32_16x16x32_bf16 v[48:51], a[40:43], a[88:91], v[48:51]
  v_mfma_f32_16x16x32_bf16 v[36:39], a[20:23], a[68:71], v[36:39]
  v_mfma_f32_16x16x32_bf16 v[40:43], a[44:47], a[68:71], v[40:43]
  v_mfma_f32_16x16x32_bf16 v[44:47], a[20:23], a[92:95], v[44:47]
  v_mfma_f32_16x16x32_bf16 v[48:51], a[44:47], a[92:95], v[48:51]
  v_mov_b32 v11, s35
  s_mov_b64 exec, 7
L_laa_w_210:
  buffer_load_dword v10, v7, s[8:11], 0 offen sc1
  s_waitcnt vmcnt(0)
  v_cmp_ge_u32 vcc, v11, v10
  s_cbranch_vccz L_laa_g_211
  s_sleep 1
  s_cmp_ge_u32 s35, 61
  s_cbranch_scc1 L_laa_nap_215
  s_sleep 6
L_laa_nap_215:
  s_sub_u32 s64, s64, 1
  s_cmp_lg_u32 s64, 0
  s_cbranch_scc1 L_laa_w_210
  s_branch L_laa_fail_207
L_laa_g_211:
  s_mov_b64 exec, -1
  buffer_load_dwordx4 v[96:99], v5, s[8:11], s37 offen offset:0 sc1
  buffer_load_dwordx4 v[100:103], v5, s[8:11], s37 offen offset:512 sc1
  buffer_load_dwordx4 v[104:107], v5, s[8:11], s37 offen offset:1024 sc1
  buffer_load_dwordx4 v[108:111], v5, s[8:11], s37 offen offset:1536 sc1
  buffer_load_dwordx4 v[112:115], v5, s[8:11], s37 offen offset:2048 sc1
  buffer_load_dwordx4 v[116:119], v5, s[8:11], s37 offen offset:2560 sc1
  buffer_load_dword v120, v6, s[8:11], s37 offen offset:0 sc1
  buffer_load_dword v122, v6, s[8:11], s37 offen offset:256 sc1
  buffer_load_dword v124, v6, s[8:11], s37 offen offset:512 sc1
  buffer_load_dword v126, v6, s[8:11], s37 offen offset:768 sc1
  buffer_load_dword v128, v6, s[8:11], s37 offen offset:1024 sc1
  buffer_load_dword v130, v6, s[8:11], s37 offen offset:1280 sc1
  buffer_load_dword v132, v6, s[8:11], s37 offen offset:1536 sc1
  buffer_load_dword v134, v6, s[8:11], s37 offen offset:1792 sc1
  buffer_load_dword v136, v6, s[8:11], s37 offen offset:2048 sc1
  buffer_load_dword v138, v6, s[8:11], s37 offen offset:2304 sc1
  buffer_load_dword v140, v6, s[8:11], s37 offen offset:2560 sc1
  buffer_load_dword v142, v6, s[8:11], s37 offen offset:2816 sc1
  s_waitcnt vmcnt(17)
  v_mfma_f32_16x16x32_bf16 v[52:55], v[96:99], a[48:51], 0
  v_mfma_f32_16x16x32_bf16 v[56:59], v[96:99], a[72:75], 0
  s_waitcnt vmcnt(16)
  v_mfma_f32_16x16x32_bf16 v[52:55], v[100:103], a[52:55], v[52:55]
  v_mfma_f32_16x16x32_bf16 v[56:59], v[100:103], a[76:79], v[56:59]
  s_waitcnt vmcnt(15)
  v_mfma_f32_16x16x32_bf16 v[52:55], v[104:107], a[56:59], v[52:55]
  v_mfma_f32_16x16x32_bf16 v[56:59], v[104:107], a[80:83], v[56:59]
  s_waitcnt vmcnt(14)
  v_mfma_f32_16x16x32_bf16 v[52:55], v[108:111], a[60:63], v[52:55]
  v_mfma_f32_16x16x32_bf16 v[56:59], v[108:111], a[84:87], v[56:59]
  s_waitcnt vmcnt(13)
  v_mfma_f32_16x16x32_bf16 v[52:55], v[112:115], a[64:67], v[52:55]
  v_mfma_f32_16x16x32_bf16 v[56:59], v[112:115], a[88:91], v[56:59]
  s_waitcnt vmcnt(12)
  v_mfma_f32_16x16x32_bf16 v[52:55], v[116:119], a[68:71], v[52:55]
  v_mfma_f32_16x16x32_bf16 v[56:59], v[116:119], a[92:95], v[56:59]
  s_nop 7
  v_max3_f32 v10, v36, v37, v38
  v_max3_f32 v11, v39, v40, v41
  v_max3_f32 v12, v44, v45, v46
  v_max3_f32 v13, v47, v48, v49
  v_max3_f32 v10, v10, v42, v43
  v_max3_f32 v11, v11, v52, v53
  v_max3_f32 v12, v12, v50, v51
  v_max3_f32 v13, v13, v56, v57
  v_max_f32 v10, v10, v11
  v_max_f32 v12, v12, v13
  v_mov_b32 v11, v10
  v_mov_b32 v13, v12
  s_nop 1
  v_permlane16_swap_b32 v11, v10
  v_permlane16_swap_b32 v13, v12
  v_max_f32 v10, v10, v11
  v_max_f32 v12, v12, v13
  v_mov_b32 v11, v10
  v_mov_b32 v13, v12
  s_nop 1
  v_permlane32_swap_b32 v11, v10
  v_permlane32_swap_b32 v13, v12
  v_max_f32 v10, v10, v11
  v_max_f32 v12, v12, v13
  v_mul_f32 v10, s39, v10
  v_mul_f32 v12, s39, v12
  v_fma_f32 v36, v36, s39, -v10
  v_fma_f32 v37, v37, s39, -v10
  v_fma_f32 v38, v38, s39, -v10
  v_fma_f32 v39, v39, s39, -v10
  v_fma_f32 v40, v40, s39, -v10
  v_fma_f32 v41, v41, s39, -v10
  v_fma_f32 v42, v42, s39, -v10
  v_fma_f32 v43, v43, s39, -v10
  v_fma_f32 v52, v52, s39, -v10
  v_fma_f32 v53, v53, s39, -v10
  v_fma_f32 v44, v44, s39, -v12
  v_fma_f32 v45, v45, s39, -v12
  v_fma_f32 v46, v46, s39, -v12
  v_fma_f32 v47, v47, s39, -v12
  v_fma_f32 v48, v48, s39, -v12
  v_fma_f32 v49, v49, s39, -v12
  v_fma_f32 v50, v50, s39, -v12
  v_fma_f32 v51, v51, s39, -v12
  v_fma_f32 v56, v56, s39, -v12
  v_fma_f32 v57, v57, s39, -v12
  v_exp_f32 v36, v36
  v_exp_f32 v37, v37
  v_exp_f32 v38, v38
  v_exp_f32 v39, v39
  v_exp_f32 v40, v40
  v_exp_f32 v41, v41
  v_exp_f32 v42, v42
  v_exp_f32 v43, v43
  v_exp_f32 v52, v52
  v_exp_f32 v53, v53
  v_exp_f32 v44, v44
  v_exp_f32 v45, v45
  v_exp_f32 v46, v46
  v_exp_f32 v47, v47
  v_exp_f32 v48, v48
  v_exp_f32 v49, v49
  v_exp_f32 v50, v50
  v_exp_f32 v51, v51
  v_exp_f32 v56, v56
  v_exp_f32 v57, v57
  v_add_f32 v10, v36, v37
  v_add_f32 v11, v38, v39
  v_add_f32 v12, v44, v45
  v_add_f32 v13, v46, v47
  v_add_f32 v10, v10, v40
  v_add_f32 v11, v11, v41
  v_add_f32 v12, v12, v48
  v_add_f32 v13, v13, v49
  v_add_f32 v10, v10, v42
  v_add_f32 v11, v11, v43
  v_add_f32 v12, v12, v50
  v_add_f32 v13, v13, v51
  v_add_f32 v10, v10, v52
  v_add_f32 v11, v11, v53
  v_add_f32 v12, v12, v56
  v_add_f32 v13, v13, v57
  v_add_f32 v10, v10, v11
  v_add_f32 v12, v12, v13
  v_mov_b32 v11, v10
  v_mov_b32 v13, v12
  s_nop 1
  v_permlane16_swap_b32 v11, v10
  v_permlane16_swap_b32 v13, v12
  v_add_f32 v10, v10, v11
  v_add_f32 v12, v12, v13
  v_mov_b32 v11, v10
  v_mov_b32 v13, v12
  s_nop 1
  v_permlane32_swap_b32 v11, v10
  v_permlane32_swap_b32 v13, v12
  v_add_f32 v10, v10, v11
  v_add_f32 v12, v12, v13
  v_rcp_f32 v10, v10
  v_rcp_f32 v12, v12
  s_nop 0
  v_mul_f32 v36, v36, v10
  v_mul_f32 v37, v37, v10
  v_mul_f32 v38, v38, v10
  v_mul_f32 v39, v39, v10
  v_mul_f32 v40, v40, v10
  v_mul_f32 v41, v41, v10
  v_mul_f32 v42, v42, v10
  v_mul_f32 v43, v43, v10
  v_mul_f32 v52, v52, v10
  v_mul_f32 v53, v53, v10
  v_mul_f32 v44, v44, v12
  v_mul_f32 v45, v45, v12
  v_mul_f32 v46, v46, v12
  v_mul_f32 v47, v47, v12
  v_mul_f32 v48, v48, v12
  v_mul_f32 v49, v49, v12
  v_mul_f32 v50, v50, v12
  v_mul_f32 v51, v51, v12
  v_mul_f32 v56, v56, v12
  v_mul_f32 v57, v57, v12
  v_cvt_pk_bf16_f32 v60, v36, v37
  v_cvt_pk_bf16_f32 v61, v38, v39
  v_cvt_pk_bf16_f32 v62, v40, v41
  v_cvt_pk_bf16_f32 v63, v42, v43
  v_cvt_pk_bf16_f32 v68, v52, v53
  v_cvt_pk_bf16_f32 v64, v44, v45
  v_cvt_pk_bf16_f32 v65, v46, v47
  v_cvt_pk_bf16_f32 v66, v48, v49
  v_cvt_pk_bf16_f32 v67, v50, v51
  v_cvt_pk_bf16_f32 v70, v56, v57
  s_waitcnt vmcnt(0)
  s_add_u32 s36, s36, 83886080
  v_mfma_f32_16x16x32_bf16 v[72:75], a[96:99], v[60:63], 0
  v_mfma_f32_16x16x32_bf16 v[76:79], a[100:103], v[60:63], 0
  v_mfma_f32_16x16x32_bf16 v[80:83], a[96:99], v[64:67], 0
  v_mfma_f32_16x16x32_bf16 v[84:87], a[100:103], v[64:67], 0
  v_mfma_f32_16x16x16_bf16 v[72:75], v[120:121], v[68:69], v[72:75]
  v_mfma_f32_16x16x16_bf16 v[76:79], v[122:123], v[68:69], v[76:79]
  v_mfma_f32_16x16x16_bf16 v[80:83], v[120:121], v[70:71], v[80:83]
  v_mfma_f32_16x16x16_bf16 v[84:87], v[122:123], v[70:71], v[84:87]
  v_mfma_f32_16x16x32_bf16 v[36:39], a[104:107], v[60:63], 0
  v_mfma_f32_16x16x32_bf16 v[40:43], a[108:111], v[60:63], 0
  v_mfma_f32_16x16x32_bf16 v[44:47], a[104:107], v[64:67], 0
  v_mfma_f32_16x16x32_bf16 v[48:51], a[108:111], v[64:67], 0
  v_mfma_f32_16x16x16_bf16 v[36:39], v[124:125], v[68:69], v[36:39]
  v_mfma_f32_16x16x16_bf16 v[40:43], v[126:127], v[68:69], v[40:43]
  v_mfma_f32_16x16x16_bf16 v[44:47], v[124:125], v[70:71], v[44:47]
  v_mfma_f32_16x16x16_bf16 v[48:51], v[126:127], v[70:71], v[48:51]
  v_cvt_pk_bf16_f32 v88, v72, v73
  v_cvt_pk_bf16_f32 v89, v74, v75
  v_cvt_pk_bf16_f32 v90, v76, v77
  v_cvt_pk_bf16_f32 v91, v78, v79
  s_add_u32 s60, s36, 0
  buffer_store_dwordx4 v[88:91], v4, s[8:11], s60 offen offset:0 sc1
  v_cvt_pk_bf16_f32 v92, v80, v81
  v_cvt_pk_bf16_f32 v93, v82, v83
  v_cvt_pk_bf16_f32 v94, v84, v85
  v_cvt_pk_bf16_f32 v95, v86, v87
  s_add_u32 s60, s36, 4096
  buffer_store_dwordx4 v[92:95], v4, s[8:11], s60 offen offset:2048 sc1
  v_mfma_f32_16x16x32_bf16 v[72:75], a[112:115], v[60:63], 0
  v_mfma_f32_16x16x32_bf16 v[76:79], a[116:119], v[60:63], 0
  v_mfma_f32_16x16x32_bf16 v[80:83], a[112:115], v[64:67], 0
  v_mfma_f32_16x16x32_bf16 v[84:87], a[116:119], v[64:67], 0
  v_mfma_f32_16x16x16_bf16 v[72:75], v[128:129], v[68:69], v[72:75]
  v_mfma_f32_16x16x16_bf16 v[76:79], v[130:131], v[68:69], v[76:79]
  v_mfma_f32_16x16x16_bf16 v[80:83], v[128:129], v[70:71], v[80:83]
  v_mfma_f32_16x16x16_bf16 v[84:87], v[130:131], v[70:71], v[84:87]
  v_cvt_pk_bf16_f32 v88, v36, v37
  v_cvt_pk_bf16_f32 v89, v38, v39
  v_cvt_pk_bf16_f32 v90, v40, v41
  v_cvt_pk_bf16_f32 v91, v42, v43
  s_add_u32 s60, s36, 0
  buffer_store_dwordx4 v[88:91], v4, s[8:11], s60 offen offset:1024 sc1
  v_cvt_pk_bf16_f32 v92, v44, v45
  v_cvt_pk_bf16_f32 v93, v46, v47
  v_cvt_pk_bf16_f32 v94, v48, v49
  v_cvt_pk_bf16_f32 v95, v50, v51
  s_add_u32 s60, s36, 4096
  buffer_store_dwordx4 v[92:95], v4, s[8:11], s60 offen offset:3072 sc1
  v_mfma_f32_16x16x32_bf16 v[36:39], a[120:123], v[60:63], 0
  v_mfma_f32_16x16x32_bf16 v[40:43], a[124:127], v[60:63], 0
  v_mfma_f32_16x16x32_bf16 v[44:47], a[120:123], v[64:67], 0
  v_mfma_f32_16x16x32_bf16 v[48:51], a[124:127], v[64:67], 0
  v_mfma_f32_16x16x16_bf16 v[36:39], v[132:133], v[68:69], v[36:39]
  v_mfma_f32_16x16x16_bf16 v[40:43], v[134:135], v[68:69], v[40:43]
  v_mfma_f32_16x16x16_bf16 v[44:47], v[132:133], v[70:71], v[44:47]
  v_mfma_f32_16x16x16_bf16 v[48:51], v[134:135], v[70:71], v[48:51]
  v_cvt_pk_bf16_f32 v88, v72, v73
  v_cvt_pk_bf16_f32 v89, v74, v75
  v_cvt_pk_bf16_f32 v90, v76, v77
  v_cvt_pk_bf16_f32 v91, v78, v79
  s_add_u32 s60, s36, 0
  buffer_store_dwordx4 v[88:91], v4, s[8:11], s60 offen offset:2048 sc1
  v_cvt_pk_bf16_f32 v92, v80, v81
  v_cvt_pk_bf16_f32 v93, v82, v83
  v_cvt_pk_bf16_f32 v94, v84, v85
  v_cvt_pk_bf16_f32 v95, v86, v87
  s_add_u32 s60, s36, 8192
  buffer_store_dwordx4 v[92:95], v4, s[8:11], s60 offen offset:0 sc1
  v_mfma_f32_16x16x32_bf16 v[72:75], a[128:131], v[60:63], 0
  v_mfma_f32_16x16x32_bf16 v[76:79], a[132:135], v[60:63], 0
  v_mfma_f32_16x16x32_bf16 v[80:83], a[128:131], v[64:67], 0
  v_mfma_f32_16x16x32_bf16 v[84:87], a[132:135], v[64:67], 0
  v_mfma_f32_16x16x16_bf16 v[72:75], v[136:137], v[68:69], v[72:75]
  v_mfma_f32_16x16x16_bf16 v[76:79], v[138:139], v[68:69], v[76:79]
  v_mfma_f32_16x16x16_bf16 v[80:83], v[136:137], v[70:71], v[80:83]
  v_mfma_f32_16x16x16_bf16 v[84:87], v[138:139], v[70:71], v[84:87]
  v_cvt_pk_bf16_f32 v88, v36, v37
  v_cvt_pk_bf16_f32 v89, v38, v39
  v_cvt_pk_bf16_f32 v90, v40, v41
  v_cvt_pk_bf16_f32 v91, v42, v43
  s_add_u32 s60, s36, 0
  buffer_store_dwordx4 v[88:91], v4, s[8:11], s60 offen offset:3072 sc1
  v_cvt_pk_bf16_f32 v92, v44, v45
  v_cvt_pk_bf16_f32 v93, v46, v47
  v_cvt_pk_bf16_f32 v94, v48, v49
  v_cvt_pk_bf16_f32 v95, v50, v51
  s_add_u32 s60, s36, 8192
  buffer_store_dwordx4 v[92:95], v4, s[8:11], s60 offen offset:1024 sc1
  v_mfma_f32_16x16x32_bf16 v[36:39], a[136:139], v[60:63], 0
  v_mfma_f32_16x16x32_bf16 v[40:43], a[140:143], v[60:63], 0
  v_mfma_f32_16x16x32_bf16 v[44:47], a[136:139], v[64:67], 0
  v_mfma_f32_16x16x32_bf16 v[48:51], a[140:143], v[64:67], 0
  v_mfma_f32_16x16x16_bf16 v[36:39], v[140:141], v[68:69], v[36:39]
  v_mfma_f32_16x16x16_bf16 v[40:43], v[142:143], v[68:69], v[40:43]
  v_mfma_f32_16x16x16_bf16 v[44:47], v[140:141], v[70:71], v[44:47]
  v_mfma_f32_16x16x16_bf16 v[48:51], v[142:143], v[70:71], v[48:51]
  v_cvt_pk_bf16_f32 v88, v72, v73
  v_cvt_pk_bf16_f32 v89, v74, v75
  v_cvt_pk_bf16_f32 v90, v76, v77
  v_cvt_pk_bf16_f32 v91, v78, v79
  s_add_u32 s60, s36, 4096
  buffer_store_dwordx4 v[88:91], v4, s[8:11], s60 offen offset:0 sc1
  v_cvt_pk_bf16_f32 v92, v80, v81
  v_cvt_pk_bf16_f32 v93, v82, v83
  v_cvt_pk_bf16_f32 v94, v84, v85
  v_cvt_pk_bf16_f32 v95, v86, v87
  s_add_u32 s60, s36, 8192
  buffer_store_dwordx4 v[92:95], v4, s[8:11], s60 offen offset:2048 sc1
  s_nop 7
  v_cvt_pk_bf16_f32 v88, v36, v37
  v_cvt_pk_bf16_f32 v89, v38, v39
  v_cvt_pk_bf16_f32 v90, v40, v41
  v_cvt_pk_bf16_f32 v91, v42, v43
  s_add_u32 s60, s36, 4096
  buffer_store_dwordx4 v[88:91], v4, s[8:11], s60 offen offset:1024 sc1
  v_cvt_pk_bf16_f32 v92, v44, v45
  v_cvt_pk_bf16_f32 v93, v46, v47
  v_cvt_pk_bf16_f32 v94, v48, v49
  v_cvt_pk_bf16_f32 v95, v50, v51
  s_add_u32 s60, s36, 8192
  buffer_store_dwordx4 v[92:95], v4, s[8:11], s60 offen offset:3072 sc1
  s_add_u32 s60, s35, 1
  v_mov_b32 v12, s60
  s_waitcnt vmcnt(0)
  buffer_store_dword v12, v8, s[8:11], 0 offen sc1
  s_add_u32 s42, s35, 4
  s_cmp_ge_u32 s42, 64
  s_cbranch_scc1 L_laa_nf_214
  s_mov_b32 s64, 400000
  s_mul_i32 s43, s42, 393216
L_laa_w_216:
  s_cmp_gt_u32 s38, s42
  s_cbranch_scc1 L_laa_g_217
  s_load_dwordx4 s[44:47], s[40:41], 0 glc
  s_waitcnt lgkmcnt(0)
  s_min_u32 s38, s44, s45
  s_min_u32 s38, s38, s46
  s_sub_u32 s64, s64, 1
  s_cmp_lg_u32 s64, 0
  s_cbranch_scc1 L_laa_w_216
  s_branch L_laa_fail_207
L_laa_g_217:
  s_add_u32 s60, s43, 50331648
  buffer_load_dwordx4 a[0:3], v4, s[8:11], s60 offen offset:0 sc1
  buffer_load_dwordx4 a[4:7], v4, s[8:11], s60 offen offset:1024 sc1
  buffer_load_dwordx4 a[8:11], v4, s[8:11], s60 offen offset:2048 sc1
  buffer_load_dwordx4 a[12:15], v4, s[8:11], s60 offen offset:3072 sc1
  s_add_u32 s60, s43, 50335744
  buffer_load_dwordx4 a[16:19], v4, s[8:11], s60 offen offset:0 sc1
  buffer_load_dwordx4 a[20:23], v4, s[8:11], s60 offen offset:1024 sc1
  buffer_load_dwordx4 a[24:27], v4, s[8:11], s60 offen offset:2048 sc1
  buffer_load_dwordx4 a[28:31], v4, s[8:11], s60 offen offset:3072 sc1
  s_add_u32 s60, s43, 50339840
  buffer_load_dwordx4 a[32:35], v4, s[8:11], s60 offen offset:0 sc1
  buffer_load_dwordx4 a[36:39], v4, s[8:11], s60 offen offset:1024 sc1
  buffer_load_dwordx4 a[40:43], v4, s[8:11], s60 offen offset:2048 sc1
  buffer_load_dwordx4 a[44:47], v4, s[8:11], s60 offen offset:3072 sc1
  s_add_u32 s60, s43, 117440512
  buffer_load_dwordx4 a[96:99], v4, s[8:11], s60 offen offset:0 sc1
  buffer_load_dwordx4 a[100:103], v4, s[8:11], s60 offen offset:1024 sc1
  buffer_load_dwordx4 a[104:107], v4, s[8:11], s60 offen offset:2048 sc1
  buffer_load_dwordx4 a[108:111], v4, s[8:11], s60 offen offset:3072 sc1
  s_add_u32 s60, s43, 117444608
  buffer_load_dwordx4 a[112:115], v4, s[8:11], s60 offen offset:0 sc1
  buffer_load_dwordx4 a[116:119], v4, s[8:11], s60 offen offset:1024 sc1
  buffer_load_dwordx4 a[120:123], v4, s[8:11], s60 offen offset:2048 sc1
  buffer_load_dwordx4 a[124:127], v4, s[8:11], s60 offen offset:3072 sc1
  s_add_u32 s60, s43, 117448704
  buffer_load_dwordx4 a[128:131], v4, s[8:11], s60 offen offset:0 sc1
  buffer_load_dwordx4 a[132:135], v4, s[8:11], s60 offen offset:1024 sc1
  buffer_load_dwordx4 a[136:139], v4, s[8:11], s60 offen offset:2048 sc1
  buffer_load_dwordx4 a[140:143], v4, s[8:11], s60 offen offset:3072 sc1
  s_add_u32 s60, s43, 83886080
  buffer_load_dwordx4 a[48:51], v4, s[8:11], s60 offen offset:0 sc1
  buffer_load_dwordx4 a[52:55], v4, s[8:11], s60 offen offset:1024 sc1
  buffer_load_dwordx4 a[56:59], v4, s[8:11], s60 offen offset:2048 sc1
  buffer_load_dwordx4 a[60:63], v4, s[8:11], s60 offen offset:3072 sc1
  s_add_u32 s60, s43, 83890176
  buffer_load_dwordx4 a[64:67], v4, s[8:11], s60 offen offset:0 sc1
  buffer_load_dwordx4 a[68:71], v4, s[8:11], s60 offen offset:1024 sc1
  buffer_load_dwordx4 a[72:75], v4, s[8:11], s60 offen offset:2048 sc1
  buffer_load_dwordx4 a[76:79], v4, s[8:11], s60 offen offset:3072 sc1
  s_add_u32 s60, s43, 83894272
  buffer_load_dwordx4 a[80:83], v4, s[8:11], s60 offen offset:0 sc1
  buffer_load_dwordx4 a[84:87], v4, s[8:11], s60 offen offset:1024 sc1
  buffer_load_dwordx4 a[88:91], v4, s[8:11], s60 offen offset:2048 sc1
  buffer_load_dwordx4 a[92:95], v4, s[8:11], s60 offen offset:3072 sc1
L_laa_nf_214:
  s_sub_u32 s42, s35, 2
  s_cmp_ge_u32 s42, 64
  s_cbranch_scc1 L_laa_skip_218
  s_mul_i32 s36, s42, 40960
  s_add_u32 s42, s42, 1
  v_mov_b32 v12, s42
  s_lshr_b32 s60, s36, s50
  buffer_load_dword v116, v149, s[72:75], s60 offen sc1
  buffer_load_dword v117, v150, s[72:75], s60 offen sc1
  buffer_load_dword v118, v151, s[72:75], s60 offen sc1
  buffer_load_dword v119, v152, s[72:75], s60 offen sc1
  buffer_load_dword v120, v153, s[72:75], s60 offen sc1
  s_mov_b32 s64, 400000
L_laa_w_219:
  s_load_dwordx8 s[12:19], s[48:49], 0 glc
  s_load_dwordx8 s[20:27], s[48:49], 128 glc
  s_load_dwordx8 s[52:59], s[48:49], 256 glc
  s_load_dwordx8 s[76:83], s[48:49], 384 glc
  s_waitcnt lgkmcnt(0)
  s_min_u32 s12, s12, s13
  s_min_u32 s12, s12, s14
  s_min_u32 s12, s12, s15
  s_min_u32 s12, s12, s16
  s_min_u32 s12, s12, s17
  s_min_u32 s12, s12, s18
  s_min_u32 s12, s12, s19
  s_min_u32 s12, s12, s20
  s_min_u32 s12, s12, s21
  s_min_u32 s12, s12, s22
  s_min_u32 s12, s12, s23
  s_min_u32 s12, s12, s24
  s_min_u32 s12, s12, s25
  s_min_u32 s12, s12, s26
  s_min_u32 s12, s12, s27
  s_min_u32 s12, s12, s52
  s_min_u32 s12, s12, s53
  s_min_u32 s12, s12, s54
  s_min_u32 s12, s12, s55
  s_min_u32 s12, s12, s56
  s_min_u32 s12, s12, s57
  s_min_u32 s12, s12, s58
  s_min_u32 s12, s12, s59
  s_min_u32 s12, s12, s76
  s_min_u32 s12, s12, s77
  s_min_u32 s12, s12, s78
  s_min_u32 s12, s12, s79
  s_min_u32 s12, s12, s80
  s_min_u32 s12, s12, s81
  s_min_u32 s12, s12, s82
  s_min_u32 s12, s12, s83
  s_cmp_ge_u32 s12, s42
  s_cbranch_scc1 L_laa_g_220
  s_sleep 1
  s_cmp_ge_u32 s35, 61
  s_cbranch_scc1 L_laa_nap_221
  s_sleep 16
L_laa_nap_221:
  s_sub_u32 s64, s64, 1
  s_cmp_lg_u32 s64, 0
  s_cbranch_scc1 L_laa_w_219
  s_branch L_laa_fail_207
L_laa_g_220:
  s_lshr_b32 s60, s36, 3
  s_add_u32 s60, s60, 23068672
  buffer_load_dword v96, v144, s[8:11], s60 offen sc1
  buffer_load_dword v97, v145, s[8:11], s60 offen sc1
  buffer_load_dword v98, v146, s[8:11], s60 offen sc1
  buffer_load_dword v99, v147, s[8:11], s60 offen sc1
  buffer_load_dword v100, v148, s[8:11], s60 offen sc1
  s_lshr_b32 s60, s36, 3
  s_add_u32 s60, s60, 25690112
  buffer_load_dword v101, v144, s[8:11], s60 offen sc1
  buffer_load_dword v102, v145, s[8:11], s60 offen sc1
  buffer_load_dword v103, v146, s[8:11], s60 offen sc1
  buffer_load_dword v104, v147, s[8:11], s60 offen sc1
  buffer_load_dword v105, v148, s[8:11], s60 offen sc1
  s_lshr_b32 s60, s36, 3
  s_add_u32 s60, s60, 28311552
  buffer_load_dword v106, v144, s[8:11], s60 offen sc1
  buffer_load_dword v107, v145, s[8:11], s60 offen sc1
  buffer_load_dword v108, v146, s[8:11], s60 offen sc1
  buffer_load_dword v109, v147, s[8:11], s60 offen sc1
  buffer_load_dword v110, v148, s[8:11], s60 offen sc1
  s_lshr_b32 s60, s36, 3
  s_add_u32 s60, s60, 30932992
  buffer_load_dword v111, v144, s[8:11], s60 offen sc1
  buffer_load_dword v112, v145, s[8:11], s60 offen sc1
  buffer_load_dword v113, v146, s[8:11], s60 offen sc1
  buffer_load_dword v114, v147, s[8:11], s60 offen sc1
  buffer_load_dword v115, v148, s[8:11], s60 offen sc1
  s_mov_b32 s62, 0xffff0000
  s_waitcnt vmcnt(20)
  v_lshlrev_b32 v36, 16, v116
  v_and_b32 v37, s62, v116
  v_lshlrev_b32 v38, 16, v117
  v_and_b32 v39, s62, v117
  v_lshlrev_b32 v40, 16, v118
  v_and_b32 v41, s62, v118
  v_lshlrev_b32 v42, 16, v119
  v_and_b32 v43, s62, v119
  v_lshlrev_b32 v44, 16, v120
  v_and_b32 v45, s62, v120
  s_waitcnt vmcnt(15)
  v_lshlrev_b32 v46, 16, v96
  v_and_b32 v47, s62, v96
  v_pk_add_f32 v[36:37], v[36:37], v[46:47]
  v_lshlrev_b32 v46, 16, v97
  v_and_b32 v47, s62, v97
  v_pk_add_f32 v[38:39], v[38:39], v[46:47]
  v_lshlrev_b32 v46, 16, v98
  v_and_b32 v47, s62, v98
  v_pk_add_f32 v[40:41], v[40:41], v[46:47]
  v_lshlrev_b32 v46, 16, v99
  v_and_b32 v47, s62, v99
  v_pk_add_f32 v[42:43], v[42:43], v[46:47]
  v_lshlrev_b32 v46, 16, v100
  v_and_b32 v47, s62, v100
  v_pk_add_f32 v[44:45], v[44:45], v[46:47]
  s_waitcnt vmcnt(10)
  v_lshlrev_b32 v46, 16, v101
  v_and_b32 v47, s62, v101
  v_pk_add_f32 v[36:37], v[36:37], v[46:47]
  v_lshlrev_b32 v46, 16, v102
  v_and_b32 v47, s62, v102
  v_pk_add_f32 v[38:39], v[38:39], v[46:47]
  v_lshlrev_b32 v46, 16, v103
  v_and_b32 v47, s62, v103
  v_pk_add_f32 v[40:41], v[40:41], v[46:47]
  v_lshlrev_b32 v46, 16, v104
  v_and_b32 v47, s62, v104
  v_pk_add_f32 v[42:43], v[42:43], v[46:47]
  v_lshlrev_b32 v46, 16, v105
  v_and_b32 v47, s62, v105
  v_pk_add_f32 v[44:45], v[44:45], v[46:47]
  s_waitcnt vmcnt(5)
  v_lshlrev_b32 v46, 16, v106
  v_and_b32 v47, s62, v106
  v_pk_add_f32 v[36:37], v[36:37], v[46:47]
  v_lshlrev_b32 v46, 16, v107
  v_and_b32 v47, s62, v107
  v_pk_add_f32 v[38:39], v[38:39], v[46:47]
  v_lshlrev_b32 v46, 16, v108
  v_and_b32 v47, s62, v108
  v_pk_add_f32 v[40:41], v[40:41], v[46:47]
  v_lshlrev_b32 v46, 16, v109
  v_and_b32 v47, s62, v109
  v_pk_add_f32 v[42:43], v[42:43], v[46:47]
  v_lshlrev_b32 v46, 16, v110
  v_and_b32 v47, s62, v110
  v_pk_add_f32 v[44:45], v[44:45], v[46:47]
  s_waitcnt vmcnt(0)
  v_lshlrev_b32 v46, 16, v111
  v_and_b32 v47, s62, v111
  v_pk_add_f32 v[36:37], v[36:37], v[46:47]
  v_lshlrev_b32 v46, 16, v112
  v_and_b32 v47, s62, v112
  v_pk_add_f32 v[38:39], v[38:39], v[46:47]
  v_lshlrev_b32 v46, 16, v113
  v_and_b32 v47, s62, v113
  v_pk_add_f32 v[40:41], v[40:41], v[46:47]
  v_lshlrev_b32 v46, 16, v114
  v_and_b32 v47, s62, v114
  v_pk_add_f32 v[42:43], v[42:43], v[46:47]
  v_lshlrev_b32 v46, 16, v115
  v_and_b32 v47, s62, v115
  v_pk_add_f32 v[44:45], v[44:45], v[46:47]
  v_cvt_pk_bf16_f32 v96, v36, v37
  v_cvt_pk_bf16_f32 v97, v38, v39
  v_cvt_pk_bf16_f32 v98, v40, v41
  v_cvt_pk_bf16_f32 v99, v42, v43
  v_cvt_pk_bf16_f32 v100, v44, v45
  s_add_u32 s60, s36, 10485760
  buffer_store_dword v96, v14, s[8:11], s60 offen offset:0 sc1
  buffer_store_dword v97, v14, s[8:11], s60 offen offset:256 sc1
  buffer_store_dword v98, v14, s[8:11], s60 offen offset:512 sc1
  buffer_store_dword v99, v14, s[8:11], s60 offen offset:768 sc1
  buffer_store_dword v100, v14, s[8:11], s60 offen offset:1024 sc1
  v_lshlrev_b32 v36, 16, v96
  v_and_b32 v37, s62, v96
  v_lshlrev_b32 v38, 16, v97
  v_and_b32 v39, s62, v97
  v_lshlrev_b32 v40, 16, v98
  v_and_b32 v41, s62, v98
  v_lshlrev_b32 v42, 16, v99
  v_and_b32 v43, s62, v99
  v_lshlrev_b32 v44, 16, v100
  v_and_b32 v45, s62, v100
  v_pk_add_f32 v[46:47], v[36:37], v[38:39]
  v_pk_add_f32 v[46:47], v[46:47], v[40:41]
  v_pk_add_f32 v[46:47], v[46:47], v[42:43]
  v_pk_add_f32 v[46:47], v[46:47], v[44:45]
  v_add_f32 v46, v46, v47
  s_nop 1
  v_add_f32_dpp v46, v46, v46 row_ror:1 row_mask:0xf bank_mask:0xf
  s_nop 1
  v_add_f32_dpp v46, v46, v46 row_ror:2 row_mask:0xf bank_mask:0xf
  s_nop 1
  v_add_f32_dpp v46, v46, v46 row_ror:4 row_mask:0xf bank_mask:0xf
  s_nop 1
  v_add_f32_dpp v46, v46, v46 row_ror:8 row_mask:0xf bank_mask:0xf
  v_mov_b32 v47, v46
  s_nop 1
  v_permlane16_swap_b32 v47, v46
  v_add_f32 v46, v46, v47
  v_mov_b32 v47, v46
  s_nop 1
  v_permlane32_swap_b32 v47, v46
  v_add_f32 v46, v46, v47
  v_mul_f32 v46, 0x3acccccd, v46
  v_sub_f32 v36, v36, v46
  v_sub_f32 v37, v37, v46
  v_sub_f32 v38, v38, v46
  v_sub_f32 v39, v39, v46
  v_sub_f32 v40, v40, v46
  v_sub_f32 v41, v41, v46
  v_sub_f32 v42, v42, v46
  v_sub_f32 v43, v43, v46
  v_sub_f32 v44, v44, v46
  v_sub_f32 v45, v45, v46
  v_pk_mul_f32 v[46:47], v[36:37], v[36:37]
  v_pk_fma_f32 v[46:47], v[38:39], v[38:39], v[46:47]
  v_pk_fma_f32 v[46:47], v[40:41], v[40:41], v[46:47]
  v_pk_fma_f32 v[46:47], v[42:43], v[42:43], v[46:47]
  v_pk_fma_f32 v[46:47], v[44:45], v[44:45], v[46:47]
  v_add_f32 v46, v46, v47
  s_nop 1
  v_add_f32_dpp v46, v46, v46 row_ror:1 row_mask:0xf bank_mask:0xf
  s_nop 1
  v_add_f32_dpp v46, v46, v46 row_ror:2 row_mask:0xf bank_mask:0xf
  s_nop 1
  v_add_f32_dpp v46, v46, v46 row_ror:4 row_mask:0xf bank_mask:0xf
  s_nop 1
  v_add_f32_dpp v46, v46, v46 row_ror:8 row_mask:0xf bank_mask:0xf
  v_mov_b32 v47, v46
  s_nop 1
  v_permlane16_swap_b32 v47, v46
  v_add_f32 v46, v46, v47
  v_mov_b32 v47, v46
  s_nop 1
  v_permlane32_swap_b32 v47, v46
  v_add_f32 v46, v46, v47
  v_mul_f32 v46, 0x3acccccd, v46
  v_add_f32 v47, 0x3727c5ac, v46
  v_rsq_f32 v47, v47
  s_nop 0
  v_mul_f32 v46, v46, v47
  v_mul_f32 v46, v46, v47
  v_add_f32 v46, 0x3727c5ac, v46
  v_rsq_f32 v46, v46
  s_nop 0
  v_mul_f32 v47, v47, v46
  v_mul_f32 v36, v36, v47
  v_mul_f32 v37, v37, v47
  v_mul_f32 v38, v38, v47
  v_mul_f32 v39, v39, v47
  v_mul_f32 v40, v40, v47
  v_mul_f32 v41, v41, v47
  v_mul_f32 v42, v42, v47
  v_mul_f32 v43, v43, v47
  v_mul_f32 v44, v44, v47
  v_mul_f32 v45, v45, v47
  v_cvt_pk_bf16_f32 v101, v36, v37
  v_cvt_pk_bf16_f32 v102, v38, v39
  v_cvt_pk_bf16_f32 v103, v40, v41
  v_cvt_pk_bf16_f32 v104, v42, v43
  v_cvt_pk_bf16_f32 v105, v44, v45
  s_add_u32 s60, s36, 16777216
  buffer_store_dword v101, v14, s[8:11], s60 offen offset:0 sc1
  buffer_store_dword v102, v14, s[8:11], s60 offen offset:256 sc1
  buffer_store_dword v103, v14, s[8:11], s60 offen offset:512 sc1
  buffer_store_dword v104, v14, s[8:11], s60 offen offset:768 sc1
  buffer_store_dword v105, v14, s[8:11], s60 offen offset:1024 sc1
  s_waitcnt vmcnt(0)
  buffer_store_dword v12, v15, s[8:11], 0 offen sc1
L_laa_skip_218:
  s_add_u32 s35, s35, 4
  s_cmp_lt_u32 s35, 66
  s_cbranch_scc1 L_laa_loop_209
  s_waitcnt vmcnt(0)
  s_call_b64 s[66:67], la_mixer
  s_branch L_laa_again_208
L_laa_fail_207:
  s_mov_b64 exec, 1
  v_mov_b32 v1, 262144
  v_mov_b32 v3, 1
  buffer_atomic_add v3, v1, s[8:11], 0 offen
  s_waitcnt vmcnt(0) lgkmcnt(0)
  s_endpgm
la_wk:
  s_cmp_lt_u32 s35, 24
  s_cbranch_scc1 la_proj
  s_lshr_b32 s34, s33, 5
  s_sub_u32 s34, s34, 4
  s_and_b32 s35, s33, 7
  v_add_u32 v1, 0, v2
  v_mul_u32_u24 v3, 6554, v1
  v_lshrrev_b32 v3, 16, v3
  v_mul_u32_u24 v4, 10, v3
  v_sub_u32 v1, v1, v4
  v_lshlrev_b32 v1, 4, v1
  v_mul_u32_u24 v4, 1280, v3
  v_add_u32 v4, v4, v1
  s_mov_b32 s60, 0
  s_mul_i32 s63, s34, 1966080
  s_add_u32 s60, s60, s63
  s_mul_i32 s63, s32, 491520
  s_add_u32 s60, s60, s63
  s_mul_i32 s63, s35, 160
  s_add_u32 s60, s60, s63
  v_add_u32 v4, s60, v4
  v_add_u32 v1, 64, v2
  v_mul_u32_u24 v3, 6554, v1
  v_lshrrev_b32 v3, 16, v3
  v_mul_u32_u24 v5, 10, v3
  v_sub_u32 v1, v1, v5
  v_lshlrev_b32 v1, 4, v1
  v_mul_u32_u24 v5, 1280, v3
  v_add_u32 v5, v5, v1
  s_mov_b32 s60, 0
  s_mul_i32 s63, s34, 1966080
  s_add_u32 s60, s60, s63
  s_mul_i32 s63, s32, 491520
  s_add_u32 s60, s60, s63
  s_mul_i32 s63, s35, 160
  s_add_u32 s60, s60, s63
  v_add_u32 v5, s60, v5
  v_add_u32 v1, 128, v2
  v_mul_u32_u24 v3, 6554, v1
  v_lshrrev_b32 v3, 16, v3
  v_mul_u32_u24 v6, 10, v3
  v_sub_u32 v1, v1, v6
  v_lshlrev_b32 v1, 4, v1
  v_mul_u32_u24 v6, 1280, v3
  v_add_u32 v6, v6, v1
  s_mov_b32 s60, 0
  s_mul_i32 s63, s34, 1966080
  s_add_u32 s60, s60, s63
  s_mul_i32 s63, s32, 491520
  s_add_u32 s60, s60, s63
  s_mul_i32 s63, s35, 160
  s_add_u32 s60, s60, s63
  v_add_u32 v6, s60, v6
  v_add_u32 v1, 192, v2
  v_mul_u32_u24 v3, 6554, v1
  v_lshrrev_b32 v3, 16, v3
  v_mul_u32_u24 v7, 10, v3
  v_sub_u32 v1, v1, v7
  v_lshlrev_b32 v1, 4, v1
  v_mul_u32_u24 v7, 1280, v3
  v_add_u32 v7, v7, v1
  s_mov_b32 s60, 0
  s_mul_i32 s63, s34, 1966080
  s_add_u32 s60, s60, s63
  s_mul_i32 s63, s32, 491520
  s_add_u32 s60, s60, s63
  s_mul_i32 s63, s35, 160
  s_add_u32 s60, s60, s63
  v_add_u32 v7, s60, v7
  v_add_u32 v1, 256, v2
  v_mul_u32_u24 v3, 6554, v1
  v_lshrrev_b32 v3, 16, v3
  v_mul_u32_u24 v8, 10, v3
  v_sub_u32 v1, v1, v8
  v_lshlrev_b32 v1, 4, v1
  v_mul_u32_u24 v8, 1280, v3
  v_add_u32 v8, v8, v1
  s_mov_b32 s60, 0
  s_mul_i32 s63, s34, 1966080
  s_add_u32 s60, s60, s63
  s_mul_i32 s63, s32, 491520
  s_add_u32 s60, s60, s63
  s_mul_i32 s63, s35, 160
  s_add_u32 s60, s60, s63
  v_add_u32 v8, s60, v8
  v_bfe_u32 v9, v2, 4, 2
  v_mul_u32_u24 v9, 640, v9
  v_bfe_u32 v1, v2, 2, 2
  v_mul_u32_u24 v1, 160, v1
  v_add_u32 v9, v9, v1
  v_bfe_u32 v1, v2, 0, 2
  v_mul_u32_u24 v1, 8, v1
  v_add_u32 v9, v9, v1
  s_mov_b32 s60, 0
  s_mul_i32 s63, s32, 40960
  s_add_u32 s60, s60, s63
  v_add_u32 v9, s60, v9
  s_mul_i32 s61, s32, 40960
  s_mov_b32 s60, 0
  s_add_u32 m0, s61, 0
  s_nop 0
  buffer_load_dwordx4 v4, s[24:27], s60 offen lds
  s_add_u32 m0, s61, 1024
  s_nop 0
  buffer_load_dwordx4 v5, s[24:27], s60 offen lds
  s_add_u32 m0, s61, 2048
  s_nop 0
  buffer_load_dwordx4 v6, s[24:27], s60 offen lds
  s_add_u32 m0, s61, 3072
  s_nop 0
  buffer_load_dwordx4 v7, s[24:27], s60 offen lds
  s_add_u32 m0, s61, 4096
  s_nop 0
  buffer_load_dwordx4 v8, s[24:27], s60 offen lds
  s_mul_i32 s61, s32, 40960
  s_mov_b32 s60, 40960
  s_add_u32 m0, s61, 5120
  s_nop 0
  buffer_load_dwordx4 v4, s[24:27], s60 offen lds
  s_add_u32 m0, s61, 6144
  s_nop 0
  buffer_load_dwordx4 v5, s[24:27], s60 offen lds
  s_add_u32 m0, s61, 7168
  s_nop 0
  buffer_load_dwordx4 v6, s[24:27], s60 offen lds
  s_add_u32 m0, s61, 8192
  s_nop 0
  buffer_load_dwordx4 v7, s[24:27], s60 offen lds
  s_add_u32 m0, s61, 9216
  s_nop 0
  buffer_load_dwordx4 v8, s[24:27], s60 offen lds
  s_mul_i32 s61, s32, 40960
  s_mov_b32 s60, 81920
  s_add_u32 m0, s61, 10240
  s_nop 0
  buffer_load_dwordx4 v4, s[24:27], s60 offen lds
  s_add_u32 m0, s61, 11264
  s_nop 0
  buffer_load_dwordx4 v5, s[24:27], s60 offen lds
  s_add_u32 m0, s61, 12288
  s_nop 0
  buffer_load_dwordx4 v6, s[24:27], s60 offen lds
  s_add_u32 m0, s61, 13312
  s_nop 0
  buffer_load_dwordx4 v7, s[24:27], s60 offen lds
  s_add_u32 m0, s61, 14336
  s_nop 0
  buffer_load_dwordx4 v8, s[24:27], s60 offen lds
  s_mul_i32 s61, s32, 40960
  s_mov_b32 s60, 122880
  s_add_u32 m0, s61, 15360
  s_nop 0
  buffer_load_dwordx4 v4, s[24:27], s60 offen lds
  s_add_u32 m0, s61, 16384
  s_nop 0
  buffer_load_dwordx4 v5, s[24:27], s60 offen lds
  s_add_u32 m0, s61, 17408
  s_nop 0
  buffer_load_dwordx4 v6, s[24:27], s60 offen lds
  s_add_u32 m0, s61, 18432
  s_nop 0
  buffer_load_dwordx4 v7, s[24:27], s60 offen lds
  s_add_u32 m0, s61, 19456
  s_nop 0
  buffer_load_dwordx4 v8, s[24:27], s60 offen lds
  s_mul_i32 s61, s32, 40960
  s_mov_b32 s60, 163840
  s_add_u32 m0, s61, 20480
  s_nop 0
  buffer_load_dwordx4 v4, s[24:27], s60 offen lds
  s_add_u32 m0, s61, 21504
  s_nop 0
  buffer_load_dwordx4 v5, s[24:27], s60 offen lds
  s_add_u32 m0, s61, 22528
  s_nop 0
  buffer_load_dwordx4 v6, s[24:27], s60 offen lds
  s_add_u32 m0, s61, 23552
  s_nop 0
  buffer_load_dwordx4 v7, s[24:27], s60 offen lds
  s_add_u32 m0, s61, 24576
  s_nop 0
  buffer_load_dwordx4 v8, s[24:27], s60 offen lds
  s_mul_i32 s61, s32, 40960
  s_mov_b32 s60, 204800
  s_add_u32 m0, s61, 25600
  s_nop 0
  buffer_load_dwordx4 v4, s[24:27], s60 offen lds
  s_add_u32 m0, s61, 26624
  s_nop 0
  buffer_load_dwordx4 v5, s[24:27], s60 offen lds
  s_add_u32 m0, s61, 27648
  s_nop 0
  buffer_load_dwordx4 v6, s[24:27], s60 offen lds
  s_add_u32 m0, s61, 28672
  s_nop 0
  buffer_load_dwordx4 v7, s[24:27], s60 offen lds
  s_add_u32 m0, s61, 29696
  s_nop 0
  buffer_load_dwordx4 v8, s[24:27], s60 offen lds
  s_mul_i32 s61, s32, 40960
  s_mov_b32 s60, 245760
  s_add_u32 m0, s61, 30720
  s_nop 0
  buffer_load_dwordx4 v4, s[24:27], s60 offen lds
  s_add_u32 m0, s61, 31744
  s_nop 0
  buffer_load_dwordx4 v5, s[24:27], s60 offen lds
  s_add_u32 m0, s61, 32768
  s_nop 0
  buffer_load_dwordx4 v6, s[24:27], s60 offen lds
  s_add_u32 m0, s61, 33792
  s_nop 0
  buffer_load_dwordx4 v7, s[24:27], s60 offen lds
  s_add_u32 m0, s61, 34816
  s_nop 0
  buffer_load_dwordx4 v8, s[24:27], s60 offen lds
  s_mul_i32 s61, s32, 40960
  s_mov_b32 s60, 286720
  s_add_u32 m0, s61, 35840
  s_nop 0
  buffer_load_dwordx4 v4, s[24:27], s60 offen lds
  s_add_u32 m0, s61, 36864
  s_nop 0
  buffer_load_dwordx4 v5, s[24:27], s60 offen lds
  s_add_u32 m0, s61, 37888
  s_nop 0
  buffer_load_dwordx4 v6, s[24:27], s60 offen lds
  s_add_u32 m0, s61, 38912
  s_nop 0
  buffer_load_dwordx4 v7, s[24:27], s60 offen lds
  s_add_u32 m0, s61, 39936
  s_nop 0
  buffer_load_dwordx4 v8, s[24:27], s60 offen lds
  s_waitcnt vmcnt(35)
  ds_read_b64_tr_b16 a[0:1], v9 offset:0
  ds_read_b64_tr_b16 a[2:3], v9 offset:2560
  ds_read_b64_tr_b16 a[4:5], v9 offset:32
  ds_read_b64_tr_b16 a[6:7], v9 offset:2592
  ds_read_b64_tr_b16 a[8:9], v9 offset:64
  ds_read_b64_tr_b16 a[10:11], v9 offset:2624
  ds_read_b64_tr_b16 a[12:13], v9 offset:96
  ds_read_b64_tr_b16 a[14:15], v9 offset:2656
  ds_read_b64_tr_b16 a[16:17], v9 offset:128
  ds_read_b64_tr_b16 a[18:19], v9 offset:2688
  s_waitcnt lgkmcnt(0)
  s_barrier
  s_call_b64 s[60:61], la_arrive
  s_mul_i32 s61, s32, 40960
  s_mov_b32 s60, 327680
  s_add_u32 m0, s61, 0
  s_nop 0
  buffer_load_dwordx4 v4, s[24:27], s60 offen lds
  s_add_u32 m0, s61, 1024
  s_nop 0
  buffer_load_dwordx4 v5, s[24:27], s60 offen lds
  s_add_u32 m0, s61, 2048
  s_nop 0
  buffer_load_dwordx4 v6, s[24:27], s60 offen lds
  s_add_u32 m0, s61, 3072
  s_nop 0
  buffer_load_dwordx4 v7, s[24:27], s60 offen lds
  s_add_u32 m0, s61, 4096
  s_nop 0
  buffer_load_dwordx4 v8, s[24:27], s60 offen lds
  s_waitcnt vmcnt(35)
  ds_read_b64_tr_b16 a[20:21], v9 offset:5120
  ds_read_b64_tr_b16 a[22:23], v9 offset:7680
  ds_read_b64_tr_b16 a[24:25], v9 offset:5152
  ds_read_b64_tr_b16 a[26:27], v9 offset:7712
  ds_read_b64_tr_b16 a[28:29], v9 offset:5184
  ds_read_b64_tr_b16 a[30:31], v9 offset:7744
  ds_read_b64_tr_b16 a[32:33], v9 offset:5216
  ds_read_b64_tr_b16 a[34:35], v9 offset:7776
  ds_read_b64_tr_b16 a[36:37], v9 offset:5248
  ds_read_b64_tr_b16 a[38:39], v9 offset:7808
  s_waitcnt lgkmcnt(0)
  s_mul_i32 s61, s32, 40960
  s_mov_b32 s60, 368640
  s_add_u32 m0, s61, 5120
  s_nop 0
  buffer_load_dwordx4 v4, s[24:27], s60 offen lds
  s_add_u32 m0, s61, 6144
  s_nop 0
  buffer_load_dwordx4 v5, s[24:27], s60 offen lds
  s_add_u32 m0, s61, 7168
  s_nop 0
  buffer_load_dwordx4 v6, s[24:27], s60 offen lds
  s_add_u32 m0, s61, 8192
  s_nop 0
  buffer_load_dwordx4 v7, s[24:27], s60 offen lds
  s_add_u32 m0, s61, 9216
  s_nop 0
  buffer_load_dwordx4 v8, s[24:27], s60 offen lds
  s_waitcnt vmcnt(35)
  ds_read_b64_tr_b16 a[40:41], v9 offset:10240
  ds_read_b64_tr_b16 a[42:43], v9 offset:12800
  ds_read_b64_tr_b16 a[44:45], v9 offset:10272
  ds_read_b64_tr_b16 a[46:47], v9 offset:12832
  ds_read_b64_tr_b16 a[48:49], v9 offset:10304
  ds_read_b64_tr_b16 a[50:51], v9 offset:12864
  ds_read_b64_tr_b16 a[52:53], v9 offset:10336
  ds_read_b64_tr_b16 a[54:55], v9 offset:12896
  ds_read_b64_tr_b16 a[56:57], v9 offset:10368
  ds_read_b64_tr_b16 a[58:59], v9 offset:12928
  s_waitcnt lgkmcnt(0)
  s_mul_i32 s61, s32, 40960
  s_mov_b32 s60, 409600
  s_add_u32 m0, s61, 10240
  s_nop 0
  buffer_load_dwordx4 v4, s[24:27], s60 offen lds
  s_add_u32 m0, s61, 11264
  s_nop 0
  buffer_load_dwordx4 v5, s[24:27], s60 offen lds
  s_add_u32 m0, s61, 12288
  s_nop 0
  buffer_load_dwordx4 v6, s[24:27], s60 offen lds
  s_add_u32 m0, s61, 13312
  s_nop 0
  buffer_load_dwordx4 v7, s[24:27], s60 offen lds
  s_add_u32 m0, s61, 14336
  s_nop 0
  buffer_load_dwordx4 v8, s[24:27], s60 offen lds
  s_waitcnt vmcnt(35)
  ds_read_b64_tr_b16 a[60:61], v9 offset:15360
  ds_read_b64_tr_b16 a[62:63], v9 offset:17920
  ds_read_b64_tr_b16 a[64:65], v9 offset:15392
  ds_read_b64_tr_b16 a[66:67], v9 offset:17952
  ds_read_b64_tr_b16 a[68:69], v9 offset:15424
  ds_read_b64_tr_b16 a[70:71], v9 offset:17984
  ds_read_b64_tr_b16 a[72:73], v9 offset:15456
  ds_read_b64_tr_b16 a[74:75], v9 offset:18016
  ds_read_b64_tr_b16 a[76:77], v9 offset:15488
  ds_read_b64_tr_b16 a[78:79], v9 offset:18048
  s_waitcnt lgkmcnt(0)
  s_mul_i32 s61, s32, 40960
  s_mov_b32 s60, 450560
  s_add_u32 m0, s61, 15360
  s_nop 0
  buffer_load_dwordx4 v4, s[24:27], s60 offen lds
  s_add_u32 m0, s61, 16384
  s_nop 0
  buffer_load_dwordx4 v5, s[24:27], s60 offen lds
  s_add_u32 m0, s61, 17408
  s_nop 0
  buffer_load_dwordx4 v6, s[24:27], s60 offen lds
  s_add_u32 m0, s61, 18432
  s_nop 0
  buffer_load_dwordx4 v7, s[24:27], s60 offen lds
  s_add_u32 m0, s61, 19456
  s_nop 0
  buffer_load_dwordx4 v8, s[24:27], s60 offen lds
  s_waitcnt vmcnt(35)
  ds_read_b64_tr_b16 a[80:81], v9 offset:20480
  ds_read_b64_tr_b16 a[82:83], v9 offset:23040
  ds_read_b64_tr_b16 a[84:85], v9 offset:20512
  ds_read_b64_tr_b16 a[86:87], v9 offset:23072
  ds_read_b64_tr_b16 a[88:89], v9 offset:20544
  ds_read_b64_tr_b16 a[90:91], v9 offset:23104
  ds_read_b64_tr_b16 a[92:93], v9 offset:20576
  ds_read_b64_tr_b16 a[94:95], v9 offset:23136
  ds_read_b64_tr_b16 a[96:97], v9 offset:20608
  ds_read_b64_tr_b16 a[98:99], v9 offset:23168
  s_waitcnt lgkmcnt(0)
  s_waitcnt vmcnt(30)
  ds_read_b64_tr_b16 a[100:101], v9 offset:25600
  ds_read_b64_tr_b16 a[102:103], v9 offset:28160
  ds_read_b64_tr_b16 a[104:105], v9 offset:25632
  ds_read_b64_tr_b16 a[106:107], v9 offset:28192
  ds_read_b64_tr_b16 a[108:109], v9 offset:25664
  ds_read_b64_tr_b16 a[110:111], v9 offset:28224
  ds_read_b64_tr_b16 a[112:113], v9 offset:25696
  ds_read_b64_tr_b16 a[114:115], v9 offset:28256
  ds_read_b64_tr_b16 a[116:117], v9 offset:25728
  ds_read_b64_tr_b16 a[118:119], v9 offset:28288
  s_waitcnt lgkmcnt(0)
  s_waitcnt vmcnt(25)
  ds_read_b64_tr_b16 a[120:121], v9 offset:30720
  ds_read_b64_tr_b16 a[122:123], v9 offset:33280
  ds_read_b64_tr_b16 a[124:125], v9 offset:30752
  ds_read_b64_tr_b16 a[126:127], v9 offset:33312
  ds_read_b64_tr_b16 a[128:129], v9 offset:30784
  ds_read_b64_tr_b16 a[130:131], v9 offset:33344
  ds_read_b64_tr_b16 a[132:133], v9 offset:30816
  ds_read_b64_tr_b16 a[134:135], v9 offset:33376
  ds_read_b64_tr_b16 a[136:137], v9 offset:30848
  ds_read_b64_tr_b16 a[138:139], v9 offset:33408
  s_waitcnt lgkmcnt(0)
  s_waitcnt vmcnt(20)
  ds_read_b64_tr_b16 a[140:141], v9 offset:35840
  ds_read_b64_tr_b16 a[142:143], v9 offset:38400
  ds_read_b64_tr_b16 a[144:145], v9 offset:35872
  ds_read_b64_tr_b16 a[146:147], v9 offset:38432
  ds_read_b64_tr_b16 a[148:149], v9 offset:35904
  ds_read_b64_tr_b16 a[150:151], v9 offset:38464
  ds_read_b64_tr_b16 a[152:153], v9 offset:35936
  ds_read_b64_tr_b16 a[154:155], v9 offset:38496
  ds_read_b64_tr_b16 a[156:157], v9 offset:35968
  ds_read_b64_tr_b16 a[158:159], v9 offset:38528
  s_waitcnt lgkmcnt(0)
  s_waitcnt vmcnt(15)
  ds_read_b64_tr_b16 a[160:161], v9 offset:0
  ds_read_b64_tr_b16 a[162:163], v9 offset:2560
  ds_read_b64_tr_b16 a[164:165], v9 offset:32
  ds_read_b64_tr_b16 a[166:167], v9 offset:2592
  ds_read_b64_tr_b16 a[168:169], v9 offset:64
  ds_read_b64_tr_b16 a[170:171], v9 offset:2624
  ds_read_b64_tr_b16 a[172:173], v9 offset:96
  ds_read_b64_tr_b16 a[174:175], v9 offset:2656
  ds_read_b64_tr_b16 a[176:177], v9 offset:128
  ds_read_b64_tr_b16 a[178:179], v9 offset:2688
  s_waitcnt lgkmcnt(0)
  s_waitcnt vmcnt(10)
  ds_read_b64_tr_b16 a[180:181], v9 offset:5120
  ds_read_b64_tr_b16 a[182:183], v9 offset:7680
  ds_read_b64_tr_b16 a[184:185], v9 offset:5152
  ds_read_b64_tr_b16 a[186:187], v9 offset:7712
  ds_read_b64_tr_b16 a[188:189], v9 offset:5184
  ds_read_b64_tr_b16 a[190:191], v9 offset:7744
  ds_read_b64_tr_b16 a[192:193], v9 offset:5216
  ds_read_b64_tr_b16 a[194:195], v9 offset:7776
  ds_read_b64_tr_b16 a[196:197], v9 offset:5248
  ds_read_b64_tr_b16 a[198:199], v9 offset:7808
  s_waitcnt lgkmcnt(0)
  s_waitcnt vmcnt(5)
  ds_read_b64_tr_b16 a[200:201], v9 offset:10240
  ds_read_b64_tr_b16 a[202:203], v9 offset:12800
  ds_read_b64_tr_b16 a[204:205], v9 offset:10272
  ds_read_b64_tr_b16 a[206:207], v9 offset:12832
  ds_read_b64_tr_b16 a[208:209], v9 offset:10304
  ds_read_b64_tr_b16 a[210:211], v9 offset:12864
  ds_read_b64_tr_b16 a[212:213], v9 offset:10336
  ds_read_b64_tr_b16 a[214:215], v9 offset:12896
  ds_read_b64_tr_b16 a[216:217], v9 offset:10368
  ds_read_b64_tr_b16 a[218:219], v9 offset:12928
  s_waitcnt lgkmcnt(0)
  s_waitcnt vmcnt(0)
  ds_read_b64_tr_b16 a[220:221], v9 offset:15360
  ds_read_b64_tr_b16 a[222:223], v9 offset:17920
  ds_read_b64_tr_b16 a[224:225], v9 offset:15392
  ds_read_b64_tr_b16 a[226:227], v9 offset:17952
  ds_read_b64_tr_b16 a[228:229], v9 offset:15424
  ds_read_b64_tr_b16 a[230:231], v9 offset:17984
  ds_read_b64_tr_b16 a[232:233], v9 offset:15456
  ds_read_b64_tr_b16 a[234:235], v9 offset:18016
  ds_read_b64_tr_b16 a[236:237], v9 offset:15488
  ds_read_b64_tr_b16 a[238:239], v9 offset:18048
  s_waitcnt lgkmcnt(0)
  s_call_b64 s[60:61], la_census
  s_barrier
L_lao_again_223:
  s_lshr_b32 s34, s33, 5
  s_sub_u32 s34, s34, 4
  s_and_b32 s35, s33, 7
  v_bfe_u32 v10, v2, 0, 6
  v_mul_u32_u24 v10, 16, v10
  s_mov_b32 s60, 83886080
  s_mul_i32 s63, s34, 98304
  s_add_u32 s60, s60, s63
  s_mul_i32 s63, s32, 24576
  s_add_u32 s60, s60, s63
  v_add_u32 v10, s60, v10
  v_bfe_u32 v11, v2, 2, 2
  v_mul_u32_u24 v11, 2688, v11
  v_bfe_u32 v1, v2, 0, 2
  v_mul_u32_u24 v1, 336, v1
  v_add_u32 v11, v11, v1
  v_bfe_u32 v1, v2, 4, 2
  v_mul_u32_u24 v1, 16, v1
  v_add_u32 v11, v11, v1
  s_mov_b32 s60, 0
  s_mul_i32 s63, s32, 10752
  s_add_u32 s60, s60, s63
  v_add_u32 v11, s60, v11
  v_add_u32 v1, 0, v2
  v_min_u32 v1, 79, v1
  v_mul_u32_u24 v3, 6554, v1
  v_lshrrev_b32 v3, 16, v3
  v_mul_u32_u24 v12, 10, v3
  v_sub_u32 v1, v1, v12
  s_lshl_b32 s60, s32, 3
  v_add_u32 v3, s60, v3
  v_mul_u32_u24 v14, 160, v3
  v_lshl_add_u32 v14, v1, 4, v14
  v_mul_u32_u24 v12, 336, v3
  v_lshl_add_u32 v12, v1, 5, v12
  v_add_u32 v1, 64, v2
  v_min_u32 v1, 79, v1
  v_mul_u32_u24 v3, 6554, v1
  v_lshrrev_b32 v3, 16, v3
  v_mul_u32_u24 v13, 10, v3
  v_sub_u32 v1, v1, v13
  s_lshl_b32 s60, s32, 3
  v_add_u32 v3, s60, v3
  v_mul_u32_u24 v15, 160, v3
  v_lshl_add_u32 v15, v1, 4, v15
  v_mul_u32_u24 v13, 336, v3
  v_lshl_add_u32 v13, v1, 5, v13
  v_cmp_gt_u32 vcc, 16, v2
  v_mov_b32 v1, 2147483632
  s_nop 0
  v_cndmask_b32 v15, v1, v15, vcc
  s_mov_b32 s60, 8192
  s_mul_i32 s63, s34, 1024
  s_add_u32 s60, s60, s63
  s_mul_i32 s63, s32, 256
  s_add_u32 s60, s60, s63
  s_mul_i32 s63, s65, 131072
  s_add_u32 s60, s60, s63
  s_add_u32 s40, s4, s60
  s_addc_u32 s41, s5, 0
  s_mov_b32 s38, 23068672
  s_mul_i32 s63, s35, 327680
  s_add_u32 s38, s38, s63
  s_mul_i32 s63, s34, 2621440
  s_add_u32 s38, s38, s63
  v_bfe_u32 v16, v2, 0, 6
  v_mul_u32_u24 v16, 4, v16
  s_mov_b32 s60, 12288
  s_mul_i32 s63, s32, 512
  s_add_u32 s60, s60, s63
  s_mul_i32 s63, s34, 128
  s_add_u32 s60, s60, s63
  s_mul_i32 s63, s35, 4
  s_add_u32 s60, s60, s63
  s_mul_i32 s63, s65, 131072
  s_add_u32 s60, s60, s63
  v_add_u32 v16, s60, v16
  v_cmp_gt_u32 vcc, 1, v2
  v_mov_b32 v1, 2147483632
  s_nop 0
  v_cndmask_b32 v16, v1, v16, vcc
  s_mov_b32 s36, 0
  s_mov_b32 s37, 0
  v_mov_b32 v3, 0
.p2align 6
L_lao_loop_224:
  s_mov_b32 s64, 400000
L_lao_w_225:
  s_and_b32 s46, s36, 3
  s_lshl_b32 s46, s46, 2
  s_add_u32 s47, s46, 128
  s_load_dword s44, s[40:41], s46 glc
  s_load_dword s45, s[40:41], s47 glc
  s_waitcnt lgkmcnt(0)
  s_min_u32 s60, s44, s45
  s_cmp_gt_u32 s60, s36
  s_cbranch_scc1 L_lao_g_226
  s_sleep 1
  s_sub_u32 s64, s64, 1
  s_cmp_lg_u32 s64, 0
  s_cbranch_scc1 L_lao_w_225
  s_branch L_lao_fail_222
L_lao_g_226:
  s_add_u32 s60, s37, 0
  buffer_load_dwordx4 v[64:67], v10, s[8:11], s60 offen offset:0 sc1
  s_add_u32 s60, s37, 4096
  buffer_load_dwordx4 v[68:71], v10, s[8:11], s60 offen offset:2048 sc1
  s_add_u32 s60, s37, 0
  buffer_load_dwordx4 v[72:75], v10, s[8:11], s60 offen offset:1024 sc1
  s_add_u32 s60, s37, 4096
  buffer_load_dwordx4 v[76:79], v10, s[8:11], s60 offen offset:3072 sc1
  s_add_u32 s60, s37, 0
  buffer_load_dwordx4 v[80:83], v10, s[8:11], s60 offen offset:2048 sc1
  s_add_u32 s60, s37, 8192
  buffer_load_dwordx4 v[84:87], v10, s[8:11], s60 offen offset:0 sc1
  s_add_u32 s60, s37, 0
  buffer_load_dwordx4 v[88:91], v10, s[8:11], s60 offen offset:3072 sc1
  s_add_u32 s60, s37, 8192
  buffer_load_dwordx4 v[92:95], v10, s[8:11], s60 offen offset:1024 sc1
  s_add_u32 s60, s37, 4096
  buffer_load_dwordx4 v[96:99], v10, s[8:11], s60 offen offset:0 sc1
  s_add_u32 s60, s37, 8192
  buffer_load_dwordx4 v[100:103], v10, s[8:11], s60 offen offset:2048 sc1
L_lao_b_228:
  s_add_u32 s36, s36, 1
  s_add_u32 s60, s37, 4096
  buffer_load_dwordx4 v[104:107], v10, s[8:11], s60 offen offset:1024 sc1
  s_add_u32 s60, s37, 8192
  buffer_load_dwordx4 v[108:111], v10, s[8:11], s60 offen offset:3072 sc1
  s_waitcnt vmcnt(10)
  v_mfma_f32_16x16x32_bf16 v[24:27], a[0:3], v[64:67], 0
  v_mfma_f32_16x16x32_bf16 v[28:31], a[0:3], v[68:71], 0
  v_mfma_f32_16x16x32_bf16 v[32:35], a[4:7], v[64:67], 0
  v_mfma_f32_16x16x32_bf16 v[36:39], a[4:7], v[68:71], 0
  v_mfma_f32_16x16x32_bf16 v[40:43], a[8:11], v[64:67], 0
  v_mfma_f32_16x16x32_bf16 v[44:47], a[8:11], v[68:71], 0
  v_mfma_f32_16x16x32_bf16 v[48:51], a[12:15], v[64:67], 0
  v_mfma_f32_16x16x32_bf16 v[52:55], a[12:15], v[68:71], 0
  v_mfma_f32_16x16x32_bf16 v[56:59], a[16:19], v[64:67], 0
  v_mfma_f32_16x16x32_bf16 v[60:63], a[16:19], v[68:71], 0
  s_add_u32 s60, s37, 12288
  buffer_load_dwordx4 v[112:115], v10, s[8:11], s60 offen offset:0 sc1
  s_add_u32 s60, s37, 16384
  buffer_load_dwordx4 v[116:119], v10, s[8:11], s60 offen offset:2048 sc1
  s_waitcnt vmcnt(10)
  v_mfma_f32_16x16x32_bf16 v[24:27], a[20:23], v[72:75], v[24:27]
  v_mfma_f32_16x16x32_bf16 v[28:31], a[20:23], v[76:79], v[28:31]
  v_mfma_f32_16x16x32_bf16 v[32:35], a[24:27], v[72:75], v[32:35]
  v_mfma_f32_16x16x32_bf16 v[36:39], a[24:27], v[76:79], v[36:39]
  v_mfma_f32_16x16x32_bf16 v[40:43], a[28:31], v[72:75], v[40:43]
  v_mfma_f32_16x16x32_bf16 v[44:47], a[28:31], v[76:79], v[44:47]
  v_mfma_f32_16x16x32_bf16 v[48:51], a[32:35], v[72:75], v[48:51]
  v_mfma_f32_16x16x32_bf16 v[52:55], a[32:35], v[76:79], v[52:55]
  v_mfma_f32_16x16x32_bf16 v[56:59], a[36:39], v[72:75], v[56:59]
  v_mfma_f32_16x16x32_bf16 v[60:63], a[36:39], v[76:79], v[60:63]
  s_and_b32 s46, s36, 3
  s_lshl_b32 s46, s46, 2
  s_add_u32 s47, s46, 128
  s_load_dword s44, s[40:41], s46 glc
  s_load_dword s45, s[40:41], s47 glc
  s_add_u32 s60, s37, 12288
  buffer_load_dwordx4 v[120:123], v10, s[8:11], s60 offen offset:1024 sc1
  s_add_u32 s60, s37, 16384
  buffer_load_dwordx4 v[124:127], v10, s[8:11], s60 offen offset:3072 sc1
  s_waitcnt vmcnt(10)
  v_mfma_f32_16x16x32_bf16 v[24:27], a[40:43], v[80:83], v[24:27]
  v_mfma_f32_16x16x32_bf16 v[28:31], a[40:43], v[84:87], v[28:31]
  v_mfma_f32_16x16x32_bf16 v[32:35], a[44:47], v[80:83], v[32:35]
  v_mfma_f32_16x16x32_bf16 v[36:39], a[44:47], v[84:87], v[36:39]
  v_mfma_f32_16x16x32_bf16 v[40:43], a[48:51], v[80:83], v[40:43]
  v_mfma_f32_16x16x32_bf16 v[44:47], a[48:51], v[84:87], v[44:47]
  v_mfma_f32_16x16x32_bf16 v[48:51], a[52:55], v[80:83], v[48:51]
  v_mfma_f32_16x16x32_bf16 v[52:55], a[52:55], v[84:87], v[52:55]
  v_mfma_f32_16x16x32_bf16 v[56:59], a[56:59], v[80:83], v[56:59]
  v_mfma_f32_16x16x32_bf16 v[60:63], a[56:59], v[84:87], v[60:63]
  s_add_u32 s60, s37, 12288
  buffer_load_dwordx4 v[128:131], v10, s[8:11], s60 offen offset:2048 sc1
  s_add_u32 s60, s37, 20480
  buffer_load_dwordx4 v[132:135], v10, s[8:11], s60 offen offset:0 sc1
  s_waitcnt vmcnt(10)
  v_mfma_f32_16x16x32_bf16 v[24:27], a[60:63], v[88:91], v[24:27]
  v_mfma_f32_16x16x32_bf16 v[28:31], a[60:63], v[92:95], v[28:31]
  v_mfma_f32_16x16x32_bf16 v[32:35], a[64:67], v[88:91], v[32:35]
  v_mfma_f32_16x16x32_bf16 v[36:39], a[64:67], v[92:95], v[36:39]
  v_mfma_f32_16x16x32_bf16 v[40:43], a[68:71], v[88:91], v[40:43]
  v_mfma_f32_16x16x32_bf16 v[44:47], a[68:71], v[92:95], v[44:47]
  v_mfma_f32_16x16x32_bf16 v[48:51], a[72:75], v[88:91], v[48:51]
  v_mfma_f32_16x16x32_bf16 v[52:55], a[72:75], v[92:95], v[52:55]
  v_mfma_f32_16x16x32_bf16 v[56:59], a[76:79], v[88:91], v[56:59]
  v_mfma_f32_16x16x32_bf16 v[60:63], a[76:79], v[92:95], v[60:63]
  s_add_u32 s60, s37, 12288
  buffer_load_dwordx4 v[136:139], v10, s[8:11], s60 offen offset:3072 sc1
  s_add_u32 s60, s37, 20480
  buffer_load_dwordx4 v[140:143], v10, s[8:11], s60 offen offset:1024 sc1
  s_waitcnt vmcnt(10)
  v_mfma_f32_16x16x32_bf16 v[24:27], a[80:83], v[96:99], v[24:27]
  v_mfma_f32_16x16x32_bf16 v[28:31], a[80:83], v[100:103], v[28:31]
  v_mfma_f32_16x16x32_bf16 v[32:35], a[84:87], v[96:99], v[32:35]
  v_mfma_f32_16x16x32_bf16 v[36:39], a[84:87], v[100:103], v[36:39]
  v_mfma_f32_16x16x32_bf16 v[40:43], a[88:91], v[96:99], v[40:43]
  v_mfma_f32_16x16x32_bf16 v[44:47], a[88:91], v[100:103], v[44:47]
  v_mfma_f32_16x16x32_bf16 v[48:51], a[92:95], v[96:99], v[48:51]
  v_mfma_f32_16x16x32_bf16 v[52:55], a[92:95], v[100:103], v[52:55]
  v_mfma_f32_16x16x32_bf16 v[56:59], a[96:99], v[96:99], v[56:59]
  v_mfma_f32_16x16x32_bf16 v[60:63], a[96:99], v[100:103], v[60:63]
  s_add_u32 s60, s37, 16384
  buffer_load_dwordx4 v[144:147], v10, s[8:11], s60 offen offset:0 sc1
  s_add_u32 s60, s37, 20480
  buffer_load_dwordx4 v[148:151], v10, s[8:11], s60 offen offset:2048 sc1
  s_waitcnt vmcnt(10)
  buffer_store_dword v3, v16, s[8:11], 0 offen sc1
  v_mfma_f32_16x16x32_bf16 v[24:27], a[100:103], v[104:107], v[24:27]
  v_mfma_f32_16x16x32_bf16 v[28:31], a[100:103], v[108:111], v[28:31]
  v_mfma_f32_16x16x32_bf16 v[32:35], a[104:107], v[104:107], v[32:35]
  v_mfma_f32_16x16x32_bf16 v[36:39], a[104:107], v[108:111], v[36:39]
  v_mfma_f32_16x16x32_bf16 v[40:43], a[108:111], v[104:107], v[40:43]
  v_mfma_f32_16x16x32_bf16 v[44:47], a[108:111], v[108:111], v[44:47]
  v_mfma_f32_16x16x32_bf16 v[48:51], a[112:115], v[104:107], v[48:51]
  v_mfma_f32_16x16x32_bf16 v[52:55], a[112:115], v[108:111], v[52:55]
  v_mfma_f32_16x16x32_bf16 v[56:59], a[116:119], v[104:107], v[56:59]
  v_mfma_f32_16x16x32_bf16 v[60:63], a[116:119], v[108:111], v[60:63]
  s_add_u32 s60, s37, 16384
  buffer_load_dwordx4 v[152:155], v10, s[8:11], s60 offen offset:1024 sc1
  s_add_u32 s60, s37, 20480
  buffer_load_dwordx4 v[156:159], v10, s[8:11], s60 offen offset:3072 sc1
  s_waitcnt vmcnt(10)
  v_mfma_f32_16x16x32_bf16 v[24:27], a[120:123], v[112:115], v[24:27]
  v_mfma_f32_16x16x32_bf16 v[28:31], a[120:123], v[116:119], v[28:31]
  v_mfma_f32_16x16x32_bf16 v[32:35], a[124:127], v[112:115], v[32:35]
  v_mfma_f32_16x16x32_bf16 v[36:39], a[124:127], v[116:119], v[36:39]
  v_mfma_f32_16x16x32_bf16 v[40:43], a[128:131], v[112:115], v[40:43]
  v_mfma_f32_16x16x32_bf16 v[44:47], a[128:131], v[116:119], v[44:47]
  v_mfma_f32_16x16x32_bf16 v[48:51], a[132:135], v[112:115], v[48:51]
  v_mfma_f32_16x16x32_bf16 v[52:55], a[132:135], v[116:119], v[52:55]
  v_mfma_f32_16x16x32_bf16 v[56:59], a[136:139], v[112:115], v[56:59]
  v_mfma_f32_16x16x32_bf16 v[60:63], a[136:139], v[116:119], v[60:63]
  s_waitcnt lgkmcnt(0)
  s_min_u32 s60, s44, s45
  s_cmp_gt_u32 s60, s36
  s_cselect_b32 s39, 1, 0
  s_add_u32 s37, s37, 393216
  s_cmp_lg_u32 s39, 0
  s_cselect_b32 s42, s37, 0x40000000
  s_add_u32 s60, s42, 0
  buffer_load_dwordx4 v[64:67], v10, s[8:11], s60 offen offset:0 sc1
  s_add_u32 s60, s42, 4096
  buffer_load_dwordx4 v[68:71], v10, s[8:11], s60 offen offset:2048 sc1
  s_waitcnt vmcnt(10)
  v_mfma_f32_16x16x32_bf16 v[24:27], a[140:143], v[120:123], v[24:27]
  v_mfma_f32_16x16x32_bf16 v[28:31], a[140:143], v[124:127], v[28:31]
  v_mfma_f32_16x16x32_bf16 v[32:35], a[144:147], v[120:123], v[32:35]
  v_mfma_f32_16x16x32_bf16 v[36:39], a[144:147], v[124:127], v[36:39]
  v_mfma_f32_16x16x32_bf16 v[40:43], a[148:151], v[120:123], v[40:43]
  v_mfma_f32_16x16x32_bf16 v[44:47], a[148:151], v[124:127], v[44:47]
  v_mfma_f32_16x16x32_bf16 v[48:51], a[152:155], v[120:123], v[48:51]
  v_mfma_f32_16x16x32_bf16 v[52:55], a[152:155], v[124:127], v[52:55]
  v_mfma_f32_16x16x32_bf16 v[56:59], a[156:159], v[120:123], v[56:59]
  v_mfma_f32_16x16x32_bf16 v[60:63], a[156:159], v[124:127], v[60:63]
  s_add_u32 s60, s42, 0
  buffer_load_dwordx4 v[72:75], v10, s[8:11], s60 offen offset:1024 sc1
  s_add_u32 s60, s42, 4096
  buffer_load_dwordx4 v[76:79], v10, s[8:11], s60 offen offset:3072 sc1
  s_waitcnt vmcnt(10)
  v_mfma_f32_16x16x32_bf16 v[24:27], a[160:163], v[128:131], v[24:27]
  v_mfma_f32_16x16x32_bf16 v[28:31], a[160:163], v[132:135], v[28:31]
  v_mfma_f32_16x16x32_bf16 v[32:35], a[164:167], v[128:131], v[32:35]
  v_mfma_f32_16x16x32_bf16 v[36:39], a[164:167], v[132:135], v[36:39]
  v_mfma_f32_16x16x32_bf16 v[40:43], a[168:171], v[128:131], v[40:43]
  v_mfma_f32_16x16x32_bf16 v[44:47], a[168:171], v[132:135], v[44:47]
  v_mfma_f32_16x16x32_bf16 v[48:51], a[172:175], v[128:131], v[48:51]
  v_mfma_f32_16x16x32_bf16 v[52:55], a[172:175], v[132:135], v[52:55]
  v_mfma_f32_16x16x32_bf16 v[56:59], a[176:179], v[128:131], v[56:59]
  v_mfma_f32_16x16x32_bf16 v[60:63], a[176:179], v[132:135], v[60:63]
  s_add_u32 s60, s42, 0
  buffer_load_dwordx4 v[80:83], v10, s[8:11], s60 offen offset:2048 sc1
  s_add_u32 s60, s42, 8192
  buffer_load_dwordx4 v[84:87], v10, s[8:11], s60 offen offset:0 sc1
  s_waitcnt vmcnt(10)
  v_mfma_f32_16x16x32_bf16 v[24:27], a[180:183], v[136:139], v[24:27]
  v_mfma_f32_16x16x32_bf16 v[28:31], a[180:183], v[140:143], v[28:31]
  v_mfma_f32_16x16x32_bf16 v[32:35], a[184:187], v[136:139], v[32:35]
  v_mfma_f32_16x16x32_bf16 v[36:39], a[184:187], v[140:143], v[36:39]
  v_mfma_f32_16x16x32_bf16 v[40:43], a[188:191], v[136:139], v[40:43]
  v_mfma_f32_16x16x32_bf16 v[44:47], a[188:191], v[140:143], v[44:47]
  v_mfma_f32_16x16x32_bf16 v[48:51], a[192:195], v[136:139], v[48:51]
  v_mfma_f32_16x16x32_bf16 v[52:55], a[192:195], v[140:143], v[52:55]
  v_mfma_f32_16x16x32_bf16 v[56:59], a[196:199], v[136:139], v[56:59]
  v_mfma_f32_16x16x32_bf16 v[60:63], a[196:199], v[140:143], v[60:63]
  s_add_u32 s60, s42, 0
  buffer_load_dwordx4 v[88:91], v10, s[8:11], s60 offen offset:3072 sc1
  s_add_u32 s60, s42, 8192
  buffer_load_dwordx4 v[92:95], v10, s[8:11], s60 offen offset:1024 sc1
  s_waitcnt vmcnt(10)
  v_mfma_f32_16x16x32_bf16 v[24:27], a[200:203], v[144:147], v[24:27]
  v_mfma_f32_16x16x32_bf16 v[28:31], a[200:203], v[148:151], v[28:31]
  v_mfma_f32_16x16x32_bf16 v[32:35], a[204:207], v[144:147], v[32:35]
  v_mfma_f32_16x16x32_bf16 v[36:39], a[204:207], v[148:151], v[36:39]
  v_mfma_f32_16x16x32_bf16 v[40:43], a[208:211], v[144:147], v[40:43]
  v_mfma_f32_16x16x32_bf16 v[44:47], a[208:211], v[148:151], v[44:47]
  v_mfma_f32_16x16x32_bf16 v[48:51], a[212:215], v[144:147], v[48:51]
  v_mfma_f32_16x16x32_bf16 v[52:55], a[212:215], v[148:151], v[52:55]
  v_mfma_f32_16x16x32_bf16 v[56:59], a[216:219], v[144:147], v[56:59]
  v_mfma_f32_16x16x32_bf16 v[60:63], a[216:219], v[148:151], v[60:63]
  s_add_u32 s60, s42, 4096
  buffer_load_dwordx4 v[96:99], v10, s[8:11], s60 offen offset:0 sc1
  s_add_u32 s60, s42, 8192
  buffer_load_dwordx4 v[100:103], v10, s[8:11], s60 offen offset:2048 sc1
  s_waitcnt vmcnt(10)
  v_mfma_f32_16x16x32_bf16 v[24:27], a[220:223], v[152:155], v[24:27]
  v_mfma_f32_16x16x32_bf16 v[28:31], a[220:223], v[156:159], v[28:31]
  v_mfma_f32_16x16x32_bf16 v[32:35], a[224:227], v[152:155], v[32:35]
  v_mfma_f32_16x16x32_bf16 v[36:39], a[224:227], v[156:159], v[36:39]
  v_mfma_f32_16x16x32_bf16 v[40:43], a[228:231], v[152:155], v[40:43]
  v_mfma_f32_16x16x32_bf16 v[44:47], a[228:231], v[156:159], v[44:47]
  v_mfma_f32_16x16x32_bf16 v[48:51], a[232:235], v[152:155], v[48:51]
  v_mfma_f32_16x16x32_bf16 v[52:55], a[232:235], v[156:159], v[52:55]
  v_mfma_f32_16x16x32_bf16 v[56:59], a[236:239], v[152:155], v[56:59]
  v_mfma_f32_16x16x32_bf16 v[60:63], a[236:239], v[156:159], v[60:63]
  s_barrier
  s_nop 5
  ds_write_b128 v11, v[24:27] offset:0
  ds_write_b128 v11, v[28:31] offset:1344
  ds_write_b128 v11, v[32:35] offset:64
  ds_write_b128 v11, v[36:39] offset:1408
  ds_write_b128 v11, v[40:43] offset:128
  ds_write_b128 v11, v[44:47] offset:1472
  ds_write_b128 v11, v[48:51] offset:192
  ds_write_b128 v11, v[52:55] offset:1536
  ds_write_b128 v11, v[56:59] offset:256
  ds_write_b128 v11, v[60:63] offset:1600
  s_waitcnt lgkmcnt(0)
  s_barrier
  ds_read_b128 v[160:163], v12 offset:0
  ds_read_b128 v[164:167], v12 offset:16
  ds_read_b128 v[168:171], v12 offset:10752
  ds_read_b128 v[172:175], v12 offset:10768
  ds_read_b128 v[176:179], v12 offset:21504
  ds_read_b128 v[180:183], v12 offset:21520
  ds_read_b128 v[184:187], v12 offset:32256
  ds_read_b128 v[188:191], v12 offset:32272
  s_waitcnt lgkmcnt(0)
  ds_read_b128 v[192:195], v13 offset:0
  ds_read_b128 v[196:199], v13 offset:16
  ds_read_b128 v[200:203], v13 offset:10752
  ds_read_b128 v[204:207], v13 offset:10768
  ds_read_b128 v[208:211], v13 offset:21504
  ds_read_b128 v[212:215], v13 offset:21520
  ds_read_b128 v[216:219], v13 offset:32256
  ds_read_b128 v[220:223], v13 offset:32272
  s_waitcnt lgkmcnt(0)
  v_pk_add_f32 v[160:161], v[160:161], v[168:169]
  v_pk_add_f32 v[176:177], v[176:177], v[184:185]
  v_pk_add_f32 v[162:163], v[162:163], v[170:171]
  v_pk_add_f32 v[178:179], v[178:179], v[186:187]
  v_pk_add_f32 v[164:165], v[164:165], v[172:173]
  v_pk_add_f32 v[180:181], v[180:181], v[188:189]
  v_pk_add_f32 v[166:167], v[166:167], v[174:175]
  v_pk_add_f32 v[182:183], v[182:183], v[190:191]
  v_pk_add_f32 v[160:161], v[160:161], v[176:177]
  v_pk_add_f32 v[162:163], v[162:163], v[178:179]
  v_pk_add_f32 v[164:165], v[164:165], v[180:181]
  v_pk_add_f32 v[166:167], v[166:167], v[182:183]
  v_cvt_pk_bf16_f32 v168, v160, v161
  v_cvt_pk_bf16_f32 v169, v162, v163
  v_cvt_pk_bf16_f32 v170, v164, v165
  v_cvt_pk_bf16_f32 v171, v166, v167
  buffer_store_dwordx4 v[168:171], v14, s[8:11], s38 offen sc1
  v_pk_add_f32 v[192:193], v[192:193], v[200:201]
  v_pk_add_f32 v[208:209], v[208:209], v[216:217]
  v_pk_add_f32 v[194:195], v[194:195], v[202:203]
  v_pk_add_f32 v[210:211], v[210:211], v[218:219]
  v_pk_add_f32 v[196:197], v[196:197], v[204:205]
  v_pk_add_f32 v[212:213], v[212:213], v[220:221]
  v_pk_add_f32 v[198:199], v[198:199], v[206:207]
  v_pk_add_f32 v[214:215], v[214:215], v[222:223]
  v_pk_add_f32 v[192:193], v[192:193], v[208:209]
  v_pk_add_f32 v[194:195], v[194:195], v[210:211]
  v_pk_add_f32 v[196:197], v[196:197], v[212:213]
  v_pk_add_f32 v[198:199], v[198:199], v[214:215]
  v_cvt_pk_bf16_f32 v200, v192, v193
  v_cvt_pk_bf16_f32 v201, v194, v195
  v_cvt_pk_bf16_f32 v202, v196, v197
  v_cvt_pk_bf16_f32 v203, v198, v199
  buffer_store_dwordx4 v[200:203], v15, s[8:11], s38 offen sc1
  v_mov_b32 v3, s36
  s_add_u32 s38, s38, 5120
  s_cmp_lg_u32 s39, 0
  s_cbranch_scc1 L_lao_b_228
  s_waitcnt vmcnt(0)
  buffer_store_dword v3, v16, s[8:11], 0 offen sc1
  s_cmp_lt_u32 s36, 64
  s_cbranch_scc1 L_lao_loop_224
  s_call_b64 s[66:67], la_mixer
  s_branch L_lao_again_223
L_lao_fail_222:
  s_mov_b64 exec, 1
  v_mov_b32 v1, 262144
  v_mov_b32 v3, 1
  buffer_atomic_add v3, v1, s[8:11], 0 offen
  s_waitcnt vmcnt(0) lgkmcnt(0)
  s_endpgm
la_proj:
  s_lshr_b32 s42, s33, 5
  s_sub_u32 s42, s42, 4
  s_lshl_b32 s60, s42, 3
  s_and_b32 s34, s33, 7
  s_add_u32 s34, s34, s60
  s_bfe_u32 s40, s33, 0x20003
  s_cmp_lt_u32 s40, 2
  s_cselect_b32 s44, s16, s12
  s_cselect_b32 s45, s17, s13
  s_mov_b32 s46, 7864320
  s_mov_b32 s47, 0x00020000
  s_cmp_lt_u32 s40, 1
  s_cselect_b32 s48, s16, s12
  s_cselect_b32 s49, s17, s13
  s_mov_b32 s50, 7864320
  s_mov_b32 s51, 0x00020000
  v_bfe_u32 v11, v2, 0, 6
  v_mul_u32_u24 v11, 16, v11
  s_mov_b32 s60, 7340032
  s_mul_i32 s63, s32, 10240
  s_add_u32 s60, s60, s63
  v_add_u32 v11, s60, v11
  v_bfe_u32 v17, v2, 0, 6
  v_mul_u32_u24 v17, 128, v17
  s_mov_b32 s60, 49152
  v_add_u32 v17, s60, v17
  s_mov_b32 s36, 0
  s_mul_i32 s38, s32, 10240
  s_add_u32 s38, s38, 122880
  s_mov_b32 s35, 0
  s_sub_u32 s43, s65, 1
  v_bfe_u32 v1, v2, 4, 1
  s_and_b32 s60, s32, 1
  s_lshl_b32 s60, s60, 1
  v_or_b32 v1, s60, v1
  v_lshlrev_b32 v1, 1, v1
  v_and_b32 v3, 7, v2
  v_xor_b32 v3, v3, v1
  v_lshlrev_b32 v3, 4, v3
  s_lshl_b32 s61, s40, 1
  s_add_u32 s61, s61, 0
  s_sub_u32 s63, s61, 3
  s_cmp_ge_u32 s61, 3
  s_cselect_b32 s61, s63, s61
  v_bfe_u32 v4, v2, 3, 3
  v_mul_u32_u24 v4, 12288, v4
  s_mov_b32 s60, 0
  s_mul_i32 s63, s34, 384
  s_add_u32 s60, s60, s63
  s_mul_i32 s63, s32, 98304
  s_add_u32 s60, s60, s63
  s_mul_i32 s63, s61, 128
  s_add_u32 s60, s60, s63
  v_add_u32 v4, s60, v4
  v_add_u32 v4, v4, v3
  s_lshl_b32 s61, s40, 1
  s_add_u32 s61, s61, 1
  s_sub_u32 s63, s61, 3
  s_cmp_ge_u32 s61, 3
  s_cselect_b32 s61, s63, s61
  v_bfe_u32 v5, v2, 3, 3
  v_mul_u32_u24 v5, 12288, v5
  s_mov_b32 s60, 0
  s_mul_i32 s63, s34, 384
  s_add_u32 s60, s60, s63
  s_mul_i32 s63, s32, 98304
  s_add_u32 s60, s60, s63
  s_mul_i32 s63, s61, 128
  s_add_u32 s60, s60, s63
  v_add_u32 v5, s60, v5
  v_add_u32 v5, v5, v3
  s_mov_b32 s61, s40
  v_bfe_u32 v6, v2, 3, 3
  v_mul_u32_u24 v6, 12288, v6
  s_mov_b32 s60, 0
  s_mul_i32 s63, s34, 384
  s_add_u32 s60, s60, s63
  s_mul_i32 s63, s32, 98304
  s_add_u32 s60, s60, s63
  s_mul_i32 s63, s61, 128
  s_add_u32 s60, s60, s63
  v_add_u32 v6, s60, v6
  v_add_u32 v6, v6, v3
  s_and_b32 s61, s32, 1
  s_lshl_b32 s61, s61, 1
  v_bfe_u32 v3, v2, 1, 1
  v_or_b32 v3, s61, v3
  v_bfe_u32 v1, v2, 3, 2
  v_xor_b32 v3, v3, v1
  v_lshlrev_b32 v3, 5, v3
  s_lshr_b32 s61, s32, 1
  v_bfe_u32 v8, v2, 4, 2
  v_mul_u32_u24 v8, 1024, v8
  v_bfe_u32 v1, v2, 2, 2
  v_mul_u32_u24 v1, 128, v1
  v_add_u32 v8, v8, v1
  v_bfe_u32 v1, v2, 0, 1
  v_mul_u32_u24 v1, 16, v1
  v_add_u32 v8, v8, v1
  s_mov_b32 s60, 0
  s_mul_i32 s63, s61, 4096
  s_add_u32 s60, s60, s63
  v_add_u32 v8, s60, v8
  v_add_u32 v8, v8, v3
  v_bfe_u32 v1, v2, 3, 2
  v_xor_b32 v3, s32, v1
  v_lshlrev_b32 v3, 5, v3
  v_bfe_u32 v9, v2, 4, 2
  v_mul_u32_u24 v9, 1024, v9
  v_bfe_u32 v1, v2, 2, 2
  v_mul_u32_u24 v1, 128, v1
  v_add_u32 v9, v9, v1
  v_bfe_u32 v1, v2, 0, 2
  v_mul_u32_u24 v1, 8, v1
  v_add_u32 v9, v9, v1
  s_mov_b32 s60, 8192
  v_add_u32 v9, s60, v9
  v_add_u32 v9, v9, v3
  s_lshl_b32 s61, s32, 10
  s_mov_b32 s60, 0
  s_add_u32 m0, s61, 0
  s_nop 0
  buffer_load_dwordx4 v4, s[44:47], s60 offen lds
  s_add_u32 m0, s61, 4096
  s_nop 0
  buffer_load_dwordx4 v5, s[48:51], s60 offen lds
  s_add_u32 m0, s61, 8192
  s_nop 0
  buffer_load_dwordx4 v6, s[20:23], s60 offen lds
  s_mov_b32 s60, 393216
  s_add_u32 m0, s61, 12288
  s_nop 0
  buffer_load_dwordx4 v4, s[44:47], s60 offen lds
  s_add_u32 m0, s61, 16384
  s_nop 0
  buffer_load_dwordx4 v5, s[48:51], s60 offen lds
  s_add_u32 m0, s61, 20480
  s_nop 0
  buffer_load_dwordx4 v6, s[20:23], s60 offen lds
  s_mov_b32 s60, 786432
  s_add_u32 m0, s61, 24576
  s_nop 0
  buffer_load_dwordx4 v4, s[44:47], s60 offen lds
  s_add_u32 m0, s61, 28672
  s_nop 0
  buffer_load_dwordx4 v5, s[48:51], s60 offen lds
  s_add_u32 m0, s61, 32768
  s_nop 0
  buffer_load_dwordx4 v6, s[20:23], s60 offen lds
  s_mov_b32 s60, 1179648
  s_add_u32 m0, s61, 36864
  s_nop 0
  buffer_load_dwordx4 v4, s[44:47], s60 offen lds
  s_add_u32 m0, s61, 40960
  s_nop 0
  buffer_load_dwordx4 v5, s[48:51], s60 offen lds
  s_add_u32 m0, s61, 45056
  s_nop 0
  buffer_load_dwordx4 v6, s[20:23], s60 offen lds
  s_mov_b32 s60, 1572864
  s_add_u32 m0, s61, 49152
  s_nop 0
  buffer_load_dwordx4 v4, s[44:47], s60 offen lds
  s_add_u32 m0, s61, 53248
  s_nop 0
  buffer_load_dwordx4 v5, s[48:51], s60 offen lds
  s_add_u32 m0, s61, 57344
  s_nop 0
  buffer_load_dwordx4 v6, s[20:23], s60 offen lds
  s_lshl_b32 s61, s32, 10
  s_mov_b32 s60, 1966080
  s_add_u32 m0, s61, 61440
  s_nop 0
  buffer_load_dwordx4 v4, s[44:47], s60 offen lds
  s_add_u32 m0, s61, 65536
  s_nop 0
  buffer_load_dwordx4 v5, s[48:51], s60 offen lds
  s_add_u32 m0, s61, 69632
  s_nop 0
  buffer_load_dwordx4 v6, s[20:23], s60 offen lds
  s_mov_b32 s60, 2359296
  s_add_u32 m0, s61, 73728
  s_nop 0
  buffer_load_dwordx4 v4, s[44:47], s60 offen lds
  s_add_u32 m0, s61, 77824
  s_nop 0
  buffer_load_dwordx4 v5, s[48:51], s60 offen lds
  s_add_u32 m0, s61, 81920
  s_nop 0
  buffer_load_dwordx4 v6, s[20:23], s60 offen lds
  s_mov_b32 s60, 2752512
  s_add_u32 m0, s61, 86016
  s_nop 0
  buffer_load_dwordx4 v4, s[44:47], s60 offen lds
  s_add_u32 m0, s61, 90112
  s_nop 0
  buffer_load_dwordx4 v5, s[48:51], s60 offen lds
  s_add_u32 m0, s61, 94208
  s_nop 0
  buffer_load_dwordx4 v6, s[20:23], s60 offen lds
  s_mov_b32 s60, 3145728
  s_add_u32 m0, s61, 98304
  s_nop 0
  buffer_load_dwordx4 v4, s[44:47], s60 offen lds
  s_add_u32 m0, s61, 102400
  s_nop 0
  buffer_load_dwordx4 v5, s[48:51], s60 offen lds
  s_add_u32 m0, s61, 106496
  s_nop 0
  buffer_load_dwordx4 v6, s[20:23], s60 offen lds
  s_mov_b32 s60, 3538944
  s_add_u32 m0, s61, 110592
  s_nop 0
  buffer_load_dwordx4 v4, s[44:47], s60 offen lds
  s_add_u32 m0, s61, 114688
  s_nop 0
  buffer_load_dwordx4 v5, s[48:51], s60 offen lds
  s_add_u32 m0, s61, 118784
  s_nop 0
  buffer_load_dwordx4 v6, s[20:23], s60 offen lds
  s_waitcnt vmcnt(15)
  s_barrier
  ds_read_b64_tr_b16 a[0:1], v8 offset:0
  ds_read_b64_tr_b16 a[2:3], v8 offset:512
  ds_read_b64_tr_b16 a[4:5], v8 offset:8
  ds_read_b64_tr_b16 a[6:7], v8 offset:520
  ds_read_b64_tr_b16 a[8:9], v9 offset:0
  ds_read_b64_tr_b16 a[10:11], v9 offset:512
  s_waitcnt lgkmcnt(6)
  ds_read_b64_tr_b16 a[12:13], v8 offset:12288
  ds_read_b64_tr_b16 a[14:15], v8 offset:12800
  ds_read_b64_tr_b16 a[16:17], v8 offset:12296
  ds_read_b64_tr_b16 a[18:19], v8 offset:12808
  ds_read_b64_tr_b16 a[20:21], v9 offset:12288
  ds_read_b64_tr_b16 a[22:23], v9 offset:12800
  s_waitcnt lgkmcnt(6)
  ds_read_b64_tr_b16 a[24:25], v8 offset:24576
  ds_read_b64_tr_b16 a[26:27], v8 offset:25088
  ds_read_b64_tr_b16 a[28:29], v8 offset:24584
  ds_read_b64_tr_b16 a[30:31], v8 offset:25096
  ds_read_b64_tr_b16 a[32:33], v9 offset:24576
  ds_read_b64_tr_b16 a[34:35], v9 offset:25088
  s_waitcnt lgkmcnt(6)
  ds_read_b64_tr_b16 a[36:37], v8 offset:36864
  ds_read_b64_tr_b16 a[38:39], v8 offset:37376
  ds_read_b64_tr_b16 a[40:41], v8 offset:36872
  ds_read_b64_tr_b16 a[42:43], v8 offset:37384
  ds_read_b64_tr_b16 a[44:45], v9 offset:36864
  ds_read_b64_tr_b16 a[46:47], v9 offset:37376
  s_waitcnt lgkmcnt(6)
  ds_read_b64_tr_b16 a[48:49], v8 offset:49152
  ds_read_b64_tr_b16 a[50:51], v8 offset:49664
  ds_read_b64_tr_b16 a[52:53], v8 offset:49160
  ds_read_b64_tr_b16 a[54:55], v8 offset:49672
  ds_read_b64_tr_b16 a[56:57], v9 offset:49152
  ds_read_b64_tr_b16 a[58:59], v9 offset:49664
  s_waitcnt lgkmcnt(6)
  s_waitcnt lgkmcnt(0)
  s_barrier
  s_call_b64 s[60:61], la_arrive
  s_lshl_b32 s61, s32, 10
  s_mov_b32 s60, 3932160
  s_add_u32 m0, s61, 0
  s_nop 0
  buffer_load_dwordx4 v4, s[44:47], s60 offen lds
  s_add_u32 m0, s61, 4096
  s_nop 0
  buffer_load_dwordx4 v5, s[48:51], s60 offen lds
  s_add_u32 m0, s61, 8192
  s_nop 0
  buffer_load_dwordx4 v6, s[20:23], s60 offen lds
  s_mov_b32 s60, 4325376
  s_add_u32 m0, s61, 12288
  s_nop 0
  buffer_load_dwordx4 v4, s[44:47], s60 offen lds
  s_add_u32 m0, s61, 16384
  s_nop 0
  buffer_load_dwordx4 v5, s[48:51], s60 offen lds
  s_add_u32 m0, s61, 20480
  s_nop 0
  buffer_load_dwordx4 v6, s[20:23], s60 offen lds
  s_mov_b32 s60, 4718592
  s_add_u32 m0, s61, 24576
  s_nop 0
  buffer_load_dwordx4 v4, s[44:47], s60 offen lds
  s_add_u32 m0, s61, 28672
  s_nop 0
  buffer_load_dwordx4 v5, s[48:51], s60 offen lds
  s_add_u32 m0, s61, 32768
  s_nop 0
  buffer_load_dwordx4 v6, s[20:23], s60 offen lds
  s_mov_b32 s60, 5111808
  s_add_u32 m0, s61, 36864
  s_nop 0
  buffer_load_dwordx4 v4, s[44:47], s60 offen lds
  s_add_u32 m0, s61, 40960
  s_nop 0
  buffer_load_dwordx4 v5, s[48:51], s60 offen lds
  s_add_u32 m0, s61, 45056
  s_nop 0
  buffer_load_dwordx4 v6, s[20:23], s60 offen lds
  s_mov_b32 s60, 5505024
  s_add_u32 m0, s61, 49152
  s_nop 0
  buffer_load_dwordx4 v4, s[44:47], s60 offen lds
  s_add_u32 m0, s61, 53248
  s_nop 0
  buffer_load_dwordx4 v5, s[48:51], s60 offen lds
  s_add_u32 m0, s61, 57344
  s_nop 0
  buffer_load_dwordx4 v6, s[20:23], s60 offen lds
  s_waitcnt vmcnt(15)
  s_barrier
  v_add_u32 v8, 61440, v8
  v_add_u32 v9, 61440, v9
  ds_read_b64_tr_b16 a[60:61], v8 offset:0
  ds_read_b64_tr_b16 a[62:63], v8 offset:512
  ds_read_b64_tr_b16 a[64:65], v8 offset:8
  ds_read_b64_tr_b16 a[66:67], v8 offset:520
  ds_read_b64_tr_b16 a[68:69], v9 offset:0
  ds_read_b64_tr_b16 a[70:71], v9 offset:512
  s_waitcnt lgkmcnt(6)
  ds_read_b64_tr_b16 a[72:73], v8 offset:12288
  ds_read_b64_tr_b16 a[74:75], v8 offset:12800
  ds_read_b64_tr_b16 a[76:77], v8 offset:12296
  ds_read_b64_tr_b16 a[78:79], v8 offset:12808
  ds_read_b64_tr_b16 a[80:81], v9 offset:12288
  ds_read_b64_tr_b16 a[82:83], v9 offset:12800
  s_waitcnt lgkmcnt(6)
  ds_read_b64_tr_b16 a[84:85], v8 offset:24576
  ds_read_b64_tr_b16 a[86:87], v8 offset:25088
  ds_read_b64_tr_b16 a[88:89], v8 offset:24584
  ds_read_b64_tr_b16 a[90:91], v8 offset:25096
  ds_read_b64_tr_b16 a[92:93], v9 offset:24576
  ds_read_b64_tr_b16 a[94:95], v9 offset:25088
  s_waitcnt lgkmcnt(6)
  ds_read_b64_tr_b16 a[96:97], v8 offset:36864
  ds_read_b64_tr_b16 a[98:99], v8 offset:37376
  ds_read_b64_tr_b16 a[100:101], v8 offset:36872
  ds_read_b64_tr_b16 a[102:103], v8 offset:37384
  ds_read_b64_tr_b16 a[104:105], v9 offset:36864
  ds_read_b64_tr_b16 a[106:107], v9 offset:37376
  s_waitcnt lgkmcnt(6)
  ds_read_b64_tr_b16 a[108:109], v8 offset:49152
  ds_read_b64_tr_b16 a[110:111], v8 offset:49664
  ds_read_b64_tr_b16 a[112:113], v8 offset:49160
  ds_read_b64_tr_b16 a[114:115], v8 offset:49672
  ds_read_b64_tr_b16 a[116:117], v9 offset:49152
  ds_read_b64_tr_b16 a[118:119], v9 offset:49664
  s_waitcnt lgkmcnt(6)
  v_subrev_u32 v8, 61440, v8
  v_subrev_u32 v9, 61440, v9
  s_waitcnt lgkmcnt(0)
  s_barrier
  s_lshl_b32 s61, s32, 10
  s_mov_b32 s60, 5898240
  s_add_u32 m0, s61, 61440
  s_nop 0
  buffer_load_dwordx4 v4, s[44:47], s60 offen lds
  s_add_u32 m0, s61, 65536
  s_nop 0
  buffer_load_dwordx4 v5, s[48:51], s60 offen lds
  s_add_u32 m0, s61, 69632
  s_nop 0
  buffer_load_dwordx4 v6, s[20:23], s60 offen lds
  s_mov_b32 s60, 6291456
  s_add_u32 m0, s61, 73728
  s_nop 0
  buffer_load_dwordx4 v4, s[44:47], s60 offen lds
  s_add_u32 m0, s61, 77824
  s_nop 0
  buffer_load_dwordx4 v5, s[48:51], s60 offen lds
  s_add_u32 m0, s61, 81920
  s_nop 0
  buffer_load_dwordx4 v6, s[20:23], s60 offen lds
  s_mov_b32 s60, 6684672
  s_add_u32 m0, s61, 86016
  s_nop 0
  buffer_load_dwordx4 v4, s[44:47], s60 offen lds
  s_add_u32 m0, s61, 90112
  s_nop 0
  buffer_load_dwordx4 v5, s[48:51], s60 offen lds
  s_add_u32 m0, s61, 94208
  s_nop 0
  buffer_load_dwordx4 v6, s[20:23], s60 offen lds
  s_mov_b32 s60, 7077888
  s_add_u32 m0, s61, 98304
  s_nop 0
  buffer_load_dwordx4 v4, s[44:47], s60 offen lds
  s_add_u32 m0, s61, 102400
  s_nop 0
  buffer_load_dwordx4 v5, s[48:51], s60 offen lds
  s_add_u32 m0, s61, 106496
  s_nop 0
  buffer_load_dwordx4 v6, s[20:23], s60 offen lds
  s_mov_b32 s60, 7471104
  s_add_u32 m0, s61, 110592
  s_nop 0
  buffer_load_dwordx4 v4, s[44:47], s60 offen lds
  s_add_u32 m0, s61, 114688
  s_nop 0
  buffer_load_dwordx4 v5, s[48:51], s60 offen lds
  s_add_u32 m0, s61, 118784
  s_nop 0
  buffer_load_dwordx4 v6, s[20:23], s60 offen lds
  s_waitcnt vmcnt(15)
  s_barrier
  ds_read_b64_tr_b16 a[120:121], v8 offset:0
  ds_read_b64_tr_b16 a[122:123], v8 offset:512
  ds_read_b64_tr_b16 a[124:125], v8 offset:8
  ds_read_b64_tr_b16 a[126:127], v8 offset:520
  ds_read_b64_tr_b16 a[128:129], v9 offset:0
  ds_read_b64_tr_b16 a[130:131], v9 offset:512
  s_waitcnt lgkmcnt(6)
  ds_read_b64_tr_b16 a[132:133], v8 offset:12288
  ds_read_b64_tr_b16 a[134:135], v8 offset:12800
  ds_read_b64_tr_b16 a[136:137], v8 offset:12296
  ds_read_b64_tr_b16 a[138:139], v8 offset:12808
  ds_read_b64_tr_b16 a[140:141], v9 offset:12288
  ds_read_b64_tr_b16 a[142:143], v9 offset:12800
  s_waitcnt lgkmcnt(6)
  ds_read_b64_tr_b16 a[144:145], v8 offset:24576
  ds_read_b64_tr_b16 a[146:147], v8 offset:25088
  ds_read_b64_tr_b16 a[148:149], v8 offset:24584
  ds_read_b64_tr_b16 a[150:151], v8 offset:25096
  ds_read_b64_tr_b16 a[152:153], v9 offset:24576
  ds_read_b64_tr_b16 a[154:155], v9 offset:25088
  s_waitcnt lgkmcnt(6)
  ds_read_b64_tr_b16 a[156:157], v8 offset:36864
  ds_read_b64_tr_b16 a[158:159], v8 offset:37376
  ds_read_b64_tr_b16 a[160:161], v8 offset:36872
  ds_read_b64_tr_b16 a[162:163], v8 offset:37384
  ds_read_b64_tr_b16 a[164:165], v9 offset:36864
  ds_read_b64_tr_b16 a[166:167], v9 offset:37376
  s_waitcnt lgkmcnt(6)
  ds_read_b64_tr_b16 a[168:169], v8 offset:49152
  ds_read_b64_tr_b16 a[170:171], v8 offset:49664
  ds_read_b64_tr_b16 a[172:173], v8 offset:49160
  ds_read_b64_tr_b16 a[174:175], v8 offset:49672
  ds_read_b64_tr_b16 a[176:177], v9 offset:49152
  ds_read_b64_tr_b16 a[178:179], v9 offset:49664
  s_waitcnt lgkmcnt(6)
  s_waitcnt lgkmcnt(0)
  s_barrier
  s_call_b64 s[60:61], la_census
  s_add_u32 m0, s38, 0
  s_add_u32 s60, s36, 0
  buffer_load_dwordx4 v11, s[8:11], s60 offen sc1 lds
  s_add_u32 m0, s38, 1024
  s_add_u32 s60, s36, 1024
  buffer_load_dwordx4 v11, s[8:11], s60 offen sc1 lds
  s_add_u32 m0, s38, 2048
  s_add_u32 s60, s36, 2048
  buffer_load_dwordx4 v11, s[8:11], s60 offen sc1 lds
  s_add_u32 m0, s38, 3072
  s_add_u32 s60, s36, 3072
  buffer_load_dwordx4 v11, s[8:11], s60 offen sc1 lds
  s_add_u32 m0, s38, 4096
  s_add_u32 s60, s36, 4096
  buffer_load_dwordx4 v11, s[8:11], s60 offen sc1 lds
  s_add_u32 m0, s38, 5120
  s_add_u32 s60, s36, 5120
  buffer_load_dwordx4 v11, s[8:11], s60 offen sc1 lds
  s_add_u32 m0, s38, 6144
  s_add_u32 s60, s36, 6144
  buffer_load_dwordx4 v11, s[8:11], s60 offen sc1 lds
  s_add_u32 m0, s38, 7168
  s_add_u32 s60, s36, 7168
  buffer_load_dwordx4 v11, s[8:11], s60 offen sc1 lds
  s_add_u32 m0, s38, 8192
  s_add_u32 s60, s36, 8192
  buffer_load_dwordx4 v11, s[8:11], s60 offen sc1 lds
  s_add_u32 m0, s38, 9216
  s_add_u32 s60, s36, 9216
  buffer_load_dwordx4 v11, s[8:11], s60 offen sc1 lds
  s_waitcnt vmcnt(10)
  s_barrier
  v_add_u32 v8, 61440, v8
  v_add_u32 v9, 61440, v9
  ds_read_b64_tr_b16 a[180:181], v8 offset:0
  ds_read_b64_tr_b16 a[182:183], v8 offset:512
  ds_read_b64_tr_b16 a[184:185], v8 offset:8
  ds_read_b64_tr_b16 a[186:187], v8 offset:520
  ds_read_b64_tr_b16 a[188:189], v9 offset:0
  ds_read_b64_tr_b16 a[190:191], v9 offset:512
  s_waitcnt lgkmcnt(6)
  ds_read_b64_tr_b16 a[192:193], v8 offset:12288
  ds_read_b64_tr_b16 a[194:195], v8 offset:12800
  ds_read_b64_tr_b16 a[196:197], v8 offset:12296
  ds_read_b64_tr_b16 a[198:199], v8 offset:12808
  ds_read_b64_tr_b16 a[200:201], v9 offset:12288
  ds_read_b64_tr_b16 a[202:203], v9 offset:12800
  s_waitcnt lgkmcnt(6)
  ds_read_b64_tr_b16 a[204:205], v8 offset:24576
  ds_read_b64_tr_b16 a[206:207], v8 offset:25088
  ds_read_b64_tr_b16 a[208:209], v8 offset:24584
  ds_read_b64_tr_b16 a[210:211], v8 offset:25096
  ds_read_b64_tr_b16 a[212:213], v9 offset:24576
  ds_read_b64_tr_b16 a[214:215], v9 offset:25088
  s_waitcnt lgkmcnt(6)
  ds_read_b64_tr_b16 a[216:217], v8 offset:36864
  ds_read_b64_tr_b16 a[218:219], v8 offset:37376
  ds_read_b64_tr_b16 a[220:221], v8 offset:36872
  ds_read_b64_tr_b16 a[222:223], v8 offset:37384
  ds_read_b64_tr_b16 a[224:225], v9 offset:36864
  ds_read_b64_tr_b16 a[226:227], v9 offset:37376
  s_waitcnt lgkmcnt(6)
  ds_read_b64_tr_b16 a[228:229], v8 offset:49152
  ds_read_b64_tr_b16 a[230:231], v8 offset:49664
  ds_read_b64_tr_b16 a[232:233], v8 offset:49160
  ds_read_b64_tr_b16 a[234:235], v8 offset:49672
  ds_read_b64_tr_b16 a[236:237], v9 offset:49152
  ds_read_b64_tr_b16 a[238:239], v9 offset:49664
  s_waitcnt lgkmcnt(6)
  v_subrev_u32 v8, 61440, v8
  v_subrev_u32 v9, 61440, v9
  s_waitcnt lgkmcnt(0)
  s_barrier
  s_branch L_lap_go_231
L_lap_again_230:
  s_lshr_b32 s42, s33, 5
  s_sub_u32 s42, s42, 4
  s_lshl_b32 s60, s42, 3
  s_and_b32 s34, s33, 7
  s_add_u32 s34, s34, s60
  s_bfe_u32 s40, s33, 0x20003
  v_bfe_u32 v11, v2, 0, 6
  v_mul_u32_u24 v11, 16, v11
  s_mov_b32 s60, 7340032
  s_mul_i32 s63, s32, 10240
  s_add_u32 s60, s60, s63
  v_add_u32 v11, s60, v11
  v_bfe_u32 v17, v2, 0, 6
  v_mul_u32_u24 v17, 128, v17
  s_mov_b32 s60, 49152
  v_add_u32 v17, s60, v17
  s_mov_b32 s36, 0
  s_mul_i32 s38, s32, 10240
  s_add_u32 s38, s38, 122880
  s_mov_b32 s35, 0
  s_sub_u32 s43, s65, 1
  s_add_u32 s62, s35, 0
  s_cmp_lt_u32 s62, s43
  s_cbranch_scc1 L_lap_hb_233
  s_mov_b32 s64, 400000
L_lap_hw_232:
  buffer_load_dwordx4 v[96:99], v17, s[8:11], 0 offen sc1
  s_waitcnt vmcnt(0)
  v_and_b32 v3, v96, v97
  v_and_b32 v1, v98, v99
  v_and_b32 v3, v3, v1
  v_cmp_eq_u32 vcc, 0, v3
  s_ff1_i32_b64 s43, vcc
  s_cmp_lt_u32 s62, s43
  s_cbranch_scc1 L_lap_hb_233
  s_sleep 1
  s_sub_u32 s64, s64, 1
  s_cmp_lg_u32 s64, 0
  s_cbranch_scc1 L_lap_hw_232
  s_branch L_lap_fail_229
L_lap_hb_233:
  s_add_u32 m0, s38, 0
  s_add_u32 s60, s36, 0
  buffer_load_dwordx4 v11, s[8:11], s60 offen sc1 lds
  s_add_u32 m0, s38, 1024
  s_add_u32 s60, s36, 1024
  buffer_load_dwordx4 v11, s[8:11], s60 offen sc1 lds
  s_add_u32 m0, s38, 2048
  s_add_u32 s60, s36, 2048
  buffer_load_dwordx4 v11, s[8:11], s60 offen sc1 lds
  s_add_u32 m0, s38, 3072
  s_add_u32 s60, s36, 3072
  buffer_load_dwordx4 v11, s[8:11], s60 offen sc1 lds
  s_add_u32 m0, s38, 4096
  s_add_u32 s60, s36, 4096
  buffer_load_dwordx4 v11, s[8:11], s60 offen sc1 lds
  s_add_u32 m0, s38, 5120
  s_add_u32 s60, s36, 5120
  buffer_load_dwordx4 v11, s[8:11], s60 offen sc1 lds
  s_add_u32 m0, s38, 6144
  s_add_u32 s60, s36, 6144
  buffer_load_dwordx4 v11, s[8:11], s60 offen sc1 lds
  s_add_u32 m0, s38, 7168
  s_add_u32 s60, s36, 7168
  buffer_load_dwordx4 v11, s[8:11], s60 offen sc1 lds
  s_add_u32 m0, s38, 8192
  s_add_u32 s60, s36, 8192
  buffer_load_dwordx4 v11, s[8:11], s60 offen sc1 lds
  s_add_u32 m0, s38, 9216
  s_add_u32 s60, s36, 9216
  buffer_load_dwordx4 v11, s[8:11], s60 offen sc1 lds
L_lap_go_231:
  s_lshl_b32 s61, s40, 2
  s_add_u32 s61, s61, s32
  s_cmp_ge_u32 s61, 6
  s_cselect_b32 s62, 33548288, 0
  v_bfe_u32 v13, v2, 0, 6
  v_mul_u32_u24 v13, 16, v13
  s_mov_b32 s60, 50331648
  s_mul_i32 s63, s34, 12288
  s_add_u32 s60, s60, s63
  s_mul_i32 s63, s61, 1024
  s_add_u32 s60, s60, s63
  s_mul_i32 s63, s62, 1
  s_add_u32 s60, s60, s63
  v_add_u32 v13, s60, v13
  v_bfe_u32 v14, v2, 0, 6
  v_mul_u32_u24 v14, 16, v14
  s_mov_b32 s60, 117440512
  s_mul_i32 s63, s34, 12288
  s_add_u32 s60, s60, s63
  s_mul_i32 s63, s61, 1024
  s_add_u32 s60, s60, s63
  v_add_u32 v14, s60, v14
  s_mov_b32 s52, 218103808
  s_mul_i32 s63, s65, 8388608
  s_add_u32 s52, s52, s63
  v_bfe_u32 v15, v2, 0, 6
  v_mul_u32_u24 v15, 4, v15
  s_mov_b32 s60, 0
  s_mul_i32 s63, s34, 128
  s_add_u32 s60, s60, s63
  s_mul_i32 s63, s40, 4
  s_add_u32 s60, s60, s63
  s_mul_i32 s63, s65, 131072
  s_add_u32 s60, s60, s63
  v_add_u32 v15, s60, v15
  v_cmp_gt_u32 vcc, 1, v2
  v_mov_b32 v1, 2147483632
  s_nop 0
  v_cndmask_b32 v15, v1, v15, vcc
  s_lshl_b32 s61, s40, 2
  s_add_u32 s61, s61, s32
  s_mul_i32 s62, s34, 10
  s_add_u32 s62, s62, s61
  s_lshr_b32 s60, s62, 6
  s_lshl_b32 s60, s60, 14
  s_and_b32 s62, s62, 63
  s_lshl_b32 s62, s62, 7
  s_add_u32 s62, s62, s60
  v_lshl_add_u32 v16, v2, 4, s62
  s_cmp_lt_u32 s61, 10
  s_cselect_b32 s61, 8, 0
  v_cmp_gt_u32 vcc, s61, v2
  v_mov_b32 v1, 2147483632
  s_nop 0
  v_cndmask_b32 v16, v1, v16, vcc
  v_mov_b32 v20, -1
  v_mov_b32 v21, -1
  v_mov_b32 v22, -1
  v_mov_b32 v23, -1
  v_lshlrev_b32 v12, 4, v2
  v_add_u32 v12, 122880, v12
  s_mov_b32 s35, 0
  s_mov_b32 s37, 0
  s_waitcnt vmcnt(0)
  s_barrier
L_lap_first_234:
  ds_read_b128 v[64:67], v12 offset:0
  ds_read_b128 v[68:71], v12 offset:20480
  ds_read_b128 v[72:75], v12 offset:1024
  ds_read_b128 v[76:79], v12 offset:21504
  ds_read_b128 v[80:83], v12 offset:2048
  ds_read_b128 v[84:87], v12 offset:22528
  s_add_u32 s62, s35, 1
  s_cmp_lt_u32 s62, s43
  s_cbranch_scc1 L_lap_hb_238
  s_mov_b32 s64, 400000
L_lap_hw_237:
  buffer_load_dwordx4 v[96:99], v17, s[8:11], 0 offen sc1
  s_waitcnt vmcnt(0)
  v_and_b32 v3, v96, v97
  v_and_b32 v1, v98, v99
  v_and_b32 v3, v3, v1
  v_cmp_eq_u32 vcc, 0, v3
  s_ff1_i32_b64 s43, vcc
  s_cmp_lt_u32 s62, s43
  s_cbranch_scc1 L_lap_hb_238
  s_sleep 1
  s_sub_u32 s64, s64, 1
  s_cmp_lg_u32 s64, 0
  s_cbranch_scc1 L_lap_hw_237
  s_branch L_lap_fail_229
L_lap_hb_238:
  s_add_u32 s36, s36, 40960
  s_min_u32 s36, s36, 2580480
  s_sub_u32 s61, s38, 122880
  s_add_u32 s62, s38, 122880
  s_cmp_ge_u32 s38, 122880
  s_cselect_b32 s38, s61, s62
  ds_read_b128 v[88:91], v12 offset:3072
  ds_read_b128 v[92:95], v12 offset:23552
  s_waitcnt lgkmcnt(6)
  v_mfma_f32_16x16x32_bf16 v[24:27], a[0:3], v[64:67], 0
  v_mfma_f32_16x16x32_bf16 v[28:31], a[0:3], v[68:71], 0
  s_add_u32 m0, s38, 0
  s_add_u32 s60, s36, 0
  buffer_load_dwordx4 v11, s[8:11], s60 offen sc1 lds
  v_mfma_f32_16x16x32_bf16 v[32:35], a[4:7], v[64:67], 0
  v_mfma_f32_16x16x32_bf16 v[36:39], a[4:7], v[68:71], 0
  v_mfma_f32_16x16x32_bf16 v[40:43], v[64:67], a[8:11], 0
  v_mfma_f32_16x16x32_bf16 v[44:47], v[68:71], a[8:11], 0
  ds_read_b128 v[64:67], v12 offset:4096
  ds_read_b128 v[68:71], v12 offset:24576
  s_waitcnt lgkmcnt(6)
  v_mfma_f32_16x16x32_bf16 v[24:27], a[12:15], v[72:75], v[24:27]
  v_mfma_f32_16x16x32_bf16 v[28:31], a[12:15], v[76:79], v[28:31]
  s_add_u32 m0, s38, 1024
  s_add_u32 s60, s36, 1024
  buffer_load_dwordx4 v11, s[8:11], s60 offen sc1 lds
  v_mfma_f32_16x16x32_bf16 v[32:35], a[16:19], v[72:75], v[32:35]
  v_mfma_f32_16x16x32_bf16 v[36:39], a[16:19], v[76:79], v[36:39]
  v_mfma_f32_16x16x32_bf16 v[40:43], v[72:75], a[20:23], v[40:43]
  v_mfma_f32_16x16x32_bf16 v[44:47], v[76:79], a[20:23], v[44:47]
  ds_read_b128 v[72:75], v12 offset:5120
  ds_read_b128 v[76:79], v12 offset:25600
  s_waitcnt lgkmcnt(6)
  v_mfma_f32_16x16x32_bf16 v[24:27], a[24:27], v[80:83], v[24:27]
  v_mfma_f32_16x16x32_bf16 v[28:31], a[24:27], v[84:87], v[28:31]
  s_add_u32 m0, s38, 2048
  s_add_u32 s60, s36, 2048
  buffer_load_dwordx4 v11, s[8:11], s60 offen sc1 lds
  v_mfma_f32_16x16x32_bf16 v[32:35], a[28:31], v[80:83], v[32:35]
  v_mfma_f32_16x16x32_bf16 v[36:39], a[28:31], v[84:87], v[36:39]
  v_mfma_f32_16x16x32_bf16 v[40:43], v[80:83], a[32:35], v[40:43]
  v_mfma_f32_16x16x32_bf16 v[44:47], v[84:87], a[32:35], v[44:47]
  ds_read_b128 v[80:83], v12 offset:6144
  ds_read_b128 v[84:87], v12 offset:26624
  s_waitcnt lgkmcnt(6)
  v_mfma_f32_16x16x32_bf16 v[24:27], a[36:39], v[88:91], v[24:27]
  v_mfma_f32_16x16x32_bf16 v[28:31], a[36:39], v[92:95], v[28:31]
  s_add_u32 m0, s38, 3072
  s_add_u32 s60, s36, 3072
  buffer_load_dwordx4 v11, s[8:11], s60 offen sc1 lds
  v_mfma_f32_16x16x32_bf16 v[32:35], a[40:43], v[88:91], v[32:35]
  v_mfma_f32_16x16x32_bf16 v[36:39], a[40:43], v[92:95], v[36:39]
  v_mfma_f32_16x16x32_bf16 v[40:43], v[88:91], a[44:47], v[40:43]
  v_mfma_f32_16x16x32_bf16 v[44:47], v[92:95], a[44:47], v[44:47]
  ds_read_b128 v[88:91], v12 offset:7168
  ds_read_b128 v[92:95], v12 offset:27648
  s_waitcnt lgkmcnt(6)
  v_mfma_f32_16x16x32_bf16 v[24:27], a[48:51], v[64:67], v[24:27]
  v_mfma_f32_16x16x32_bf16 v[28:31], a[48:51], v[68:71], v[28:31]
  s_add_u32 m0, s38, 4096
  s_add_u32 s60, s36, 4096
  buffer_load_dwordx4 v11, s[8:11], s60 offen sc1 lds
  v_mfma_f32_16x16x32_bf16 v[32:35], a[52:55], v[64:67], v[32:35]
  v_mfma_f32_16x16x32_bf16 v[36:39], a[52:55], v[68:71], v[36:39]
  v_mfma_f32_16x16x32_bf16 v[40:43], v[64:67], a[56:59], v[40:43]
  v_mfma_f32_16x16x32_bf16 v[44:47], v[68:71], a[56:59], v[44:47]
  ds_read_b128 v[64:67], v12 offset:8192
  ds_read_b128 v[68:71], v12 offset:28672
  s_waitcnt lgkmcnt(6)
  v_mfma_f32_16x16x32_bf16 v[24:27], a[60:63], v[72:75], v[24:27]
  v_mfma_f32_16x16x32_bf16 v[28:31], a[60:63], v[76:79], v[28:31]
  s_add_u32 m0, s38, 5120
  s_add_u32 s60, s36, 5120
  buffer_load_dwordx4 v11, s[8:11], s60 offen sc1 lds
  v_mfma_f32_16x16x32_bf16 v[32:35], a[64:67], v[72:75], v[32:35]
  v_mfma_f32_16x16x32_bf16 v[36:39], a[64:67], v[76:79], v[36:39]
  v_mfma_f32_16x16x32_bf16 v[40:43], v[72:75], a[68:71], v[40:43]
  v_mfma_f32_16x16x32_bf16 v[44:47], v[76:79], a[68:71], v[44:47]
  ds_read_b128 v[72:75], v12 offset:9216
  ds_read_b128 v[76:79], v12 offset:29696
  s_waitcnt lgkmcnt(6)
  v_mfma_f32_16x16x32_bf16 v[24:27], a[72:75], v[80:83], v[24:27]
  v_mfma_f32_16x16x32_bf16 v[28:31], a[72:75], v[84:87], v[28:31]
  s_add_u32 m0, s38, 6144
  s_add_u32 s60, s36, 6144
  buffer_load_dwordx4 v11, s[8:11], s60 offen sc1 lds
  v_mfma_f32_16x16x32_bf16 v[32:35], a[76:79], v[80:83], v[32:35]
  v_mfma_f32_16x16x32_bf16 v[36:39], a[76:79], v[84:87], v[36:39]
  v_mfma_f32_16x16x32_bf16 v[40:43], v[80:83], a[80:83], v[40:43]
  v_mfma_f32_16x16x32_bf16 v[44:47], v[84:87], a[80:83], v[44:47]
  ds_read_b128 v[80:83], v12 offset:10240
  ds_read_b128 v[84:87], v12 offset:30720
  s_waitcnt lgkmcnt(6)
  v_mfma_f32_16x16x32_bf16 v[24:27], a[84:87], v[88:91], v[24:27]
  v_mfma_f32_16x16x32_bf16 v[28:31], a[84:87], v[92:95], v[28:31]
  s_add_u32 m0, s38, 7168
  s_add_u32 s60, s36, 7168
  buffer_load_dwordx4 v11, s[8:11], s60 offen sc1 lds
  v_mfma_f32_16x16x32_bf16 v[32:35], a[88:91], v[88:91], v[32:35]
  v_mfma_f32_16x16x32_bf16 v[36:39], a[88:91], v[92:95], v[36:39]
  v_mfma_f32_16x16x32_bf16 v[40:43], v[88:91], a[92:95], v[40:43]
  v_mfma_f32_16x16x32_bf16 v[44:47], v[92:95], a[92:95], v[44:47]
  ds_read_b128 v[88:91], v12 offset:11264
  ds_read_b128 v[92:95], v12 offset:31744
  s_waitcnt lgkmcnt(6)
  v_mfma_f32_16x16x32_bf16 v[24:27], a[96:99], v[64:67], v[24:27]
  v_mfma_f32_16x16x32_bf16 v[28:31], a[96:99], v[68:71], v[28:31]
  s_add_u32 m0, s38, 8192
  s_add_u32 s60, s36, 8192
  buffer_load_dwordx4 v11, s[8:11], s60 offen sc1 lds
  v_mfma_f32_16x16x32_bf16 v[32:35], a[100:103], v[64:67], v[32:35]
  v_mfma_f32_16x16x32_bf16 v[36:39], a[100:103], v[68:71], v[36:39]
  v_mfma_f32_16x16x32_bf16 v[40:43], v[64:67], a[104:107], v[40:43]
  v_mfma_f32_16x16x32_bf16 v[44:47], v[68:71], a[104:107], v[44:47]
  ds_read_b128 v[64:67], v12 offset:12288
  ds_read_b128 v[68:71], v12 offset:32768
  s_waitcnt lgkmcnt(6)
  v_mfma_f32_16x16x32_bf16 v[24:27], a[108:111], v[72:75], v[24:27]
  v_mfma_f32_16x16x32_bf16 v[28:31], a[108:111], v[76:79], v[28:31]
  s_add_u32 m0, s38, 9216
  s_add_u32 s60, s36, 9216
  buffer_load_dwordx4 v11, s[8:11], s60 offen sc1 lds
  v_mfma_f32_16x16x32_bf16 v[32:35], a[112:115], v[72:75], v[32:35]
  v_mfma_f32_16x16x32_bf16 v[36:39], a[112:115], v[76:79], v[36:39]
  v_mfma_f32_16x16x32_bf16 v[40:43], v[72:75], a[116:119], v[40:43]
  v_mfma_f32_16x16x32_bf16 v[44:47], v[76:79], a[116:119], v[44:47]
  ds_read_b128 v[72:75], v12 offset:13312
  ds_read_b128 v[76:79], v12 offset:33792
  s_waitcnt lgkmcnt(6)
  v_mfma_f32_16x16x32_bf16 v[24:27], a[120:123], v[80:83], v[24:27]
  v_mfma_f32_16x16x32_bf16 v[28:31], a[120:123], v[84:87], v[28:31]
  v_mfma_f32_16x16x32_bf16 v[32:35], a[124:127], v[80:83], v[32:35]
  v_mfma_f32_16x16x32_bf16 v[36:39], a[124:127], v[84:87], v[36:39]
  v_mfma_f32_16x16x32_bf16 v[40:43], v[80:83], a[128:131], v[40:43]
  v_mfma_f32_16x16x32_bf16 v[44:47], v[84:87], a[128:131], v[44:47]
  ds_read_b128 v[80:83], v12 offset:14336
  ds_read_b128 v[84:87], v12 offset:34816
  s_waitcnt lgkmcnt(6)
  v_mfma_f32_16x16x32_bf16 v[24:27], a[132:135], v[88:91], v[24:27]
  v_mfma_f32_16x16x32_bf16 v[28:31], a[132:135], v[92:95], v[28:31]
  v_mfma_f32_16x16x32_bf16 v[32:35], a[136:139], v[88:91], v[32:35]
  v_mfma_f32_16x16x32_bf16 v[36:39], a[136:139], v[92:95], v[36:39]
  v_mfma_f32_16x16x32_bf16 v[40:43], v[88:91], a[140:143], v[40:43]
  v_mfma_f32_16x16x32_bf16 v[44:47], v[92:95], a[140:143], v[44:47]
  ds_read_b128 v[88:91], v12 offset:15360
  ds_read_b128 v[92:95], v12 offset:35840
  s_waitcnt lgkmcnt(6)
  v_mfma_f32_16x16x32_bf16 v[24:27], a[144:147], v[64:67], v[24:27]
  v_mfma_f32_16x16x32_bf16 v[28:31], a[144:147], v[68:71], v[28:31]
  v_mfma_f32_16x16x32_bf16 v[32:35], a[148:151], v[64:67], v[32:35]
  v_mfma_f32_16x16x32_bf16 v[36:39], a[148:151], v[68:71], v[36:39]
  v_mfma_f32_16x16x32_bf16 v[40:43], v[64:67], a[152:155], v[40:43]
  v_mfma_f32_16x16x32_bf16 v[44:47], v[68:71], a[152:155], v[44:47]
  ds_read_b128 v[64:67], v12 offset:16384
  ds_read_b128 v[68:71], v12 offset:36864
  s_waitcnt lgkmcnt(6)
  v_mfma_f32_16x16x32_bf16 v[24:27], a[156:159], v[72:75], v[24:27]
  v_mfma_f32_16x16x32_bf16 v[28:31], a[156:159], v[76:79], v[28:31]
  v_mfma_f32_16x16x32_bf16 v[32:35], a[160:163], v[72:75], v[32:35]
  v_mfma_f32_16x16x32_bf16 v[36:39], a[160:163], v[76:79], v[36:39]
  v_mfma_f32_16x16x32_bf16 v[40:43], v[72:75], a[164:167], v[40:43]
  v_mfma_f32_16x16x32_bf16 v[44:47], v[76:79], a[164:167], v[44:47]
  ds_read_b128 v[72:75], v12 offset:17408
  ds_read_b128 v[76:79], v12 offset:37888
  s_waitcnt lgkmcnt(6)
  v_mfma_f32_16x16x32_bf16 v[24:27], a[168:171], v[80:83], v[24:27]
  v_mfma_f32_16x16x32_bf16 v[28:31], a[168:171], v[84:87], v[28:31]
  v_mfma_f32_16x16x32_bf16 v[32:35], a[172:175], v[80:83], v[32:35]
  v_mfma_f32_16x16x32_bf16 v[36:39], a[172:175], v[84:87], v[36:39]
  v_mfma_f32_16x16x32_bf16 v[40:43], v[80:83], a[176:179], v[40:43]
  v_mfma_f32_16x16x32_bf16 v[44:47], v[84:87], a[176:179], v[44:47]
  ds_read_b128 v[80:83], v12 offset:18432
  ds_read_b128 v[84:87], v12 offset:38912
  s_waitcnt lgkmcnt(6)
  v_mfma_f32_16x16x32_bf16 v[24:27], a[180:183], v[88:91], v[24:27]
  v_mfma_f32_16x16x32_bf16 v[28:31], a[180:183], v[92:95], v[28:31]
  v_mfma_f32_16x16x32_bf16 v[32:35], a[184:187], v[88:91], v[32:35]
  v_mfma_f32_16x16x32_bf16 v[36:39], a[184:187], v[92:95], v[36:39]
  v_mfma_f32_16x16x32_bf16 v[40:43], v[88:91], a[188:191], v[40:43]
  v_mfma_f32_16x16x32_bf16 v[44:47], v[92:95], a[188:191], v[44:47]
  ds_read_b128 v[88:91], v12 offset:19456
  ds_read_b128 v[92:95], v12 offset:39936
  s_waitcnt lgkmcnt(6)
  v_mfma_f32_16x16x32_bf16 v[24:27], a[192:195], v[64:67], v[24:27]
  v_mfma_f32_16x16x32_bf16 v[28:31], a[192:195], v[68:71], v[28:31]
  v_mfma_f32_16x16x32_bf16 v[32:35], a[196:199], v[64:67], v[32:35]
  v_mfma_f32_16x16x32_bf16 v[36:39], a[196:199], v[68:71], v[36:39]
  v_mfma_f32_16x16x32_bf16 v[40:43], v[64:67], a[200:203], v[40:43]
  v_mfma_f32_16x16x32_bf16 v[44:47], v[68:71], a[200:203], v[44:47]
  s_waitcnt lgkmcnt(4)
  v_mfma_f32_16x16x32_bf16 v[24:27], a[204:207], v[72:75], v[24:27]
  v_mfma_f32_16x16x32_bf16 v[28:31], a[204:207], v[76:79], v[28:31]
  v_mfma_f32_16x16x32_bf16 v[32:35], a[208:211], v[72:75], v[32:35]
  v_mfma_f32_16x16x32_bf16 v[36:39], a[208:211], v[76:79], v[36:39]
  v_mfma_f32_16x16x32_bf16 v[40:43], v[72:75], a[212:215], v[40:43]
  v_mfma_f32_16x16x32_bf16 v[44:47], v[76:79], a[212:215], v[44:47]
  s_waitcnt lgkmcnt(2)
  v_mfma_f32_16x16x32_bf16 v[24:27], a[216:219], v[80:83], v[24:27]
  v_mfma_f32_16x16x32_bf16 v[28:31], a[216:219], v[84:87], v[28:31]
  v_mfma_f32_16x16x32_bf16 v[32:35], a[220:223], v[80:83], v[32:35]
  v_mfma_f32_16x16x32_bf16 v[36:39], a[220:223], v[84:87], v[36:39]
  v_mfma_f32_16x16x32_bf16 v[40:43], v[80:83], a[224:227], v[40:43]
  v_mfma_f32_16x16x32_bf16 v[44:47], v[84:87], a[224:227], v[44:47]
  s_waitcnt lgkmcnt(0)
  v_mfma_f32_16x16x32_bf16 v[24:27], a[228:231], v[88:91], v[24:27]
  v_mfma_f32_16x16x32_bf16 v[28:31], a[228:231], v[92:95], v[28:31]
  v_mfma_f32_16x16x32_bf16 v[32:35], a[232:235], v[88:91], v[32:35]
  v_mfma_f32_16x16x32_bf16 v[36:39], a[232:235], v[92:95], v[36:39]
  v_mfma_f32_16x16x32_bf16 v[40:43], v[88:91], a[236:239], v[40:43]
  v_mfma_f32_16x16x32_bf16 v[44:47], v[92:95], a[236:239], v[44:47]
  v_xor_b32 v12, 122880, v12
  s_add_u32 s35, s35, 1
  s_add_u32 s60, s35, 1
  s_lshr_b32 s61, s60, 4
  s_xor_b32 s61, s61, s6
  s_and_b32 s61, s61, 1
  s_lshl_b32 s61, s61, 13
  s_lshl_b32 s60, s60, 17
  s_add_u32 s41, s60, s61
  s_add_u32 s41, s41, s52
  v_cvt_pk_bf16_f32 v48, v24, v25
  v_cvt_pk_bf16_f32 v49, v26, v27
  v_cvt_pk_bf16_f32 v50, v32, v33
  v_cvt_pk_bf16_f32 v51, v34, v35
  v_cvt_pk_bf16_f32 v52, v28, v29
  v_cvt_pk_bf16_f32 v53, v30, v31
  v_cvt_pk_bf16_f32 v54, v36, v37
  v_cvt_pk_bf16_f32 v55, v38, v39
  v_cvt_pk_bf16_f32 v56, v40, v41
  v_cvt_pk_bf16_f32 v57, v42, v43
  v_cvt_pk_bf16_f32 v58, v44, v45
  v_cvt_pk_bf16_f32 v59, v46, v47
  s_cmp_eq_u32 s35, 3
  s_cbranch_scc1 L_lap_loop_235
  buffer_store_dwordx4 v[48:51], v13, s[8:11], s37 offen sc1
  s_add_u32 s60, s37, 6144
  buffer_store_dwordx4 v[52:55], v13, s[8:11], s60 offen sc1
  buffer_store_dwordx4 v[56:59], v14, s[8:11], s37 offen sc1
  buffer_store_dwordx4 v[20:23], v16, s[8:11], s41 offen sc1
  s_add_u32 s37, s37, 393216
  s_waitcnt vmcnt(0)
  s_barrier
  s_cmp_lg_u32 s32, 0
  s_cbranch_scc1 L_lap_f_239
  v_mov_b32 v3, s35
  buffer_store_dword v3, v15, s[8:11], 0 offen sc1
L_lap_f_239:
  s_branch L_lap_first_234
.p2align 6
L_lap_loop_235:
  s_waitcnt vmcnt(0)
  s_barrier
  s_sub_u32 s39, s35, 1
  s_cmp_lg_u32 s32, 0
  s_cbranch_scc1 L_lap_f_240
  v_mov_b32 v3, s39
  buffer_store_dword v3, v15, s[8:11], 0 offen sc1
L_lap_f_240:
  ds_read_b128 v[64:67], v12 offset:0
  ds_read_b128 v[68:71], v12 offset:20480
  ds_read_b128 v[72:75], v12 offset:1024
  ds_read_b128 v[76:79], v12 offset:21504
  ds_read_b128 v[80:83], v12 offset:2048
  ds_read_b128 v[84:87], v12 offset:22528
  s_add_u32 s62, s35, 1
  s_cmp_lt_u32 s62, s43
  s_cbranch_scc1 L_lap_hb_242
  s_mov_b32 s64, 400000
L_lap_hw_241:
  buffer_load_dwordx4 v[96:99], v17, s[8:11], 0 offen sc1
  s_waitcnt vmcnt(0)
  v_and_b32 v3, v96, v97
  v_and_b32 v1, v98, v99
  v_and_b32 v3, v3, v1
  v_cmp_eq_u32 vcc, 0, v3
  s_ff1_i32_b64 s43, vcc
  s_cmp_lt_u32 s62, s43
  s_cbranch_scc1 L_lap_hb_242
  s_sleep 1
  s_sub_u32 s64, s64, 1
  s_cmp_lg_u32 s64, 0
  s_cbranch_scc1 L_lap_hw_241
  s_branch L_lap_fail_229
L_lap_hb_242:
  s_add_u32 s36, s36, 40960
  s_min_u32 s36, s36, 2580480
  s_sub_u32 s61, s38, 122880
  s_add_u32 s62, s38, 122880
  s_cmp_ge_u32 s38, 122880
  s_cselect_b32 s38, s61, s62
  ds_read_b128 v[88:91], v12 offset:3072
  ds_read_b128 v[92:95], v12 offset:23552
  s_waitcnt lgkmcnt(6)
  v_mfma_f32_16x16x32_bf16 v[24:27], a[0:3], v[64:67], 0
  v_mfma_f32_16x16x32_bf16 v[28:31], a[0:3], v[68:71], 0
  buffer_store_dwordx4 v[48:51], v13, s[8:11], s37 offen sc1
  v_mfma_f32_16x16x32_bf16 v[32:35], a[4:7], v[64:67], 0
  v_mfma_f32_16x16x32_bf16 v[36:39], a[4:7], v[68:71], 0
  v_mfma_f32_16x16x32_bf16 v[40:43], v[64:67], a[8:11], 0
  v_mfma_f32_16x16x32_bf16 v[44:47], v[68:71], a[8:11], 0
  ds_read_b128 v[64:67], v12 offset:4096
  ds_read_b128 v[68:71], v12 offset:24576
  s_waitcnt lgkmcnt(6)
  v_mfma_f32_16x16x32_bf16 v[24:27], a[12:15], v[72:75], v[24:27]
  v_mfma_f32_16x16x32_bf16 v[28:31], a[12:15], v[76:79], v[28:31]
  s_add_u32 s60, s37, 6144
  buffer_store_dwordx4 v[52:55], v13, s[8:11], s60 offen sc1
  v_mfma_f32_16x16x32_bf16 v[32:35], a[16:19], v[72:75], v[32:35]
  v_mfma_f32_16x16x32_bf16 v[36:39], a[16:19], v[76:79], v[36:39]
  v_mfma_f32_16x16x32_bf16 v[40:43], v[72:75], a[20:23], v[40:43]
  v_mfma_f32_16x16x32_bf16 v[44:47], v[76:79], a[20:23], v[44:47]
  ds_read_b128 v[72:75], v12 offset:5120
  ds_read_b128 v[76:79], v12 offset:25600
  s_waitcnt lgkmcnt(6)
  v_mfma_f32_16x16x32_bf16 v[24:27], a[24:27], v[80:83], v[24:27]
  v_mfma_f32_16x16x32_bf16 v[28:31], a[24:27], v[84:87], v[28:31]
  buffer_store_dwordx4 v[56:59], v14, s[8:11], s37 offen sc1
  v_mfma_f32_16x16x32_bf16 v[32:35], a[28:31], v[80:83], v[32:35]
  v_mfma_f32_16x16x32_bf16 v[36:39], a[28:31], v[84:87], v[36:39]
  v_mfma_f32_16x16x32_bf16 v[40:43], v[80:83], a[32:35], v[40:43]
  v_mfma_f32_16x16x32_bf16 v[44:47], v[84:87], a[32:35], v[44:47]
  ds_read_b128 v[80:83], v12 offset:6144
  ds_read_b128 v[84:87], v12 offset:26624
  s_waitcnt lgkmcnt(6)
  v_mfma_f32_16x16x32_bf16 v[24:27], a[36:39], v[88:91], v[24:27]
  v_mfma_f32_16x16x32_bf16 v[28:31], a[36:39], v[92:95], v[28:31]
  buffer_store_dwordx4 v[20:23], v16, s[8:11], s41 offen sc1
  s_add_u32 s37, s37, 393216
  v_mfma_f32_16x16x32_bf16 v[32:35], a[40:43], v[88:91], v[32:35]
  v_mfma_f32_16x16x32_bf16 v[36:39], a[40:43], v[92:95], v[36:39]
  v_mfma_f32_16x16x32_bf16 v[40:43], v[88:91], a[44:47], v[40:43]
  v_mfma_f32_16x16x32_bf16 v[44:47], v[92:95], a[44:47], v[44:47]
  ds_read_b128 v[88:91], v12 offset:7168
  ds_read_b128 v[92:95], v12 offset:27648
  s_waitcnt lgkmcnt(6)
  v_mfma_f32_16x16x32_bf16 v[24:27], a[48:51], v[64:67], v[24:27]
  v_mfma_f32_16x16x32_bf16 v[28:31], a[48:51], v[68:71], v[28:31]
  s_add_u32 m0, s38, 0
  s_add_u32 s60, s36, 0
  buffer_load_dwordx4 v11, s[8:11], s60 offen sc1 lds
  v_mfma_f32_16x16x32_bf16 v[32:35], a[52:55], v[64:67], v[32:35]
  v_mfma_f32_16x16x32_bf16 v[36:39], a[52:55], v[68:71], v[36:39]
  v_mfma_f32_16x16x32_bf16 v[40:43], v[64:67], a[56:59], v[40:43]
  v_mfma_f32_16x16x32_bf16 v[44:47], v[68:71], a[56:59], v[44:47]
  ds_read_b128 v[64:67], v12 offset:8192
  ds_read_b128 v[68:71], v12 offset:28672
  s_waitcnt lgkmcnt(6)
  v_mfma_f32_16x16x32_bf16 v[24:27], a[60:63], v[72:75], v[24:27]
  v_mfma_f32_16x16x32_bf16 v[28:31], a[60:63], v[76:79], v[28:31]
  s_add_u32 m0, s38, 1024
  s_add_u32 s60, s36, 1024
  buffer_load_dwordx4 v11, s[8:11], s60 offen sc1 lds
  v_mfma_f32_16x16x32_bf16 v[32:35], a[64:67], v[72:75], v[32:35]
  v_mfma_f32_16x16x32_bf16 v[36:39], a[64:67], v[76:79], v[36:39]
  v_mfma_f32_16x16x32_bf16 v[40:43], v[72:75], a[68:71], v[40:43]
  v_mfma_f32_16x16x32_bf16 v[44:47], v[76:79], a[68:71], v[44:47]
  ds_read_b128 v[72:75], v12 offset:9216
  ds_read_b128 v[76:79], v12 offset:29696
  s_waitcnt lgkmcnt(6)
  v_mfma_f32_16x16x32_bf16 v[24:27], a[72:75], v[80:83], v[24:27]
  v_mfma_f32_16x16x32_bf16 v[28:31], a[72:75], v[84:87], v[28:31]
  s_add_u32 m0, s38, 2048
  s_add_u32 s60, s36, 2048
  buffer_load_dwordx4 v11, s[8:11], s60 offen sc1 lds
  v_mfma_f32_16x16x32_bf16 v[32:35], a[76:79], v[80:83], v[32:35]
  v_mfma_f32_16x16x32_bf16 v[36:39], a[76:79], v[84:87], v[36:39]
  v_mfma_f32_16x16x32_bf16 v[40:43], v[80:83], a[80:83], v[40:43]
  v_mfma_f32_16x16x32_bf16 v[44:47], v[84:87], a[80:83], v[44:47]
  ds_read_b128 v[80:83], v12 offset:10240
  ds_read_b128 v[84:87], v12 offset:30720
  s_waitcnt lgkmcnt(6)
  v_mfma_f32_16x16x32_bf16 v[24:27], a[84:87], v[88:91], v[24:27]
  v_mfma_f32_16x16x32_bf16 v[28:31], a[84:87], v[92:95], v[28:31]
  s_add_u32 m0, s38, 3072
  s_add_u32 s60, s36, 3072
  buffer_load_dwordx4 v11, s[8:11], s60 offen sc1 lds
  v_mfma_f32_16x16x32_bf16 v[32:35], a[88:91], v[88:91], v[32:35]
  v_mfma_f32_16x16x32_bf16 v[36:39], a[88:91], v[92:95], v[36:39]
  v_mfma_f32_16x16x32_bf16 v[40:43], v[88:91], a[92:95], v[40:43]
  v_mfma_f32_16x16x32_bf16 v[44:47], v[92:95], a[92:95], v[44:47]
  ds_read_b128 v[88:91], v12 offset:11264
  ds_read_b128 v[92:95], v12 offset:31744
  s_waitcnt lgkmcnt(6)
  v_mfma_f32_16x16x32_bf16 v[24:27], a[96:99], v[64:67], v[24:27]
  v_mfma_f32_16x16x32_bf16 v[28:31], a[96:99], v[68:71], v[28:31]
  s_add_u32 m0, s38, 4096
  s_add_u32 s60, s36, 4096
  buffer_load_dwordx4 v11, s[8:11], s60 offen sc1 lds
  v_mfma_f32_16x16x32_bf16 v[32:35], a[100:103], v[64:67], v[32:35]
  v_mfma_f32_16x16x32_bf16 v[36:39], a[100:103], v[68:71], v[36:39]
  v_mfma_f32_16x16x32_bf16 v[40:43], v[64:67], a[104:107], v[40:43]
  v_mfma_f32_16x16x32_bf16 v[44:47], v[68:71], a[104:107], v[44:47]
  ds_read_b128 v[64:67], v12 offset:12288
  ds_read_b128 v[68:71], v12 offset:32768
  s_waitcnt lgkmcnt(6)
  v_mfma_f32_16x16x32_bf16 v[24:27], a[108:111], v[72:75], v[24:27]
  v_mfma_f32_16x16x32_bf16 v[28:31], a[108:111], v[76:79], v[28:31]
  s_add_u32 m0, s38, 5120
  s_add_u32 s60, s36, 5120
  buffer_load_dwordx4 v11, s[8:11], s60 offen sc1 lds
  v_mfma_f32_16x16x32_bf16 v[32:35], a[112:115], v[72:75], v[32:35]
  v_mfma_f32_16x16x32_bf16 v[36:39], a[112:115], v[76:79], v[36:39]
  v_mfma_f32_16x16x32_bf16 v[40:43], v[72:75], a[116:119], v[40:43]
  v_mfma_f32_16x16x32_bf16 v[44:47], v[76:79], a[116:119], v[44:47]
  ds_read_b128 v[72:75], v12 offset:13312
  ds_read_b128 v[76:79], v12 offset:33792
  s_waitcnt lgkmcnt(6)
  v_mfma_f32_16x16x32_bf16 v[24:27], a[120:123], v[80:83], v[24:27]
  v_mfma_f32_16x16x32_bf16 v[28:31], a[120:123], v[84:87], v[28:31]
  s_add_u32 m0, s38, 6144
  s_add_u32 s60, s36, 6144
  buffer_load_dwordx4 v11, s[8:11], s60 offen sc1 lds
  v_mfma_f32_16x16x32_bf16 v[32:35], a[124:127], v[80:83], v[32:35]
  v_mfma_f32_16x16x32_bf16 v[36:39], a[124:127], v[84:87], v[36:39]
  v_mfma_f32_16x16x32_bf16 v[40:43], v[80:83], a[128:131], v[40:43]
  v_mfma_f32_16x16x32_bf16 v[44:47], v[84:87], a[128:131], v[44:47]
  ds_read_b128 v[80:83], v12 offset:14336
  ds_read_b128 v[84:87], v12 offset:34816
  s_waitcnt lgkmcnt(6)
  v_mfma_f32_16x16x32_bf16 v[24:27], a[132:135], v[88:91], v[24:27]
  v_mfma_f32_16x16x32_bf16 v[28:31], a[132:135], v[92:95], v[28:31]
  s_add_u32 m0, s38, 7168
  s_add_u32 s60, s36, 7168
  buffer_load_dwordx4 v11, s[8:11], s60 offen sc1 lds
  v_mfma_f32_16x16x32_bf16 v[32:35], a[136:139], v[88:91], v[32:35]
  v_mfma_f32_16x16x32_bf16 v[36:39], a[136:139], v[92:95], v[36:39]
  v_mfma_f32_16x16x32_bf16 v[40:43], v[88:91], a[140:143], v[40:43]
  v_mfma_f32_16x16x32_bf16 v[44:47], v[92:95], a[140:143], v[44:47]
  ds_read_b128 v[88:91], v12 offset:15360
  ds_read_b128 v[92:95], v12 offset:35840
  s_waitcnt lgkmcnt(6)
  v_mfma_f32_16x16x32_bf16 v[24:27], a[144:147], v[64:67], v[24:27]
  v_mfma_f32_16x16x32_bf16 v[28:31], a[144:147], v[68:71], v[28:31]
  s_add_u32 m0, s38, 8192
  s_add_u32 s60, s36, 8192
  buffer_load_dwordx4 v11, s[8:11], s60 offen sc1 lds
  v_mfma_f32_16x16x32_bf16 v[32:35], a[148:151], v[64:67], v[32:35]
  v_mfma_f32_16x16x32_bf16 v[36:39], a[148:151], v[68:71], v[36:39]
  v_mfma_f32_16x16x32_bf16 v[40:43], v[64:67], a[152:155], v[40:43]
  v_mfma_f32_16x16x32_bf16 v[44:47], v[68:71], a[152:155], v[44:47]
  ds_read_b128 v[64:67], v12 offset:16384
  ds_read_b128 v[68:71], v12 offset:36864
  s_waitcnt lgkmcnt(6)
  v_mfma_f32_16x16x32_bf16 v[24:27], a[156:159], v[72:75], v[24:27]
  v_mfma_f32_16x16x32_bf16 v[28:31], a[156:159], v[76:79], v[28:31]
  s_add_u32 m0, s38, 9216
  s_add_u32 s60, s36, 9216
  buffer_load_dwordx4 v11, s[8:11], s60 offen sc1 lds
  v_mfma_f32_16x16x32_bf16 v[32:35], a[160:163], v[72:75], v[32:35]
  v_mfma_f32_16x16x32_bf16 v[36:39], a[160:163], v[76:79], v[36:39]
  v_mfma_f32_16x16x32_bf16 v[40:43], v[72:75], a[164:167], v[40:43]
  v_mfma_f32_16x16x32_bf16 v[44:47], v[76:79], a[164:167], v[44:47]
  ds_read_b128 v[72:75], v12 offset:17408
  ds_read_b128 v[76:79], v12 offset:37888
  s_waitcnt lgkmcnt(6)
  v_mfma_f32_16x16x32_bf16 v[24:27], a[168:171], v[80:83], v[24:27]
  v_mfma_f32_16x16x32_bf16 v[28:31], a[168:171], v[84:87], v[28:31]
  v_mfma_f32_16x16x32_bf16 v[32:35], a[172:175], v[80:83], v[32:35]
  v_mfma_f32_16x16x32_bf16 v[36:39], a[172:175], v[84:87], v[36:39]
  v_mfma_f32_16x16x32_bf16 v[40:43], v[80:83], a[176:179], v[40:43]
  v_mfma_f32_16x16x32_bf16 v[44:47], v[84:87], a[176:179], v[44:47]
  ds_read_b128 v[80:83], v12 offset:18432
  ds_read_b128 v[84:87], v12 offset:38912
  s_waitcnt lgkmcnt(6)
  v_mfma_f32_16x16x32_bf16 v[24:27], a[180:183], v[88:91], v[24:27]
  v_mfma_f32_16x16x32_bf16 v[28:31], a[180:183], v[92:95], v[28:31]
  v_mfma_f32_16x16x32_bf16 v[32:35], a[184:187], v[88:91], v[32:35]
  v_mfma_f32_16x16x32_bf16 v[36:39], a[184:187], v[92:95], v[36:39]
  v_mfma_f32_16x16x32_bf16 v[40:43], v[88:91], a[188:191], v[40:43]
  v_mfma_f32_16x16x32_bf16 v[44:47], v[92:95], a[188:191], v[44:47]
  ds_read_b128 v[88:91], v12 offset:19456
  ds_read_b128 v[92:95], v12 offset:39936
  s_waitcnt lgkmcnt(6)
  v_mfma_f32_16x16x32_bf16 v[24:27], a[192:195], v[64:67], v[24:27]
  v_mfma_f32_16x16x32_bf16 v[28:31], a[192:195], v[68:71], v[28:31]
  v_mfma_f32_16x16x32_bf16 v[32:35], a[196:199], v[64:67], v[32:35]
  v_mfma_f32_16x16x32_bf16 v[36:39], a[196:199], v[68:71], v[36:39]
  v_mfma_f32_16x16x32_bf16 v[40:43], v[64:67], a[200:203], v[40:43]
  v_mfma_f32_16x16x32_bf16 v[44:47], v[68:71], a[200:203], v[44:47]
  s_waitcnt lgkmcnt(4)
  v_mfma_f32_16x16x32_bf16 v[24:27], a[204:207], v[72:75], v[24:27]
  v_mfma_f32_16x16x32_bf16 v[28:31], a[204:207], v[76:79], v[28:31]
  v_mfma_f32_16x16x32_bf16 v[32:35], a[208:211], v[72:75], v[32:35]
  v_mfma_f32_16x16x32_bf16 v[36:39], a[208:211], v[76:79], v[36:39]
  v_mfma_f32_16x16x32_bf16 v[40:43], v[72:75], a[212:215], v[40:43]
  v_mfma_f32_16x16x32_bf16 v[44:47], v[76:79], a[212:215], v[44:47]
  s_waitcnt lgkmcnt(2)
  v_mfma_f32_16x16x32_bf16 v[24:27], a[216:219], v[80:83], v[24:27]
  v_mfma_f32_16x16x32_bf16 v[28:31], a[216:219], v[84:87], v[28:31]
  v_mfma_f32_16x16x32_bf16 v[32:35], a[220:223], v[80:83], v[32:35]
  v_mfma_f32_16x16x32_bf16 v[36:39], a[220:223], v[84:87], v[36:39]
  v_mfma_f32_16x16x32_bf16 v[40:43], v[80:83], a[224:227], v[40:43]
  v_mfma_f32_16x16x32_bf16 v[44:47], v[84:87], a[224:227], v[44:47]
  s_waitcnt lgkmcnt(0)
  v_mfma_f32_16x16x32_bf16 v[24:27], a[228:231], v[88:91], v[24:27]
  v_mfma_f32_16x16x32_bf16 v[28:31], a[228:231], v[92:95], v[28:31]
  v_mfma_f32_16x16x32_bf16 v[32:35], a[232:235], v[88:91], v[32:35]
  v_mfma_f32_16x16x32_bf16 v[36:39], a[232:235], v[92:95], v[36:39]
  v_mfma_f32_16x16x32_bf16 v[40:43], v[88:91], a[236:239], v[40:43]
  v_mfma_f32_16x16x32_bf16 v[44:47], v[92:95], a[236:239], v[44:47]
  v_xor_b32 v12, 122880, v12
  s_add_u32 s35, s35, 1
  s_add_u32 s60, s35, 1
  s_lshr_b32 s61, s60, 4
  s_xor_b32 s61, s61, s6
  s_and_b32 s61, s61, 1
  s_lshl_b32 s61, s61, 13
  s_lshl_b32 s60, s60, 17
  s_add_u32 s41, s60, s61
  s_add_u32 s41, s41, s52
  v_cvt_pk_bf16_f32 v48, v24, v25
  v_cvt_pk_bf16_f32 v49, v26, v27
  v_cvt_pk_bf16_f32 v50, v32, v33
  v_cvt_pk_bf16_f32 v51, v34, v35
  v_cvt_pk_bf16_f32 v52, v28, v29
  v_cvt_pk_bf16_f32 v53, v30, v31
  v_cvt_pk_bf16_f32 v54, v36, v37
  v_cvt_pk_bf16_f32 v55, v38, v39
  v_cvt_pk_bf16_f32 v56, v40, v41
  v_cvt_pk_bf16_f32 v57, v42, v43
  v_cvt_pk_bf16_f32 v58, v44, v45
  v_cvt_pk_bf16_f32 v59, v46, v47
  s_cmp_lt_u32 s35, 64
  s_cbranch_scc1 L_lap_loop_235
  buffer_store_dwordx4 v[48:51], v13, s[8:11], s37 offen sc1
  s_add_u32 s60, s37, 6144
  buffer_store_dwordx4 v[52:55], v13, s[8:11], s60 offen sc1
  buffer_store_dwordx4 v[56:59], v14, s[8:11], s37 offen sc1
  buffer_store_dwordx4 v[20:23], v16, s[8:11], s41 offen sc1
  s_add_u32 s37, s37, 393216
  s_waitcnt vmcnt(0)
  s_barrier
  s_cmp_lg_u32 s32, 0
  s_cbranch_scc1 L_lap_f_243
  v_mov_b32 v3, 64
  buffer_store_dword v3, v15, s[8:11], 0 offen sc1
L_lap_f_243:
  s_mul_i32 s61, s42, 24
  s_and_b32 s62, s33, 31
  s_add_u32 s61, s61, s62
  v_bfe_u32 v3, v2, 0, 6
  v_mul_u32_u24 v3, 128, v3
  s_mov_b32 s60, 0
  s_mul_i32 s63, s61, 65536
  s_add_u32 s60, s60, s63
  s_mul_i32 s63, s32, 16384
  s_add_u32 s60, s60, s63
  v_add_u32 v3, s60, v3
  s_mov_b32 s61, 8192
  buffer_load_dword v4, v3, s[80:83], 0 offen
  buffer_load_dword v5, v3, s[80:83], s61 offen
  s_and_b32 s34, s33, 7
  s_mul_i32 s36, s42, 3
  s_add_u32 s36, s36, s40
  v_bfe_u32 v1, v2, 4, 2
  v_lshlrev_b32 v1, 1, v1
  v_and_b32 v3, 7, v2
  v_xor_b32 v3, v3, v1
  v_lshlrev_b32 v3, 4, v3
  v_bfe_u32 v6, v2, 3, 3
  v_mul_u32_u24 v6, 3072, v6
  s_mov_b32 s60, 0
  s_mul_i32 s63, s36, 256
  s_add_u32 s60, s60, s63
  s_mul_i32 s63, s32, 24576
  s_add_u32 s60, s60, s63
  v_add_u32 v6, s60, v6
  v_add_u32 v6, v6, v3
  s_mul_i32 s61, s32, 80
  s_add_u32 s61, s61, 0
  v_add_u32 v1, s61, v2
  v_mul_u32_u24 v3, 6554, v1
  v_lshrrev_b32 v3, 16, v3
  v_mul_u32_u24 v7, 10, v3
  v_sub_u32 v1, v1, v7
  v_mul_u32_u24 v7, 1280, v3
  v_lshl_add_u32 v7, v1, 4, v7
  s_mul_i32 s61, s34, 160
  v_add_u32 v7, s61, v7
  s_mul_i32 s61, s32, 80
  s_add_u32 s61, s61, 16
  v_add_u32 v1, s61, v2
  v_mul_u32_u24 v3, 6554, v1
  v_lshrrev_b32 v3, 16, v3
  v_mul_u32_u24 v8, 10, v3
  v_sub_u32 v1, v1, v8
  v_mul_u32_u24 v8, 1280, v3
  v_lshl_add_u32 v8, v1, 4, v8
  s_mul_i32 s61, s34, 160
  v_add_u32 v8, s61, v8
  s_and_b32 s61, s32, 1
  s_lshl_b32 s61, s61, 1
  v_bfe_u32 v3, v2, 1, 1
  v_or_b32 v3, s61, v3
  v_bfe_u32 v1, v2, 3, 2
  v_xor_b32 v3, v3, v1
  v_lshlrev_b32 v3, 5, v3
  s_lshr_b32 s61, s32, 1
  v_bfe_u32 v9, v2, 2, 4
  v_mul_u32_u24 v9, 128, v9
  v_bfe_u32 v1, v2, 0, 1
  v_mul_u32_u24 v1, 16, v1
  v_add_u32 v9, v9, v1
  s_mov_b32 s60, 0
  s_mul_i32 s63, s61, 4096
  s_add_u32 s60, s60, s63
  v_add_u32 v9, s60, v9
  v_add_u32 v9, v9, v3
  v_bfe_u32 v10, v2, 2, 4
  v_mul_u32_u24 v10, 160, v10
  v_bfe_u32 v1, v2, 0, 2
  v_mul_u32_u24 v1, 8, v1
  v_add_u32 v10, v10, v1
  s_mov_b32 s60, 16384
  v_add_u32 v10, s60, v10
  v_bfe_u32 v11, v2, 3, 2
  v_mul_u32_u24 v11, 128, v11
  v_bfe_u32 v1, v2, 0, 3
  v_mul_u32_u24 v1, 4, v1
  v_add_u32 v11, v11, v1
  s_mov_b32 s60, 16384
  s_mul_i32 s63, s65, 131072
  s_add_u32 s60, s60, s63
  v_add_u32 v11, s60, v11
  s_load_dwordx2 s[44:45], s[0:1], 72
  s_waitcnt lgkmcnt(0)
  s_and_b32 s45, s45, 0xffff
  s_mov_b32 s46, 3072
  s_mov_b32 s47, 0x00020000
  v_bfe_u32 v3, v2, 4, 2
  v_mul_u32_u24 v3, 16, v3
  s_mov_b32 s60, 0
  s_mul_i32 s63, s36, 256
  s_add_u32 s60, s60, s63
  s_mul_i32 s63, s32, 64
  s_add_u32 s60, s60, s63
  v_add_u32 v3, s60, v3
  buffer_load_dwordx4 v[12:15], v3, s[44:47], 0 offen
  v_mov_b32 v16, 0
  v_mov_b32 v17, 0
  v_mov_b32 v18, 0
  v_mov_b32 v19, 0
  v_mov_b32 v20, 0
  v_mov_b32 v21, 0
  v_mov_b32 v22, 0
  v_mov_b32 v23, 0
  v_mov_b32 v24, 0
  v_mov_b32 v25, 0
  v_mov_b32 v26, 0
  v_mov_b32 v27, 0
  v_mov_b32 v28, 0
  v_mov_b32 v29, 0
  v_mov_b32 v30, 0
  v_mov_b32 v31, 0
  v_mov_b32 v32, 0
  v_mov_b32 v33, 0
  v_mov_b32 v34, 0
  v_mov_b32 v35, 0
  v_mov_b32 v36, 0
  v_mov_b32 v37, 0
  v_mov_b32 v38, 0
  v_mov_b32 v39, 0
  v_mov_b32 v40, 0
  v_mov_b32 v41, 0
  v_mov_b32 v42, 0
  v_mov_b32 v43, 0
  v_mov_b32 v44, 0
  v_mov_b32 v45, 0
  v_mov_b32 v46, 0
  v_mov_b32 v47, 0
  v_mov_b32 v48, 0
  v_mov_b32 v49, 0
  v_mov_b32 v50, 0
  v_mov_b32 v51, 0
  v_mov_b32 v52, 0
  v_mov_b32 v53, 0
  v_mov_b32 v54, 0
  v_mov_b32 v55, 0
  s_mov_b32 s35, 0
  s_mov_b32 s37, 0
  s_mov_b32 s38, 16777216
  s_mov_b32 s39, 0
  s_lshl_b32 s61, s32, 10
  s_add_u32 m0, s61, s39
  s_add_u32 s61, s61, s39
  buffer_load_dwordx4 v6, s[76:79], s37 offen lds
  s_add_u32 m0, s61, 4096
  s_add_u32 s60, s37, 128
  buffer_load_dwordx4 v6, s[76:79], s60 offen lds
L_lap_bl_244:
  s_cmp_lg_u32 s32, 0
  s_cbranch_scc1 L_lap_bg_246
  s_mov_b32 s64, 400000
  s_and_b32 s62, s35, 3
  s_lshl_b32 s62, s62, 9
  v_mov_b32 v3, s35
L_lap_bw_245:
  buffer_load_dword v4, v11, s[8:11], s62 offen sc1
  s_waitcnt vmcnt(0)
  v_cmp_ge_u32 vcc, v3, v4
  s_cbranch_vccz L_lap_bg_246
  s_sleep 2
  s_sub_u32 s64, s64, 1
  s_cmp_lg_u32 s64, 0
  s_cbranch_scc1 L_lap_bw_245
  s_branch L_lap_fail_229
L_lap_bg_246:
  s_barrier
  s_mul_i32 s61, s32, 1280
  s_add_u32 m0, s61, 16384
  s_add_u32 s61, s61, 16640
  buffer_load_dwordx4 v7, s[8:11], s38 offen sc1 lds
  s_mov_b32 m0, s61
  s_xor_b32 s39, s39, 8192
  buffer_load_dwordx4 v8, s[8:11], s38 offen sc1 lds
  s_add_u32 s37, s37, 98304
  s_add_u32 s38, s38, 40960
  s_lshl_b32 s61, s32, 10
  s_add_u32 m0, s61, s39
  s_add_u32 s61, s61, s39
  buffer_load_dwordx4 v6, s[76:79], s37 offen lds
  s_add_u32 m0, s61, 4096
  s_add_u32 s60, s37, 128
  buffer_load_dwordx4 v6, s[76:79], s60 offen lds
  s_waitcnt vmcnt(2)
  s_barrier
  ds_read_b64_tr_b16 v[56:57], v9 offset:0
  ds_read_b64_tr_b16 v[58:59], v9 offset:2048
  ds_read_b64_tr_b16 v[60:61], v9 offset:8
  ds_read_b64_tr_b16 v[62:63], v9 offset:2056
  ds_read_b64_tr_b16 v[64:65], v10 offset:0
  ds_read_b64_tr_b16 v[66:67], v10 offset:2560
  ds_read_b64_tr_b16 v[68:69], v10 offset:32
  ds_read_b64_tr_b16 v[70:71], v10 offset:2592
  ds_read_b64_tr_b16 v[72:73], v10 offset:64
  ds_read_b64_tr_b16 v[74:75], v10 offset:2624
  ds_read_b64_tr_b16 v[76:77], v10 offset:96
  ds_read_b64_tr_b16 v[78:79], v10 offset:2656
  ds_read_b64_tr_b16 v[80:81], v10 offset:128
  ds_read_b64_tr_b16 v[82:83], v10 offset:2688
  v_xor_b32 v9, 8192, v9
  s_waitcnt lgkmcnt(8)
  v_mfma_f32_16x16x32_bf16 v[16:19], v[56:59], v[64:67], v[16:19]
  v_mfma_f32_16x16x32_bf16 v[20:23], v[60:63], v[64:67], v[20:23]
  s_waitcnt lgkmcnt(6)
  v_mfma_f32_16x16x32_bf16 v[24:27], v[56:59], v[68:71], v[24:27]
  v_mfma_f32_16x16x32_bf16 v[28:31], v[60:63], v[68:71], v[28:31]
  s_waitcnt lgkmcnt(4)
  v_mfma_f32_16x16x32_bf16 v[32:35], v[56:59], v[72:75], v[32:35]
  v_mfma_f32_16x16x32_bf16 v[36:39], v[60:63], v[72:75], v[36:39]
  s_waitcnt lgkmcnt(2)
  v_mfma_f32_16x16x32_bf16 v[40:43], v[56:59], v[76:79], v[40:43]
  v_mfma_f32_16x16x32_bf16 v[44:47], v[60:63], v[76:79], v[44:47]
  s_waitcnt lgkmcnt(0)
  v_mfma_f32_16x16x32_bf16 v[48:51], v[56:59], v[80:83], v[48:51]
  v_mfma_f32_16x16x32_bf16 v[52:55], v[60:63], v[80:83], v[52:55]
  s_add_u32 s35, s35, 1
  s_cmp_lt_u32 s35, 64
  s_cbranch_scc1 L_lap_bl_244
  s_mov_b32 s61, 0xffff0000
  s_mov_b32 s62, 0xbdd2d3e8
  v_mov_b32 v4, 0xc0135761
  v_lshlrev_b32 v56, 16, v12
  v_and_b32 v57, s61, v12
  v_lshlrev_b32 v58, 16, v13
  v_and_b32 v59, s61, v13
  v_lshlrev_b32 v60, 16, v14
  v_and_b32 v61, s61, v14
  v_lshlrev_b32 v62, 16, v15
  v_and_b32 v63, s61, v15
  v_bfe_u32 v3, v2, 0, 6
  v_mul_u32_u24 v3, 16, v3
  s_mov_b32 s60, 19922944
  s_mul_i32 s63, s34, 245760
  s_add_u32 s60, s60, s63
  s_mul_i32 s63, s36, 4096
  s_add_u32 s60, s60, s63
  s_mul_i32 s63, s32, 1024
  s_add_u32 s60, s60, s63
  v_add_u32 v3, s60, v3
  v_pk_add_f32 v[16:17], v[16:17], v[56:57]
  v_pk_add_f32 v[18:19], v[18:19], v[58:59]
  v_pk_add_f32 v[20:21], v[20:21], v[60:61]
  v_pk_add_f32 v[22:23], v[22:23], v[62:63]
  v_mul_f32 v84, v16, v16
  v_mul_f32 v85, v17, v17
  v_mul_f32 v86, v18, v18
  v_mul_f32 v87, v19, v19
  v_mul_f32 v88, v20, v20
  v_mul_f32 v89, v21, v21
  v_mul_f32 v90, v22, v22
  v_mul_f32 v91, v23, v23
  v_fma_f32 v84, v84, s62, v4
  v_fma_f32 v85, v85, s62, v4
  v_fma_f32 v86, v86, s62, v4
  v_fma_f32 v87, v87, s62, v4
  v_fma_f32 v88, v88, s62, v4
  v_fma_f32 v89, v89, s62, v4
  v_fma_f32 v90, v90, s62, v4
  v_fma_f32 v91, v91, s62, v4
  v_mul_f32 v84, v84, v16
  v_mul_f32 v85, v85, v17
  v_mul_f32 v86, v86, v18
  v_mul_f32 v87, v87, v19
  v_mul_f32 v88, v88, v20
  v_mul_f32 v89, v89, v21
  v_mul_f32 v90, v90, v22
  v_mul_f32 v91, v91, v23
  v_exp_f32 v84, v84
  v_exp_f32 v85, v85
  v_exp_f32 v86, v86
  v_exp_f32 v87, v87
  v_exp_f32 v88, v88
  v_exp_f32 v89, v89
  v_exp_f32 v90, v90
  v_exp_f32 v91, v91
  v_add_f32 v84, 1.0, v84
  v_add_f32 v85, 1.0, v85
  v_add_f32 v86, 1.0, v86
  v_add_f32 v87, 1.0, v87
  v_add_f32 v88, 1.0, v88
  v_add_f32 v89, 1.0, v89
  v_add_f32 v90, 1.0, v90
  v_add_f32 v91, 1.0, v91
  v_rcp_f32 v84, v84
  v_rcp_f32 v85, v85
  v_rcp_f32 v86, v86
  v_rcp_f32 v87, v87
  v_rcp_f32 v88, v88
  v_rcp_f32 v89, v89
  v_rcp_f32 v90, v90
  v_rcp_f32 v91, v91
  v_mul_f32 v16, v16, v84
  v_mul_f32 v17, v17, v85
  v_mul_f32 v18, v18, v86
  v_mul_f32 v19, v19, v87
  v_mul_f32 v20, v20, v88
  v_mul_f32 v21, v21, v89
  v_mul_f32 v22, v22, v90
  v_mul_f32 v23, v23, v91
  v_cvt_pk_bf16_f32 v84, v16, v17
  v_cvt_pk_bf16_f32 v85, v18, v19
  v_cvt_pk_bf16_f32 v86, v20, v21
  v_cvt_pk_bf16_f32 v87, v22, v23
  s_mov_b32 s60, 0
  buffer_store_dwordx4 v[84:87], v3, s[8:11], s60 offen sc1
  v_pk_add_f32 v[24:25], v[24:25], v[56:57]
  v_pk_add_f32 v[26:27], v[26:27], v[58:59]
  v_pk_add_f32 v[28:29], v[28:29], v[60:61]
  v_pk_add_f32 v[30:31], v[30:31], v[62:63]
  v_mul_f32 v92, v24, v24
  v_mul_f32 v93, v25, v25
  v_mul_f32 v94, v26, v26
  v_mul_f32 v95, v27, v27
  v_mul_f32 v96, v28, v28
  v_mul_f32 v97, v29, v29
  v_mul_f32 v98, v30, v30
  v_mul_f32 v99, v31, v31
  v_fma_f32 v92, v92, s62, v4
  v_fma_f32 v93, v93, s62, v4
  v_fma_f32 v94, v94, s62, v4
  v_fma_f32 v95, v95, s62, v4
  v_fma_f32 v96, v96, s62, v4
  v_fma_f32 v97, v97, s62, v4
  v_fma_f32 v98, v98, s62, v4
  v_fma_f32 v99, v99, s62, v4
  v_mul_f32 v92, v92, v24
  v_mul_f32 v93, v93, v25
  v_mul_f32 v94, v94, v26
  v_mul_f32 v95, v95, v27
  v_mul_f32 v96, v96, v28
  v_mul_f32 v97, v97, v29
  v_mul_f32 v98, v98, v30
  v_mul_f32 v99, v99, v31
  v_exp_f32 v92, v92
  v_exp_f32 v93, v93
  v_exp_f32 v94, v94
  v_exp_f32 v95, v95
  v_exp_f32 v96, v96
  v_exp_f32 v97, v97
  v_exp_f32 v98, v98
  v_exp_f32 v99, v99
  v_add_f32 v92, 1.0, v92
  v_add_f32 v93, 1.0, v93
  v_add_f32 v94, 1.0, v94
  v_add_f32 v95, 1.0, v95
  v_add_f32 v96, 1.0, v96
  v_add_f32 v97, 1.0, v97
  v_add_f32 v98, 1.0, v98
  v_add_f32 v99, 1.0, v99
  v_rcp_f32 v92, v92
  v_rcp_f32 v93, v93
  v_rcp_f32 v94, v94
  v_rcp_f32 v95, v95
  v_rcp_f32 v96, v96
  v_rcp_f32 v97, v97
  v_rcp_f32 v98, v98
  v_rcp_f32 v99, v99
  v_mul_f32 v24, v24, v92
  v_mul_f32 v25, v25, v93
  v_mul_f32 v26, v26, v94
  v_mul_f32 v27, v27, v95
  v_mul_f32 v28, v28, v96
  v_mul_f32 v29, v29, v97
  v_mul_f32 v30, v30, v98
  v_mul_f32 v31, v31, v99
  v_cvt_pk_bf16_f32 v92, v24, v25
  v_cvt_pk_bf16_f32 v93, v26, v27
  v_cvt_pk_bf16_f32 v94, v28, v29
  v_cvt_pk_bf16_f32 v95, v30, v31
  s_mov_b32 s60, 49152
  buffer_store_dwordx4 v[92:95], v3, s[8:11], s60 offen sc1
  v_pk_add_f32 v[32:33], v[32:33], v[56:57]
  v_pk_add_f32 v[34:35], v[34:35], v[58:59]
  v_pk_add_f32 v[36:37], v[36:37], v[60:61]
  v_pk_add_f32 v[38:39], v[38:39], v[62:63]
  v_mul_f32 v100, v32, v32
  v_mul_f32 v101, v33, v33
  v_mul_f32 v102, v34, v34
  v_mul_f32 v103, v35, v35
  v_mul_f32 v104, v36, v36
  v_mul_f32 v105, v37, v37
  v_mul_f32 v106, v38, v38
  v_mul_f32 v107, v39, v39
  v_fma_f32 v100, v100, s62, v4
  v_fma_f32 v101, v101, s62, v4
  v_fma_f32 v102, v102, s62, v4
  v_fma_f32 v103, v103, s62, v4
  v_fma_f32 v104, v104, s62, v4
  v_fma_f32 v105, v105, s62, v4
  v_fma_f32 v106, v106, s62, v4
  v_fma_f32 v107, v107, s62, v4
  v_mul_f32 v100, v100, v32
  v_mul_f32 v101, v101, v33
  v_mul_f32 v102, v102, v34
  v_mul_f32 v103, v103, v35
  v_mul_f32 v104, v104, v36
  v_mul_f32 v105, v105, v37
  v_mul_f32 v106, v106, v38
  v_mul_f32 v107, v107, v39
  v_exp_f32 v100, v100
  v_exp_f32 v101, v101
  v_exp_f32 v102, v102
  v_exp_f32 v103, v103
  v_exp_f32 v104, v104
  v_exp_f32 v105, v105
  v_exp_f32 v106, v106
  v_exp_f32 v107, v107
  v_add_f32 v100, 1.0, v100
  v_add_f32 v101, 1.0, v101
  v_add_f32 v102, 1.0, v102
  v_add_f32 v103, 1.0, v103
  v_add_f32 v104, 1.0, v104
  v_add_f32 v105, 1.0, v105
  v_add_f32 v106, 1.0, v106
  v_add_f32 v107, 1.0, v107
  v_rcp_f32 v100, v100
  v_rcp_f32 v101, v101
  v_rcp_f32 v102, v102
  v_rcp_f32 v103, v103
  v_rcp_f32 v104, v104
  v_rcp_f32 v105, v105
  v_rcp_f32 v106, v106
  v_rcp_f32 v107, v107
  v_mul_f32 v32, v32, v100
  v_mul_f32 v33, v33, v101
  v_mul_f32 v34, v34, v102
  v_mul_f32 v35, v35, v103
  v_mul_f32 v36, v36, v104
  v_mul_f32 v37, v37, v105
  v_mul_f32 v38, v38, v106
  v_mul_f32 v39, v39, v107
  v_cvt_pk_bf16_f32 v100, v32, v33
  v_cvt_pk_bf16_f32 v101, v34, v35
  v_cvt_pk_bf16_f32 v102, v36, v37
  v_cvt_pk_bf16_f32 v103, v38, v39
  s_mov_b32 s60, 98304
  buffer_store_dwordx4 v[100:103], v3, s[8:11], s60 offen sc1
  v_pk_add_f32 v[40:41], v[40:41], v[56:57]
  v_pk_add_f32 v[42:43], v[42:43], v[58:59]
  v_pk_add_f32 v[44:45], v[44:45], v[60:61]
  v_pk_add_f32 v[46:47], v[46:47], v[62:63]
  v_mul_f32 v108, v40, v40
  v_mul_f32 v109, v41, v41
  v_mul_f32 v110, v42, v42
  v_mul_f32 v111, v43, v43
  v_mul_f32 v112, v44, v44
  v_mul_f32 v113, v45, v45
  v_mul_f32 v114, v46, v46
  v_mul_f32 v115, v47, v47
  v_fma_f32 v108, v108, s62, v4
  v_fma_f32 v109, v109, s62, v4
  v_fma_f32 v110, v110, s62, v4
  v_fma_f32 v111, v111, s62, v4
  v_fma_f32 v112, v112, s62, v4
  v_fma_f32 v113, v113, s62, v4
  v_fma_f32 v114, v114, s62, v4
  v_fma_f32 v115, v115, s62, v4
  v_mul_f32 v108, v108, v40
  v_mul_f32 v109, v109, v41
  v_mul_f32 v110, v110, v42
  v_mul_f32 v111, v111, v43
  v_mul_f32 v112, v112, v44
  v_mul_f32 v113, v113, v45
  v_mul_f32 v114, v114, v46
  v_mul_f32 v115, v115, v47
  v_exp_f32 v108, v108
  v_exp_f32 v109, v109
  v_exp_f32 v110, v110
  v_exp_f32 v111, v111
  v_exp_f32 v112, v112
  v_exp_f32 v113, v113
  v_exp_f32 v114, v114
  v_exp_f32 v115, v115
  v_add_f32 v108, 1.0, v108
  v_add_f32 v109, 1.0, v109
  v_add_f32 v110, 1.0, v110
  v_add_f32 v111, 1.0, v111
  v_add_f32 v112, 1.0, v112
  v_add_f32 v113, 1.0, v113
  v_add_f32 v114, 1.0, v114
  v_add_f32 v115, 1.0, v115
  v_rcp_f32 v108, v108
  v_rcp_f32 v109, v109
  v_rcp_f32 v110, v110
  v_rcp_f32 v111, v111
  v_rcp_f32 v112, v112
  v_rcp_f32 v113, v113
  v_rcp_f32 v114, v114
  v_rcp_f32 v115, v115
  v_mul_f32 v40, v40, v108
  v_mul_f32 v41, v41, v109
  v_mul_f32 v42, v42, v110
  v_mul_f32 v43, v43, v111
  v_mul_f32 v44, v44, v112
  v_mul_f32 v45, v45, v113
  v_mul_f32 v46, v46, v114
  v_mul_f32 v47, v47, v115
  v_cvt_pk_bf16_f32 v108, v40, v41
  v_cvt_pk_bf16_f32 v109, v42, v43
  v_cvt_pk_bf16_f32 v110, v44, v45
  v_cvt_pk_bf16_f32 v111, v46, v47
  s_mov_b32 s60, 147456
  buffer_store_dwordx4 v[108:111], v3, s[8:11], s60 offen sc1
  v_pk_add_f32 v[48:49], v[48:49], v[56:57]
  v_pk_add_f32 v[50:51], v[50:51], v[58:59]
  v_pk_add_f32 v[52:53], v[52:53], v[60:61]
  v_pk_add_f32 v[54:55], v[54:55], v[62:63]
  v_mul_f32 v116, v48, v48
  v_mul_f32 v117, v49, v49
  v_mul_f32 v118, v50, v50
  v_mul_f32 v119, v51, v51
  v_mul_f32 v120, v52, v52
  v_mul_f32 v121, v53, v53
  v_mul_f32 v122, v54, v54
  v_mul_f32 v123, v55, v55
  v_fma_f32 v116, v116, s62, v4
  v_fma_f32 v117, v117, s62, v4
  v_fma_f32 v118, v118, s62, v4
  v_fma_f32 v119, v119, s62, v4
  v_fma_f32 v120, v120, s62, v4
  v_fma_f32 v121, v121, s62, v4
  v_fma_f32 v122, v122, s62, v4
  v_fma_f32 v123, v123, s62, v4
  v_mul_f32 v116, v116, v48
  v_mul_f32 v117, v117, v49
  v_mul_f32 v118, v118, v50
  v_mul_f32 v119, v119, v51
  v_mul_f32 v120, v120, v52
  v_mul_f32 v121, v121, v53
  v_mul_f32 v122, v122, v54
  v_mul_f32 v123, v123, v55
  v_exp_f32 v116, v116
  v_exp_f32 v117, v117
  v_exp_f32 v118, v118
  v_exp_f32 v119, v119
  v_exp_f32 v120, v120
  v_exp_f32 v121, v121
  v_exp_f32 v122, v122
  v_exp_f32 v123, v123
  v_add_f32 v116, 1.0, v116
  v_add_f32 v117, 1.0, v117
  v_add_f32 v118, 1.0, v118
  v_add_f32 v119, 1.0, v119
  v_add_f32 v120, 1.0, v120
  v_add_f32 v121, 1.0, v121
  v_add_f32 v122, 1.0, v122
  v_add_f32 v123, 1.0, v123
  v_rcp_f32 v116, v116
  v_rcp_f32 v117, v117
  v_rcp_f32 v118, v118
  v_rcp_f32 v119, v119
  v_rcp_f32 v120, v120
  v_rcp_f32 v121, v121
  v_rcp_f32 v122, v122
  v_rcp_f32 v123, v123
  v_mul_f32 v48, v48, v116
  v_mul_f32 v49, v49, v117
  v_mul_f32 v50, v50, v118
  v_mul_f32 v51, v51, v119
  v_mul_f32 v52, v52, v120
  v_mul_f32 v53, v53, v121
  v_mul_f32 v54, v54, v122
  v_mul_f32 v55, v55, v123
  v_cvt_pk_bf16_f32 v116, v48, v49
  v_cvt_pk_bf16_f32 v117, v50, v51
  v_cvt_pk_bf16_f32 v118, v52, v53
  v_cvt_pk_bf16_f32 v119, v54, v55
  s_mov_b32 s60, 196608
  buffer_store_dwordx4 v[116:119], v3, s[8:11], s60 offen sc1
  s_mov_b32 s61, 20480
  s_mul_i32 s63, s34, 512
  s_add_u32 s61, s61, s63
  s_mul_i32 s63, s42, 128
  s_add_u32 s61, s61, s63
  s_mul_i32 s63, s40, 4
  s_add_u32 s61, s61, s63
  s_mul_i32 s63, s32, 268435456
  s_add_u32 s61, s61, s63
  s_mul_i32 s63, s65, 131072
  s_add_u32 s61, s61, s63
  v_mov_b32 v3, 1
  s_waitcnt vmcnt(0)
  s_barrier
  s_mov_b64 exec, 1
  buffer_store_dword v3, off, s[8:11], s61 sc1
  s_mov_b64 exec, -1
  s_call_b64 s[66:67], la_mixer
  s_branch L_lap_again_230
L_lap_fail_229:
  s_mov_b64 exec, 1
  v_mov_b32 v1, 262144
  v_mov_b32 v3, 1
  buffer_atomic_add v3, v1, s[8:11], 0 offen
  s_waitcnt vmcnt(0) lgkmcnt(0)
  s_endpgm
la_mixer:
  s_load_dwordx4 s[52:55], s[0:1], 80
  s_load_dwordx2 s[56:57], s[0:1], 96
  s_waitcnt vmcnt(0) lgkmcnt(0)
  s_barrier
  s_mov_b32 s40, s52
  s_and_b32 s41, s53, 0xffff
  s_mov_b32 s42, 6291456
  s_mov_b32 s43, 0x00020000
  s_mov_b32 s44, s54
  s_and_b32 s45, s55, 0xffff
  s_mov_b32 s46, 4096
  s_mov_b32 s47, 0x00020000
  s_mov_b32 s48, s56
  s_and_b32 s49, s57, 0xffff
  s_mov_b32 s50, 2621440
  s_mov_b32 s51, 0x00020000
  s_add_u32 s72, s4, 13631488
  s_addc_u32 s73, s5, 0
  s_and_b32 s73, s73, 0xffff
  s_mov_b32 s74, 2621440
  s_mov_b32 s75, 0x00020000
  s_lshr_b32 s34, s33, 3
  s_and_b32 s35, s33, 7
  s_mul_i32 s38, s32, 40960
  v_bfe_u32 v1, v2, 4, 1
  v_or_b32 v1, 0, v1
  v_lshlrev_b32 v1, 1, v1
  v_and_b32 v3, 7, v2
  v_xor_b32 v3, v3, v1
  v_lshlrev_b32 v3, 4, v3
  v_bfe_u32 v4, v2, 3, 3
  v_mul_u32_u24 v4, 4096, v4
  s_mov_b32 s60, 0
  s_mul_i32 s63, s32, 1572864
  s_add_u32 s60, s60, s63
  s_mul_i32 s63, s34, 128
  s_add_u32 s60, s60, s63
  v_add_u32 v4, s60, v4
  v_add_u32 v4, v4, v3
  v_bfe_u32 v1, v2, 4, 1
  v_or_b32 v1, 2, v1
  v_lshlrev_b32 v1, 1, v1
  v_and_b32 v3, 7, v2
  v_xor_b32 v3, v3, v1
  v_lshlrev_b32 v3, 4, v3
  v_bfe_u32 v5, v2, 3, 3
  v_mul_u32_u24 v5, 4096, v5
  s_mov_b32 s60, 32768
  s_mul_i32 s63, s32, 1572864
  s_add_u32 s60, s60, s63
  s_mul_i32 s63, s34, 128
  s_add_u32 s60, s60, s63
  v_add_u32 v5, s60, v5
  v_add_u32 v5, v5, v3
  v_bfe_u32 v1, v2, 3, 2
  v_xor_b32 v3, 0, v1
  v_lshlrev_b32 v3, 5, v3
  v_bfe_u32 v8, v2, 4, 2
  v_mul_u32_u24 v8, 1024, v8
  v_bfe_u32 v1, v2, 2, 2
  v_mul_u32_u24 v1, 128, v1
  v_add_u32 v8, v8, v1
  v_bfe_u32 v1, v2, 0, 2
  v_mul_u32_u24 v1, 8, v1
  v_add_u32 v8, v8, v1
  s_mov_b32 s60, 0
  s_mul_i32 s63, s32, 40960
  s_add_u32 s60, s60, s63
  v_add_u32 v8, s60, v8
  v_add_u32 v8, v8, v3
  v_bfe_u32 v1, v2, 3, 2
  v_xor_b32 v3, 1, v1
  v_lshlrev_b32 v3, 5, v3
  v_bfe_u32 v9, v2, 4, 2
  v_mul_u32_u24 v9, 1024, v9
  v_bfe_u32 v1, v2, 2, 2
  v_mul_u32_u24 v1, 128, v1
  v_add_u32 v9, v9, v1
  v_bfe_u32 v1, v2, 0, 2
  v_mul_u32_u24 v1, 8, v1
  v_add_u32 v9, v9, v1
  s_mov_b32 s60, 0
  s_mul_i32 s63, s32, 40960
  s_add_u32 s60, s60, s63
  v_add_u32 v9, s60, v9
  v_add_u32 v9, v9, v3
  v_bfe_u32 v1, v2, 3, 2
  v_xor_b32 v3, 2, v1
  v_lshlrev_b32 v3, 5, v3
  v_bfe_u32 v10, v2, 4, 2
  v_mul_u32_u24 v10, 1024, v10
  v_bfe_u32 v1, v2, 2, 2
  v_mul_u32_u24 v1, 128, v1
  v_add_u32 v10, v10, v1
  v_bfe_u32 v1, v2, 0, 2
  v_mul_u32_u24 v1, 8, v1
  v_add_u32 v10, v10, v1
  s_mov_b32 s60, 0
  s_mul_i32 s63, s32, 40960
  s_add_u32 s60, s60, s63
  v_add_u32 v10, s60, v10
  v_add_u32 v10, v10, v3
  v_bfe_u32 v1, v2, 3, 2
  v_xor_b32 v3, 3, v1
  v_lshlrev_b32 v3, 5, v3
  v_bfe_u32 v11, v2, 4, 2
  v_mul_u32_u24 v11, 1024, v11
  v_bfe_u32 v1, v2, 2, 2
  v_mul_u32_u24 v1, 128, v1
  v_add_u32 v11, v11, v1
  v_bfe_u32 v1, v2, 0, 2
  v_mul_u32_u24 v1, 8, v1
  v_add_u32 v11, v11, v1
  s_mov_b32 s60, 0
  s_mul_i32 s63, s32, 40960
  s_add_u32 s60, s60, s63
  v_add_u32 v11, s60, v11
  v_add_u32 v11, v11, v3
  s_add_u32 m0, s38, 0
  s_mov_b32 s60, 0
  buffer_load_dwordx4 v4, s[40:43], s60 offen lds
  s_add_u32 m0, s38, 1024
  s_mov_b32 s60, 0
  buffer_load_dwordx4 v5, s[40:43], s60 offen lds
  s_add_u32 m0, s38, 2048
  s_mov_b32 s60, 65536
  buffer_load_dwordx4 v4, s[40:43], s60 offen lds
  s_add_u32 m0, s38, 3072
  s_mov_b32 s60, 65536
  buffer_load_dwordx4 v5, s[40:43], s60 offen lds
  s_add_u32 m0, s38, 4096
  s_mov_b32 s60, 131072
  buffer_load_dwordx4 v4, s[40:43], s60 offen lds
  s_add_u32 m0, s38, 5120
  s_mov_b32 s60, 131072
  buffer_load_dwordx4 v5, s[40:43], s60 offen lds
  s_add_u32 m0, s38, 6144
  s_mov_b32 s60, 196608
  buffer_load_dwordx4 v4, s[40:43], s60 offen lds
  s_add_u32 m0, s38, 7168
  s_mov_b32 s60, 196608
  buffer_load_dwordx4 v5, s[40:43], s60 offen lds
  s_add_u32 m0, s38, 8192
  s_mov_b32 s60, 262144
  buffer_load_dwordx4 v4, s[40:43], s60 offen lds
  s_add_u32 m0, s38, 9216
  s_mov_b32 s60, 262144
  buffer_load_dwordx4 v5, s[40:43], s60 offen lds
  s_add_u32 m0, s38, 10240
  s_mov_b32 s60, 327680
  buffer_load_dwordx4 v4, s[40:43], s60 offen lds
  s_add_u32 m0, s38, 11264
  s_mov_b32 s60, 327680
  buffer_load_dwordx4 v5, s[40:43], s60 offen lds
  s_add_u32 m0, s38, 12288
  s_mov_b32 s60, 393216
  buffer_load_dwordx4 v4, s[40:43], s60 offen lds
  s_add_u32 m0, s38, 13312
  s_mov_b32 s60, 393216
  buffer_load_dwordx4 v5, s[40:43], s60 offen lds
  s_add_u32 m0, s38, 14336
  s_mov_b32 s60, 458752
  buffer_load_dwordx4 v4, s[40:43], s60 offen lds
  s_add_u32 m0, s38, 15360
  s_mov_b32 s60, 458752
  buffer_load_dwordx4 v5, s[40:43], s60 offen lds
  s_add_u32 m0, s38, 16384
  s_mov_b32 s60, 524288
  buffer_load_dwordx4 v4, s[40:43], s60 offen lds
  s_add_u32 m0, s38, 17408
  s_mov_b32 s60, 524288
  buffer_load_dwordx4 v5, s[40:43], s60 offen lds
  s_add_u32 m0, s38, 18432
  s_mov_b32 s60, 589824
  buffer_load_dwordx4 v4, s[40:43], s60 offen lds
  s_add_u32 m0, s38, 19456
  s_mov_b32 s60, 589824
  buffer_load_dwordx4 v5, s[40:43], s60 offen lds
  s_add_u32 m0, s38, 20480
  s_mov_b32 s60, 655360
  buffer_load_dwordx4 v4, s[40:43], s60 offen lds
  s_add_u32 m0, s38, 21504
  s_mov_b32 s60, 655360
  buffer_load_dwordx4 v5, s[40:43], s60 offen lds
  s_add_u32 m0, s38, 22528
  s_mov_b32 s60, 720896
  buffer_load_dwordx4 v4, s[40:43], s60 offen lds
  s_add_u32 m0, s38, 23552
  s_mov_b32 s60, 720896
  buffer_load_dwordx4 v5, s[40:43], s60 offen lds
  v_bfe_u32 v6, v2, 0, 6
  v_mul_u32_u24 v6, 16, v6
  s_mov_b32 s60, 19922944
  s_mul_i32 s63, s35, 245760
  s_add_u32 s60, s60, s63
  s_mul_i32 s63, s32, 12288
  s_add_u32 s60, s60, s63
  v_add_u32 v6, s60, v6
  v_bfe_u32 v7, v2, 0, 6
  v_mul_u32_u24 v7, 16, v7
  s_mov_b32 s60, 24576
  s_mul_i32 s63, s32, 40960
  s_add_u32 s60, s60, s63
  v_add_u32 v7, s60, v7
  v_add_u32 v1, 0, v2
  v_min_u32 v1, 159, v1
  v_lshlrev_b32 v21, 4, v1
  v_mul_u32_u24 v3, 6554, v1
  v_lshrrev_b32 v3, 16, v3
  v_mul_u32_u24 v36, 10, v3
  v_sub_u32 v1, v1, v36
  s_lshl_b32 s60, s32, 4
  v_add_u32 v3, s60, v3
  v_mul_u32_u24 v15, 336, v3
  v_lshl_add_u32 v15, v1, 5, v15
  s_lshl_b32 s60, s34, 6
  v_add_u32 v3, s60, v3
  v_mul_u32_u24 v12, 1280, v3
  v_lshl_add_u32 v12, v1, 4, v12
  s_mul_i32 s60, s35, 160
  v_add_u32 v12, s60, v12
  v_lshlrev_b32 v3, 1, v3
  buffer_load_ushort v18, v3, s[44:47], 0 offen
  v_add_u32 v1, 64, v2
  v_min_u32 v1, 159, v1
  v_lshlrev_b32 v22, 4, v1
  v_mul_u32_u24 v3, 6554, v1
  v_lshrrev_b32 v3, 16, v3
  v_mul_u32_u24 v36, 10, v3
  v_sub_u32 v1, v1, v36
  s_lshl_b32 s60, s32, 4
  v_add_u32 v3, s60, v3
  v_mul_u32_u24 v16, 336, v3
  v_lshl_add_u32 v16, v1, 5, v16
  s_lshl_b32 s60, s34, 6
  v_add_u32 v3, s60, v3
  v_mul_u32_u24 v13, 1280, v3
  v_lshl_add_u32 v13, v1, 4, v13
  s_mul_i32 s60, s35, 160
  v_add_u32 v13, s60, v13
  v_lshlrev_b32 v3, 1, v3
  buffer_load_ushort v19, v3, s[44:47], 0 offen
  v_add_u32 v1, 128, v2
  v_min_u32 v1, 159, v1
  v_lshlrev_b32 v23, 4, v1
  v_mul_u32_u24 v3, 6554, v1
  v_lshrrev_b32 v3, 16, v3
  v_mul_u32_u24 v36, 10, v3
  v_sub_u32 v1, v1, v36
  s_lshl_b32 s60, s32, 4
  v_add_u32 v3, s60, v3
  v_mul_u32_u24 v17, 336, v3
  v_lshl_add_u32 v17, v1, 5, v17
  s_lshl_b32 s60, s34, 6
  v_add_u32 v3, s60, v3
  v_mul_u32_u24 v14, 1280, v3
  v_lshl_add_u32 v14, v1, 4, v14
  s_mul_i32 s60, s35, 160
  v_add_u32 v14, s60, v14
  v_lshlrev_b32 v3, 1, v3
  buffer_load_ushort v20, v3, s[44:47], 0 offen
  v_bfe_u32 v3, v2, 0, 6
  v_mul_u32_u24 v3, 4, v3
  s_mov_b32 s60, 20480
  s_mul_i32 s63, s35, 512
  s_add_u32 s60, s60, s63
  s_mul_i32 s63, s32, 128
  s_add_u32 s60, s60, s63
  s_mul_i32 s63, s65, 131072
  s_add_u32 s60, s60, s63
  v_add_u32 v3, s60, v3
  s_mov_b32 s64, 400000
  s_mov_b64 exec, 7
la_mw:
  buffer_load_dword v1, v3, s[8:11], 0 offen sc1
  s_waitcnt vmcnt(0)
  v_cmp_eq_u32 vcc, 0, v1
  s_cbranch_vccz la_mg
  s_sleep 2
  s_sub_u32 s64, s64, 1
  s_cmp_lg_u32 s64, 0
  s_cbranch_scc1 la_mw
  s_branch la_exit2
la_mg:
  s_mov_b64 exec, -1
  s_add_u32 m0, s38, 24576
  s_mov_b32 s60, 0
  buffer_load_dwordx4 v6, s[8:11], s60 offen sc1 lds
  s_add_u32 m0, s38, 25600
  s_mov_b32 s60, 49152
  buffer_load_dwordx4 v6, s[8:11], s60 offen sc1 lds
  s_add_u32 m0, s38, 26624
  s_mov_b32 s60, 98304
  buffer_load_dwordx4 v6, s[8:11], s60 offen sc1 lds
  s_add_u32 m0, s38, 27648
  s_mov_b32 s60, 147456
  buffer_load_dwordx4 v6, s[8:11], s60 offen sc1 lds
  s_add_u32 m0, s38, 28672
  s_mov_b32 s60, 196608
  buffer_load_dwordx4 v6, s[8:11], s60 offen sc1 lds
  s_add_u32 m0, s38, 29696
  s_mov_b32 s60, 1024
  buffer_load_dwordx4 v6, s[8:11], s60 offen sc1 lds
  s_add_u32 m0, s38, 30720
  s_mov_b32 s60, 50176
  buffer_load_dwordx4 v6, s[8:11], s60 offen sc1 lds
  s_add_u32 m0, s38, 31744
  s_mov_b32 s60, 99328
  buffer_load_dwordx4 v6, s[8:11], s60 offen sc1 lds
  s_add_u32 m0, s38, 32768
  s_mov_b32 s60, 148480
  buffer_load_dwordx4 v6, s[8:11], s60 offen sc1 lds
  s_add_u32 m0, s38, 33792
  s_mov_b32 s60, 197632
  buffer_load_dwordx4 v6, s[8:11], s60 offen sc1 lds
  s_add_u32 m0, s38, 34816
  s_mov_b32 s60, 2048
  buffer_load_dwordx4 v6, s[8:11], s60 offen sc1 lds
  s_add_u32 m0, s38, 35840
  s_mov_b32 s60, 51200
  buffer_load_dwordx4 v6, s[8:11], s60 offen sc1 lds
  s_add_u32 m0, s38, 36864
  s_mov_b32 s60, 100352
  buffer_load_dwordx4 v6, s[8:11], s60 offen sc1 lds
  s_add_u32 m0, s38, 37888
  s_mov_b32 s60, 149504
  buffer_load_dwordx4 v6, s[8:11], s60 offen sc1 lds
  s_add_u32 m0, s38, 38912
  s_mov_b32 s60, 198656
  buffer_load_dwordx4 v6, s[8:11], s60 offen sc1 lds
  s_mov_b32 s39, 10485760
  buffer_load_dwordx4 v[24:27], v12, s[8:11], s39 offen sc1
  buffer_load_dwordx4 v[28:31], v13, s[8:11], s39 offen sc1
  buffer_load_dwordx4 v[32:35], v14, s[8:11], s39 offen sc1
  s_waitcnt vmcnt(13)
  ds_read_b64_tr_b16 v[36:37], v8 offset:0
  ds_read_b64_tr_b16 v[38:39], v8 offset:512
  ds_read_b64_tr_b16 v[40:41], v9 offset:0
  ds_read_b64_tr_b16 v[42:43], v9 offset:512
  ds_read_b64_tr_b16 v[44:45], v10 offset:0
  ds_read_b64_tr_b16 v[46:47], v10 offset:512
  ds_read_b64_tr_b16 v[48:49], v11 offset:0
  ds_read_b64_tr_b16 v[50:51], v11 offset:512
  ds_read_b128 v[52:55], v7 offset:0
  ds_read_b128 v[56:59], v7 offset:1024
  ds_read_b128 v[60:63], v7 offset:2048
  ds_read_b128 v[64:67], v7 offset:3072
  ds_read_b128 v[68:71], v7 offset:4096
  s_waitcnt lgkmcnt(4)
  v_mfma_f32_16x16x32_bf16 v[72:75], v[52:55], v[36:39], 0
  v_mfma_f32_16x16x32_bf16 v[92:95], v[52:55], v[40:43], 0
  v_mfma_f32_16x16x32_bf16 v[112:115], v[52:55], v[44:47], 0
  v_mfma_f32_16x16x32_bf16 v[132:135], v[52:55], v[48:51], 0
  s_waitcnt lgkmcnt(3)
  v_mfma_f32_16x16x32_bf16 v[76:79], v[56:59], v[36:39], 0
  v_mfma_f32_16x16x32_bf16 v[96:99], v[56:59], v[40:43], 0
  v_mfma_f32_16x16x32_bf16 v[116:119], v[56:59], v[44:47], 0
  v_mfma_f32_16x16x32_bf16 v[136:139], v[56:59], v[48:51], 0
  s_waitcnt lgkmcnt(2)
  v_mfma_f32_16x16x32_bf16 v[80:83], v[60:63], v[36:39], 0
  v_mfma_f32_16x16x32_bf16 v[100:103], v[60:63], v[40:43], 0
  v_mfma_f32_16x16x32_bf16 v[120:123], v[60:63], v[44:47], 0
  v_mfma_f32_16x16x32_bf16 v[140:143], v[60:63], v[48:51], 0
  s_waitcnt lgkmcnt(1)
  v_mfma_f32_16x16x32_bf16 v[84:87], v[64:67], v[36:39], 0
  v_mfma_f32_16x16x32_bf16 v[104:107], v[64:67], v[40:43], 0
  v_mfma_f32_16x16x32_bf16 v[124:127], v[64:67], v[44:47], 0
  v_mfma_f32_16x16x32_bf16 v[144:147], v[64:67], v[48:51], 0
  s_waitcnt lgkmcnt(0)
  s_add_u32 m0, s38, 24576
  s_mov_b32 s60, 3072
  buffer_load_dwordx4 v6, s[8:11], s60 offen sc1 lds
  s_add_u32 m0, s38, 25600
  s_mov_b32 s60, 52224
  buffer_load_dwordx4 v6, s[8:11], s60 offen sc1 lds
  s_add_u32 m0, s38, 26624
  s_mov_b32 s60, 101376
  buffer_load_dwordx4 v6, s[8:11], s60 offen sc1 lds
  s_add_u32 m0, s38, 27648
  s_mov_b32 s60, 150528
  buffer_load_dwordx4 v6, s[8:11], s60 offen sc1 lds
  s_add_u32 m0, s38, 28672
  s_mov_b32 s60, 199680
  buffer_load_dwordx4 v6, s[8:11], s60 offen sc1 lds
  s_add_u32 m0, s38, 0
  s_mov_b32 s60, 786432
  buffer_load_dwordx4 v4, s[40:43], s60 offen lds
  s_add_u32 m0, s38, 1024
  s_mov_b32 s60, 786432
  buffer_load_dwordx4 v5, s[40:43], s60 offen lds
  s_add_u32 m0, s38, 2048
  s_mov_b32 s60, 851968
  buffer_load_dwordx4 v4, s[40:43], s60 offen lds
  s_add_u32 m0, s38, 3072
  s_mov_b32 s60, 851968
  buffer_load_dwordx4 v5, s[40:43], s60 offen lds
  v_mfma_f32_16x16x32_bf16 v[88:91], v[68:71], v[36:39], 0
  v_mfma_f32_16x16x32_bf16 v[108:111], v[68:71], v[40:43], 0
  v_mfma_f32_16x16x32_bf16 v[128:131], v[68:71], v[44:47], 0
  v_mfma_f32_16x16x32_bf16 v[148:151], v[68:71], v[48:51], 0
  s_waitcnt vmcnt(17)
  ds_read_b64_tr_b16 v[36:37], v8 offset:4096
  ds_read_b64_tr_b16 v[38:39], v8 offset:4608
  ds_read_b64_tr_b16 v[40:41], v9 offset:4096
  ds_read_b64_tr_b16 v[42:43], v9 offset:4608
  ds_read_b64_tr_b16 v[44:45], v10 offset:4096
  ds_read_b64_tr_b16 v[46:47], v10 offset:4608
  ds_read_b64_tr_b16 v[48:49], v11 offset:4096
  ds_read_b64_tr_b16 v[50:51], v11 offset:4608
  ds_read_b128 v[52:55], v7 offset:5120
  ds_read_b128 v[56:59], v7 offset:6144
  ds_read_b128 v[60:63], v7 offset:7168
  ds_read_b128 v[64:67], v7 offset:8192
  ds_read_b128 v[68:71], v7 offset:9216
  s_waitcnt lgkmcnt(4)
  v_mfma_f32_16x16x32_bf16 v[72:75], v[52:55], v[36:39], v[72:75]
  v_mfma_f32_16x16x32_bf16 v[92:95], v[52:55], v[40:43], v[92:95]
  v_mfma_f32_16x16x32_bf16 v[112:115], v[52:55], v[44:47], v[112:115]
  v_mfma_f32_16x16x32_bf16 v[132:135], v[52:55], v[48:51], v[132:135]
  s_waitcnt lgkmcnt(3)
  v_mfma_f32_16x16x32_bf16 v[76:79], v[56:59], v[36:39], v[76:79]
  v_mfma_f32_16x16x32_bf16 v[96:99], v[56:59], v[40:43], v[96:99]
  v_mfma_f32_16x16x32_bf16 v[116:119], v[56:59], v[44:47], v[116:119]
  v_mfma_f32_16x16x32_bf16 v[136:139], v[56:59], v[48:51], v[136:139]
  s_waitcnt lgkmcnt(2)
  v_mfma_f32_16x16x32_bf16 v[80:83], v[60:63], v[36:39], v[80:83]
  v_mfma_f32_16x16x32_bf16 v[100:103], v[60:63], v[40:43], v[100:103]
  v_mfma_f32_16x16x32_bf16 v[120:123], v[60:63], v[44:47], v[120:123]
  v_mfma_f32_16x16x32_bf16 v[140:143], v[60:63], v[48:51], v[140:143]
  s_waitcnt lgkmcnt(1)
  v_mfma_f32_16x16x32_bf16 v[84:87], v[64:67], v[36:39], v[84:87]
  v_mfma_f32_16x16x32_bf16 v[104:107], v[64:67], v[40:43], v[104:107]
  v_mfma_f32_16x16x32_bf16 v[124:127], v[64:67], v[44:47], v[124:127]
  v_mfma_f32_16x16x32_bf16 v[144:147], v[64:67], v[48:51], v[144:147]
  s_waitcnt lgkmcnt(0)
  s_add_u32 m0, s38, 29696
  s_mov_b32 s60, 4096
  buffer_load_dwordx4 v6, s[8:11], s60 offen sc1 lds
  s_add_u32 m0, s38, 30720
  s_mov_b32 s60, 53248
  buffer_load_dwordx4 v6, s[8:11], s60 offen sc1 lds
  s_add_u32 m0, s38, 31744
  s_mov_b32 s60, 102400
  buffer_load_dwordx4 v6, s[8:11], s60 offen sc1 lds
  s_add_u32 m0, s38, 32768
  s_mov_b32 s60, 151552
  buffer_load_dwordx4 v6, s[8:11], s60 offen sc1 lds
  s_add_u32 m0, s38, 33792
  s_mov_b32 s60, 200704
  buffer_load_dwordx4 v6, s[8:11], s60 offen sc1 lds
  s_add_u32 m0, s38, 4096
  s_mov_b32 s60, 917504
  buffer_load_dwordx4 v4, s[40:43], s60 offen lds
  s_add_u32 m0, s38, 5120
  s_mov_b32 s60, 917504
  buffer_load_dwordx4 v5, s[40:43], s60 offen lds
  s_add_u32 m0, s38, 6144
  s_mov_b32 s60, 983040
  buffer_load_dwordx4 v4, s[40:43], s60 offen lds
  s_add_u32 m0, s38, 7168
  s_mov_b32 s60, 983040
  buffer_load_dwordx4 v5, s[40:43], s60 offen lds
  v_mfma_f32_16x16x32_bf16 v[88:91], v[68:71], v[36:39], v[88:91]
  v_mfma_f32_16x16x32_bf16 v[108:111], v[68:71], v[40:43], v[108:111]
  v_mfma_f32_16x16x32_bf16 v[128:131], v[68:71], v[44:47], v[128:131]
  v_mfma_f32_16x16x32_bf16 v[148:151], v[68:71], v[48:51], v[148:151]
  s_waitcnt vmcnt(21)
  ds_read_b64_tr_b16 v[36:37], v8 offset:8192
  ds_read_b64_tr_b16 v[38:39], v8 offset:8704
  ds_read_b64_tr_b16 v[40:41], v9 offset:8192
  ds_read_b64_tr_b16 v[42:43], v9 offset:8704
  ds_read_b64_tr_b16 v[44:45], v10 offset:8192
  ds_read_b64_tr_b16 v[46:47], v10 offset:8704
  ds_read_b64_tr_b16 v[48:49], v11 offset:8192
  ds_read_b64_tr_b16 v[50:51], v11 offset:8704
  ds_read_b128 v[52:55], v7 offset:10240
  ds_read_b128 v[56:59], v7 offset:11264
  ds_read_b128 v[60:63], v7 offset:12288
  ds_read_b128 v[64:67], v7 offset:13312
  ds_read_b128 v[68:71], v7 offset:14336
  s_waitcnt lgkmcnt(4)
  v_mfma_f32_16x16x32_bf16 v[72:75], v[52:55], v[36:39], v[72:75]
  v_mfma_f32_16x16x32_bf16 v[92:95], v[52:55], v[40:43], v[92:95]
  v_mfma_f32_16x16x32_bf16 v[112:115], v[52:55], v[44:47], v[112:115]
  v_mfma_f32_16x16x32_bf16 v[132:135], v[52:55], v[48:51], v[132:135]
  s_waitcnt lgkmcnt(3)
  v_mfma_f32_16x16x32_bf16 v[76:79], v[56:59], v[36:39], v[76:79]
  v_mfma_f32_16x16x32_bf16 v[96:99], v[56:59], v[40:43], v[96:99]
  v_mfma_f32_16x16x32_bf16 v[116:119], v[56:59], v[44:47], v[116:119]
  v_mfma_f32_16x16x32_bf16 v[136:139], v[56:59], v[48:51], v[136:139]
  s_waitcnt lgkmcnt(2)
  v_mfma_f32_16x16x32_bf16 v[80:83], v[60:63], v[36:39], v[80:83]
  v_mfma_f32_16x16x32_bf16 v[100:103], v[60:63], v[40:43], v[100:103]
  v_mfma_f32_16x16x32_bf16 v[120:123], v[60:63], v[44:47], v[120:123]
  v_mfma_f32_16x16x32_bf16 v[140:143], v[60:63], v[48:51], v[140:143]
  s_waitcnt lgkmcnt(1)
  v_mfma_f32_16x16x32_bf16 v[84:87], v[64:67], v[36:39], v[84:87]
  v_mfma_f32_16x16x32_bf16 v[104:107], v[64:67], v[40:43], v[104:107]
  v_mfma_f32_16x16x32_bf16 v[124:127], v[64:67], v[44:47], v[124:127]
  v_mfma_f32_16x16x32_bf16 v[144:147], v[64:67], v[48:51], v[144:147]
  s_waitcnt lgkmcnt(0)
  s_add_u32 m0, s38, 34816
  s_mov_b32 s60, 5120
  buffer_load_dwordx4 v6, s[8:11], s60 offen sc1 lds
  s_add_u32 m0, s38, 35840
  s_mov_b32 s60, 54272
  buffer_load_dwordx4 v6, s[8:11], s60 offen sc1 lds
  s_add_u32 m0, s38, 36864
  s_mov_b32 s60, 103424
  buffer_load_dwordx4 v6, s[8:11], s60 offen sc1 lds
  s_add_u32 m0, s38, 37888
  s_mov_b32 s60, 152576
  buffer_load_dwordx4 v6, s[8:11], s60 offen sc1 lds
  s_add_u32 m0, s38, 38912
  s_mov_b32 s60, 201728
  buffer_load_dwordx4 v6, s[8:11], s60 offen sc1 lds
  s_add_u32 m0, s38, 8192
  s_mov_b32 s60, 1048576
  buffer_load_dwordx4 v4, s[40:43], s60 offen lds
  s_add_u32 m0, s38, 9216
  s_mov_b32 s60, 1048576
  buffer_load_dwordx4 v5, s[40:43], s60 offen lds
  s_add_u32 m0, s38, 10240
  s_mov_b32 s60, 1114112
  buffer_load_dwordx4 v4, s[40:43], s60 offen lds
  s_add_u32 m0, s38, 11264
  s_mov_b32 s60, 1114112
  buffer_load_dwordx4 v5, s[40:43], s60 offen lds
  v_mfma_f32_16x16x32_bf16 v[88:91], v[68:71], v[36:39], v[88:91]
  v_mfma_f32_16x16x32_bf16 v[108:111], v[68:71], v[40:43], v[108:111]
  v_mfma_f32_16x16x32_bf16 v[128:131], v[68:71], v[44:47], v[128:131]
  v_mfma_f32_16x16x32_bf16 v[148:151], v[68:71], v[48:51], v[148:151]
  s_waitcnt vmcnt(22)
  ds_read_b64_tr_b16 v[36:37], v8 offset:12288
  ds_read_b64_tr_b16 v[38:39], v8 offset:12800
  ds_read_b64_tr_b16 v[40:41], v9 offset:12288
  ds_read_b64_tr_b16 v[42:43], v9 offset:12800
  ds_read_b64_tr_b16 v[44:45], v10 offset:12288
  ds_read_b64_tr_b16 v[46:47], v10 offset:12800
  ds_read_b64_tr_b16 v[48:49], v11 offset:12288
  ds_read_b64_tr_b16 v[50:51], v11 offset:12800
  ds_read_b128 v[52:55], v7 offset:0
  ds_read_b128 v[56:59], v7 offset:1024
  ds_read_b128 v[60:63], v7 offset:2048
  ds_read_b128 v[64:67], v7 offset:3072
  ds_read_b128 v[68:71], v7 offset:4096
  s_waitcnt lgkmcnt(4)
  v_mfma_f32_16x16x32_bf16 v[72:75], v[52:55], v[36:39], v[72:75]
  v_mfma_f32_16x16x32_bf16 v[92:95], v[52:55], v[40:43], v[92:95]
  v_mfma_f32_16x16x32_bf16 v[112:115], v[52:55], v[44:47], v[112:115]
  v_mfma_f32_16x16x32_bf16 v[132:135], v[52:55], v[48:51], v[132:135]
  s_waitcnt lgkmcnt(3)
  v_mfma_f32_16x16x32_bf16 v[76:79], v[56:59], v[36:39], v[76:79]
  v_mfma_f32_16x16x32_bf16 v[96:99], v[56:59], v[40:43], v[96:99]
  v_mfma_f32_16x16x32_bf16 v[116:119], v[56:59], v[44:47], v[116:119]
  v_mfma_f32_16x16x32_bf16 v[136:139], v[56:59], v[48:51], v[136:139]
  s_waitcnt lgkmcnt(2)
  v_mfma_f32_16x16x32_bf16 v[80:83], v[60:63], v[36:39], v[80:83]
  v_mfma_f32_16x16x32_bf16 v[100:103], v[60:63], v[40:43], v[100:103]
  v_mfma_f32_16x16x32_bf16 v[120:123], v[60:63], v[44:47], v[120:123]
  v_mfma_f32_16x16x32_bf16 v[140:143], v[60:63], v[48:51], v[140:143]
  s_waitcnt lgkmcnt(1)
  v_mfma_f32_16x16x32_bf16 v[84:87], v[64:67], v[36:39], v[84:87]
  v_mfma_f32_16x16x32_bf16 v[104:107], v[64:67], v[40:43], v[104:107]
  v_mfma_f32_16x16x32_bf16 v[124:127], v[64:67], v[44:47], v[124:127]
  v_mfma_f32_16x16x32_bf16 v[144:147], v[64:67], v[48:51], v[144:147]
  s_waitcnt lgkmcnt(0)
  s_add_u32 m0, s38, 24576
  s_mov_b32 s60, 6144
  buffer_load_dwordx4 v6, s[8:11], s60 offen sc1 lds
  s_add_u32 m0, s38, 25600
  s_mov_b32 s60, 55296
  buffer_load_dwordx4 v6, s[8:11], s60 offen sc1 lds
  s_add_u32 m0, s38, 26624
  s_mov_b32 s60, 104448
  buffer_load_dwordx4 v6, s[8:11], s60 offen sc1 lds
  s_add_u32 m0, s38, 27648
  s_mov_b32 s60, 153600
  buffer_load_dwordx4 v6, s[8:11], s60 offen sc1 lds
  s_add_u32 m0, s38, 28672
  s_mov_b32 s60, 202752
  buffer_load_dwordx4 v6, s[8:11], s60 offen sc1 lds
  s_add_u32 m0, s38, 12288
  s_mov_b32 s60, 1179648
  buffer_load_dwordx4 v4, s[40:43], s60 offen lds
  s_add_u32 m0, s38, 13312
  s_mov_b32 s60, 1179648
  buffer_load_dwordx4 v5, s[40:43], s60 offen lds
  s_add_u32 m0, s38, 14336
  s_mov_b32 s60, 1245184
  buffer_load_dwordx4 v4, s[40:43], s60 offen lds
  s_add_u32 m0, s38, 15360
  s_mov_b32 s60, 1245184
  buffer_load_dwordx4 v5, s[40:43], s60 offen lds
  v_mfma_f32_16x16x32_bf16 v[88:91], v[68:71], v[36:39], v[88:91]
  v_mfma_f32_16x16x32_bf16 v[108:111], v[68:71], v[40:43], v[108:111]
  v_mfma_f32_16x16x32_bf16 v[128:131], v[68:71], v[44:47], v[128:131]
  v_mfma_f32_16x16x32_bf16 v[148:151], v[68:71], v[48:51], v[148:151]
  s_waitcnt vmcnt(22)
  ds_read_b64_tr_b16 v[36:37], v8 offset:16384
  ds_read_b64_tr_b16 v[38:39], v8 offset:16896
  ds_read_b64_tr_b16 v[40:41], v9 offset:16384
  ds_read_b64_tr_b16 v[42:43], v9 offset:16896
  ds_read_b64_tr_b16 v[44:45], v10 offset:16384
  ds_read_b64_tr_b16 v[46:47], v10 offset:16896
  ds_read_b64_tr_b16 v[48:49], v11 offset:16384
  ds_read_b64_tr_b16 v[50:51], v11 offset:16896
  ds_read_b128 v[52:55], v7 offset:5120
  ds_read_b128 v[56:59], v7 offset:6144
  ds_read_b128 v[60:63], v7 offset:7168
  ds_read_b128 v[64:67], v7 offset:8192
  ds_read_b128 v[68:71], v7 offset:9216
  s_waitcnt lgkmcnt(4)
  v_mfma_f32_16x16x32_bf16 v[72:75], v[52:55], v[36:39], v[72:75]
  v_mfma_f32_16x16x32_bf16 v[92:95], v[52:55], v[40:43], v[92:95]
  v_mfma_f32_16x16x32_bf16 v[112:115], v[52:55], v[44:47], v[112:115]
  v_mfma_f32_16x16x32_bf16 v[132:135], v[52:55], v[48:51], v[132:135]
  s_waitcnt lgkmcnt(3)
  v_mfma_f32_16x16x32_bf16 v[76:79], v[56:59], v[36:39], v[76:79]
  v_mfma_f32_16x16x32_bf16 v[96:99], v[56:59], v[40:43], v[96:99]
  v_mfma_f32_16x16x32_bf16 v[116:119], v[56:59], v[44:47], v[116:119]
  v_mfma_f32_16x16x32_bf16 v[136:139], v[56:59], v[48:51], v[136:139]
  s_waitcnt lgkmcnt(2)
  v_mfma_f32_16x16x32_bf16 v[80:83], v[60:63], v[36:39], v[80:83]
  v_mfma_f32_16x16x32_bf16 v[100:103], v[60:63], v[40:43], v[100:103]
  v_mfma_f32_16x16x32_bf16 v[120:123], v[60:63], v[44:47], v[120:123]
  v_mfma_f32_16x16x32_bf16 v[140:143], v[60:63], v[48:51], v[140:143]
  s_waitcnt lgkmcnt(1)
  v_mfma_f32_16x16x32_bf16 v[84:87], v[64:67], v[36:39], v[84:87]
  v_mfma_f32_16x16x32_bf16 v[104:107], v[64:67], v[40:43], v[104:107]
  v_mfma_f32_16x16x32_bf16 v[124:127], v[64:67], v[44:47], v[124:127]
  v_mfma_f32_16x16x32_bf16 v[144:147], v[64:67], v[48:51], v[144:147]
  s_waitcnt lgkmcnt(0)
  s_add_u32 m0, s38, 29696
  s_mov_b32 s60, 7168
  buffer_load_dwordx4 v6, s[8:11], s60 offen sc1 lds
  s_add_u32 m0, s38, 30720
  s_mov_b32 s60, 56320
  buffer_load_dwordx4 v6, s[8:11], s60 offen sc1 lds
  s_add_u32 m0, s38, 31744
  s_mov_b32 s60, 105472
  buffer_load_dwordx4 v6, s[8:11], s60 offen sc1 lds
  s_add_u32 m0, s38, 32768
  s_mov_b32 s60, 154624
  buffer_load_dwordx4 v6, s[8:11], s60 offen sc1 lds
  s_add_u32 m0, s38, 33792
  s_mov_b32 s60, 203776
  buffer_load_dwordx4 v6, s[8:11], s60 offen sc1 lds
  s_add_u32 m0, s38, 16384
  s_mov_b32 s60, 1310720
  buffer_load_dwordx4 v4, s[40:43], s60 offen lds
  s_add_u32 m0, s38, 17408
  s_mov_b32 s60, 1310720
  buffer_load_dwordx4 v5, s[40:43], s60 offen lds
  s_add_u32 m0, s38, 18432
  s_mov_b32 s60, 1376256
  buffer_load_dwordx4 v4, s[40:43], s60 offen lds
  s_add_u32 m0, s38, 19456
  s_mov_b32 s60, 1376256
  buffer_load_dwordx4 v5, s[40:43], s60 offen lds
  v_mfma_f32_16x16x32_bf16 v[88:91], v[68:71], v[36:39], v[88:91]
  v_mfma_f32_16x16x32_bf16 v[108:111], v[68:71], v[40:43], v[108:111]
  v_mfma_f32_16x16x32_bf16 v[128:131], v[68:71], v[44:47], v[128:131]
  v_mfma_f32_16x16x32_bf16 v[148:151], v[68:71], v[48:51], v[148:151]
  s_waitcnt vmcnt(22)
  ds_read_b64_tr_b16 v[36:37], v8 offset:20480
  ds_read_b64_tr_b16 v[38:39], v8 offset:20992
  ds_read_b64_tr_b16 v[40:41], v9 offset:20480
  ds_read_b64_tr_b16 v[42:43], v9 offset:20992
  ds_read_b64_tr_b16 v[44:45], v10 offset:20480
  ds_read_b64_tr_b16 v[46:47], v10 offset:20992
  ds_read_b64_tr_b16 v[48:49], v11 offset:20480
  ds_read_b64_tr_b16 v[50:51], v11 offset:20992
  ds_read_b128 v[52:55], v7 offset:10240
  ds_read_b128 v[56:59], v7 offset:11264
  ds_read_b128 v[60:63], v7 offset:12288
  ds_read_b128 v[64:67], v7 offset:13312
  ds_read_b128 v[68:71], v7 offset:14336
  s_waitcnt lgkmcnt(4)
  v_mfma_f32_16x16x32_bf16 v[72:75], v[52:55], v[36:39], v[72:75]
  v_mfma_f32_16x16x32_bf16 v[92:95], v[52:55], v[40:43], v[92:95]
  v_mfma_f32_16x16x32_bf16 v[112:115], v[52:55], v[44:47], v[112:115]
  v_mfma_f32_16x16x32_bf16 v[132:135], v[52:55], v[48:51], v[132:135]
  s_waitcnt lgkmcnt(3)
  v_mfma_f32_16x16x32_bf16 v[76:79], v[56:59], v[36:39], v[76:79]
  v_mfma_f32_16x16x32_bf16 v[96:99], v[56:59], v[40:43], v[96:99]
  v_mfma_f32_16x16x32_bf16 v[116:119], v[56:59], v[44:47], v[116:119]
  v_mfma_f32_16x16x32_bf16 v[136:139], v[56:59], v[48:51], v[136:139]
  s_waitcnt lgkmcnt(2)
  v_mfma_f32_16x16x32_bf16 v[80:83], v[60:63], v[36:39], v[80:83]
  v_mfma_f32_16x16x32_bf16 v[100:103], v[60:63], v[40:43], v[100:103]
  v_mfma_f32_16x16x32_bf16 v[120:123], v[60:63], v[44:47], v[120:123]
  v_mfma_f32_16x16x32_bf16 v[140:143], v[60:63], v[48:51], v[140:143]
  s_waitcnt lgkmcnt(1)
  v_mfma_f32_16x16x32_bf16 v[84:87], v[64:67], v[36:39], v[84:87]
  v_mfma_f32_16x16x32_bf16 v[104:107], v[64:67], v[40:43], v[104:107]
  v_mfma_f32_16x16x32_bf16 v[124:127], v[64:67], v[44:47], v[124:127]
  v_mfma_f32_16x16x32_bf16 v[144:147], v[64:67], v[48:51], v[144:147]
  s_waitcnt lgkmcnt(0)
  s_add_u32 m0, s38, 34816
  s_mov_b32 s60, 8192
  buffer_load_dwordx4 v6, s[8:11], s60 offen sc1 lds
  s_add_u32 m0, s38, 35840
  s_mov_b32 s60, 57344
  buffer_load_dwordx4 v6, s[8:11], s60 offen sc1 lds
  s_add_u32 m0, s38, 36864
  s_mov_b32 s60, 106496
  buffer_load_dwordx4 v6, s[8:11], s60 offen sc1 lds
  s_add_u32 m0, s38, 37888
  s_mov_b32 s60, 155648
  buffer_load_dwordx4 v6, s[8:11], s60 offen sc1 lds
  s_add_u32 m0, s38, 38912
  s_mov_b32 s60, 204800
  buffer_load_dwordx4 v6, s[8:11], s60 offen sc1 lds
  s_add_u32 m0, s38, 20480
  s_mov_b32 s60, 1441792
  buffer_load_dwordx4 v4, s[40:43], s60 offen lds
  s_add_u32 m0, s38, 21504
  s_mov_b32 s60, 1441792
  buffer_load_dwordx4 v5, s[40:43], s60 offen lds
  s_add_u32 m0, s38, 22528
  s_mov_b32 s60, 1507328
  buffer_load_dwordx4 v4, s[40:43], s60 offen lds
  s_add_u32 m0, s38, 23552
  s_mov_b32 s60, 1507328
  buffer_load_dwordx4 v5, s[40:43], s60 offen lds
  v_mfma_f32_16x16x32_bf16 v[88:91], v[68:71], v[36:39], v[88:91]
  v_mfma_f32_16x16x32_bf16 v[108:111], v[68:71], v[40:43], v[108:111]
  v_mfma_f32_16x16x32_bf16 v[128:131], v[68:71], v[44:47], v[128:131]
  v_mfma_f32_16x16x32_bf16 v[148:151], v[68:71], v[48:51], v[148:151]
  s_waitcnt vmcnt(22)
  ds_read_b64_tr_b16 v[36:37], v8 offset:0
  ds_read_b64_tr_b16 v[38:39], v8 offset:512
  ds_read_b64_tr_b16 v[40:41], v9 offset:0
  ds_read_b64_tr_b16 v[42:43], v9 offset:512
  ds_read_b64_tr_b16 v[44:45], v10 offset:0
  ds_read_b64_tr_b16 v[46:47], v10 offset:512
  ds_read_b64_tr_b16 v[48:49], v11 offset:0
  ds_read_b64_tr_b16 v[50:51], v11 offset:512
  ds_read_b128 v[52:55], v7 offset:0
  ds_read_b128 v[56:59], v7 offset:1024
  ds_read_b128 v[60:63], v7 offset:2048
  ds_read_b128 v[64:67], v7 offset:3072
  ds_read_b128 v[68:71], v7 offset:4096
  s_waitcnt lgkmcnt(4)
  v_mfma_f32_16x16x32_bf16 v[72:75], v[52:55], v[36:39], v[72:75]
  v_mfma_f32_16x16x32_bf16 v[92:95], v[52:55], v[40:43], v[92:95]
  v_mfma_f32_16x16x32_bf16 v[112:115], v[52:55], v[44:47], v[112:115]
  v_mfma_f32_16x16x32_bf16 v[132:135], v[52:55], v[48:51], v[132:135]
  s_waitcnt lgkmcnt(3)
  v_mfma_f32_16x16x32_bf16 v[76:79], v[56:59], v[36:39], v[76:79]
  v_mfma_f32_16x16x32_bf16 v[96:99], v[56:59], v[40:43], v[96:99]
  v_mfma_f32_16x16x32_bf16 v[116:119], v[56:59], v[44:47], v[116:119]
  v_mfma_f32_16x16x32_bf16 v[136:139], v[56:59], v[48:51], v[136:139]
  s_waitcnt lgkmcnt(2)
  v_mfma_f32_16x16x32_bf16 v[80:83], v[60:63], v[36:39], v[80:83]
  v_mfma_f32_16x16x32_bf16 v[100:103], v[60:63], v[40:43], v[100:103]
  v_mfma_f32_16x16x32_bf16 v[120:123], v[60:63], v[44:47], v[120:123]
  v_mfma_f32_16x16x32_bf16 v[140:143], v[60:63], v[48:51], v[140:143]
  s_waitcnt lgkmcnt(1)
  v_mfma_f32_16x16x32_bf16 v[84:87], v[64:67], v[36:39], v[84:87]
  v_mfma_f32_16x16x32_bf16 v[104:107], v[64:67], v[40:43], v[104:107]
  v_mfma_f32_16x16x32_bf16 v[124:127], v[64:67], v[44:47], v[124:127]
  v_mfma_f32_16x16x32_bf16 v[144:147], v[64:67], v[48:51], v[144:147]
  s_waitcnt lgkmcnt(0)
  s_add_u32 m0, s38, 24576
  s_mov_b32 s60, 9216
  buffer_load_dwordx4 v6, s[8:11], s60 offen sc1 lds
  s_add_u32 m0, s38, 25600
  s_mov_b32 s60, 58368
  buffer_load_dwordx4 v6, s[8:11], s60 offen sc1 lds
  s_add_u32 m0, s38, 26624
  s_mov_b32 s60, 107520
  buffer_load_dwordx4 v6, s[8:11], s60 offen sc1 lds
  s_add_u32 m0, s38, 27648
  s_mov_b32 s60, 156672
  buffer_load_dwordx4 v6, s[8:11], s60 offen sc1 lds
  s_add_u32 m0, s38, 28672
  s_mov_b32 s60, 205824
  buffer_load_dwordx4 v6, s[8:11], s60 offen sc1 lds
  v_mfma_f32_16x16x32_bf16 v[88:91], v[68:71], v[36:39], v[88:91]
  v_mfma_f32_16x16x32_bf16 v[108:111], v[68:71], v[40:43], v[108:111]
  v_mfma_f32_16x16x32_bf16 v[128:131], v[68:71], v[44:47], v[128:131]
  v_mfma_f32_16x16x32_bf16 v[148:151], v[68:71], v[48:51], v[148:151]
  s_waitcnt vmcnt(18)
  ds_read_b64_tr_b16 v[36:37], v8 offset:4096
  ds_read_b64_tr_b16 v[38:39], v8 offset:4608
  ds_read_b64_tr_b16 v[40:41], v9 offset:4096
  ds_read_b64_tr_b16 v[42:43], v9 offset:4608
  ds_read_b64_tr_b16 v[44:45], v10 offset:4096
  ds_read_b64_tr_b16 v[46:47], v10 offset:4608
  ds_read_b64_tr_b16 v[48:49], v11 offset:4096
  ds_read_b64_tr_b16 v[50:51], v11 offset:4608
  ds_read_b128 v[52:55], v7 offset:5120
  ds_read_b128 v[56:59], v7 offset:6144
  ds_read_b128 v[60:63], v7 offset:7168
  ds_read_b128 v[64:67], v7 offset:8192
  ds_read_b128 v[68:71], v7 offset:9216
  s_waitcnt lgkmcnt(4)
  v_mfma_f32_16x16x32_bf16 v[72:75], v[52:55], v[36:39], v[72:75]
  v_mfma_f32_16x16x32_bf16 v[92:95], v[52:55], v[40:43], v[92:95]
  v_mfma_f32_16x16x32_bf16 v[112:115], v[52:55], v[44:47], v[112:115]
  v_mfma_f32_16x16x32_bf16 v[132:135], v[52:55], v[48:51], v[132:135]
  s_waitcnt lgkmcnt(3)
  v_mfma_f32_16x16x32_bf16 v[76:79], v[56:59], v[36:39], v[76:79]
  v_mfma_f32_16x16x32_bf16 v[96:99], v[56:59], v[40:43], v[96:99]
  v_mfma_f32_16x16x32_bf16 v[116:119], v[56:59], v[44:47], v[116:119]
  v_mfma_f32_16x16x32_bf16 v[136:139], v[56:59], v[48:51], v[136:139]
  s_waitcnt lgkmcnt(2)
  v_mfma_f32_16x16x32_bf16 v[80:83], v[60:63], v[36:39], v[80:83]
  v_mfma_f32_16x16x32_bf16 v[100:103], v[60:63], v[40:43], v[100:103]
  v_mfma_f32_16x16x32_bf16 v[120:123], v[60:63], v[44:47], v[120:123]
  v_mfma_f32_16x16x32_bf16 v[140:143], v[60:63], v[48:51], v[140:143]
  s_waitcnt lgkmcnt(1)
  v_mfma_f32_16x16x32_bf16 v[84:87], v[64:67], v[36:39], v[84:87]
  v_mfma_f32_16x16x32_bf16 v[104:107], v[64:67], v[40:43], v[104:107]
  v_mfma_f32_16x16x32_bf16 v[124:127], v[64:67], v[44:47], v[124:127]
  v_mfma_f32_16x16x32_bf16 v[144:147], v[64:67], v[48:51], v[144:147]
  s_waitcnt lgkmcnt(0)
  s_add_u32 m0, s38, 29696
  s_mov_b32 s60, 10240
  buffer_load_dwordx4 v6, s[8:11], s60 offen sc1 lds
  s_add_u32 m0, s38, 30720
  s_mov_b32 s60, 59392
  buffer_load_dwordx4 v6, s[8:11], s60 offen sc1 lds
  s_add_u32 m0, s38, 31744
  s_mov_b32 s60, 108544
  buffer_load_dwordx4 v6, s[8:11], s60 offen sc1 lds
  s_add_u32 m0, s38, 32768
  s_mov_b32 s60, 157696
  buffer_load_dwordx4 v6, s[8:11], s60 offen sc1 lds
  s_add_u32 m0, s38, 33792
  s_mov_b32 s60, 206848
  buffer_load_dwordx4 v6, s[8:11], s60 offen sc1 lds
  v_mfma_f32_16x16x32_bf16 v[88:91], v[68:71], v[36:39], v[88:91]
  v_mfma_f32_16x16x32_bf16 v[108:111], v[68:71], v[40:43], v[108:111]
  v_mfma_f32_16x16x32_bf16 v[128:131], v[68:71], v[44:47], v[128:131]
  v_mfma_f32_16x16x32_bf16 v[148:151], v[68:71], v[48:51], v[148:151]
  s_waitcnt vmcnt(14)
  ds_read_b64_tr_b16 v[36:37], v8 offset:8192
  ds_read_b64_tr_b16 v[38:39], v8 offset:8704
  ds_read_b64_tr_b16 v[40:41], v9 offset:8192
  ds_read_b64_tr_b16 v[42:43], v9 offset:8704
  ds_read_b64_tr_b16 v[44:45], v10 offset:8192
  ds_read_b64_tr_b16 v[46:47], v10 offset:8704
  ds_read_b64_tr_b16 v[48:49], v11 offset:8192
  ds_read_b64_tr_b16 v[50:51], v11 offset:8704
  ds_read_b128 v[52:55], v7 offset:10240
  ds_read_b128 v[56:59], v7 offset:11264
  ds_read_b128 v[60:63], v7 offset:12288
  ds_read_b128 v[64:67], v7 offset:13312
  ds_read_b128 v[68:71], v7 offset:14336
  s_waitcnt lgkmcnt(4)
  v_mfma_f32_16x16x32_bf16 v[72:75], v[52:55], v[36:39], v[72:75]
  v_mfma_f32_16x16x32_bf16 v[92:95], v[52:55], v[40:43], v[92:95]
  v_mfma_f32_16x16x32_bf16 v[112:115], v[52:55], v[44:47], v[112:115]
  v_mfma_f32_16x16x32_bf16 v[132:135], v[52:55], v[48:51], v[132:135]
  s_waitcnt lgkmcnt(3)
  v_mfma_f32_16x16x32_bf16 v[76:79], v[56:59], v[36:39], v[76:79]
  v_mfma_f32_16x16x32_bf16 v[96:99], v[56:59], v[40:43], v[96:99]
  v_mfma_f32_16x16x32_bf16 v[116:119], v[56:59], v[44:47], v[116:119]
  v_mfma_f32_16x16x32_bf16 v[136:139], v[56:59], v[48:51], v[136:139]
  s_waitcnt lgkmcnt(2)
  v_mfma_f32_16x16x32_bf16 v[80:83], v[60:63], v[36:39], v[80:83]
  v_mfma_f32_16x16x32_bf16 v[100:103], v[60:63], v[40:43], v[100:103]
  v_mfma_f32_16x16x32_bf16 v[120:123], v[60:63], v[44:47], v[120:123]
  v_mfma_f32_16x16x32_bf16 v[140:143], v[60:63], v[48:51], v[140:143]
  s_waitcnt lgkmcnt(1)
  v_mfma_f32_16x16x32_bf16 v[84:87], v[64:67], v[36:39], v[84:87]
  v_mfma_f32_16x16x32_bf16 v[104:107], v[64:67], v[40:43], v[104:107]
  v_mfma_f32_16x16x32_bf16 v[124:127], v[64:67], v[44:47], v[124:127]
  v_mfma_f32_16x16x32_bf16 v[144:147], v[64:67], v[48:51], v[144:147]
  s_waitcnt lgkmcnt(0)
  s_add_u32 m0, s38, 34816
  s_mov_b32 s60, 11264
  buffer_load_dwordx4 v6, s[8:11], s60 offen sc1 lds
  s_add_u32 m0, s38, 35840
  s_mov_b32 s60, 60416
  buffer_load_dwordx4 v6, s[8:11], s60 offen sc1 lds
  s_add_u32 m0, s38, 36864
  s_mov_b32 s60, 109568
  buffer_load_dwordx4 v6, s[8:11], s60 offen sc1 lds
  s_add_u32 m0, s38, 37888
  s_mov_b32 s60, 158720
  buffer_load_dwordx4 v6, s[8:11], s60 offen sc1 lds
  s_add_u32 m0, s38, 38912
  s_mov_b32 s60, 207872
  buffer_load_dwordx4 v6, s[8:11], s60 offen sc1 lds
  v_mfma_f32_16x16x32_bf16 v[88:91], v[68:71], v[36:39], v[88:91]
  v_mfma_f32_16x16x32_bf16 v[108:111], v[68:71], v[40:43], v[108:111]
  v_mfma_f32_16x16x32_bf16 v[128:131], v[68:71], v[44:47], v[128:131]
  v_mfma_f32_16x16x32_bf16 v[148:151], v[68:71], v[48:51], v[148:151]
  s_waitcnt vmcnt(10)
  ds_read_b64_tr_b16 v[36:37], v8 offset:12288
  ds_read_b64_tr_b16 v[38:39], v8 offset:12800
  ds_read_b64_tr_b16 v[40:41], v9 offset:12288
  ds_read_b64_tr_b16 v[42:43], v9 offset:12800
  ds_read_b64_tr_b16 v[44:45], v10 offset:12288
  ds_read_b64_tr_b16 v[46:47], v10 offset:12800
  ds_read_b64_tr_b16 v[48:49], v11 offset:12288
  ds_read_b64_tr_b16 v[50:51], v11 offset:12800
  ds_read_b128 v[52:55], v7 offset:0
  ds_read_b128 v[56:59], v7 offset:1024
  ds_read_b128 v[60:63], v7 offset:2048
  ds_read_b128 v[64:67], v7 offset:3072
  ds_read_b128 v[68:71], v7 offset:4096
  s_waitcnt lgkmcnt(4)
  v_mfma_f32_16x16x32_bf16 v[72:75], v[52:55], v[36:39], v[72:75]
  v_mfma_f32_16x16x32_bf16 v[92:95], v[52:55], v[40:43], v[92:95]
  v_mfma_f32_16x16x32_bf16 v[112:115], v[52:55], v[44:47], v[112:115]
  v_mfma_f32_16x16x32_bf16 v[132:135], v[52:55], v[48:51], v[132:135]
  s_waitcnt lgkmcnt(3)
  v_mfma_f32_16x16x32_bf16 v[76:79], v[56:59], v[36:39], v[76:79]
  v_mfma_f32_16x16x32_bf16 v[96:99], v[56:59], v[40:43], v[96:99]
  v_mfma_f32_16x16x32_bf16 v[116:119], v[56:59], v[44:47], v[116:119]
  v_mfma_f32_16x16x32_bf16 v[136:139], v[56:59], v[48:51], v[136:139]
  s_waitcnt lgkmcnt(2)
  v_mfma_f32_16x16x32_bf16 v[80:83], v[60:63], v[36:39], v[80:83]
  v_mfma_f32_16x16x32_bf16 v[100:103], v[60:63], v[40:43], v[100:103]
  v_mfma_f32_16x16x32_bf16 v[120:123], v[60:63], v[44:47], v[120:123]
  v_mfma_f32_16x16x32_bf16 v[140:143], v[60:63], v[48:51], v[140:143]
  s_waitcnt lgkmcnt(1)
  v_mfma_f32_16x16x32_bf16 v[84:87], v[64:67], v[36:39], v[84:87]
  v_mfma_f32_16x16x32_bf16 v[104:107], v[64:67], v[40:43], v[104:107]
  v_mfma_f32_16x16x32_bf16 v[124:127], v[64:67], v[44:47], v[124:127]
  v_mfma_f32_16x16x32_bf16 v[144:147], v[64:67], v[48:51], v[144:147]
  s_waitcnt lgkmcnt(0)
  v_mfma_f32_16x16x32_bf16 v[88:91], v[68:71], v[36:39], v[88:91]
  v_mfma_f32_16x16x32_bf16 v[108:111], v[68:71], v[40:43], v[108:111]
  v_mfma_f32_16x16x32_bf16 v[128:131], v[68:71], v[44:47], v[128:131]
  v_mfma_f32_16x16x32_bf16 v[148:151], v[68:71], v[48:51], v[148:151]
  s_waitcnt vmcnt(5)
  ds_read_b64_tr_b16 v[36:37], v8 offset:16384
  ds_read_b64_tr_b16 v[38:39], v8 offset:16896
  ds_read_b64_tr_b16 v[40:41], v9 offset:16384
  ds_read_b64_tr_b16 v[42:43], v9 offset:16896
  ds_read_b64_tr_b16 v[44:45], v10 offset:16384
  ds_read_b64_tr_b16 v[46:47], v10 offset:16896
  ds_read_b64_tr_b16 v[48:49], v11 offset:16384
  ds_read_b64_tr_b16 v[50:51], v11 offset:16896
  ds_read_b128 v[52:55], v7 offset:5120
  ds_read_b128 v[56:59], v7 offset:6144
  ds_read_b128 v[60:63], v7 offset:7168
  ds_read_b128 v[64:67], v7 offset:8192
  ds_read_b128 v[68:71], v7 offset:9216
  s_waitcnt lgkmcnt(4)
  v_mfma_f32_16x16x32_bf16 v[72:75], v[52:55], v[36:39], v[72:75]
  v_mfma_f32_16x16x32_bf16 v[92:95], v[52:55], v[40:43], v[92:95]
  v_mfma_f32_16x16x32_bf16 v[112:115], v[52:55], v[44:47], v[112:115]
  v_mfma_f32_16x16x32_bf16 v[132:135], v[52:55], v[48:51], v[132:135]
  s_waitcnt lgkmcnt(3)
  v_mfma_f32_16x16x32_bf16 v[76:79], v[56:59], v[36:39], v[76:79]
  v_mfma_f32_16x16x32_bf16 v[96:99], v[56:59], v[40:43], v[96:99]
  v_mfma_f32_16x16x32_bf16 v[116:119], v[56:59], v[44:47], v[116:119]
  v_mfma_f32_16x16x32_bf16 v[136:139], v[56:59], v[48:51], v[136:139]
  s_waitcnt lgkmcnt(2)
  v_mfma_f32_16x16x32_bf16 v[80:83], v[60:63], v[36:39], v[80:83]
  v_mfma_f32_16x16x32_bf16 v[100:103], v[60:63], v[40:43], v[100:103]
  v_mfma_f32_16x16x32_bf16 v[120:123], v[60:63], v[44:47], v[120:123]
  v_mfma_f32_16x16x32_bf16 v[140:143], v[60:63], v[48:51], v[140:143]
  s_waitcnt lgkmcnt(1)
  v_mfma_f32_16x16x32_bf16 v[84:87], v[64:67], v[36:39], v[84:87]
  v_mfma_f32_16x16x32_bf16 v[104:107], v[64:67], v[40:43], v[104:107]
  v_mfma_f32_16x16x32_bf16 v[124:127], v[64:67], v[44:47], v[124:127]
  v_mfma_f32_16x16x32_bf16 v[144:147], v[64:67], v[48:51], v[144:147]
  s_waitcnt lgkmcnt(0)
  v_mfma_f32_16x16x32_bf16 v[88:91], v[68:71], v[36:39], v[88:91]
  v_mfma_f32_16x16x32_bf16 v[108:111], v[68:71], v[40:43], v[108:111]
  v_mfma_f32_16x16x32_bf16 v[128:131], v[68:71], v[44:47], v[128:131]
  v_mfma_f32_16x16x32_bf16 v[148:151], v[68:71], v[48:51], v[148:151]
  s_waitcnt vmcnt(0)
  ds_read_b64_tr_b16 v[36:37], v8 offset:20480
  ds_read_b64_tr_b16 v[38:39], v8 offset:20992
  ds_read_b64_tr_b16 v[40:41], v9 offset:20480
  ds_read_b64_tr_b16 v[42:43], v9 offset:20992
  ds_read_b64_tr_b16 v[44:45], v10 offset:20480
  ds_read_b64_tr_b16 v[46:47], v10 offset:20992
  ds_read_b64_tr_b16 v[48:49], v11 offset:20480
  ds_read_b64_tr_b16 v[50:51], v11 offset:20992
  ds_read_b128 v[52:55], v7 offset:10240
  ds_read_b128 v[56:59], v7 offset:11264
  ds_read_b128 v[60:63], v7 offset:12288
  ds_read_b128 v[64:67], v7 offset:13312
  ds_read_b128 v[68:71], v7 offset:14336
  s_waitcnt lgkmcnt(4)
  v_mfma_f32_16x16x32_bf16 v[72:75], v[52:55], v[36:39], v[72:75]
  v_mfma_f32_16x16x32_bf16 v[92:95], v[52:55], v[40:43], v[92:95]
  v_mfma_f32_16x16x32_bf16 v[112:115], v[52:55], v[44:47], v[112:115]
  v_mfma_f32_16x16x32_bf16 v[132:135], v[52:55], v[48:51], v[132:135]
  s_waitcnt lgkmcnt(3)
  v_mfma_f32_16x16x32_bf16 v[76:79], v[56:59], v[36:39], v[76:79]
  v_mfma_f32_16x16x32_bf16 v[96:99], v[56:59], v[40:43], v[96:99]
  v_mfma_f32_16x16x32_bf16 v[116:119], v[56:59], v[44:47], v[116:119]
  v_mfma_f32_16x16x32_bf16 v[136:139], v[56:59], v[48:51], v[136:139]
  s_waitcnt lgkmcnt(2)
  v_mfma_f32_16x16x32_bf16 v[80:83], v[60:63], v[36:39], v[80:83]
  v_mfma_f32_16x16x32_bf16 v[100:103], v[60:63], v[40:43], v[100:103]
  v_mfma_f32_16x16x32_bf16 v[120:123], v[60:63], v[44:47], v[120:123]
  v_mfma_f32_16x16x32_bf16 v[140:143], v[60:63], v[48:51], v[140:143]
  s_waitcnt lgkmcnt(1)
  v_mfma_f32_16x16x32_bf16 v[84:87], v[64:67], v[36:39], v[84:87]
  v_mfma_f32_16x16x32_bf16 v[104:107], v[64:67], v[40:43], v[104:107]
  v_mfma_f32_16x16x32_bf16 v[124:127], v[64:67], v[44:47], v[124:127]
  v_mfma_f32_16x16x32_bf16 v[144:147], v[64:67], v[48:51], v[144:147]
  s_waitcnt lgkmcnt(0)
  v_mfma_f32_16x16x32_bf16 v[88:91], v[68:71], v[36:39], v[88:91]
  v_mfma_f32_16x16x32_bf16 v[108:111], v[68:71], v[40:43], v[108:111]
  v_mfma_f32_16x16x32_bf16 v[128:131], v[68:71], v[44:47], v[128:131]
  v_mfma_f32_16x16x32_bf16 v[148:151], v[68:71], v[48:51], v[148:151]
  v_bfe_u32 v4, v2, 0, 4
  v_mul_u32_u24 v4, 336, v4
  v_bfe_u32 v1, v2, 4, 2
  v_mul_u32_u24 v1, 16, v1
  v_add_u32 v4, v4, v1
  s_mov_b32 s60, 0
  s_mul_i32 s63, s32, 21504
  s_add_u32 s60, s60, s63
  v_add_u32 v4, s60, v4
  s_mov_b32 s61, 0
  s_mul_i32 s63, s35, 327680
  s_add_u32 s61, s61, s63
  s_mul_i32 s63, s34, 10240
  s_add_u32 s61, s61, s63
  s_mul_i32 s63, s32, 2560
  s_add_u32 s61, s61, s63
  s_cmp_eq_u32 s65, 0
  s_cselect_b64 vcc, -1, 0
  v_add_u32 v1, s61, v21
  v_cndmask_b32 v12, v12, v1, vcc
  v_add_u32 v1, s61, v22
  v_cndmask_b32 v13, v13, v1, vcc
  v_add_u32 v1, s61, v23
  v_cndmask_b32 v14, v14, v1, vcc
  v_cmp_gt_u32 vcc, 32, v2
  v_mov_b32 v1, 2147483632
  s_nop 0
  v_cndmask_b32 v14, v1, v14, vcc
  s_barrier
  ds_write_b128 v4, v[72:75] offset:0
  ds_write_b128 v4, v[76:79] offset:64
  ds_write_b128 v4, v[80:83] offset:128
  ds_write_b128 v4, v[84:87] offset:192
  ds_write_b128 v4, v[88:91] offset:256
  ds_write_b128 v4, v[92:95] offset:5376
  ds_write_b128 v4, v[96:99] offset:5440
  ds_write_b128 v4, v[100:103] offset:5504
  ds_write_b128 v4, v[104:107] offset:5568
  ds_write_b128 v4, v[108:111] offset:5632
  s_waitcnt lgkmcnt(0)
  ds_write_b128 v4, v[112:115] offset:10752
  ds_write_b128 v4, v[116:119] offset:10816
  ds_write_b128 v4, v[120:123] offset:10880
  ds_write_b128 v4, v[124:127] offset:10944
  ds_write_b128 v4, v[128:131] offset:11008
  ds_write_b128 v4, v[132:135] offset:16128
  ds_write_b128 v4, v[136:139] offset:16192
  ds_write_b128 v4, v[140:143] offset:16256
  ds_write_b128 v4, v[144:147] offset:16320
  ds_write_b128 v4, v[148:151] offset:16384
  s_waitcnt lgkmcnt(0)
  s_barrier
  s_mov_b32 s36, 0xffff0000
  ds_read_b128 v[36:39], v15 offset:0
  ds_read_b128 v[40:43], v15 offset:16
  ds_read_b128 v[44:47], v15 offset:21504
  ds_read_b128 v[48:51], v15 offset:21520
  ds_read_b128 v[52:55], v15 offset:43008
  ds_read_b128 v[56:59], v15 offset:43024
  ds_read_b128 v[60:63], v15 offset:64512
  ds_read_b128 v[64:67], v15 offset:64528
  s_waitcnt lgkmcnt(0)
  ds_read_b128 v[68:71], v16 offset:0
  ds_read_b128 v[72:75], v16 offset:16
  ds_read_b128 v[76:79], v16 offset:21504
  ds_read_b128 v[80:83], v16 offset:21520
  ds_read_b128 v[84:87], v16 offset:43008
  ds_read_b128 v[88:91], v16 offset:43024
  ds_read_b128 v[92:95], v16 offset:64512
  ds_read_b128 v[96:99], v16 offset:64528
  s_waitcnt lgkmcnt(0)
  ds_read_b128 v[100:103], v17 offset:0
  ds_read_b128 v[104:107], v17 offset:16
  ds_read_b128 v[108:111], v17 offset:21504
  ds_read_b128 v[112:115], v17 offset:21520
  ds_read_b128 v[116:119], v17 offset:43008
  ds_read_b128 v[120:123], v17 offset:43024
  ds_read_b128 v[124:127], v17 offset:64512
  ds_read_b128 v[128:131], v17 offset:64528
  s_waitcnt lgkmcnt(0)
  v_pk_add_f32 v[36:37], v[36:37], v[44:45]
  v_pk_add_f32 v[52:53], v[52:53], v[60:61]
  v_pk_add_f32 v[38:39], v[38:39], v[46:47]
  v_pk_add_f32 v[54:55], v[54:55], v[62:63]
  v_pk_add_f32 v[40:41], v[40:41], v[48:49]
  v_pk_add_f32 v[56:57], v[56:57], v[64:65]
  v_pk_add_f32 v[42:43], v[42:43], v[50:51]
  v_pk_add_f32 v[58:59], v[58:59], v[66:67]
  v_lshlrev_b32 v44, 16, v24
  v_and_b32 v45, s36, v24
  v_lshlrev_b32 v46, 16, v25
  v_and_b32 v47, s36, v25
  v_lshlrev_b32 v48, 16, v26
  v_and_b32 v49, s36, v26
  v_lshlrev_b32 v50, 16, v27
  v_and_b32 v51, s36, v27
  v_lshlrev_b32 v18, 16, v18
  v_pk_add_f32 v[36:37], v[36:37], v[52:53]
  v_pk_add_f32 v[38:39], v[38:39], v[54:55]
  v_pk_add_f32 v[40:41], v[40:41], v[56:57]
  v_pk_add_f32 v[42:43], v[42:43], v[58:59]
  v_add_f32 v36, v36, v18
  v_add_f32 v37, v37, v18
  v_add_f32 v38, v38, v18
  v_add_f32 v39, v39, v18
  v_add_f32 v40, v40, v18
  v_add_f32 v41, v41, v18
  v_add_f32 v42, v42, v18
  v_add_f32 v43, v43, v18
  v_pk_add_f32 v[36:37], v[36:37], v[44:45]
  v_pk_add_f32 v[38:39], v[38:39], v[46:47]
  v_pk_add_f32 v[40:41], v[40:41], v[48:49]
  v_pk_add_f32 v[42:43], v[42:43], v[50:51]
  v_cvt_pk_bf16_f32 v52, v36, v37
  v_cvt_pk_bf16_f32 v53, v38, v39
  v_cvt_pk_bf16_f32 v54, v40, v41
  v_cvt_pk_bf16_f32 v55, v42, v43
  v_pk_add_f32 v[68:69], v[68:69], v[76:77]
  v_pk_add_f32 v[84:85], v[84:85], v[92:93]
  v_pk_add_f32 v[70:71], v[70:71], v[78:79]
  v_pk_add_f32 v[86:87], v[86:87], v[94:95]
  v_pk_add_f32 v[72:73], v[72:73], v[80:81]
  v_pk_add_f32 v[88:89], v[88:89], v[96:97]
  v_pk_add_f32 v[74:75], v[74:75], v[82:83]
  v_pk_add_f32 v[90:91], v[90:91], v[98:99]
  v_lshlrev_b32 v76, 16, v28
  v_and_b32 v77, s36, v28
  v_lshlrev_b32 v78, 16, v29
  v_and_b32 v79, s36, v29
  v_lshlrev_b32 v80, 16, v30
  v_and_b32 v81, s36, v30
  v_lshlrev_b32 v82, 16, v31
  v_and_b32 v83, s36, v31
  v_lshlrev_b32 v19, 16, v19
  v_pk_add_f32 v[68:69], v[68:69], v[84:85]
  v_pk_add_f32 v[70:71], v[70:71], v[86:87]
  v_pk_add_f32 v[72:73], v[72:73], v[88:89]
  v_pk_add_f32 v[74:75], v[74:75], v[90:91]
  v_add_f32 v68, v68, v19
  v_add_f32 v69, v69, v19
  v_add_f32 v70, v70, v19
  v_add_f32 v71, v71, v19
  v_add_f32 v72, v72, v19
  v_add_f32 v73, v73, v19
  v_add_f32 v74, v74, v19
  v_add_f32 v75, v75, v19
  v_pk_add_f32 v[68:69], v[68:69], v[76:77]
  v_pk_add_f32 v[70:71], v[70:71], v[78:79]
  v_pk_add_f32 v[72:73], v[72:73], v[80:81]
  v_pk_add_f32 v[74:75], v[74:75], v[82:83]
  v_cvt_pk_bf16_f32 v84, v68, v69
  v_cvt_pk_bf16_f32 v85, v70, v71
  v_cvt_pk_bf16_f32 v86, v72, v73
  v_cvt_pk_bf16_f32 v87, v74, v75
  v_pk_add_f32 v[100:101], v[100:101], v[108:109]
  v_pk_add_f32 v[116:117], v[116:117], v[124:125]
  v_pk_add_f32 v[102:103], v[102:103], v[110:111]
  v_pk_add_f32 v[118:119], v[118:119], v[126:127]
  v_pk_add_f32 v[104:105], v[104:105], v[112:113]
  v_pk_add_f32 v[120:121], v[120:121], v[128:129]
  v_pk_add_f32 v[106:107], v[106:107], v[114:115]
  v_pk_add_f32 v[122:123], v[122:123], v[130:131]
  v_lshlrev_b32 v108, 16, v32
  v_and_b32 v109, s36, v32
  v_lshlrev_b32 v110, 16, v33
  v_and_b32 v111, s36, v33
  v_lshlrev_b32 v112, 16, v34
  v_and_b32 v113, s36, v34
  v_lshlrev_b32 v114, 16, v35
  v_and_b32 v115, s36, v35
  v_lshlrev_b32 v20, 16, v20
  v_pk_add_f32 v[100:101], v[100:101], v[116:117]
  v_pk_add_f32 v[102:103], v[102:103], v[118:119]
  v_pk_add_f32 v[104:105], v[104:105], v[120:121]
  v_pk_add_f32 v[106:107], v[106:107], v[122:123]
  v_add_f32 v100, v100, v20
  v_add_f32 v101, v101, v20
  v_add_f32 v102, v102, v20
  v_add_f32 v103, v103, v20
  v_add_f32 v104, v104, v20
  v_add_f32 v105, v105, v20
  v_add_f32 v106, v106, v20
  v_add_f32 v107, v107, v20
  v_pk_add_f32 v[100:101], v[100:101], v[108:109]
  v_pk_add_f32 v[102:103], v[102:103], v[110:111]
  v_pk_add_f32 v[104:105], v[104:105], v[112:113]
  v_pk_add_f32 v[106:107], v[106:107], v[114:115]
  v_cvt_pk_bf16_f32 v116, v100, v101
  v_cvt_pk_bf16_f32 v117, v102, v103
  v_cvt_pk_bf16_f32 v118, v104, v105
  v_cvt_pk_bf16_f32 v119, v106, v107
  s_cmp_eq_u32 s65, 0
  s_cbranch_scc1 la_mid
  buffer_store_dwordx4 v[52:55], v12, s[48:51], 0 offen
  buffer_store_dwordx4 v[84:87], v13, s[48:51], 0 offen
  buffer_store_dwordx4 v[116:119], v14, s[48:51], 0 offen
la_exit2:
  s_endpgm
la_mid:
  buffer_store_dwordx4 v[52:55], v12, s[72:75], 0 offen sc1
  buffer_store_dwordx4 v[84:87], v13, s[72:75], 0 offen sc1
  buffer_store_dwordx4 v[116:119], v14, s[72:75], 0 offen sc1
  s_mov_b32 s61, 32768
  s_mul_i32 s63, s34, 512
  s_add_u32 s61, s61, s63
  s_mul_i32 s63, s35, 64
  s_add_u32 s61, s61, s63
  s_mul_i32 s63, s32, 4
  s_add_u32 s61, s61, s63
  s_lshr_b32 s37, s35, 1
  v_bfe_u32 v3, v2, 0, 3
  v_mul_u32_u24 v3, 64, v3
  s_mov_b32 s60, 32768
  s_mul_i32 s63, s34, 512
  s_add_u32 s60, s60, s63
  s_mul_i32 s63, s37, 4
  s_add_u32 s60, s60, s63
  v_add_u32 v3, s60, v3
  v_and_b32 v1, 31, v2
  v_add_u32 v1, 0, v1
  v_mul_u32_u24 v7, 6554, v1
  v_lshrrev_b32 v7, 16, v7
  v_mul_u32_u24 v4, 10, v7
  v_sub_u32 v1, v1, v4
  v_mul_u32_u24 v4, 327680, v7
  v_lshl_add_u32 v4, v1, 4, v4
  v_lshrrev_b32 v1, 5, v2
  v_mul_u32_u24 v1, 160, v1
  v_add_u32 v4, v4, v1
  v_and_b32 v1, 31, v2
  v_add_u32 v1, 32, v1
  v_mul_u32_u24 v7, 6554, v1
  v_lshrrev_b32 v7, 16, v7
  v_mul_u32_u24 v5, 10, v7
  v_sub_u32 v1, v1, v5
  v_mul_u32_u24 v5, 327680, v7
  v_lshl_add_u32 v5, v1, 4, v5
  v_lshrrev_b32 v1, 5, v2
  v_mul_u32_u24 v1, 160, v1
  v_add_u32 v5, v5, v1
  v_and_b32 v1, 31, v2
  v_add_u32 v1, 64, v1
  v_mul_u32_u24 v7, 6554, v1
  v_lshrrev_b32 v7, 16, v7
  v_mul_u32_u24 v6, 10, v7
  v_sub_u32 v1, v1, v6
  v_mul_u32_u24 v6, 327680, v7
  v_lshl_add_u32 v6, v1, 4, v6
  v_lshrrev_b32 v1, 5, v2
  v_mul_u32_u24 v1, 160, v1
  v_add_u32 v6, v6, v1
  s_mov_b32 s39, 0
  s_mul_i32 s63, s33, 1280
  s_add_u32 s39, s39, s63
  s_mul_i32 s63, s32, 320
  s_add_u32 s39, s39, s63
  s_mov_b32 s58, 0x0000ffff
  s_mov_b32 s59, s58
  v_mov_b32 v1, 2147483632
  v_cndmask_b32 v6, v1, v6, s[58:59]
  v_mov_b32 v1, 1
  s_waitcnt vmcnt(0)
  s_mov_b64 exec, 1
  buffer_store_dword v1, off, s[8:11], s61 sc1
  s_mov_b64 exec, -1
  s_mov_b32 s64, 400000
la_lw:
  buffer_load_dword v1, v3, s[8:11], 0 offen sc1
  s_waitcnt vmcnt(0)
  v_cmp_eq_u32 vcc, 0, v1
  s_cbranch_vccz la_lg
  s_sleep 1
  s_sub_u32 s64, s64, 1
  s_cmp_lg_u32 s64, 0
  s_cbranch_scc1 la_lw
  s_branch la_exit2
la_lg:
  buffer_load_dwordx4 v[8:11], v4, s[72:75], s39 offen sc1
  buffer_load_dwordx4 v[12:15], v5, s[72:75], s39 offen sc1
  buffer_load_dwordx4 v[16:19], v6, s[72:75], s39 offen sc1
  s_lshr_b32 s37, s33, 2
  s_and_b32 s38, s33, 3
  s_lshr_b32 s61, s32, 1
  s_and_b32 s62, s32, 1
  v_bfe_u32 v4, v2, 2, 3
  v_mul_u32_u24 v4, 1024, v4
  v_bfe_u32 v1, v2, 0, 2
  v_mul_u32_u24 v1, 256, v1
  v_add_u32 v4, v4, v1
  v_bfe_u32 v1, v2, 5, 1
  v_mul_u32_u24 v1, 16, v1
  v_add_u32 v4, v4, v1
  s_mov_b32 s60, 7340032
  s_mul_i32 s63, s37, 40960
  s_add_u32 s60, s60, s63
  s_mul_i32 s63, s61, 20480
  s_add_u32 s60, s60, s63
  s_mul_i32 s63, s38, 64
  s_add_u32 s60, s60, s63
  s_mul_i32 s63, s62, 32
  s_add_u32 s60, s60, s63
  v_add_u32 v4, s60, v4
  v_mov_b32 v1, 2147483632
  v_cndmask_b32 v5, v1, v4, s[58:59]
  s_waitcnt vmcnt(0)
  v_lshlrev_b32 v20, 16, v8
  v_and_b32 v21, s36, v8
  v_lshlrev_b32 v22, 16, v9
  v_and_b32 v23, s36, v9
  v_lshlrev_b32 v24, 16, v10
  v_and_b32 v25, s36, v10
  v_lshlrev_b32 v26, 16, v11
  v_and_b32 v27, s36, v11
  v_lshlrev_b32 v28, 16, v12
  v_and_b32 v29, s36, v12
  v_lshlrev_b32 v30, 16, v13
  v_and_b32 v31, s36, v13
  v_lshlrev_b32 v32, 16, v14
  v_and_b32 v33, s36, v14
  v_lshlrev_b32 v34, 16, v15
  v_and_b32 v35, s36, v15
  v_lshlrev_b32 v36, 16, v16
  v_and_b32 v37, s36, v16
  v_lshlrev_b32 v38, 16, v17
  v_and_b32 v39, s36, v17
  v_lshlrev_b32 v40, 16, v18
  v_and_b32 v41, s36, v18
  v_lshlrev_b32 v42, 16, v19
  v_and_b32 v43, s36, v19
  v_pk_add_f32 v[44:45], v[20:21], v[22:23]
  v_pk_add_f32 v[44:45], v[44:45], v[24:25]
  v_pk_add_f32 v[44:45], v[44:45], v[26:27]
  v_pk_add_f32 v[44:45], v[44:45], v[28:29]
  v_pk_add_f32 v[44:45], v[44:45], v[30:31]
  v_pk_add_f32 v[44:45], v[44:45], v[32:33]
  v_pk_add_f32 v[44:45], v[44:45], v[34:35]
  v_pk_add_f32 v[44:45], v[44:45], v[36:37]
  v_pk_add_f32 v[44:45], v[44:45], v[38:39]
  v_pk_add_f32 v[44:45], v[44:45], v[40:41]
  v_pk_add_f32 v[44:45], v[44:45], v[42:43]
  v_add_f32 v44, v44, v45
  s_nop 1
  v_add_f32_dpp v44, v44, v44 row_ror:1 row_mask:0xf bank_mask:0xf
  s_nop 1
  v_add_f32_dpp v44, v44, v44 row_ror:2 row_mask:0xf bank_mask:0xf
  s_nop 1
  v_add_f32_dpp v44, v44, v44 row_ror:4 row_mask:0xf bank_mask:0xf
  s_nop 1
  v_add_f32_dpp v44, v44, v44 row_ror:8 row_mask:0xf bank_mask:0xf
  v_mov_b32 v45, v44
  s_nop 1
  v_permlane16_swap_b32 v45, v44
  v_add_f32 v44, v44, v45
  v_mul_f32 v44, 0x3acccccd, v44
  v_cndmask_b32 v45, 0, v44, s[58:59]
  v_sub_f32 v20, v20, v44
  v_sub_f32 v21, v21, v44
  v_sub_f32 v22, v22, v44
  v_sub_f32 v23, v23, v44
  v_sub_f32 v24, v24, v44
  v_sub_f32 v25, v25, v44
  v_sub_f32 v26, v26, v44
  v_sub_f32 v27, v27, v44
  v_sub_f32 v28, v28, v44
  v_sub_f32 v29, v29, v44
  v_sub_f32 v30, v30, v44
  v_sub_f32 v31, v31, v44
  v_sub_f32 v32, v32, v44
  v_sub_f32 v33, v33, v44
  v_sub_f32 v34, v34, v44
  v_sub_f32 v35, v35, v44
  v_sub_f32 v36, v36, v45
  v_sub_f32 v37, v37, v45
  v_sub_f32 v38, v38, v45
  v_sub_f32 v39, v39, v45
  v_sub_f32 v40, v40, v45
  v_sub_f32 v41, v41, v45
  v_sub_f32 v42, v42, v45
  v_sub_f32 v43, v43, v45
  v_pk_mul_f32 v[44:45], v[20:21], v[20:21]
  v_pk_fma_f32 v[44:45], v[22:23], v[22:23], v[44:45]
  v_pk_fma_f32 v[44:45], v[24:25], v[24:25], v[44:45]
  v_pk_fma_f32 v[44:45], v[26:27], v[26:27], v[44:45]
  v_pk_fma_f32 v[44:45], v[28:29], v[28:29], v[44:45]
  v_pk_fma_f32 v[44:45], v[30:31], v[30:31], v[44:45]
  v_pk_fma_f32 v[44:45], v[32:33], v[32:33], v[44:45]
  v_pk_fma_f32 v[44:45], v[34:35], v[34:35], v[44:45]
  v_pk_fma_f32 v[44:45], v[36:37], v[36:37], v[44:45]
  v_pk_fma_f32 v[44:45], v[38:39], v[38:39], v[44:45]
  v_pk_fma_f32 v[44:45], v[40:41], v[40:41], v[44:45]
  v_pk_fma_f32 v[44:45], v[42:43], v[42:43], v[44:45]
  v_add_f32 v44, v44, v45
  s_nop 1
  v_add_f32_dpp v44, v44, v44 row_ror:1 row_mask:0xf bank_mask:0xf
  s_nop 1
  v_add_f32_dpp v44, v44, v44 row_ror:2 row_mask:0xf bank_mask:0xf
  s_nop 1
  v_add_f32_dpp v44, v44, v44 row_ror:4 row_mask:0xf bank_mask:0xf
  s_nop 1
  v_add_f32_dpp v44, v44, v44 row_ror:8 row_mask:0xf bank_mask:0xf
  v_mov_b32 v45, v44
  s_nop 1
  v_permlane16_swap_b32 v45, v44
  v_add_f32 v44, v44, v45
  v_mul_f32 v44, 0x3acccccd, v44
  v_add_f32 v44, 0x3727c5ac, v44
  v_rsq_f32 v44, v44
  s_nop 0
  v_mul_f32 v20, v20, v44
  v_mul_f32 v21, v21, v44
  v_mul_f32 v22, v22, v44
  v_mul_f32 v23, v23, v44
  v_mul_f32 v24, v24, v44
  v_mul_f32 v25, v25, v44
  v_mul_f32 v26, v26, v44
  v_mul_f32 v27, v27, v44
  v_mul_f32 v28, v28, v44
  v_mul_f32 v29, v29, v44
  v_mul_f32 v30, v30, v44
  v_mul_f32 v31, v31, v44
  v_mul_f32 v32, v32, v44
  v_mul_f32 v33, v33, v44
  v_mul_f32 v34, v34, v44
  v_mul_f32 v35, v35, v44
  v_mul_f32 v36, v36, v44
  v_mul_f32 v37, v37, v44
  v_mul_f32 v38, v38, v44
  v_mul_f32 v39, v39, v44
  v_mul_f32 v40, v40, v44
  v_mul_f32 v41, v41, v44
  v_mul_f32 v42, v42, v44
  v_mul_f32 v43, v43, v44
  v_cvt_pk_bf16_f32 v8, v20, v21
  v_cvt_pk_bf16_f32 v9, v22, v23
  v_cvt_pk_bf16_f32 v10, v24, v25
  v_cvt_pk_bf16_f32 v11, v26, v27
  v_cvt_pk_bf16_f32 v12, v28, v29
  v_cvt_pk_bf16_f32 v13, v30, v31
  v_cvt_pk_bf16_f32 v14, v32, v33
  v_cvt_pk_bf16_f32 v15, v34, v35
  v_cvt_pk_bf16_f32 v16, v36, v37
  v_cvt_pk_bf16_f32 v17, v38, v39
  v_cvt_pk_bf16_f32 v18, v40, v41
  v_cvt_pk_bf16_f32 v19, v42, v43
  s_mov_b32 s61, 0
  buffer_store_dwordx4 v[8:11], v4, s[8:11], s61 offen sc1
  s_mov_b32 s61, 8192
  buffer_store_dwordx4 v[12:15], v4, s[8:11], s61 offen sc1
  s_mov_b32 s61, 16384
  buffer_store_dwordx4 v[16:19], v5, s[8:11], s61 offen sc1
  s_mov_b32 s61, 49152
  s_mul_i32 s63, s37, 128
  s_add_u32 s61, s61, s63
  s_mul_i32 s63, s38, 4
  s_add_u32 s61, s61, s63
  v_mov_b32 v1, 1
  s_waitcnt vmcnt(0)
  s_barrier
  s_cmp_lg_u32 s32, 0
  s_cbranch_scc1 la_mr
  s_mov_b64 exec, 1
  buffer_store_dword v1, off, s[8:11], s61 sc1
  s_mov_b64 exec, -1
la_mr:
  s_mov_b32 s65, 1
  s_setpc_b64 s[66:67]
.section .rodata,"a"
.p2align 6
.amdhsa_kernel interleave_layers__memory_aug_recurrent_mem_tr__mixer_token_mlp__prompt_kernel
.amdhsa_next_free_vgpr 512
.amdhsa_next_free_sgpr 102
.amdhsa_accum_offset 256
.amdhsa_group_segment_fixed_size 0
.amdhsa_kernarg_size 120
.amdhsa_user_sgpr_count 2
.amdhsa_user_sgpr_kernarg_segment_ptr 1
.amdhsa_system_sgpr_workgroup_id_x 1
.amdhsa_float_denorm_mode_32 3
.amdhsa_float_denorm_mode_16_64 3
.end_amdhsa_kernel
```
